```python
import torch

def _softmax(x, axis=-1):
    return torch.softmax(x, dim=axis)
def _gelu(x):
    return torch.nn.functional.gelu(x, approximate="tanh")
def _silu(x):
    return torch.nn.functional.silu(x)
def _sigmoid(x):
    return torch.sigmoid(x)
def _layernorm(x, axis=-1, eps=1e-5):
    m = x.mean(dim=axis, keepdim=True)
    v = x.var(dim=axis, keepdim=True, unbiased=False)
    return (x - m) / torch.sqrt(v + eps)
def _scatter_add(tgt, idx, src, axis=0):
    return tgt.clone().index_add_(axis, idx, src)
def _segment_sum(src, seg, n):
    out = torch.zeros((n,) + src.shape[1:], dtype=src.dtype)
    return out.index_add_(0, seg, src)
def _pad(x, pw):
    flat = tuple(v for pair in reversed(pw) for v in pair)
    return torch.nn.functional.pad(x, flat)

kernel_name = 'gated_mix__linear_attn_block__compressed_kv_cla__prompt'

def setup_inputs():

    _w = (lambda a: (lambda t: t.to(torch.bfloat16) if t.is_floating_point() else t)(torch.as_tensor(a)))
    def _A_setup():
        B, S, D = 1, 2048, 512
        return {
            "x": _w((lambda *s: torch.randn(*s, dtype=torch.bfloat16) * 0.05)(B, S, D)),
            "wqkv": _w((lambda *s: torch.randn(*s, dtype=torch.bfloat16) * 0.8)(D, 3 * D)),
            "wo": _w((lambda *s: torch.randn(*s, dtype=torch.bfloat16) * 0.4)(D, D)),
        }
    _A_in = _A_setup()

    def _B_setup():
        B, H, Sq, Sk, D, M = 1, 32, 2048, 2048, 128, 512
        Dc = 4 * D
        return {
            "x": _w((lambda *s: torch.randn(*s, dtype=torch.bfloat16) * 0.05)(B, Sq, M)),
            "c_kv": _w((lambda *s: torch.randn(*s, dtype=torch.bfloat16) * 0.8)(B, Sk, Dc)),
            "w_q": _w((lambda *s: torch.randn(*s, dtype=torch.bfloat16) * 6.4)(M, H, D) * (M ** -0.5)),
            "w_uk": _w((lambda *s: torch.randn(*s, dtype=torch.bfloat16) * 6.4)(Dc, H, D) * (Dc ** -0.5)),
            "w_uv": _w((lambda *s: torch.randn(*s, dtype=torch.bfloat16) * 0.8)(Dc, H, D) * (Dc ** -0.5)),
            "w_o": _w((lambda *s: torch.randn(*s, dtype=torch.bfloat16) * 0.8)(H, D, M) * ((H * D) ** -0.5)),
        }
    _B_in = _B_setup()

    return {
        "A_x": _A_in["x"],
        "A_wqkv": _A_in["wqkv"],
        "A_wo": _A_in["wo"],
        "B_x": _B_in["x"],
        "B_c_kv": _B_in["c_kv"],
        "B_w_q": _B_in["w_q"],
        "B_w_uk": _B_in["w_uk"],
        "B_w_uv": _B_in["w_uv"],
        "B_w_o": _B_in["w_o"],
        "gate_w": _w((lambda *s: torch.randn(*s, dtype=torch.bfloat16) * 0.05)(512) * 16.0),
    }

def reference(A_x, A_wqkv, A_wo, B_x, B_c_kv, B_w_q, B_w_uk, B_w_uv, B_w_o, gate_w):
    def _A_ref(x, wqkv, wo):
        B, S, D = x.shape
        H = 32; Dh = D // H
        qkv = (lambda x, *d: x.permute(*d))((x @ wqkv).reshape(B, S, 3, H, Dh), 2, 0, 3, 1, 4)
        q, k, v = qkv[0], qkv[1], qkv[2]
        phi = lambda t: torch.where(t > 0, t + 1, torch.exp(t)) + 1e-6
        pq, pk = phi(q), phi(k)
        kv = torch.einsum("bhsd,bhse->bhde", pk, v)
        z = torch.einsum("bhsd->bhd", pk)
        num = torch.einsum("bhqd,bhde->bhqe", pq, kv)
        den = torch.einsum("bhqd,bhd->bhq", pq, z)[..., None] + 1e-6
        o = num / den
        return (lambda x, *d: x.permute(*d))(o, 0, 2, 1, 3).reshape(B, S, D) @ wo

    def _B_ref(x, c_kv, w_q, w_uk, w_uv, w_o):
        B, Sq, M = x.shape[0], x.shape[1], x.shape[2]
        Sk = c_kv.shape[1]
        H, D = w_q.shape[1], w_q.shape[2]
        q = torch.einsum("bqm,mhd->bhqd", x, w_q)
        k = torch.einsum("bkc,chd->bhkd", c_kv, w_uk)
        v = torch.einsum("bkc,chd->bhkd", c_kv, w_uv)
        scores = torch.einsum("bhqd,bhkd->bhqk", q, k) * (D ** -0.5)
        off = Sk - Sq
        qi = torch.arange(Sq)[:, None]
        kj = torch.arange(Sk)[None, :]
        cmask = kj <= (qi + off)
        scores = torch.where(cmask[None, None], scores, -1e9)
        p = _softmax(scores, axis=-1)
        ctx = torch.einsum("bhqk,bhkd->bhqd", p, v)
        return torch.einsum("bhqd,hdm->bqm", ctx, w_o)

    x = A_x
    g = _sigmoid((x * gate_w).sum(-1, keepdims=True))
    a = _A_ref(x, A_wqkv, A_wo)
    b = _B_ref(x, B_c_kv, B_w_q, B_w_uk, B_w_uv, B_w_o)
    return g * a + (1 - g) * b
```

```asm
; @launch grid=(256,1,1) block=(512,1,1) lds=163840
.amdgcn_target "amdgcn-amd-amdhsa--gfx950"
.text
.globl gated_mix__linear_attn_block__compressed_kv_cla__prompt_kernel
.p2align 8
.type gated_mix__linear_attn_block__compressed_kv_cla__prompt_kernel,@function
gated_mix__linear_attn_block__compressed_kv_cla__prompt_kernel:
    s_cmp_ge_u32 s2, 256
    s_cbranch_scc1 fmain_end
    s_load_dwordx4 s[8:11], s[0:1], 32
    s_load_dwordx4 s[12:15], s[0:1], 48
    s_load_dwordx4 s[4:7], s[0:1], 0
    s_load_dwordx2 s[16:17], s[0:1], 72
    s_load_dwordx2 s[20:21], s[0:1], 96
    s_getpc_b64 s[78:79]
fmain_pc:
    s_lshr_b32 s76, s2, 3
    s_lshl_b32 s76, s76, 7
    v_lshl_add_u32 v11, v0, 12, s76
    v_cmp_gt_u32 vcc, fmain_end-fmain_pc, v11
    s_and_saveexec_b64 s[84:85], vcc
    s_cbranch_execz fmain_ntc
    global_load_dword v176, v11, s[78:79]
fmain_ntc:
    s_mov_b64 exec, -1
    v_lshrrev_b32 v1, 6, v0
    v_and_b32 v0, 63, v0
    v_readfirstlane_b32 s22, v1
    v_lshlrev_b32 v255, 4, v0
    v_and_b32 v252, 15, v0
    v_lshrrev_b32 v253, 4, v0
    s_and_b32 s23, s2, 7
    s_lshl_b32 s23, s23, 2
    s_lshr_b32 s76, s2, 6
    s_add_u32 s23, s23, s76
    s_lshr_b32 s24, s2, 3
    s_and_b32 s24, s24, 7
    s_lshr_b32 s29, s22, 2
    v_lshrrev_b32 v2, 3, v0
    v_lshlrev_b32 v2, 10, v2
    v_and_b32 v3, 7, v0
    v_xor_b32 v4, v3, v253
    v_xor_b32 v5, 4, v4
    v_lshl_add_u32 v240, v4, 4, v2
    v_lshl_add_u32 v5, v5, 4, v2
    v_add_u32 v241, 7168, v5
    v_add_u32 v242, 14336, v240
    v_add_u32 v243, 21504, v5
    s_and_b32 s76, s22, 3
    s_and_b32 s77, s22, 1
    s_lshl_b32 s77, s77, 2
    s_lshl_b32 s76, s76, 3
    v_or_b32 v2, s77, v253
    v_lshrrev_b32 v3, 1, v252
    v_xor_b32 v2, v2, v3
    v_and_b32 v3, 1, v252
    v_lshlrev_b32 v3, 4, v3
    v_add_u32 v4, s76, v253
    v_lshl_add_u32 v5, v2, 5, v3
    v_lshl_add_u32 v244, v4, 13, v5
    v_add_u32 v245, 31744, v244
    s_lshl_b32 s68, s22, 12
    s_lshl_b32 s69, s22, 11
    s_add_u32 s69, s69, 98304
    s_and_b32 s78, s22, 3
    s_lshl_b32 s76, s24, 2
    s_add_u32 s76, s76, s78
    s_sub_u32 s77, 63, s76
    s_cmp_eq_u32 s29, 0
    s_cselect_b32 s26, s76, s77
    s_lshl_b32 s25, s26, 5
    s_lshl_b32 s30, s77, 5
    s_add_u32 s79, s25, s23
    s_lshl_b32 s79, s79, 10
    v_add_u32 v12, s79, v255
    s_and_b32 s76, s22, 3
    s_lshl_b32 s76, s76, 4
    s_lshl_b32 s77, s29, 3
    s_add_u32 s76, s76, s77
    s_add_u32 s76, s76, s24
    s_lshl_b32 s76, s76, 15
    s_waitcnt lgkmcnt(0)
    s_add_u32 s32, s8, s76
    s_addc_u32 s33, s9, 0
    s_mov_b32 s34, 32768
    s_mov_b32 s35, 0x20000
    s_lshl_b32 s76, s23, 8
    s_cmp_eq_u32 s29, 0
    s_cselect_b32 s77, s12, s14
    s_cselect_b32 s78, s13, s15
    s_sub_u32 s79, 4194304, s76
    s_add_u32 s40, s77, s76
    s_addc_u32 s41, s78, 0
    s_mov_b32 s42, s79
    s_mov_b32 s43, 0x20000
    s_add_u32 m0, s69, 0
    s_mov_b32 s77, 0
    buffer_load_dwordx4 v244, s[40:43], s77 offen offset:0 lds
    buffer_load_dwordx4 v245, s[40:43], s77 offen offset:1024 lds
    s_add_u32 m0, s68, 0
    s_movk_i32 s76, 0
    buffer_load_dwordx4 v240, s[32:35], s76 offen offset:0 lds
    buffer_load_dwordx4 v241, s[32:35], s76 offen offset:1024 lds
    s_add_u32 m0, s68, 0
    s_movk_i32 s76, 0
    buffer_load_dwordx4 v242, s[32:35], s76 offen offset:2048 lds
    buffer_load_dwordx4 v243, s[32:35], s76 offen offset:3072 lds
    s_add_u32 m0, s69, 16384
    s_mov_b32 s77, 262144
    buffer_load_dwordx4 v244, s[40:43], s77 offen offset:0 lds
    buffer_load_dwordx4 v245, s[40:43], s77 offen offset:1024 lds
    global_load_dwordx4 v[16:19], v12, s[4:5]
    global_load_dwordx4 v[20:23], v255, s[16:17]
    s_add_u32 s78, s20, 56623104
    s_addc_u32 s79, s21, 0
    s_load_dwordx2 s[18:19], s[78:79], 0
    v_mul_u32_u24 v6, 3072, v4
    v_lshl_add_u32 v6, v2, 10, v6
    v_add_u32 v6, v6, v3
    v_cmp_gt_u32 vcc, 3, v2
    v_mov_b32 v7, 0x7fff0000
    v_add_u32 v8, 11264, v6
    v_cndmask_b32 v6, v7, v6, vcc
    v_cndmask_b32 v8, v7, v8, vcc
    s_lshl_b32 s76, s23, 16
    s_lshl_b32 s77, s24, 7
    s_add_u32 s76, s76, s77
    v_lshl_add_u32 v177, v0, 10, s76
    s_and_b32 s76, s22, 1
    s_lshl_b32 s76, s76, 18
    s_lshl_b32 s77, s24, 19
    s_add_u32 s76, s76, s77
    v_lshrrev_b32 v9, 1, v0
    v_lshlrev_b32 v9, 13, v9
    v_and_b32 v10, 1, v0
    v_lshl_add_u32 v9, v10, 7, v9
    v_add_u32 v178, s76, v9
    s_and_b32 s76, s23, 3
    s_lshl_b32 s76, s76, 4
    s_lshl_b32 s77, s24, 6
    s_add_u32 s76, s76, s77
    v_lshrrev_b32 v9, 2, v0
    v_add_u32 v9, s76, v9
    v_mul_u32_u24 v9, 3072, v9
    v_and_b32 v10, 3, v0
    v_lshl_add_u32 v9, v10, 10, v9
    v_cmp_gt_u32 vcc, 3, v10
    s_nop 1
    v_cndmask_b32 v9, v7, v9, vcc
    s_add_u32 s28, s24, 3
    s_bitcmp1_b32 s22, 1
    s_cselect_b32 s28, 99, s28
    s_cmp_eq_u32 s29, 0
    s_cselect_b64 vcc, -1, 0
    s_nop 1
    v_cndmask_b32 v246, v6, v244, vcc
    v_cndmask_b32 v247, v8, v245, vcc
    v_cndmask_b32 v178, v9, v178, vcc
    s_mov_b32 s70, 98304
    s_cselect_b32 s70, 262144, s70
    s_lshl_b32 s76, s25, 10
    s_add_u32 s36, s4, s76
    s_addc_u32 s37, s5, 0
    s_mov_b32 s38, 32768
    s_mov_b32 s39, 0x20000
    s_lshl_b32 s76, s23, 8
    s_lshl_b32 s77, s23, 5
    s_cmp_eq_u32 s29, 0
    s_cselect_b32 s76, s76, s77
    s_cselect_b32 s77, s10, s6
    s_cselect_b32 s78, s11, s7
    s_mov_b32 s79, 1572864
    s_cselect_b32 s79, 4194304, s79
    s_sub_u32 s79, s79, s76
    s_add_u32 s44, s77, s76
    s_addc_u32 s45, s78, 0
    s_mov_b32 s46, s79
    s_mov_b32 s47, 0x20000
    s_lshl_b32 s76, s23, 20
    s_lshl_b32 s77, s24, 16
    s_sub_u32 s77, 1048576, s77
    s_add_u32 s48, s20, s76
    s_addc_u32 s49, s21, 0
    s_mov_b32 s50, s77
    s_mov_b32 s51, 0x20000
    s_add_u32 s52, s20, s76
    s_addc_u32 s53, s21, 0
    s_mov_b32 s54, 1048576
    s_mov_b32 s55, 0x20000
    s_add_u32 s56, s20, 33554432
    s_addc_u32 s57, s21, 0
    s_mov_b32 s58, 18874368
    s_mov_b32 s59, 0x20000
    s_add_u32 s60, s20, 54525952
    s_addc_u32 s61, s21, 0
    s_mov_b32 s62, 2097160
    s_mov_b32 s63, 0x20000
    s_add_u32 s64, s20, 57671680
    s_addc_u32 s65, s21, 0
    s_mov_b32 s66, 131072
    s_mov_b32 s67, 0x20000
    s_lshl_b32 s73, s24, 14
    s_lshr_b32 s76, s22, 1
    s_and_b32 s76, s76, 1
    s_lshl_b32 s76, s76, 17
    s_add_u32 s73, s73, s76
    s_lshl_b32 s76, s29, 13
    s_add_u32 s73, s73, s76
    s_and_b32 s76, s22, 1
    s_lshl_b32 s76, s76, 12
    s_add_u32 s73, s73, s76
    v_lshrrev_b32 v2, 1, v252
    v_xor_b32 v2, v2, v253
    v_lshlrev_b32 v2, 4, v2
    v_lshl_add_u32 v2, v252, 7, v2
    s_lshr_b32 s76, s22, 1
    s_and_b32 s76, s76, 1
    s_lshl_b32 s76, s76, 14
    v_add_u32 v228, s76, v2
    v_xor_b32 v229, 64, v228
    v_add_u32 v230, 0x10000, v228
    v_add_u32 v231, 0x10000, v229
    v_add_u32 v248, s68, v2
    v_xor_b32 v249, 64, v248
    v_add_u32 v250, 0x10000, v248
    v_add_u32 v251, 0x10000, v249
    v_lshrrev_b32 v2, 2, v252
    v_lshl_add_u32 v3, v253, 3, v2
    v_lshlrev_b32 v3, 8, v3
    v_and_b32 v4, 1, v253
    v_lshl_or_b32 v4, v4, 2, v2
    v_lshl_add_u32 v3, v4, 5, v3
    v_and_b32 v4, 3, v252
    v_lshl_add_u32 v3, v4, 3, v3
    v_add_u32 v254, 98304, v3
    s_and_b32 s76, s22, 1
    s_lshl_b32 s76, s76, 7
    s_lshl_b32 s77, s29, 13
    v_xor_b32 v3, s76, v254
    v_add_u32 v3, s77, v3
    v_xor_b32 v236, 0, v3
    v_xor_b32 v237, 32, v3
    v_xor_b32 v238, 64, v3
    v_xor_b32 v239, 96, v3
    v_xor_b32 v232, 0, v254
    v_xor_b32 v233, 32, v254
    v_xor_b32 v234, 64, v254
    v_xor_b32 v235, 96, v254
    s_load_dwordx2 s[8:9], s[0:1], 64
    s_load_dwordx2 s[10:11], s[0:1], 16
    s_load_dwordx2 s[12:13], s[0:1], 80
    s_add_u32 m0, s68, 32768
    s_movk_i32 s76, 128
    buffer_load_dwordx4 v240, s[32:35], s76 offen offset:0 lds
    buffer_load_dwordx4 v241, s[32:35], s76 offen offset:1024 lds
    s_add_u32 m0, s68, 32768
    s_movk_i32 s76, 128
    buffer_load_dwordx4 v242, s[32:35], s76 offen offset:2048 lds
    buffer_load_dwordx4 v243, s[32:35], s76 offen offset:3072 lds
    s_waitcnt vmcnt(8) lgkmcnt(0)
    s_barrier
    ds_read_b64_tr_b16 v[160:161], v236 offset:0
    ds_read_b64_tr_b16 v[162:163], v236 offset:1024
    ds_read_b64_tr_b16 v[164:165], v237 offset:0
    ds_read_b64_tr_b16 v[166:167], v237 offset:1024
    ds_read_b64_tr_b16 v[168:169], v238 offset:0
    ds_read_b64_tr_b16 v[170:171], v238 offset:1024
    ds_read_b64_tr_b16 v[172:173], v239 offset:0
    ds_read_b64_tr_b16 v[174:175], v239 offset:1024
    ds_read_b128 v[128:131], v228 offset:0
    ds_read_b128 v[132:135], v228 offset:2048
    ds_read_b128 v[136:139], v228 offset:4096
    ds_read_b128 v[140:143], v228 offset:6144
    ds_read_b128 v[144:147], v228 offset:8192
    ds_read_b128 v[148:151], v228 offset:10240
    ds_read_b128 v[152:155], v228 offset:12288
    ds_read_b128 v[156:159], v228 offset:14336
    s_add_u32 m0, s69, 32768
    s_mov_b32 s77, 524288
    buffer_load_dwordx4 v244, s[40:43], s77 offen offset:0 lds
    buffer_load_dwordx4 v245, s[40:43], s77 offen offset:1024 lds
    s_waitcnt vmcnt(6)
    v_mov_b32 v24, 0
    v_mov_b32 v25, 0x3f803f80
    v_lshlrev_b32 v26, 16, v16
    v_and_b32 v27, 0xffff0000, v16
    v_lshlrev_b32 v28, 16, v20
    v_and_b32 v29, 0xffff0000, v20
    v_pk_mul_f32 v[26:27], v[26:27], v[28:29]
    v_cvt_pk_bf16_f32 v30, v26, v27
    v_lshlrev_b32 v26, 16, v17
    v_and_b32 v27, 0xffff0000, v17
    v_lshlrev_b32 v28, 16, v21
    v_and_b32 v29, 0xffff0000, v21
    v_pk_mul_f32 v[26:27], v[26:27], v[28:29]
    v_cvt_pk_bf16_f32 v31, v26, v27
    v_lshlrev_b32 v26, 16, v18
    v_and_b32 v27, 0xffff0000, v18
    v_lshlrev_b32 v28, 16, v22
    v_and_b32 v29, 0xffff0000, v22
    v_pk_mul_f32 v[26:27], v[26:27], v[28:29]
    v_cvt_pk_bf16_f32 v32, v26, v27
    v_lshlrev_b32 v26, 16, v19
    v_and_b32 v27, 0xffff0000, v19
    v_lshlrev_b32 v28, 16, v23
    v_and_b32 v29, 0xffff0000, v23
    v_pk_mul_f32 v[26:27], v[26:27], v[28:29]
    v_cvt_pk_bf16_f32 v33, v26, v27
    v_dot2_f32_bf16 v24, v30, v25, v24
    v_dot2_f32_bf16 v24, v31, v25, v24
    v_dot2_f32_bf16 v24, v32, v25, v24
    v_dot2_f32_bf16 v24, v33, v25, v24
    s_nop 2
    v_add_f32 v24, v24, v24 row_ror:8
    s_nop 1
    v_add_f32 v24, v24, v24 row_ror:4
    s_nop 1
    v_add_f32 v24, v24, v24 row_ror:2
    s_nop 1
    v_add_f32 v24, v24, v24 row_ror:1
    s_nop 1
    v_mov_b32 v26, v24
    s_nop 1
    v_permlane16_swap_b32 v24, v26
    s_nop 1
    v_add_f32 v24, v24, v26
    v_mov_b32 v26, v24
    s_nop 1
    v_permlane32_swap_b32 v24, v26
    s_nop 1
    v_add_f32 v24, v24, v26
    v_cvt_pk_bf16_f32 v24, v24, v24
    v_lshlrev_b32 v24, 16, v24
    v_mul_f32 v24, 0xbfb8aa3b, v24
    v_exp_f32 v24, v24
    s_nop 0
    v_add_f32 v24, 1.0, v24
    v_rcp_f32 v24, v24
    s_nop 0
    v_cvt_pk_bf16_f32 v24, v24, v24
    v_lshlrev_b32 v24, 16, v24
    s_nop 0
    v_readfirstlane_b32 s16, v24
    s_add_u32 s18, s18, 1
    s_cmp_eq_u32 s29, 1
    s_cbranch_scc1 fmain_p1v
    s_waitcnt vmcnt(6) lgkmcnt(0)
    s_barrier
    v_mfma_f32_16x16x32_bf16 v[0:3], v[160:163], v[128:131], 0
    ds_read_b64_tr_b16 v[212:213], v236 offset:16384
    v_mfma_f32_16x16x32_bf16 v[64:67], v[164:167], v[128:131], 0
    s_add_u32 m0, s69, 49152
    s_mov_b32 s77, 786432
    buffer_load_dwordx4 v244, s[40:43], s77 offen offset:0 lds
    v_mfma_f32_16x16x32_bf16 v[4:7], v[168:171], v[128:131], 0
    ds_read_b64_tr_b16 v[214:215], v236 offset:17408
    v_mfma_f32_16x16x32_bf16 v[68:71], v[172:175], v[128:131], 0
    ds_read_b64_tr_b16 v[216:217], v237 offset:16384
    v_mfma_f32_16x16x32_bf16 v[8:11], v[160:163], v[132:135], 0
    buffer_load_dwordx4 v245, s[40:43], s77 offen offset:1024 lds
    v_mfma_f32_16x16x32_bf16 v[72:75], v[164:167], v[132:135], 0
    ds_read_b64_tr_b16 v[218:219], v237 offset:17408
    v_mfma_f32_16x16x32_bf16 v[12:15], v[168:171], v[132:135], 0
    ds_read_b64_tr_b16 v[220:221], v238 offset:16384
    v_mfma_f32_16x16x32_bf16 v[76:79], v[172:175], v[132:135], 0
    s_add_u32 m0, s68, 65536
    s_movk_i32 s76, 256
    buffer_load_dwordx4 v240, s[32:35], s76 offen offset:0 lds
    v_mfma_f32_16x16x32_bf16 v[16:19], v[160:163], v[136:139], 0
    ds_read_b64_tr_b16 v[222:223], v238 offset:17408
    v_mfma_f32_16x16x32_bf16 v[80:83], v[164:167], v[136:139], 0
    ds_read_b64_tr_b16 v[224:225], v239 offset:16384
    v_mfma_f32_16x16x32_bf16 v[20:23], v[168:171], v[136:139], 0
    buffer_load_dwordx4 v241, s[32:35], s76 offen offset:1024 lds
    v_mfma_f32_16x16x32_bf16 v[84:87], v[172:175], v[136:139], 0
    ds_read_b64_tr_b16 v[226:227], v239 offset:17408
    v_mfma_f32_16x16x32_bf16 v[24:27], v[160:163], v[140:143], 0
    ds_read_b128 v[180:183], v229 offset:0
    v_mfma_f32_16x16x32_bf16 v[88:91], v[164:167], v[140:143], 0
    s_add_u32 m0, s68, 65536
    s_movk_i32 s76, 256
    buffer_load_dwordx4 v242, s[32:35], s76 offen offset:2048 lds
    v_mfma_f32_16x16x32_bf16 v[28:31], v[168:171], v[140:143], 0
    ds_read_b128 v[184:187], v229 offset:2048
    v_mfma_f32_16x16x32_bf16 v[92:95], v[172:175], v[140:143], 0
    ds_read_b128 v[188:191], v229 offset:4096
    v_mfma_f32_16x16x32_bf16 v[32:35], v[160:163], v[144:147], 0
    buffer_load_dwordx4 v243, s[32:35], s76 offen offset:3072 lds
    v_mfma_f32_16x16x32_bf16 v[96:99], v[164:167], v[144:147], 0
    ds_read_b128 v[192:195], v229 offset:6144
    v_mfma_f32_16x16x32_bf16 v[36:39], v[168:171], v[144:147], 0
    ds_read_b128 v[196:199], v229 offset:8192
    v_mfma_f32_16x16x32_bf16 v[100:103], v[172:175], v[144:147], 0
    s_add_u32 m0, s69, 0
    s_mov_b32 s77, 1048576
    buffer_load_dwordx4 v244, s[40:43], s77 offen offset:0 lds
    v_mfma_f32_16x16x32_bf16 v[40:43], v[160:163], v[148:151], 0
    ds_read_b128 v[200:203], v229 offset:10240
    v_mfma_f32_16x16x32_bf16 v[104:107], v[164:167], v[148:151], 0
    ds_read_b128 v[204:207], v229 offset:12288
    v_mfma_f32_16x16x32_bf16 v[44:47], v[168:171], v[148:151], 0
    buffer_load_dwordx4 v245, s[40:43], s77 offen offset:1024 lds
    v_mfma_f32_16x16x32_bf16 v[108:111], v[172:175], v[148:151], 0
    ds_read_b128 v[208:211], v229 offset:14336
    v_mfma_f32_16x16x32_bf16 v[48:51], v[160:163], v[152:155], 0
    v_mfma_f32_16x16x32_bf16 v[112:115], v[164:167], v[152:155], 0
    v_mfma_f32_16x16x32_bf16 v[52:55], v[168:171], v[152:155], 0
    v_mfma_f32_16x16x32_bf16 v[116:119], v[172:175], v[152:155], 0
    v_mfma_f32_16x16x32_bf16 v[56:59], v[160:163], v[156:159], 0
    v_mfma_f32_16x16x32_bf16 v[120:123], v[164:167], v[156:159], 0
    v_mfma_f32_16x16x32_bf16 v[60:63], v[168:171], v[156:159], 0
    v_mfma_f32_16x16x32_bf16 v[124:127], v[172:175], v[156:159], 0
    s_waitcnt vmcnt(8) lgkmcnt(0)
    s_barrier
    v_mfma_f32_16x16x32_bf16 v[0:3], v[212:215], v[180:183], v[0:3]
    ds_read_b64_tr_b16 v[160:161], v236 offset:32768
    v_mfma_f32_16x16x32_bf16 v[64:67], v[216:219], v[180:183], v[64:67]
    s_add_u32 m0, s69, 16384
    s_mov_b32 s77, 1310720
    buffer_load_dwordx4 v244, s[40:43], s77 offen offset:0 lds
    v_mfma_f32_16x16x32_bf16 v[4:7], v[220:223], v[180:183], v[4:7]
    ds_read_b64_tr_b16 v[162:163], v236 offset:33792
    v_mfma_f32_16x16x32_bf16 v[68:71], v[224:227], v[180:183], v[68:71]
    ds_read_b64_tr_b16 v[164:165], v237 offset:32768
    v_mfma_f32_16x16x32_bf16 v[8:11], v[212:215], v[184:187], v[8:11]
    v_mfma_f32_16x16x32_bf16 v[72:75], v[216:219], v[184:187], v[72:75]
    ds_read_b64_tr_b16 v[166:167], v237 offset:33792
    v_mfma_f32_16x16x32_bf16 v[12:15], v[220:223], v[184:187], v[12:15]
    ds_read_b64_tr_b16 v[168:169], v238 offset:32768
    v_mfma_f32_16x16x32_bf16 v[76:79], v[224:227], v[184:187], v[76:79]
    buffer_load_dwordx4 v245, s[40:43], s77 offen offset:1024 lds
    v_mfma_f32_16x16x32_bf16 v[16:19], v[212:215], v[188:191], v[16:19]
    ds_read_b64_tr_b16 v[170:171], v238 offset:33792
    v_mfma_f32_16x16x32_bf16 v[80:83], v[216:219], v[188:191], v[80:83]
    ds_read_b64_tr_b16 v[172:173], v239 offset:32768
    v_mfma_f32_16x16x32_bf16 v[20:23], v[220:223], v[188:191], v[20:23]
    v_mfma_f32_16x16x32_bf16 v[84:87], v[224:227], v[188:191], v[84:87]
    ds_read_b64_tr_b16 v[174:175], v239 offset:33792
    v_mfma_f32_16x16x32_bf16 v[24:27], v[212:215], v[192:195], v[24:27]
    ds_read_b128 v[128:131], v228 offset:32768
    v_mfma_f32_16x16x32_bf16 v[88:91], v[216:219], v[192:195], v[88:91]
    s_add_u32 m0, s68, 0
    s_movk_i32 s76, 384
    buffer_load_dwordx4 v240, s[32:35], s76 offen offset:0 lds
    v_mfma_f32_16x16x32_bf16 v[28:31], v[220:223], v[192:195], v[28:31]
    ds_read_b128 v[132:135], v228 offset:34816
    v_mfma_f32_16x16x32_bf16 v[92:95], v[224:227], v[192:195], v[92:95]
    ds_read_b128 v[136:139], v228 offset:36864
    v_mfma_f32_16x16x32_bf16 v[32:35], v[212:215], v[196:199], v[32:35]
    v_mfma_f32_16x16x32_bf16 v[96:99], v[216:219], v[196:199], v[96:99]
    ds_read_b128 v[140:143], v228 offset:38912
    v_mfma_f32_16x16x32_bf16 v[36:39], v[220:223], v[196:199], v[36:39]
    ds_read_b128 v[144:147], v228 offset:40960
    v_mfma_f32_16x16x32_bf16 v[100:103], v[224:227], v[196:199], v[100:103]
    buffer_load_dwordx4 v241, s[32:35], s76 offen offset:1024 lds
    v_mfma_f32_16x16x32_bf16 v[40:43], v[212:215], v[200:203], v[40:43]
    ds_read_b128 v[148:151], v228 offset:43008
    v_mfma_f32_16x16x32_bf16 v[104:107], v[216:219], v[200:203], v[104:107]
    ds_read_b128 v[152:155], v228 offset:45056
    v_mfma_f32_16x16x32_bf16 v[44:47], v[220:223], v[200:203], v[44:47]
    v_mfma_f32_16x16x32_bf16 v[108:111], v[224:227], v[200:203], v[108:111]
    ds_read_b128 v[156:159], v228 offset:47104
    v_mfma_f32_16x16x32_bf16 v[48:51], v[212:215], v[204:207], v[48:51]
    v_mfma_f32_16x16x32_bf16 v[112:115], v[216:219], v[204:207], v[112:115]
    v_mfma_f32_16x16x32_bf16 v[52:55], v[220:223], v[204:207], v[52:55]
    v_mfma_f32_16x16x32_bf16 v[116:119], v[224:227], v[204:207], v[116:119]
    v_mfma_f32_16x16x32_bf16 v[56:59], v[212:215], v[208:211], v[56:59]
    v_mfma_f32_16x16x32_bf16 v[120:123], v[216:219], v[208:211], v[120:123]
    v_mfma_f32_16x16x32_bf16 v[60:63], v[220:223], v[208:211], v[60:63]
    v_mfma_f32_16x16x32_bf16 v[124:127], v[224:227], v[208:211], v[124:127]
    s_waitcnt vmcnt(10) lgkmcnt(0)
    s_barrier
    v_mfma_f32_16x16x32_bf16 v[0:3], v[160:163], v[128:131], v[0:3]
    ds_read_b64_tr_b16 v[212:213], v236 offset:49152
    v_mfma_f32_16x16x32_bf16 v[64:67], v[164:167], v[128:131], v[64:67]
    s_add_u32 m0, s69, 32768
    s_mov_b32 s77, 1572864
    buffer_load_dwordx4 v244, s[40:43], s77 offen offset:0 lds
    v_mfma_f32_16x16x32_bf16 v[4:7], v[168:171], v[128:131], v[4:7]
    ds_read_b64_tr_b16 v[214:215], v236 offset:50176
    v_mfma_f32_16x16x32_bf16 v[68:71], v[172:175], v[128:131], v[68:71]
    ds_read_b64_tr_b16 v[216:217], v237 offset:49152
    v_mfma_f32_16x16x32_bf16 v[8:11], v[160:163], v[132:135], v[8:11]
    v_mfma_f32_16x16x32_bf16 v[72:75], v[164:167], v[132:135], v[72:75]
    ds_read_b64_tr_b16 v[218:219], v237 offset:50176
    v_mfma_f32_16x16x32_bf16 v[12:15], v[168:171], v[132:135], v[12:15]
    ds_read_b64_tr_b16 v[220:221], v238 offset:49152
    v_mfma_f32_16x16x32_bf16 v[76:79], v[172:175], v[132:135], v[76:79]
    buffer_load_dwordx4 v245, s[40:43], s77 offen offset:1024 lds
    v_mfma_f32_16x16x32_bf16 v[16:19], v[160:163], v[136:139], v[16:19]
    ds_read_b64_tr_b16 v[222:223], v238 offset:50176
    v_mfma_f32_16x16x32_bf16 v[80:83], v[164:167], v[136:139], v[80:83]
    ds_read_b64_tr_b16 v[224:225], v239 offset:49152
    v_mfma_f32_16x16x32_bf16 v[20:23], v[168:171], v[136:139], v[20:23]
    v_mfma_f32_16x16x32_bf16 v[84:87], v[172:175], v[136:139], v[84:87]
    ds_read_b64_tr_b16 v[226:227], v239 offset:50176
    v_mfma_f32_16x16x32_bf16 v[24:27], v[160:163], v[140:143], v[24:27]
    ds_read_b128 v[180:183], v229 offset:32768
    v_mfma_f32_16x16x32_bf16 v[88:91], v[164:167], v[140:143], v[88:91]
    s_add_u32 m0, s68, 0
    s_movk_i32 s76, 384
    buffer_load_dwordx4 v242, s[32:35], s76 offen offset:2048 lds
    v_mfma_f32_16x16x32_bf16 v[28:31], v[168:171], v[140:143], v[28:31]
    ds_read_b128 v[184:187], v229 offset:34816
    v_mfma_f32_16x16x32_bf16 v[92:95], v[172:175], v[140:143], v[92:95]
    ds_read_b128 v[188:191], v229 offset:36864
    v_mfma_f32_16x16x32_bf16 v[32:35], v[160:163], v[144:147], v[32:35]
    v_mfma_f32_16x16x32_bf16 v[96:99], v[164:167], v[144:147], v[96:99]
    ds_read_b128 v[192:195], v229 offset:38912
    v_mfma_f32_16x16x32_bf16 v[36:39], v[168:171], v[144:147], v[36:39]
    ds_read_b128 v[196:199], v229 offset:40960
    v_mfma_f32_16x16x32_bf16 v[100:103], v[172:175], v[144:147], v[100:103]
    buffer_load_dwordx4 v243, s[32:35], s76 offen offset:3072 lds
    v_mfma_f32_16x16x32_bf16 v[40:43], v[160:163], v[148:151], v[40:43]
    ds_read_b128 v[200:203], v229 offset:43008
    v_mfma_f32_16x16x32_bf16 v[104:107], v[164:167], v[148:151], v[104:107]
    ds_read_b128 v[204:207], v229 offset:45056
    v_mfma_f32_16x16x32_bf16 v[44:47], v[168:171], v[148:151], v[44:47]
    v_mfma_f32_16x16x32_bf16 v[108:111], v[172:175], v[148:151], v[108:111]
    ds_read_b128 v[208:211], v229 offset:47104
    v_mfma_f32_16x16x32_bf16 v[48:51], v[160:163], v[152:155], v[48:51]
    v_mfma_f32_16x16x32_bf16 v[112:115], v[164:167], v[152:155], v[112:115]
    v_mfma_f32_16x16x32_bf16 v[52:55], v[168:171], v[152:155], v[52:55]
    v_mfma_f32_16x16x32_bf16 v[116:119], v[172:175], v[152:155], v[116:119]
    v_mfma_f32_16x16x32_bf16 v[56:59], v[160:163], v[156:159], v[56:59]
    v_mfma_f32_16x16x32_bf16 v[120:123], v[164:167], v[156:159], v[120:123]
    v_mfma_f32_16x16x32_bf16 v[60:63], v[168:171], v[156:159], v[60:63]
    v_mfma_f32_16x16x32_bf16 v[124:127], v[172:175], v[156:159], v[124:127]
    s_waitcnt vmcnt(8) lgkmcnt(0)
    s_barrier
    v_mfma_f32_16x16x32_bf16 v[0:3], v[212:215], v[180:183], v[0:3]
    ds_read_b64_tr_b16 v[160:161], v236 offset:0
    v_mfma_f32_16x16x32_bf16 v[64:67], v[216:219], v[180:183], v[64:67]
    s_add_u32 m0, s69, 49152
    s_mov_b32 s77, 1835008
    buffer_load_dwordx4 v244, s[40:43], s77 offen offset:0 lds
    v_mfma_f32_16x16x32_bf16 v[4:7], v[220:223], v[180:183], v[4:7]
    ds_read_b64_tr_b16 v[162:163], v236 offset:1024
    v_mfma_f32_16x16x32_bf16 v[68:71], v[224:227], v[180:183], v[68:71]
    ds_read_b64_tr_b16 v[164:165], v237 offset:0
    v_mfma_f32_16x16x32_bf16 v[8:11], v[212:215], v[184:187], v[8:11]
    v_mfma_f32_16x16x32_bf16 v[72:75], v[216:219], v[184:187], v[72:75]
    ds_read_b64_tr_b16 v[166:167], v237 offset:1024
    v_mfma_f32_16x16x32_bf16 v[12:15], v[220:223], v[184:187], v[12:15]
    ds_read_b64_tr_b16 v[168:169], v238 offset:0
    v_mfma_f32_16x16x32_bf16 v[76:79], v[224:227], v[184:187], v[76:79]
    buffer_load_dwordx4 v245, s[40:43], s77 offen offset:1024 lds
    v_mfma_f32_16x16x32_bf16 v[16:19], v[212:215], v[188:191], v[16:19]
    ds_read_b64_tr_b16 v[170:171], v238 offset:1024
    v_mfma_f32_16x16x32_bf16 v[80:83], v[216:219], v[188:191], v[80:83]
    ds_read_b64_tr_b16 v[172:173], v239 offset:0
    v_mfma_f32_16x16x32_bf16 v[20:23], v[220:223], v[188:191], v[20:23]
    v_mfma_f32_16x16x32_bf16 v[84:87], v[224:227], v[188:191], v[84:87]
    ds_read_b64_tr_b16 v[174:175], v239 offset:1024
    v_mfma_f32_16x16x32_bf16 v[24:27], v[212:215], v[192:195], v[24:27]
    ds_read_b128 v[128:131], v230 offset:0
    v_mfma_f32_16x16x32_bf16 v[88:91], v[216:219], v[192:195], v[88:91]
    s_add_u32 m0, s68, 32768
    s_movk_i32 s76, 512
    buffer_load_dwordx4 v240, s[32:35], s76 offen offset:0 lds
    v_mfma_f32_16x16x32_bf16 v[28:31], v[220:223], v[192:195], v[28:31]
    ds_read_b128 v[132:135], v230 offset:2048
    s_cmp_eq_u32 s28, 3
    s_cbranch_scc1 Lgated_tch_1
Lgated_tch_1_r:
    v_mfma_f32_16x16x32_bf16 v[92:95], v[224:227], v[192:195], v[92:95]
    ds_read_b128 v[136:139], v230 offset:4096
    v_mfma_f32_16x16x32_bf16 v[32:35], v[212:215], v[196:199], v[32:35]
    v_mfma_f32_16x16x32_bf16 v[96:99], v[216:219], v[196:199], v[96:99]
    ds_read_b128 v[140:143], v230 offset:6144
    v_mfma_f32_16x16x32_bf16 v[36:39], v[220:223], v[196:199], v[36:39]
    ds_read_b128 v[144:147], v230 offset:8192
    v_mfma_f32_16x16x32_bf16 v[100:103], v[224:227], v[196:199], v[100:103]
    buffer_load_dwordx4 v241, s[32:35], s76 offen offset:1024 lds
    v_mfma_f32_16x16x32_bf16 v[40:43], v[212:215], v[200:203], v[40:43]
    ds_read_b128 v[148:151], v230 offset:10240
    v_mfma_f32_16x16x32_bf16 v[104:107], v[216:219], v[200:203], v[104:107]
    ds_read_b128 v[152:155], v230 offset:12288
    v_mfma_f32_16x16x32_bf16 v[44:47], v[220:223], v[200:203], v[44:47]
    v_mfma_f32_16x16x32_bf16 v[108:111], v[224:227], v[200:203], v[108:111]
    ds_read_b128 v[156:159], v230 offset:14336
    v_mfma_f32_16x16x32_bf16 v[48:51], v[212:215], v[204:207], v[48:51]
    v_mfma_f32_16x16x32_bf16 v[112:115], v[216:219], v[204:207], v[112:115]
    v_mfma_f32_16x16x32_bf16 v[52:55], v[220:223], v[204:207], v[52:55]
    v_mfma_f32_16x16x32_bf16 v[116:119], v[224:227], v[204:207], v[116:119]
    v_mfma_f32_16x16x32_bf16 v[56:59], v[212:215], v[208:211], v[56:59]
    v_mfma_f32_16x16x32_bf16 v[120:123], v[216:219], v[208:211], v[120:123]
    v_mfma_f32_16x16x32_bf16 v[60:63], v[220:223], v[208:211], v[60:63]
    v_mfma_f32_16x16x32_bf16 v[124:127], v[224:227], v[208:211], v[124:127]
    s_waitcnt vmcnt(10) lgkmcnt(0)
    s_barrier
    v_mfma_f32_16x16x32_bf16 v[0:3], v[160:163], v[128:131], v[0:3]
    ds_read_b64_tr_b16 v[212:213], v236 offset:16384
    v_mfma_f32_16x16x32_bf16 v[64:67], v[164:167], v[128:131], v[64:67]
    s_add_u32 m0, s69, 0
    s_mov_b32 s77, 2097152
    buffer_load_dwordx4 v244, s[40:43], s77 offen offset:0 lds
    v_mfma_f32_16x16x32_bf16 v[4:7], v[168:171], v[128:131], v[4:7]
    ds_read_b64_tr_b16 v[214:215], v236 offset:17408
    v_mfma_f32_16x16x32_bf16 v[68:71], v[172:175], v[128:131], v[68:71]
    ds_read_b64_tr_b16 v[216:217], v237 offset:16384
    v_mfma_f32_16x16x32_bf16 v[8:11], v[160:163], v[132:135], v[8:11]
    v_mfma_f32_16x16x32_bf16 v[72:75], v[164:167], v[132:135], v[72:75]
    ds_read_b64_tr_b16 v[218:219], v237 offset:17408
    v_mfma_f32_16x16x32_bf16 v[12:15], v[168:171], v[132:135], v[12:15]
    ds_read_b64_tr_b16 v[220:221], v238 offset:16384
    v_mfma_f32_16x16x32_bf16 v[76:79], v[172:175], v[132:135], v[76:79]
    buffer_load_dwordx4 v245, s[40:43], s77 offen offset:1024 lds
    v_mfma_f32_16x16x32_bf16 v[16:19], v[160:163], v[136:139], v[16:19]
    ds_read_b64_tr_b16 v[222:223], v238 offset:17408
    v_mfma_f32_16x16x32_bf16 v[80:83], v[164:167], v[136:139], v[80:83]
    ds_read_b64_tr_b16 v[224:225], v239 offset:16384
    v_mfma_f32_16x16x32_bf16 v[20:23], v[168:171], v[136:139], v[20:23]
    v_mfma_f32_16x16x32_bf16 v[84:87], v[172:175], v[136:139], v[84:87]
    ds_read_b64_tr_b16 v[226:227], v239 offset:17408
    v_mfma_f32_16x16x32_bf16 v[24:27], v[160:163], v[140:143], v[24:27]
    ds_read_b128 v[180:183], v231 offset:0
    v_mfma_f32_16x16x32_bf16 v[88:91], v[164:167], v[140:143], v[88:91]
    s_add_u32 m0, s68, 32768
    s_movk_i32 s76, 512
    buffer_load_dwordx4 v242, s[32:35], s76 offen offset:2048 lds
    v_mfma_f32_16x16x32_bf16 v[28:31], v[168:171], v[140:143], v[28:31]
    ds_read_b128 v[184:187], v231 offset:2048
    s_cmp_eq_u32 s28, 4
    s_cbranch_scc1 Lgated_tch_2
Lgated_tch_2_r:
    v_mfma_f32_16x16x32_bf16 v[92:95], v[172:175], v[140:143], v[92:95]
    ds_read_b128 v[188:191], v231 offset:4096
    v_mfma_f32_16x16x32_bf16 v[32:35], v[160:163], v[144:147], v[32:35]
    v_mfma_f32_16x16x32_bf16 v[96:99], v[164:167], v[144:147], v[96:99]
    ds_read_b128 v[192:195], v231 offset:6144
    v_mfma_f32_16x16x32_bf16 v[36:39], v[168:171], v[144:147], v[36:39]
    ds_read_b128 v[196:199], v231 offset:8192
    v_mfma_f32_16x16x32_bf16 v[100:103], v[172:175], v[144:147], v[100:103]
    buffer_load_dwordx4 v243, s[32:35], s76 offen offset:3072 lds
    v_mfma_f32_16x16x32_bf16 v[40:43], v[160:163], v[148:151], v[40:43]
    ds_read_b128 v[200:203], v231 offset:10240
    v_mfma_f32_16x16x32_bf16 v[104:107], v[164:167], v[148:151], v[104:107]
    ds_read_b128 v[204:207], v231 offset:12288
    v_mfma_f32_16x16x32_bf16 v[44:47], v[168:171], v[148:151], v[44:47]
    v_mfma_f32_16x16x32_bf16 v[108:111], v[172:175], v[148:151], v[108:111]
    ds_read_b128 v[208:211], v231 offset:14336
    v_mfma_f32_16x16x32_bf16 v[48:51], v[160:163], v[152:155], v[48:51]
    v_mfma_f32_16x16x32_bf16 v[112:115], v[164:167], v[152:155], v[112:115]
    v_mfma_f32_16x16x32_bf16 v[52:55], v[168:171], v[152:155], v[52:55]
    v_mfma_f32_16x16x32_bf16 v[116:119], v[172:175], v[152:155], v[116:119]
    v_mfma_f32_16x16x32_bf16 v[56:59], v[160:163], v[156:159], v[56:59]
    v_mfma_f32_16x16x32_bf16 v[120:123], v[164:167], v[156:159], v[120:123]
    v_mfma_f32_16x16x32_bf16 v[60:63], v[168:171], v[156:159], v[60:63]
    v_mfma_f32_16x16x32_bf16 v[124:127], v[172:175], v[156:159], v[124:127]
    s_waitcnt vmcnt(8) lgkmcnt(0)
    s_barrier
    v_mfma_f32_16x16x32_bf16 v[0:3], v[212:215], v[180:183], v[0:3]
    ds_read_b64_tr_b16 v[160:161], v236 offset:32768
    v_mfma_f32_16x16x32_bf16 v[64:67], v[216:219], v[180:183], v[64:67]
    s_add_u32 m0, s69, 16384
    s_mov_b32 s77, 2359296
    buffer_load_dwordx4 v244, s[40:43], s77 offen offset:0 lds
    v_mfma_f32_16x16x32_bf16 v[4:7], v[220:223], v[180:183], v[4:7]
    ds_read_b64_tr_b16 v[162:163], v236 offset:33792
    v_mfma_f32_16x16x32_bf16 v[68:71], v[224:227], v[180:183], v[68:71]
    ds_read_b64_tr_b16 v[164:165], v237 offset:32768
    v_mfma_f32_16x16x32_bf16 v[8:11], v[212:215], v[184:187], v[8:11]
    v_mfma_f32_16x16x32_bf16 v[72:75], v[216:219], v[184:187], v[72:75]
    ds_read_b64_tr_b16 v[166:167], v237 offset:33792
    v_mfma_f32_16x16x32_bf16 v[12:15], v[220:223], v[184:187], v[12:15]
    ds_read_b64_tr_b16 v[168:169], v238 offset:32768
    v_mfma_f32_16x16x32_bf16 v[76:79], v[224:227], v[184:187], v[76:79]
    buffer_load_dwordx4 v245, s[40:43], s77 offen offset:1024 lds
    v_mfma_f32_16x16x32_bf16 v[16:19], v[212:215], v[188:191], v[16:19]
    ds_read_b64_tr_b16 v[170:171], v238 offset:33792
    v_mfma_f32_16x16x32_bf16 v[80:83], v[216:219], v[188:191], v[80:83]
    ds_read_b64_tr_b16 v[172:173], v239 offset:32768
    v_mfma_f32_16x16x32_bf16 v[20:23], v[220:223], v[188:191], v[20:23]
    v_mfma_f32_16x16x32_bf16 v[84:87], v[224:227], v[188:191], v[84:87]
    ds_read_b64_tr_b16 v[174:175], v239 offset:33792
    v_mfma_f32_16x16x32_bf16 v[24:27], v[212:215], v[192:195], v[24:27]
    ds_read_b128 v[128:131], v228 offset:0
    v_mfma_f32_16x16x32_bf16 v[88:91], v[216:219], v[192:195], v[88:91]
    s_add_u32 m0, s68, 65536
    s_movk_i32 s76, 640
    buffer_load_dwordx4 v240, s[32:35], s76 offen offset:0 lds
    v_mfma_f32_16x16x32_bf16 v[28:31], v[220:223], v[192:195], v[28:31]
    ds_read_b128 v[132:135], v228 offset:2048
    s_cmp_eq_u32 s28, 5
    s_cbranch_scc1 Lgated_tch_3
Lgated_tch_3_r:
    v_mfma_f32_16x16x32_bf16 v[92:95], v[224:227], v[192:195], v[92:95]
    ds_read_b128 v[136:139], v228 offset:4096
    v_mfma_f32_16x16x32_bf16 v[32:35], v[212:215], v[196:199], v[32:35]
    v_mfma_f32_16x16x32_bf16 v[96:99], v[216:219], v[196:199], v[96:99]
    ds_read_b128 v[140:143], v228 offset:6144
    v_mfma_f32_16x16x32_bf16 v[36:39], v[220:223], v[196:199], v[36:39]
    ds_read_b128 v[144:147], v228 offset:8192
    v_mfma_f32_16x16x32_bf16 v[100:103], v[224:227], v[196:199], v[100:103]
    buffer_load_dwordx4 v241, s[32:35], s76 offen offset:1024 lds
    v_mfma_f32_16x16x32_bf16 v[40:43], v[212:215], v[200:203], v[40:43]
    ds_read_b128 v[148:151], v228 offset:10240
    v_mfma_f32_16x16x32_bf16 v[104:107], v[216:219], v[200:203], v[104:107]
    ds_read_b128 v[152:155], v228 offset:12288
    v_mfma_f32_16x16x32_bf16 v[44:47], v[220:223], v[200:203], v[44:47]
    v_mfma_f32_16x16x32_bf16 v[108:111], v[224:227], v[200:203], v[108:111]
    ds_read_b128 v[156:159], v228 offset:14336
    v_mfma_f32_16x16x32_bf16 v[48:51], v[212:215], v[204:207], v[48:51]
    v_mfma_f32_16x16x32_bf16 v[112:115], v[216:219], v[204:207], v[112:115]
    v_mfma_f32_16x16x32_bf16 v[52:55], v[220:223], v[204:207], v[52:55]
    v_mfma_f32_16x16x32_bf16 v[116:119], v[224:227], v[204:207], v[116:119]
    v_mfma_f32_16x16x32_bf16 v[56:59], v[212:215], v[208:211], v[56:59]
    v_mfma_f32_16x16x32_bf16 v[120:123], v[216:219], v[208:211], v[120:123]
    v_mfma_f32_16x16x32_bf16 v[60:63], v[220:223], v[208:211], v[60:63]
    v_mfma_f32_16x16x32_bf16 v[124:127], v[224:227], v[208:211], v[124:127]
    s_waitcnt vmcnt(10) lgkmcnt(0)
    s_barrier
    v_mfma_f32_16x16x32_bf16 v[0:3], v[160:163], v[128:131], v[0:3]
    ds_read_b64_tr_b16 v[212:213], v236 offset:49152
    v_mfma_f32_16x16x32_bf16 v[64:67], v[164:167], v[128:131], v[64:67]
    s_add_u32 m0, s69, 32768
    s_mov_b32 s77, 2621440
    buffer_load_dwordx4 v244, s[40:43], s77 offen offset:0 lds
    v_mfma_f32_16x16x32_bf16 v[4:7], v[168:171], v[128:131], v[4:7]
    ds_read_b64_tr_b16 v[214:215], v236 offset:50176
    v_mfma_f32_16x16x32_bf16 v[68:71], v[172:175], v[128:131], v[68:71]
    ds_read_b64_tr_b16 v[216:217], v237 offset:49152
    v_mfma_f32_16x16x32_bf16 v[8:11], v[160:163], v[132:135], v[8:11]
    v_mfma_f32_16x16x32_bf16 v[72:75], v[164:167], v[132:135], v[72:75]
    ds_read_b64_tr_b16 v[218:219], v237 offset:50176
    v_mfma_f32_16x16x32_bf16 v[12:15], v[168:171], v[132:135], v[12:15]
    ds_read_b64_tr_b16 v[220:221], v238 offset:49152
    v_mfma_f32_16x16x32_bf16 v[76:79], v[172:175], v[132:135], v[76:79]
    buffer_load_dwordx4 v245, s[40:43], s77 offen offset:1024 lds
    v_mfma_f32_16x16x32_bf16 v[16:19], v[160:163], v[136:139], v[16:19]
    ds_read_b64_tr_b16 v[222:223], v238 offset:50176
    v_mfma_f32_16x16x32_bf16 v[80:83], v[164:167], v[136:139], v[80:83]
    ds_read_b64_tr_b16 v[224:225], v239 offset:49152
    v_mfma_f32_16x16x32_bf16 v[20:23], v[168:171], v[136:139], v[20:23]
    v_mfma_f32_16x16x32_bf16 v[84:87], v[172:175], v[136:139], v[84:87]
    ds_read_b64_tr_b16 v[226:227], v239 offset:50176
    v_mfma_f32_16x16x32_bf16 v[24:27], v[160:163], v[140:143], v[24:27]
    ds_read_b128 v[180:183], v229 offset:0
    v_mfma_f32_16x16x32_bf16 v[88:91], v[164:167], v[140:143], v[88:91]
    s_add_u32 m0, s68, 65536
    s_movk_i32 s76, 640
    buffer_load_dwordx4 v242, s[32:35], s76 offen offset:2048 lds
    v_mfma_f32_16x16x32_bf16 v[28:31], v[168:171], v[140:143], v[28:31]
    ds_read_b128 v[184:187], v229 offset:2048
    s_cmp_eq_u32 s28, 6
    s_cbranch_scc1 Lgated_tch_4
Lgated_tch_4_r:
    v_mfma_f32_16x16x32_bf16 v[92:95], v[172:175], v[140:143], v[92:95]
    ds_read_b128 v[188:191], v229 offset:4096
    v_mfma_f32_16x16x32_bf16 v[32:35], v[160:163], v[144:147], v[32:35]
    v_mfma_f32_16x16x32_bf16 v[96:99], v[164:167], v[144:147], v[96:99]
    ds_read_b128 v[192:195], v229 offset:6144
    v_mfma_f32_16x16x32_bf16 v[36:39], v[168:171], v[144:147], v[36:39]
    ds_read_b128 v[196:199], v229 offset:8192
    v_mfma_f32_16x16x32_bf16 v[100:103], v[172:175], v[144:147], v[100:103]
    buffer_load_dwordx4 v243, s[32:35], s76 offen offset:3072 lds
    v_mfma_f32_16x16x32_bf16 v[40:43], v[160:163], v[148:151], v[40:43]
    ds_read_b128 v[200:203], v229 offset:10240
    v_mfma_f32_16x16x32_bf16 v[104:107], v[164:167], v[148:151], v[104:107]
    ds_read_b128 v[204:207], v229 offset:12288
    v_mfma_f32_16x16x32_bf16 v[44:47], v[168:171], v[148:151], v[44:47]
    v_mfma_f32_16x16x32_bf16 v[108:111], v[172:175], v[148:151], v[108:111]
    ds_read_b128 v[208:211], v229 offset:14336
    v_mfma_f32_16x16x32_bf16 v[48:51], v[160:163], v[152:155], v[48:51]
    v_mfma_f32_16x16x32_bf16 v[112:115], v[164:167], v[152:155], v[112:115]
    v_mfma_f32_16x16x32_bf16 v[52:55], v[168:171], v[152:155], v[52:55]
    v_mfma_f32_16x16x32_bf16 v[116:119], v[172:175], v[152:155], v[116:119]
    v_mfma_f32_16x16x32_bf16 v[56:59], v[160:163], v[156:159], v[56:59]
    v_mfma_f32_16x16x32_bf16 v[120:123], v[164:167], v[156:159], v[120:123]
    v_mfma_f32_16x16x32_bf16 v[60:63], v[168:171], v[156:159], v[60:63]
    v_mfma_f32_16x16x32_bf16 v[124:127], v[172:175], v[156:159], v[124:127]
    s_waitcnt vmcnt(8) lgkmcnt(0)
    s_barrier
    v_mfma_f32_16x16x32_bf16 v[0:3], v[212:215], v[180:183], v[0:3]
    ds_read_b64_tr_b16 v[160:161], v236 offset:0
    v_mfma_f32_16x16x32_bf16 v[64:67], v[216:219], v[180:183], v[64:67]
    s_add_u32 m0, s69, 49152
    s_mov_b32 s77, 2883584
    buffer_load_dwordx4 v244, s[40:43], s77 offen offset:0 lds
    v_mfma_f32_16x16x32_bf16 v[4:7], v[220:223], v[180:183], v[4:7]
    ds_read_b64_tr_b16 v[162:163], v236 offset:1024
    v_mfma_f32_16x16x32_bf16 v[68:71], v[224:227], v[180:183], v[68:71]
    ds_read_b64_tr_b16 v[164:165], v237 offset:0
    v_mfma_f32_16x16x32_bf16 v[8:11], v[212:215], v[184:187], v[8:11]
    v_mfma_f32_16x16x32_bf16 v[72:75], v[216:219], v[184:187], v[72:75]
    ds_read_b64_tr_b16 v[166:167], v237 offset:1024
    v_mfma_f32_16x16x32_bf16 v[12:15], v[220:223], v[184:187], v[12:15]
    ds_read_b64_tr_b16 v[168:169], v238 offset:0
    v_mfma_f32_16x16x32_bf16 v[76:79], v[224:227], v[184:187], v[76:79]
    buffer_load_dwordx4 v245, s[40:43], s77 offen offset:1024 lds
    v_mfma_f32_16x16x32_bf16 v[16:19], v[212:215], v[188:191], v[16:19]
    ds_read_b64_tr_b16 v[170:171], v238 offset:1024
    v_mfma_f32_16x16x32_bf16 v[80:83], v[216:219], v[188:191], v[80:83]
    ds_read_b64_tr_b16 v[172:173], v239 offset:0
    v_mfma_f32_16x16x32_bf16 v[20:23], v[220:223], v[188:191], v[20:23]
    v_mfma_f32_16x16x32_bf16 v[84:87], v[224:227], v[188:191], v[84:87]
    ds_read_b64_tr_b16 v[174:175], v239 offset:1024
    v_mfma_f32_16x16x32_bf16 v[24:27], v[212:215], v[192:195], v[24:27]
    ds_read_b128 v[128:131], v228 offset:32768
    v_mfma_f32_16x16x32_bf16 v[88:91], v[216:219], v[192:195], v[88:91]
    s_add_u32 m0, s68, 0
    s_movk_i32 s76, 768
    buffer_load_dwordx4 v240, s[32:35], s76 offen offset:0 lds
    v_mfma_f32_16x16x32_bf16 v[28:31], v[220:223], v[192:195], v[28:31]
    ds_read_b128 v[132:135], v228 offset:34816
    s_cmp_eq_u32 s28, 7
    s_cbranch_scc1 Lgated_tch_5
Lgated_tch_5_r:
    v_mfma_f32_16x16x32_bf16 v[92:95], v[224:227], v[192:195], v[92:95]
    ds_read_b128 v[136:139], v228 offset:36864
    v_mfma_f32_16x16x32_bf16 v[32:35], v[212:215], v[196:199], v[32:35]
    v_mfma_f32_16x16x32_bf16 v[96:99], v[216:219], v[196:199], v[96:99]
    ds_read_b128 v[140:143], v228 offset:38912
    v_mfma_f32_16x16x32_bf16 v[36:39], v[220:223], v[196:199], v[36:39]
    ds_read_b128 v[144:147], v228 offset:40960
    v_mfma_f32_16x16x32_bf16 v[100:103], v[224:227], v[196:199], v[100:103]
    buffer_load_dwordx4 v241, s[32:35], s76 offen offset:1024 lds
    v_mfma_f32_16x16x32_bf16 v[40:43], v[212:215], v[200:203], v[40:43]
    ds_read_b128 v[148:151], v228 offset:43008
    v_mfma_f32_16x16x32_bf16 v[104:107], v[216:219], v[200:203], v[104:107]
    ds_read_b128 v[152:155], v228 offset:45056
    v_mfma_f32_16x16x32_bf16 v[44:47], v[220:223], v[200:203], v[44:47]
    v_mfma_f32_16x16x32_bf16 v[108:111], v[224:227], v[200:203], v[108:111]
    ds_read_b128 v[156:159], v228 offset:47104
    v_mfma_f32_16x16x32_bf16 v[48:51], v[212:215], v[204:207], v[48:51]
    v_mfma_f32_16x16x32_bf16 v[112:115], v[216:219], v[204:207], v[112:115]
    v_mfma_f32_16x16x32_bf16 v[52:55], v[220:223], v[204:207], v[52:55]
    v_mfma_f32_16x16x32_bf16 v[116:119], v[224:227], v[204:207], v[116:119]
    v_mfma_f32_16x16x32_bf16 v[56:59], v[212:215], v[208:211], v[56:59]
    v_mfma_f32_16x16x32_bf16 v[120:123], v[216:219], v[208:211], v[120:123]
    v_mfma_f32_16x16x32_bf16 v[60:63], v[220:223], v[208:211], v[60:63]
    v_mfma_f32_16x16x32_bf16 v[124:127], v[224:227], v[208:211], v[124:127]
    s_waitcnt vmcnt(10) lgkmcnt(0)
    s_barrier
    v_mfma_f32_16x16x32_bf16 v[0:3], v[160:163], v[128:131], v[0:3]
    ds_read_b64_tr_b16 v[212:213], v236 offset:16384
    v_mfma_f32_16x16x32_bf16 v[64:67], v[164:167], v[128:131], v[64:67]
    s_add_u32 m0, s69, 0
    s_mov_b32 s77, 3145728
    buffer_load_dwordx4 v244, s[40:43], s77 offen offset:0 lds
    v_mfma_f32_16x16x32_bf16 v[4:7], v[168:171], v[128:131], v[4:7]
    ds_read_b64_tr_b16 v[214:215], v236 offset:17408
    v_mfma_f32_16x16x32_bf16 v[68:71], v[172:175], v[128:131], v[68:71]
    ds_read_b64_tr_b16 v[216:217], v237 offset:16384
    v_mfma_f32_16x16x32_bf16 v[8:11], v[160:163], v[132:135], v[8:11]
    v_mfma_f32_16x16x32_bf16 v[72:75], v[164:167], v[132:135], v[72:75]
    ds_read_b64_tr_b16 v[218:219], v237 offset:17408
    v_mfma_f32_16x16x32_bf16 v[12:15], v[168:171], v[132:135], v[12:15]
    ds_read_b64_tr_b16 v[220:221], v238 offset:16384
    v_mfma_f32_16x16x32_bf16 v[76:79], v[172:175], v[132:135], v[76:79]
    buffer_load_dwordx4 v245, s[40:43], s77 offen offset:1024 lds
    v_mfma_f32_16x16x32_bf16 v[16:19], v[160:163], v[136:139], v[16:19]
    ds_read_b64_tr_b16 v[222:223], v238 offset:17408
    v_mfma_f32_16x16x32_bf16 v[80:83], v[164:167], v[136:139], v[80:83]
    ds_read_b64_tr_b16 v[224:225], v239 offset:16384
    v_mfma_f32_16x16x32_bf16 v[20:23], v[168:171], v[136:139], v[20:23]
    v_mfma_f32_16x16x32_bf16 v[84:87], v[172:175], v[136:139], v[84:87]
    ds_read_b64_tr_b16 v[226:227], v239 offset:17408
    v_mfma_f32_16x16x32_bf16 v[24:27], v[160:163], v[140:143], v[24:27]
    ds_read_b128 v[180:183], v229 offset:32768
    v_mfma_f32_16x16x32_bf16 v[88:91], v[164:167], v[140:143], v[88:91]
    s_add_u32 m0, s68, 0
    s_movk_i32 s76, 768
    buffer_load_dwordx4 v242, s[32:35], s76 offen offset:2048 lds
    v_mfma_f32_16x16x32_bf16 v[28:31], v[168:171], v[140:143], v[28:31]
    ds_read_b128 v[184:187], v229 offset:34816
    s_cmp_eq_u32 s28, 8
    s_cbranch_scc1 Lgated_tch_6
Lgated_tch_6_r:
    v_mfma_f32_16x16x32_bf16 v[92:95], v[172:175], v[140:143], v[92:95]
    ds_read_b128 v[188:191], v229 offset:36864
    v_mfma_f32_16x16x32_bf16 v[32:35], v[160:163], v[144:147], v[32:35]
    v_mfma_f32_16x16x32_bf16 v[96:99], v[164:167], v[144:147], v[96:99]
    ds_read_b128 v[192:195], v229 offset:38912
    v_mfma_f32_16x16x32_bf16 v[36:39], v[168:171], v[144:147], v[36:39]
    ds_read_b128 v[196:199], v229 offset:40960
    v_mfma_f32_16x16x32_bf16 v[100:103], v[172:175], v[144:147], v[100:103]
    buffer_load_dwordx4 v243, s[32:35], s76 offen offset:3072 lds
    v_mfma_f32_16x16x32_bf16 v[40:43], v[160:163], v[148:151], v[40:43]
    ds_read_b128 v[200:203], v229 offset:43008
    v_mfma_f32_16x16x32_bf16 v[104:107], v[164:167], v[148:151], v[104:107]
    ds_read_b128 v[204:207], v229 offset:45056
    v_mfma_f32_16x16x32_bf16 v[44:47], v[168:171], v[148:151], v[44:47]
    v_mfma_f32_16x16x32_bf16 v[108:111], v[172:175], v[148:151], v[108:111]
    ds_read_b128 v[208:211], v229 offset:47104
    v_mfma_f32_16x16x32_bf16 v[48:51], v[160:163], v[152:155], v[48:51]
    v_mfma_f32_16x16x32_bf16 v[112:115], v[164:167], v[152:155], v[112:115]
    v_mfma_f32_16x16x32_bf16 v[52:55], v[168:171], v[152:155], v[52:55]
    v_mfma_f32_16x16x32_bf16 v[116:119], v[172:175], v[152:155], v[116:119]
    v_mfma_f32_16x16x32_bf16 v[56:59], v[160:163], v[156:159], v[56:59]
    v_mfma_f32_16x16x32_bf16 v[120:123], v[164:167], v[156:159], v[120:123]
    v_mfma_f32_16x16x32_bf16 v[60:63], v[168:171], v[156:159], v[60:63]
    v_mfma_f32_16x16x32_bf16 v[124:127], v[172:175], v[156:159], v[124:127]
    s_waitcnt vmcnt(8) lgkmcnt(0)
    s_barrier
    v_mfma_f32_16x16x32_bf16 v[0:3], v[212:215], v[180:183], v[0:3]
    ds_read_b64_tr_b16 v[160:161], v236 offset:32768
    v_mfma_f32_16x16x32_bf16 v[64:67], v[216:219], v[180:183], v[64:67]
    s_add_u32 m0, s69, 16384
    s_mov_b32 s77, 3407872
    buffer_load_dwordx4 v244, s[40:43], s77 offen offset:0 lds
    v_mfma_f32_16x16x32_bf16 v[4:7], v[220:223], v[180:183], v[4:7]
    ds_read_b64_tr_b16 v[162:163], v236 offset:33792
    v_mfma_f32_16x16x32_bf16 v[68:71], v[224:227], v[180:183], v[68:71]
    ds_read_b64_tr_b16 v[164:165], v237 offset:32768
    v_mfma_f32_16x16x32_bf16 v[8:11], v[212:215], v[184:187], v[8:11]
    v_mfma_f32_16x16x32_bf16 v[72:75], v[216:219], v[184:187], v[72:75]
    ds_read_b64_tr_b16 v[166:167], v237 offset:33792
    v_mfma_f32_16x16x32_bf16 v[12:15], v[220:223], v[184:187], v[12:15]
    ds_read_b64_tr_b16 v[168:169], v238 offset:32768
    v_mfma_f32_16x16x32_bf16 v[76:79], v[224:227], v[184:187], v[76:79]
    buffer_load_dwordx4 v245, s[40:43], s77 offen offset:1024 lds
    v_mfma_f32_16x16x32_bf16 v[16:19], v[212:215], v[188:191], v[16:19]
    ds_read_b64_tr_b16 v[170:171], v238 offset:33792
    v_mfma_f32_16x16x32_bf16 v[80:83], v[216:219], v[188:191], v[80:83]
    ds_read_b64_tr_b16 v[172:173], v239 offset:32768
    v_mfma_f32_16x16x32_bf16 v[20:23], v[220:223], v[188:191], v[20:23]
    v_mfma_f32_16x16x32_bf16 v[84:87], v[224:227], v[188:191], v[84:87]
    ds_read_b64_tr_b16 v[174:175], v239 offset:33792
    v_mfma_f32_16x16x32_bf16 v[24:27], v[212:215], v[192:195], v[24:27]
    ds_read_b128 v[128:131], v230 offset:0
    v_mfma_f32_16x16x32_bf16 v[88:91], v[216:219], v[192:195], v[88:91]
    s_add_u32 m0, s68, 32768
    s_movk_i32 s76, 896
    buffer_load_dwordx4 v240, s[32:35], s76 offen offset:0 lds
    v_mfma_f32_16x16x32_bf16 v[28:31], v[220:223], v[192:195], v[28:31]
    ds_read_b128 v[132:135], v230 offset:2048
    s_cmp_eq_u32 s28, 9
    s_cbranch_scc1 Lgated_tch_7
Lgated_tch_7_r:
    v_mfma_f32_16x16x32_bf16 v[92:95], v[224:227], v[192:195], v[92:95]
    ds_read_b128 v[136:139], v230 offset:4096
    v_mfma_f32_16x16x32_bf16 v[32:35], v[212:215], v[196:199], v[32:35]
    v_mfma_f32_16x16x32_bf16 v[96:99], v[216:219], v[196:199], v[96:99]
    ds_read_b128 v[140:143], v230 offset:6144
    v_mfma_f32_16x16x32_bf16 v[36:39], v[220:223], v[196:199], v[36:39]
    ds_read_b128 v[144:147], v230 offset:8192
    v_mfma_f32_16x16x32_bf16 v[100:103], v[224:227], v[196:199], v[100:103]
    buffer_load_dwordx4 v241, s[32:35], s76 offen offset:1024 lds
    v_mfma_f32_16x16x32_bf16 v[40:43], v[212:215], v[200:203], v[40:43]
    ds_read_b128 v[148:151], v230 offset:10240
    v_mfma_f32_16x16x32_bf16 v[104:107], v[216:219], v[200:203], v[104:107]
    ds_read_b128 v[152:155], v230 offset:12288
    v_mfma_f32_16x16x32_bf16 v[44:47], v[220:223], v[200:203], v[44:47]
    v_mfma_f32_16x16x32_bf16 v[108:111], v[224:227], v[200:203], v[108:111]
    ds_read_b128 v[156:159], v230 offset:14336
    v_mfma_f32_16x16x32_bf16 v[48:51], v[212:215], v[204:207], v[48:51]
    v_mfma_f32_16x16x32_bf16 v[112:115], v[216:219], v[204:207], v[112:115]
    v_mfma_f32_16x16x32_bf16 v[52:55], v[220:223], v[204:207], v[52:55]
    v_mfma_f32_16x16x32_bf16 v[116:119], v[224:227], v[204:207], v[116:119]
    v_mfma_f32_16x16x32_bf16 v[56:59], v[212:215], v[208:211], v[56:59]
    v_mfma_f32_16x16x32_bf16 v[120:123], v[216:219], v[208:211], v[120:123]
    v_mfma_f32_16x16x32_bf16 v[60:63], v[220:223], v[208:211], v[60:63]
    v_mfma_f32_16x16x32_bf16 v[124:127], v[224:227], v[208:211], v[124:127]
    s_waitcnt vmcnt(10) lgkmcnt(0)
    s_barrier
    v_mfma_f32_16x16x32_bf16 v[0:3], v[160:163], v[128:131], v[0:3]
    ds_read_b64_tr_b16 v[212:213], v236 offset:49152
    v_mfma_f32_16x16x32_bf16 v[64:67], v[164:167], v[128:131], v[64:67]
    s_add_u32 m0, s69, 32768
    s_mov_b32 s77, 3670016
    buffer_load_dwordx4 v244, s[40:43], s77 offen offset:0 lds
    v_mfma_f32_16x16x32_bf16 v[4:7], v[168:171], v[128:131], v[4:7]
    ds_read_b64_tr_b16 v[214:215], v236 offset:50176
    v_mfma_f32_16x16x32_bf16 v[68:71], v[172:175], v[128:131], v[68:71]
    ds_read_b64_tr_b16 v[216:217], v237 offset:49152
    v_mfma_f32_16x16x32_bf16 v[8:11], v[160:163], v[132:135], v[8:11]
    v_mfma_f32_16x16x32_bf16 v[72:75], v[164:167], v[132:135], v[72:75]
    ds_read_b64_tr_b16 v[218:219], v237 offset:50176
    v_mfma_f32_16x16x32_bf16 v[12:15], v[168:171], v[132:135], v[12:15]
    ds_read_b64_tr_b16 v[220:221], v238 offset:49152
    v_mfma_f32_16x16x32_bf16 v[76:79], v[172:175], v[132:135], v[76:79]
    buffer_load_dwordx4 v245, s[40:43], s77 offen offset:1024 lds
    v_mfma_f32_16x16x32_bf16 v[16:19], v[160:163], v[136:139], v[16:19]
    ds_read_b64_tr_b16 v[222:223], v238 offset:50176
    v_mfma_f32_16x16x32_bf16 v[80:83], v[164:167], v[136:139], v[80:83]
    ds_read_b64_tr_b16 v[224:225], v239 offset:49152
    v_mfma_f32_16x16x32_bf16 v[20:23], v[168:171], v[136:139], v[20:23]
    v_mfma_f32_16x16x32_bf16 v[84:87], v[172:175], v[136:139], v[84:87]
    ds_read_b64_tr_b16 v[226:227], v239 offset:50176
    v_mfma_f32_16x16x32_bf16 v[24:27], v[160:163], v[140:143], v[24:27]
    ds_read_b128 v[180:183], v231 offset:0
    v_mfma_f32_16x16x32_bf16 v[88:91], v[164:167], v[140:143], v[88:91]
    s_add_u32 m0, s68, 32768
    s_movk_i32 s76, 896
    buffer_load_dwordx4 v242, s[32:35], s76 offen offset:2048 lds
    v_mfma_f32_16x16x32_bf16 v[28:31], v[168:171], v[140:143], v[28:31]
    ds_read_b128 v[184:187], v231 offset:2048
    s_cmp_eq_u32 s28, 10
    s_cbranch_scc1 Lgated_tch_8
Lgated_tch_8_r:
    v_mfma_f32_16x16x32_bf16 v[92:95], v[172:175], v[140:143], v[92:95]
    ds_read_b128 v[188:191], v231 offset:4096
    v_mfma_f32_16x16x32_bf16 v[32:35], v[160:163], v[144:147], v[32:35]
    v_mfma_f32_16x16x32_bf16 v[96:99], v[164:167], v[144:147], v[96:99]
    ds_read_b128 v[192:195], v231 offset:6144
    v_mfma_f32_16x16x32_bf16 v[36:39], v[168:171], v[144:147], v[36:39]
    ds_read_b128 v[196:199], v231 offset:8192
    v_mfma_f32_16x16x32_bf16 v[100:103], v[172:175], v[144:147], v[100:103]
    buffer_load_dwordx4 v243, s[32:35], s76 offen offset:3072 lds
    v_mfma_f32_16x16x32_bf16 v[40:43], v[160:163], v[148:151], v[40:43]
    ds_read_b128 v[200:203], v231 offset:10240
    v_mfma_f32_16x16x32_bf16 v[104:107], v[164:167], v[148:151], v[104:107]
    ds_read_b128 v[204:207], v231 offset:12288
    v_mfma_f32_16x16x32_bf16 v[44:47], v[168:171], v[148:151], v[44:47]
    v_mfma_f32_16x16x32_bf16 v[108:111], v[172:175], v[148:151], v[108:111]
    ds_read_b128 v[208:211], v231 offset:14336
    v_mfma_f32_16x16x32_bf16 v[48:51], v[160:163], v[152:155], v[48:51]
    v_mfma_f32_16x16x32_bf16 v[112:115], v[164:167], v[152:155], v[112:115]
    v_mfma_f32_16x16x32_bf16 v[52:55], v[168:171], v[152:155], v[52:55]
    v_mfma_f32_16x16x32_bf16 v[116:119], v[172:175], v[152:155], v[116:119]
    v_mfma_f32_16x16x32_bf16 v[56:59], v[160:163], v[156:159], v[56:59]
    v_mfma_f32_16x16x32_bf16 v[120:123], v[164:167], v[156:159], v[120:123]
    v_mfma_f32_16x16x32_bf16 v[60:63], v[168:171], v[156:159], v[60:63]
    v_mfma_f32_16x16x32_bf16 v[124:127], v[172:175], v[156:159], v[124:127]
    s_waitcnt vmcnt(8) lgkmcnt(0)
    s_barrier
    v_mfma_f32_16x16x32_bf16 v[0:3], v[212:215], v[180:183], v[0:3]
    ds_read_b64_tr_b16 v[160:161], v236 offset:0
    v_mfma_f32_16x16x32_bf16 v[64:67], v[216:219], v[180:183], v[64:67]
    s_add_u32 m0, s69, 49152
    s_mov_b32 s77, 3932160
    buffer_load_dwordx4 v244, s[40:43], s77 offen offset:0 lds
    v_mfma_f32_16x16x32_bf16 v[4:7], v[220:223], v[180:183], v[4:7]
    ds_read_b64_tr_b16 v[162:163], v236 offset:1024
    v_mfma_f32_16x16x32_bf16 v[68:71], v[224:227], v[180:183], v[68:71]
    ds_read_b64_tr_b16 v[164:165], v237 offset:0
    v_mfma_f32_16x16x32_bf16 v[8:11], v[212:215], v[184:187], v[8:11]
    v_mfma_f32_16x16x32_bf16 v[72:75], v[216:219], v[184:187], v[72:75]
    ds_read_b64_tr_b16 v[166:167], v237 offset:1024
    v_mfma_f32_16x16x32_bf16 v[12:15], v[220:223], v[184:187], v[12:15]
    ds_read_b64_tr_b16 v[168:169], v238 offset:0
    v_mfma_f32_16x16x32_bf16 v[76:79], v[224:227], v[184:187], v[76:79]
    buffer_load_dwordx4 v245, s[40:43], s77 offen offset:1024 lds
    v_mfma_f32_16x16x32_bf16 v[16:19], v[212:215], v[188:191], v[16:19]
    ds_read_b64_tr_b16 v[170:171], v238 offset:1024
    v_mfma_f32_16x16x32_bf16 v[80:83], v[216:219], v[188:191], v[80:83]
    ds_read_b64_tr_b16 v[172:173], v239 offset:0
    v_mfma_f32_16x16x32_bf16 v[20:23], v[220:223], v[188:191], v[20:23]
    v_mfma_f32_16x16x32_bf16 v[84:87], v[224:227], v[188:191], v[84:87]
    ds_read_b64_tr_b16 v[174:175], v239 offset:1024
    v_mfma_f32_16x16x32_bf16 v[24:27], v[212:215], v[192:195], v[24:27]
    ds_read_b128 v[128:131], v228 offset:0
    v_mfma_f32_16x16x32_bf16 v[88:91], v[216:219], v[192:195], v[88:91]
    s_add_u32 m0, s68, 65536
    s_movk_i32 s76, 0
    buffer_load_dwordx4 v240, s[36:39], s76 offen offset:0 lds
    v_mfma_f32_16x16x32_bf16 v[28:31], v[220:223], v[192:195], v[28:31]
    ds_read_b128 v[132:135], v228 offset:2048
    v_mfma_f32_16x16x32_bf16 v[92:95], v[224:227], v[192:195], v[92:95]
    ds_read_b128 v[136:139], v228 offset:4096
    v_mfma_f32_16x16x32_bf16 v[32:35], v[212:215], v[196:199], v[32:35]
    v_mfma_f32_16x16x32_bf16 v[96:99], v[216:219], v[196:199], v[96:99]
    ds_read_b128 v[140:143], v228 offset:6144
    v_mfma_f32_16x16x32_bf16 v[36:39], v[220:223], v[196:199], v[36:39]
    ds_read_b128 v[144:147], v228 offset:8192
    v_mfma_f32_16x16x32_bf16 v[100:103], v[224:227], v[196:199], v[100:103]
    buffer_load_dwordx4 v241, s[36:39], s76 offen offset:1024 lds
    v_mfma_f32_16x16x32_bf16 v[40:43], v[212:215], v[200:203], v[40:43]
    ds_read_b128 v[148:151], v228 offset:10240
    v_mfma_f32_16x16x32_bf16 v[104:107], v[216:219], v[200:203], v[104:107]
    ds_read_b128 v[152:155], v228 offset:12288
    v_mfma_f32_16x16x32_bf16 v[44:47], v[220:223], v[200:203], v[44:47]
    v_mfma_f32_16x16x32_bf16 v[108:111], v[224:227], v[200:203], v[108:111]
    ds_read_b128 v[156:159], v228 offset:14336
    v_mfma_f32_16x16x32_bf16 v[48:51], v[212:215], v[204:207], v[48:51]
    v_mfma_f32_16x16x32_bf16 v[112:115], v[216:219], v[204:207], v[112:115]
    v_mfma_f32_16x16x32_bf16 v[52:55], v[220:223], v[204:207], v[52:55]
    v_mfma_f32_16x16x32_bf16 v[116:119], v[224:227], v[204:207], v[116:119]
    v_mfma_f32_16x16x32_bf16 v[56:59], v[212:215], v[208:211], v[56:59]
    v_mfma_f32_16x16x32_bf16 v[120:123], v[216:219], v[208:211], v[120:123]
    v_mfma_f32_16x16x32_bf16 v[60:63], v[220:223], v[208:211], v[60:63]
    v_mfma_f32_16x16x32_bf16 v[124:127], v[224:227], v[208:211], v[124:127]
    s_waitcnt vmcnt(10) lgkmcnt(0)
    s_barrier
    v_mfma_f32_16x16x32_bf16 v[0:3], v[160:163], v[128:131], v[0:3]
    ds_read_b64_tr_b16 v[212:213], v236 offset:16384
    v_mfma_f32_16x16x32_bf16 v[64:67], v[164:167], v[128:131], v[64:67]
    s_add_u32 m0, s69, 0
    s_mul_i32 s77, s70, 0
    buffer_load_dwordx4 v246, s[44:47], s77 offen offset:0 lds
    v_mfma_f32_16x16x32_bf16 v[4:7], v[168:171], v[128:131], v[4:7]
    ds_read_b64_tr_b16 v[214:215], v236 offset:17408
    v_mfma_f32_16x16x32_bf16 v[68:71], v[172:175], v[128:131], v[68:71]
    ds_read_b64_tr_b16 v[216:217], v237 offset:16384
    v_mfma_f32_16x16x32_bf16 v[8:11], v[160:163], v[132:135], v[8:11]
    v_mfma_f32_16x16x32_bf16 v[72:75], v[164:167], v[132:135], v[72:75]
    ds_read_b64_tr_b16 v[218:219], v237 offset:17408
    v_mfma_f32_16x16x32_bf16 v[12:15], v[168:171], v[132:135], v[12:15]
    ds_read_b64_tr_b16 v[220:221], v238 offset:16384
    v_mfma_f32_16x16x32_bf16 v[76:79], v[172:175], v[132:135], v[76:79]
    buffer_load_dwordx4 v247, s[44:47], s77 offen offset:1024 lds
    v_mfma_f32_16x16x32_bf16 v[16:19], v[160:163], v[136:139], v[16:19]
    ds_read_b64_tr_b16 v[222:223], v238 offset:17408
    v_mfma_f32_16x16x32_bf16 v[80:83], v[164:167], v[136:139], v[80:83]
    ds_read_b64_tr_b16 v[224:225], v239 offset:16384
    v_mfma_f32_16x16x32_bf16 v[20:23], v[168:171], v[136:139], v[20:23]
    v_mfma_f32_16x16x32_bf16 v[84:87], v[172:175], v[136:139], v[84:87]
    ds_read_b64_tr_b16 v[226:227], v239 offset:17408
    v_mfma_f32_16x16x32_bf16 v[24:27], v[160:163], v[140:143], v[24:27]
    ds_read_b128 v[180:183], v229 offset:0
    v_mfma_f32_16x16x32_bf16 v[88:91], v[164:167], v[140:143], v[88:91]
    s_add_u32 m0, s68, 65536
    s_movk_i32 s76, 0
    buffer_load_dwordx4 v242, s[36:39], s76 offen offset:2048 lds
    v_mfma_f32_16x16x32_bf16 v[28:31], v[168:171], v[140:143], v[28:31]
    ds_read_b128 v[184:187], v229 offset:2048
    v_mfma_f32_16x16x32_bf16 v[92:95], v[172:175], v[140:143], v[92:95]
    ds_read_b128 v[188:191], v229 offset:4096
    v_mfma_f32_16x16x32_bf16 v[32:35], v[160:163], v[144:147], v[32:35]
    v_mfma_f32_16x16x32_bf16 v[96:99], v[164:167], v[144:147], v[96:99]
    ds_read_b128 v[192:195], v229 offset:6144
    v_mfma_f32_16x16x32_bf16 v[36:39], v[168:171], v[144:147], v[36:39]
    ds_read_b128 v[196:199], v229 offset:8192
    v_mfma_f32_16x16x32_bf16 v[100:103], v[172:175], v[144:147], v[100:103]
    buffer_load_dwordx4 v243, s[36:39], s76 offen offset:3072 lds
    v_mfma_f32_16x16x32_bf16 v[40:43], v[160:163], v[148:151], v[40:43]
    ds_read_b128 v[200:203], v229 offset:10240
    v_mfma_f32_16x16x32_bf16 v[104:107], v[164:167], v[148:151], v[104:107]
    ds_read_b128 v[204:207], v229 offset:12288
    v_mfma_f32_16x16x32_bf16 v[44:47], v[168:171], v[148:151], v[44:47]
    v_mfma_f32_16x16x32_bf16 v[108:111], v[172:175], v[148:151], v[108:111]
    ds_read_b128 v[208:211], v229 offset:14336
    v_mfma_f32_16x16x32_bf16 v[48:51], v[160:163], v[152:155], v[48:51]
    v_mfma_f32_16x16x32_bf16 v[112:115], v[164:167], v[152:155], v[112:115]
    v_mfma_f32_16x16x32_bf16 v[52:55], v[168:171], v[152:155], v[52:55]
    v_mfma_f32_16x16x32_bf16 v[116:119], v[172:175], v[152:155], v[116:119]
    v_mfma_f32_16x16x32_bf16 v[56:59], v[160:163], v[156:159], v[56:59]
    v_mfma_f32_16x16x32_bf16 v[120:123], v[164:167], v[156:159], v[120:123]
    v_mfma_f32_16x16x32_bf16 v[60:63], v[168:171], v[156:159], v[60:63]
    v_mfma_f32_16x16x32_bf16 v[124:127], v[172:175], v[156:159], v[124:127]
    s_waitcnt vmcnt(8) lgkmcnt(0)
    s_barrier
    v_mfma_f32_16x16x32_bf16 v[0:3], v[212:215], v[180:183], v[0:3]
    ds_read_b64_tr_b16 v[160:161], v236 offset:32768
    v_mfma_f32_16x16x32_bf16 v[64:67], v[216:219], v[180:183], v[64:67]
    s_add_u32 m0, s69, 16384
    s_mul_i32 s77, s70, 1
    buffer_load_dwordx4 v246, s[44:47], s77 offen offset:0 lds
    v_mfma_f32_16x16x32_bf16 v[4:7], v[220:223], v[180:183], v[4:7]
    ds_read_b64_tr_b16 v[162:163], v236 offset:33792
    v_mfma_f32_16x16x32_bf16 v[68:71], v[224:227], v[180:183], v[68:71]
    ds_read_b64_tr_b16 v[164:165], v237 offset:32768
    v_mfma_f32_16x16x32_bf16 v[8:11], v[212:215], v[184:187], v[8:11]
    v_mfma_f32_16x16x32_bf16 v[72:75], v[216:219], v[184:187], v[72:75]
    ds_read_b64_tr_b16 v[166:167], v237 offset:33792
    v_mfma_f32_16x16x32_bf16 v[12:15], v[220:223], v[184:187], v[12:15]
    ds_read_b64_tr_b16 v[168:169], v238 offset:32768
    v_mfma_f32_16x16x32_bf16 v[76:79], v[224:227], v[184:187], v[76:79]
    buffer_load_dwordx4 v247, s[44:47], s77 offen offset:1024 lds
    v_mfma_f32_16x16x32_bf16 v[16:19], v[212:215], v[188:191], v[16:19]
    ds_read_b64_tr_b16 v[170:171], v238 offset:33792
    v_mfma_f32_16x16x32_bf16 v[80:83], v[216:219], v[188:191], v[80:83]
    ds_read_b64_tr_b16 v[172:173], v239 offset:32768
    v_mfma_f32_16x16x32_bf16 v[20:23], v[220:223], v[188:191], v[20:23]
    v_mfma_f32_16x16x32_bf16 v[84:87], v[224:227], v[188:191], v[84:87]
    ds_read_b64_tr_b16 v[174:175], v239 offset:33792
    v_mfma_f32_16x16x32_bf16 v[24:27], v[212:215], v[192:195], v[24:27]
    ds_read_b128 v[128:131], v228 offset:32768
    v_mfma_f32_16x16x32_bf16 v[88:91], v[216:219], v[192:195], v[88:91]
    s_add_u32 m0, s68, 0
    s_movk_i32 s76, 128
    buffer_load_dwordx4 v240, s[36:39], s76 offen offset:0 lds
    v_mfma_f32_16x16x32_bf16 v[28:31], v[220:223], v[192:195], v[28:31]
    ds_read_b128 v[132:135], v228 offset:34816
    v_mfma_f32_16x16x32_bf16 v[92:95], v[224:227], v[192:195], v[92:95]
    ds_read_b128 v[136:139], v228 offset:36864
    v_mfma_f32_16x16x32_bf16 v[32:35], v[212:215], v[196:199], v[32:35]
    v_mfma_f32_16x16x32_bf16 v[96:99], v[216:219], v[196:199], v[96:99]
    ds_read_b128 v[140:143], v228 offset:38912
    v_mfma_f32_16x16x32_bf16 v[36:39], v[220:223], v[196:199], v[36:39]
    ds_read_b128 v[144:147], v228 offset:40960
    v_mfma_f32_16x16x32_bf16 v[100:103], v[224:227], v[196:199], v[100:103]
    buffer_load_dwordx4 v241, s[36:39], s76 offen offset:1024 lds
    v_mfma_f32_16x16x32_bf16 v[40:43], v[212:215], v[200:203], v[40:43]
    ds_read_b128 v[148:151], v228 offset:43008
    v_mfma_f32_16x16x32_bf16 v[104:107], v[216:219], v[200:203], v[104:107]
    ds_read_b128 v[152:155], v228 offset:45056
    v_mfma_f32_16x16x32_bf16 v[44:47], v[220:223], v[200:203], v[44:47]
    v_mfma_f32_16x16x32_bf16 v[108:111], v[224:227], v[200:203], v[108:111]
    ds_read_b128 v[156:159], v228 offset:47104
    v_mfma_f32_16x16x32_bf16 v[48:51], v[212:215], v[204:207], v[48:51]
    v_mfma_f32_16x16x32_bf16 v[112:115], v[216:219], v[204:207], v[112:115]
    v_mfma_f32_16x16x32_bf16 v[52:55], v[220:223], v[204:207], v[52:55]
    v_mfma_f32_16x16x32_bf16 v[116:119], v[224:227], v[204:207], v[116:119]
    v_mfma_f32_16x16x32_bf16 v[56:59], v[212:215], v[208:211], v[56:59]
    v_mfma_f32_16x16x32_bf16 v[120:123], v[216:219], v[208:211], v[120:123]
    v_mfma_f32_16x16x32_bf16 v[60:63], v[220:223], v[208:211], v[60:63]
    v_mfma_f32_16x16x32_bf16 v[124:127], v[224:227], v[208:211], v[124:127]
    s_waitcnt vmcnt(10) lgkmcnt(0)
    s_barrier
    v_mfma_f32_16x16x32_bf16 v[0:3], v[160:163], v[128:131], v[0:3]
    ds_read_b64_tr_b16 v[212:213], v236 offset:49152
    v_mfma_f32_16x16x32_bf16 v[64:67], v[164:167], v[128:131], v[64:67]
    s_add_u32 m0, s69, 32768
    s_mul_i32 s77, s70, 2
    buffer_load_dwordx4 v246, s[44:47], s77 offen offset:0 lds
    v_mfma_f32_16x16x32_bf16 v[4:7], v[168:171], v[128:131], v[4:7]
    ds_read_b64_tr_b16 v[214:215], v236 offset:50176
    v_mfma_f32_16x16x32_bf16 v[68:71], v[172:175], v[128:131], v[68:71]
    ds_read_b64_tr_b16 v[216:217], v237 offset:49152
    v_mfma_f32_16x16x32_bf16 v[8:11], v[160:163], v[132:135], v[8:11]
    v_mfma_f32_16x16x32_bf16 v[72:75], v[164:167], v[132:135], v[72:75]
    ds_read_b64_tr_b16 v[218:219], v237 offset:50176
    v_mfma_f32_16x16x32_bf16 v[12:15], v[168:171], v[132:135], v[12:15]
    ds_read_b64_tr_b16 v[220:221], v238 offset:49152
    v_mfma_f32_16x16x32_bf16 v[76:79], v[172:175], v[132:135], v[76:79]
    buffer_load_dwordx4 v247, s[44:47], s77 offen offset:1024 lds
    v_mfma_f32_16x16x32_bf16 v[16:19], v[160:163], v[136:139], v[16:19]
    ds_read_b64_tr_b16 v[222:223], v238 offset:50176
    v_mfma_f32_16x16x32_bf16 v[80:83], v[164:167], v[136:139], v[80:83]
    ds_read_b64_tr_b16 v[224:225], v239 offset:49152
    v_mfma_f32_16x16x32_bf16 v[20:23], v[168:171], v[136:139], v[20:23]
    v_mfma_f32_16x16x32_bf16 v[84:87], v[172:175], v[136:139], v[84:87]
    ds_read_b64_tr_b16 v[226:227], v239 offset:50176
    v_mfma_f32_16x16x32_bf16 v[24:27], v[160:163], v[140:143], v[24:27]
    ds_read_b128 v[180:183], v229 offset:32768
    v_mfma_f32_16x16x32_bf16 v[88:91], v[164:167], v[140:143], v[88:91]
    s_add_u32 m0, s68, 0
    s_movk_i32 s76, 128
    buffer_load_dwordx4 v242, s[36:39], s76 offen offset:2048 lds
    v_mfma_f32_16x16x32_bf16 v[28:31], v[168:171], v[140:143], v[28:31]
    ds_read_b128 v[184:187], v229 offset:34816
    v_mfma_f32_16x16x32_bf16 v[92:95], v[172:175], v[140:143], v[92:95]
    ds_read_b128 v[188:191], v229 offset:36864
    v_mfma_f32_16x16x32_bf16 v[32:35], v[160:163], v[144:147], v[32:35]
    v_mfma_f32_16x16x32_bf16 v[96:99], v[164:167], v[144:147], v[96:99]
    ds_read_b128 v[192:195], v229 offset:38912
    v_mfma_f32_16x16x32_bf16 v[36:39], v[168:171], v[144:147], v[36:39]
    ds_read_b128 v[196:199], v229 offset:40960
    v_mfma_f32_16x16x32_bf16 v[100:103], v[172:175], v[144:147], v[100:103]
    buffer_load_dwordx4 v243, s[36:39], s76 offen offset:3072 lds
    v_mfma_f32_16x16x32_bf16 v[40:43], v[160:163], v[148:151], v[40:43]
    ds_read_b128 v[200:203], v229 offset:43008
    v_mfma_f32_16x16x32_bf16 v[104:107], v[164:167], v[148:151], v[104:107]
    ds_read_b128 v[204:207], v229 offset:45056
    v_mfma_f32_16x16x32_bf16 v[44:47], v[168:171], v[148:151], v[44:47]
    v_mfma_f32_16x16x32_bf16 v[108:111], v[172:175], v[148:151], v[108:111]
    ds_read_b128 v[208:211], v229 offset:47104
    v_mfma_f32_16x16x32_bf16 v[48:51], v[160:163], v[152:155], v[48:51]
    v_mfma_f32_16x16x32_bf16 v[112:115], v[164:167], v[152:155], v[112:115]
    v_mfma_f32_16x16x32_bf16 v[52:55], v[168:171], v[152:155], v[52:55]
    v_mfma_f32_16x16x32_bf16 v[116:119], v[172:175], v[152:155], v[116:119]
    v_mfma_f32_16x16x32_bf16 v[56:59], v[160:163], v[156:159], v[56:59]
    v_mfma_f32_16x16x32_bf16 v[120:123], v[164:167], v[156:159], v[120:123]
    v_mfma_f32_16x16x32_bf16 v[60:63], v[168:171], v[156:159], v[60:63]
    v_mfma_f32_16x16x32_bf16 v[124:127], v[172:175], v[156:159], v[124:127]
    s_waitcnt vmcnt(8) lgkmcnt(0)
    s_barrier
    v_mfma_f32_16x16x32_bf16 v[0:3], v[212:215], v[180:183], v[0:3]
    v_xor_b32 v236, 128, v254
    v_xor_b32 v237, 160, v254
    v_xor_b32 v238, 192, v254
    v_xor_b32 v239, 224, v254
    v_mfma_f32_16x16x32_bf16 v[64:67], v[216:219], v[180:183], v[64:67]
    ds_read_b128 v[172:175], v250 offset:0
    s_add_u32 m0, s69, 49152
    s_mul_i32 s77, s70, 3
    buffer_load_dwordx4 v246, s[44:47], s77 offen offset:0 lds
    v_mfma_f32_16x16x32_bf16 v[4:7], v[220:223], v[180:183], v[4:7]
    ds_read_b128 v[176:179], v250 offset:2048
    v_mfma_f32_16x16x32_bf16 v[68:71], v[224:227], v[180:183], v[68:71]
    ds_read_b64_tr_b16 v[128:129], v232 offset:0
    v_mfma_f32_16x16x32_bf16 v[8:11], v[212:215], v[184:187], v[8:11]
    ds_read_b64_tr_b16 v[130:131], v232 offset:1024
    buffer_load_dwordx4 v247, s[44:47], s77 offen offset:1024 lds
    v_mfma_f32_16x16x32_bf16 v[72:75], v[216:219], v[184:187], v[72:75]
    ds_read_b64_tr_b16 v[132:133], v233 offset:0
    v_mfma_f32_16x16x32_bf16 v[12:15], v[220:223], v[184:187], v[12:15]
    ds_read_b64_tr_b16 v[134:135], v233 offset:1024
    v_cvt_pk_bf16_f32 v67, v66, v67
    v_cvt_pk_bf16_f32 v66, v64, v65
    v_mfma_f32_16x16x32_bf16 v[76:79], v[224:227], v[184:187], v[76:79]
    ds_read_b64_tr_b16 v[136:137], v234 offset:0
    v_cvt_pk_bf16_f32 v64, v0, v1
    v_cvt_pk_bf16_f32 v65, v2, v3
    v_mfma_f32_16x16x32_bf16 v[16:19], v[212:215], v[188:191], v[16:19]
    ds_read_b64_tr_b16 v[138:139], v234 offset:1024
    s_add_u32 m0, s68, 32768
    s_movk_i32 s76, 256
    buffer_load_dwordx4 v240, s[36:39], s76 offen offset:0 lds
    v_mfma_f32_16x16x32_bf16 v[80:83], v[216:219], v[188:191], v[80:83]
    ds_read_b64_tr_b16 v[140:141], v235 offset:0
    v_cvt_pk_bf16_f32 v71, v70, v71
    v_cvt_pk_bf16_f32 v70, v68, v69
    v_mfma_f32_16x16x32_bf16 v[20:23], v[220:223], v[188:191], v[20:23]
    ds_read_b64_tr_b16 v[142:143], v235 offset:1024
    v_cvt_pk_bf16_f32 v68, v4, v5
    v_cvt_pk_bf16_f32 v69, v6, v7
    v_mfma_f32_16x16x32_bf16 v[84:87], v[224:227], v[188:191], v[84:87]
    ds_read_b64_tr_b16 v[144:145], v236 offset:0
    buffer_load_dwordx4 v241, s[36:39], s76 offen offset:1024 lds
    v_mfma_f32_16x16x32_bf16 v[24:27], v[212:215], v[192:195], v[24:27]
    ds_read_b64_tr_b16 v[146:147], v236 offset:1024
    v_cvt_pk_bf16_f32 v75, v74, v75
    v_cvt_pk_bf16_f32 v74, v72, v73
    v_mfma_f32_16x16x32_bf16 v[88:91], v[216:219], v[192:195], v[88:91]
    v_cvt_pk_bf16_f32 v72, v8, v9
    v_cvt_pk_bf16_f32 v73, v10, v11
    v_mfma_f32_16x16x32_bf16 v[28:31], v[220:223], v[192:195], v[28:31]
    ds_read_b64_tr_b16 v[148:149], v237 offset:0
    v_mfma_f32_16x16x32_bf16 v[92:95], v[224:227], v[192:195], v[92:95]
    ds_read_b64_tr_b16 v[150:151], v237 offset:1024
    v_cvt_pk_bf16_f32 v79, v78, v79
    v_cvt_pk_bf16_f32 v78, v76, v77
    v_mfma_f32_16x16x32_bf16 v[32:35], v[212:215], v[196:199], v[32:35]
    ds_read_b64_tr_b16 v[152:153], v238 offset:0
    v_cvt_pk_bf16_f32 v76, v12, v13
    v_cvt_pk_bf16_f32 v77, v14, v15
    v_mfma_f32_16x16x32_bf16 v[96:99], v[216:219], v[196:199], v[96:99]
    ds_read_b64_tr_b16 v[154:155], v238 offset:1024
    v_mfma_f32_16x16x32_bf16 v[36:39], v[220:223], v[196:199], v[36:39]
    ds_read_b64_tr_b16 v[156:157], v239 offset:0
    v_cvt_pk_bf16_f32 v83, v82, v83
    v_cvt_pk_bf16_f32 v82, v80, v81
    v_mfma_f32_16x16x32_bf16 v[100:103], v[224:227], v[196:199], v[100:103]
    ds_read_b64_tr_b16 v[158:159], v239 offset:1024
    v_cvt_pk_bf16_f32 v80, v16, v17
    v_cvt_pk_bf16_f32 v81, v18, v19
    v_mfma_f32_16x16x32_bf16 v[40:43], v[212:215], v[200:203], v[40:43]
    ds_read_b64_tr_b16 v[160:161], v232 offset:8192
    s_add_u32 s78, s73, 0
    buffer_store_dwordx4 v[64:67], v255, s[52:55], s78 offen offset:0 sc1
    v_mfma_f32_16x16x32_bf16 v[104:107], v[216:219], v[200:203], v[104:107]
    ds_read_b64_tr_b16 v[162:163], v232 offset:9216
    v_cvt_pk_bf16_f32 v87, v86, v87
    v_cvt_pk_bf16_f32 v86, v84, v85
    v_mfma_f32_16x16x32_bf16 v[44:47], v[220:223], v[200:203], v[44:47]
    ds_read_b64_tr_b16 v[164:165], v233 offset:8192
    v_cvt_pk_bf16_f32 v84, v20, v21
    v_cvt_pk_bf16_f32 v85, v22, v23
    s_add_u32 s78, s73, 0
    buffer_store_dwordx4 v[68:71], v255, s[52:55], s78 offen offset:1024 sc1
    v_mfma_f32_16x16x32_bf16 v[108:111], v[224:227], v[200:203], v[108:111]
    ds_read_b64_tr_b16 v[166:167], v233 offset:9216
    v_mfma_f32_16x16x32_bf16 v[48:51], v[212:215], v[204:207], v[48:51]
    ds_read_b64_tr_b16 v[168:169], v234 offset:8192
    v_cvt_pk_bf16_f32 v91, v90, v91
    v_cvt_pk_bf16_f32 v90, v88, v89
    s_add_u32 s78, s73, 0
    buffer_store_dwordx4 v[72:75], v255, s[52:55], s78 offen offset:2048 sc1
    v_mfma_f32_16x16x32_bf16 v[112:115], v[216:219], v[204:207], v[112:115]
    ds_read_b64_tr_b16 v[170:171], v234 offset:9216
    v_cvt_pk_bf16_f32 v88, v24, v25
    v_cvt_pk_bf16_f32 v89, v26, v27
    v_mfma_f32_16x16x32_bf16 v[52:55], v[220:223], v[204:207], v[52:55]
    s_add_u32 s78, s73, 0
    buffer_store_dwordx4 v[76:79], v255, s[52:55], s78 offen offset:3072 sc1
    v_mfma_f32_16x16x32_bf16 v[116:119], v[224:227], v[204:207], v[116:119]
    v_cvt_pk_bf16_f32 v95, v94, v95
    v_cvt_pk_bf16_f32 v94, v92, v93
    v_mfma_f32_16x16x32_bf16 v[56:59], v[212:215], v[208:211], v[56:59]
    v_cvt_pk_bf16_f32 v92, v28, v29
    v_cvt_pk_bf16_f32 v93, v30, v31
    v_mfma_f32_16x16x32_bf16 v[120:123], v[216:219], v[208:211], v[120:123]
    v_mfma_f32_16x16x32_bf16 v[60:63], v[220:223], v[208:211], v[60:63]
    v_mfma_f32_16x16x32_bf16 v[124:127], v[224:227], v[208:211], v[124:127]
    s_branch fmain_p2
fmain_p1v:
    s_waitcnt vmcnt(6) lgkmcnt(0)
    s_barrier
    v_mfma_f32_16x16x32_bf16 v[0:3], v[128:131], v[160:163], 0
    ds_read_b64_tr_b16 v[212:213], v236 offset:16384
    v_mfma_f32_16x16x32_bf16 v[64:67], v[132:135], v[160:163], 0
    s_add_u32 m0, s69, 49152
    s_mov_b32 s77, 786432
    buffer_load_dwordx4 v244, s[40:43], s77 offen offset:0 lds
    v_mfma_f32_16x16x32_bf16 v[4:7], v[128:131], v[164:167], 0
    ds_read_b64_tr_b16 v[214:215], v236 offset:17408
    v_mfma_f32_16x16x32_bf16 v[68:71], v[132:135], v[164:167], 0
    ds_read_b64_tr_b16 v[216:217], v237 offset:16384
    v_mfma_f32_16x16x32_bf16 v[8:11], v[128:131], v[168:171], 0
    buffer_load_dwordx4 v245, s[40:43], s77 offen offset:1024 lds
    v_mfma_f32_16x16x32_bf16 v[72:75], v[132:135], v[168:171], 0
    ds_read_b64_tr_b16 v[218:219], v237 offset:17408
    v_mfma_f32_16x16x32_bf16 v[12:15], v[128:131], v[172:175], 0
    ds_read_b64_tr_b16 v[220:221], v238 offset:16384
    v_mfma_f32_16x16x32_bf16 v[76:79], v[132:135], v[172:175], 0
    s_add_u32 m0, s68, 65536
    s_movk_i32 s76, 256
    buffer_load_dwordx4 v240, s[32:35], s76 offen offset:0 lds
    v_mfma_f32_16x16x32_bf16 v[16:19], v[136:139], v[160:163], 0
    ds_read_b64_tr_b16 v[222:223], v238 offset:17408
    v_mfma_f32_16x16x32_bf16 v[80:83], v[140:143], v[160:163], 0
    ds_read_b64_tr_b16 v[224:225], v239 offset:16384
    v_mfma_f32_16x16x32_bf16 v[20:23], v[136:139], v[164:167], 0
    buffer_load_dwordx4 v241, s[32:35], s76 offen offset:1024 lds
    v_mfma_f32_16x16x32_bf16 v[84:87], v[140:143], v[164:167], 0
    ds_read_b64_tr_b16 v[226:227], v239 offset:17408
    v_mfma_f32_16x16x32_bf16 v[24:27], v[136:139], v[168:171], 0
    ds_read_b128 v[180:183], v229 offset:0
    v_mfma_f32_16x16x32_bf16 v[88:91], v[140:143], v[168:171], 0
    s_add_u32 m0, s68, 65536
    s_movk_i32 s76, 256
    buffer_load_dwordx4 v242, s[32:35], s76 offen offset:2048 lds
    v_mfma_f32_16x16x32_bf16 v[28:31], v[136:139], v[172:175], 0
    ds_read_b128 v[184:187], v229 offset:2048
    v_mfma_f32_16x16x32_bf16 v[92:95], v[140:143], v[172:175], 0
    ds_read_b128 v[188:191], v229 offset:4096
    v_mfma_f32_16x16x32_bf16 v[32:35], v[144:147], v[160:163], 0
    buffer_load_dwordx4 v243, s[32:35], s76 offen offset:3072 lds
    v_mfma_f32_16x16x32_bf16 v[96:99], v[148:151], v[160:163], 0
    ds_read_b128 v[192:195], v229 offset:6144
    v_mfma_f32_16x16x32_bf16 v[36:39], v[144:147], v[164:167], 0
    ds_read_b128 v[196:199], v229 offset:8192
    v_mfma_f32_16x16x32_bf16 v[100:103], v[148:151], v[164:167], 0
    s_add_u32 m0, s69, 0
    s_mov_b32 s77, 1048576
    buffer_load_dwordx4 v244, s[40:43], s77 offen offset:0 lds
    v_mfma_f32_16x16x32_bf16 v[40:43], v[144:147], v[168:171], 0
    ds_read_b128 v[200:203], v229 offset:10240
    v_mfma_f32_16x16x32_bf16 v[104:107], v[148:151], v[168:171], 0
    ds_read_b128 v[204:207], v229 offset:12288
    v_mfma_f32_16x16x32_bf16 v[44:47], v[144:147], v[172:175], 0
    buffer_load_dwordx4 v245, s[40:43], s77 offen offset:1024 lds
    v_mfma_f32_16x16x32_bf16 v[108:111], v[148:151], v[172:175], 0
    ds_read_b128 v[208:211], v229 offset:14336
    v_mfma_f32_16x16x32_bf16 v[48:51], v[152:155], v[160:163], 0
    v_mfma_f32_16x16x32_bf16 v[112:115], v[156:159], v[160:163], 0
    v_mfma_f32_16x16x32_bf16 v[52:55], v[152:155], v[164:167], 0
    v_mfma_f32_16x16x32_bf16 v[116:119], v[156:159], v[164:167], 0
    v_mfma_f32_16x16x32_bf16 v[56:59], v[152:155], v[168:171], 0
    v_mfma_f32_16x16x32_bf16 v[120:123], v[156:159], v[168:171], 0
    v_mfma_f32_16x16x32_bf16 v[60:63], v[152:155], v[172:175], 0
    v_mfma_f32_16x16x32_bf16 v[124:127], v[156:159], v[172:175], 0
    s_waitcnt vmcnt(8) lgkmcnt(0)
    s_barrier
    v_mfma_f32_16x16x32_bf16 v[0:3], v[180:183], v[212:215], v[0:3]
    ds_read_b64_tr_b16 v[160:161], v236 offset:32768
    v_mfma_f32_16x16x32_bf16 v[64:67], v[184:187], v[212:215], v[64:67]
    s_add_u32 m0, s69, 16384
    s_mov_b32 s77, 1310720
    buffer_load_dwordx4 v244, s[40:43], s77 offen offset:0 lds
    v_mfma_f32_16x16x32_bf16 v[4:7], v[180:183], v[216:219], v[4:7]
    ds_read_b64_tr_b16 v[162:163], v236 offset:33792
    v_mfma_f32_16x16x32_bf16 v[68:71], v[184:187], v[216:219], v[68:71]
    ds_read_b64_tr_b16 v[164:165], v237 offset:32768
    v_mfma_f32_16x16x32_bf16 v[8:11], v[180:183], v[220:223], v[8:11]
    v_mfma_f32_16x16x32_bf16 v[72:75], v[184:187], v[220:223], v[72:75]
    ds_read_b64_tr_b16 v[166:167], v237 offset:33792
    v_mfma_f32_16x16x32_bf16 v[12:15], v[180:183], v[224:227], v[12:15]
    ds_read_b64_tr_b16 v[168:169], v238 offset:32768
    v_mfma_f32_16x16x32_bf16 v[76:79], v[184:187], v[224:227], v[76:79]
    buffer_load_dwordx4 v245, s[40:43], s77 offen offset:1024 lds
    v_mfma_f32_16x16x32_bf16 v[16:19], v[188:191], v[212:215], v[16:19]
    ds_read_b64_tr_b16 v[170:171], v238 offset:33792
    v_mfma_f32_16x16x32_bf16 v[80:83], v[192:195], v[212:215], v[80:83]
    ds_read_b64_tr_b16 v[172:173], v239 offset:32768
    v_mfma_f32_16x16x32_bf16 v[20:23], v[188:191], v[216:219], v[20:23]
    v_mfma_f32_16x16x32_bf16 v[84:87], v[192:195], v[216:219], v[84:87]
    ds_read_b64_tr_b16 v[174:175], v239 offset:33792
    v_mfma_f32_16x16x32_bf16 v[24:27], v[188:191], v[220:223], v[24:27]
    ds_read_b128 v[128:131], v228 offset:32768
    v_mfma_f32_16x16x32_bf16 v[88:91], v[192:195], v[220:223], v[88:91]
    s_add_u32 m0, s68, 0
    s_movk_i32 s76, 384
    buffer_load_dwordx4 v240, s[32:35], s76 offen offset:0 lds
    v_mfma_f32_16x16x32_bf16 v[28:31], v[188:191], v[224:227], v[28:31]
    ds_read_b128 v[132:135], v228 offset:34816
    v_mfma_f32_16x16x32_bf16 v[92:95], v[192:195], v[224:227], v[92:95]
    ds_read_b128 v[136:139], v228 offset:36864
    v_mfma_f32_16x16x32_bf16 v[32:35], v[196:199], v[212:215], v[32:35]
    v_mfma_f32_16x16x32_bf16 v[96:99], v[200:203], v[212:215], v[96:99]
    ds_read_b128 v[140:143], v228 offset:38912
    v_mfma_f32_16x16x32_bf16 v[36:39], v[196:199], v[216:219], v[36:39]
    ds_read_b128 v[144:147], v228 offset:40960
    v_mfma_f32_16x16x32_bf16 v[100:103], v[200:203], v[216:219], v[100:103]
    buffer_load_dwordx4 v241, s[32:35], s76 offen offset:1024 lds
    v_mfma_f32_16x16x32_bf16 v[40:43], v[196:199], v[220:223], v[40:43]
    ds_read_b128 v[148:151], v228 offset:43008
    v_mfma_f32_16x16x32_bf16 v[104:107], v[200:203], v[220:223], v[104:107]
    ds_read_b128 v[152:155], v228 offset:45056
    v_mfma_f32_16x16x32_bf16 v[44:47], v[196:199], v[224:227], v[44:47]
    v_mfma_f32_16x16x32_bf16 v[108:111], v[200:203], v[224:227], v[108:111]
    ds_read_b128 v[156:159], v228 offset:47104
    v_mfma_f32_16x16x32_bf16 v[48:51], v[204:207], v[212:215], v[48:51]
    v_mfma_f32_16x16x32_bf16 v[112:115], v[208:211], v[212:215], v[112:115]
    v_mfma_f32_16x16x32_bf16 v[52:55], v[204:207], v[216:219], v[52:55]
    v_mfma_f32_16x16x32_bf16 v[116:119], v[208:211], v[216:219], v[116:119]
    v_mfma_f32_16x16x32_bf16 v[56:59], v[204:207], v[220:223], v[56:59]
    v_mfma_f32_16x16x32_bf16 v[120:123], v[208:211], v[220:223], v[120:123]
    v_mfma_f32_16x16x32_bf16 v[60:63], v[204:207], v[224:227], v[60:63]
    v_mfma_f32_16x16x32_bf16 v[124:127], v[208:211], v[224:227], v[124:127]
    s_waitcnt vmcnt(10) lgkmcnt(0)
    s_barrier
    v_mfma_f32_16x16x32_bf16 v[0:3], v[128:131], v[160:163], v[0:3]
    ds_read_b64_tr_b16 v[212:213], v236 offset:49152
    v_mfma_f32_16x16x32_bf16 v[64:67], v[132:135], v[160:163], v[64:67]
    s_add_u32 m0, s69, 32768
    s_mov_b32 s77, 1572864
    buffer_load_dwordx4 v244, s[40:43], s77 offen offset:0 lds
    v_mfma_f32_16x16x32_bf16 v[4:7], v[128:131], v[164:167], v[4:7]
    ds_read_b64_tr_b16 v[214:215], v236 offset:50176
    v_mfma_f32_16x16x32_bf16 v[68:71], v[132:135], v[164:167], v[68:71]
    ds_read_b64_tr_b16 v[216:217], v237 offset:49152
    v_mfma_f32_16x16x32_bf16 v[8:11], v[128:131], v[168:171], v[8:11]
    v_mfma_f32_16x16x32_bf16 v[72:75], v[132:135], v[168:171], v[72:75]
    ds_read_b64_tr_b16 v[218:219], v237 offset:50176
    v_mfma_f32_16x16x32_bf16 v[12:15], v[128:131], v[172:175], v[12:15]
    ds_read_b64_tr_b16 v[220:221], v238 offset:49152
    v_mfma_f32_16x16x32_bf16 v[76:79], v[132:135], v[172:175], v[76:79]
    buffer_load_dwordx4 v245, s[40:43], s77 offen offset:1024 lds
    v_mfma_f32_16x16x32_bf16 v[16:19], v[136:139], v[160:163], v[16:19]
    ds_read_b64_tr_b16 v[222:223], v238 offset:50176
    v_mfma_f32_16x16x32_bf16 v[80:83], v[140:143], v[160:163], v[80:83]
    ds_read_b64_tr_b16 v[224:225], v239 offset:49152
    v_mfma_f32_16x16x32_bf16 v[20:23], v[136:139], v[164:167], v[20:23]
    v_mfma_f32_16x16x32_bf16 v[84:87], v[140:143], v[164:167], v[84:87]
    ds_read_b64_tr_b16 v[226:227], v239 offset:50176
    v_mfma_f32_16x16x32_bf16 v[24:27], v[136:139], v[168:171], v[24:27]
    ds_read_b128 v[180:183], v229 offset:32768
    v_mfma_f32_16x16x32_bf16 v[88:91], v[140:143], v[168:171], v[88:91]
    s_add_u32 m0, s68, 0
    s_movk_i32 s76, 384
    buffer_load_dwordx4 v242, s[32:35], s76 offen offset:2048 lds
    v_mfma_f32_16x16x32_bf16 v[28:31], v[136:139], v[172:175], v[28:31]
    ds_read_b128 v[184:187], v229 offset:34816
    v_mfma_f32_16x16x32_bf16 v[92:95], v[140:143], v[172:175], v[92:95]
    ds_read_b128 v[188:191], v229 offset:36864
    v_mfma_f32_16x16x32_bf16 v[32:35], v[144:147], v[160:163], v[32:35]
    v_mfma_f32_16x16x32_bf16 v[96:99], v[148:151], v[160:163], v[96:99]
    ds_read_b128 v[192:195], v229 offset:38912
    v_mfma_f32_16x16x32_bf16 v[36:39], v[144:147], v[164:167], v[36:39]
    ds_read_b128 v[196:199], v229 offset:40960
    v_mfma_f32_16x16x32_bf16 v[100:103], v[148:151], v[164:167], v[100:103]
    buffer_load_dwordx4 v243, s[32:35], s76 offen offset:3072 lds
    v_mfma_f32_16x16x32_bf16 v[40:43], v[144:147], v[168:171], v[40:43]
    ds_read_b128 v[200:203], v229 offset:43008
    v_mfma_f32_16x16x32_bf16 v[104:107], v[148:151], v[168:171], v[104:107]
    ds_read_b128 v[204:207], v229 offset:45056
    v_mfma_f32_16x16x32_bf16 v[44:47], v[144:147], v[172:175], v[44:47]
    v_mfma_f32_16x16x32_bf16 v[108:111], v[148:151], v[172:175], v[108:111]
    ds_read_b128 v[208:211], v229 offset:47104
    v_mfma_f32_16x16x32_bf16 v[48:51], v[152:155], v[160:163], v[48:51]
    v_mfma_f32_16x16x32_bf16 v[112:115], v[156:159], v[160:163], v[112:115]
    v_mfma_f32_16x16x32_bf16 v[52:55], v[152:155], v[164:167], v[52:55]
    v_mfma_f32_16x16x32_bf16 v[116:119], v[156:159], v[164:167], v[116:119]
    v_mfma_f32_16x16x32_bf16 v[56:59], v[152:155], v[168:171], v[56:59]
    v_mfma_f32_16x16x32_bf16 v[120:123], v[156:159], v[168:171], v[120:123]
    v_mfma_f32_16x16x32_bf16 v[60:63], v[152:155], v[172:175], v[60:63]
    v_mfma_f32_16x16x32_bf16 v[124:127], v[156:159], v[172:175], v[124:127]
    s_waitcnt vmcnt(8) lgkmcnt(0)
    s_barrier
    v_mfma_f32_16x16x32_bf16 v[0:3], v[180:183], v[212:215], v[0:3]
    ds_read_b64_tr_b16 v[160:161], v236 offset:0
    v_mfma_f32_16x16x32_bf16 v[64:67], v[184:187], v[212:215], v[64:67]
    s_add_u32 m0, s69, 49152
    s_mov_b32 s77, 1835008
    buffer_load_dwordx4 v244, s[40:43], s77 offen offset:0 lds
    v_mfma_f32_16x16x32_bf16 v[4:7], v[180:183], v[216:219], v[4:7]
    ds_read_b64_tr_b16 v[162:163], v236 offset:1024
    v_mfma_f32_16x16x32_bf16 v[68:71], v[184:187], v[216:219], v[68:71]
    ds_read_b64_tr_b16 v[164:165], v237 offset:0
    v_mfma_f32_16x16x32_bf16 v[8:11], v[180:183], v[220:223], v[8:11]
    v_mfma_f32_16x16x32_bf16 v[72:75], v[184:187], v[220:223], v[72:75]
    ds_read_b64_tr_b16 v[166:167], v237 offset:1024
    v_mfma_f32_16x16x32_bf16 v[12:15], v[180:183], v[224:227], v[12:15]
    ds_read_b64_tr_b16 v[168:169], v238 offset:0
    v_mfma_f32_16x16x32_bf16 v[76:79], v[184:187], v[224:227], v[76:79]
    buffer_load_dwordx4 v245, s[40:43], s77 offen offset:1024 lds
    v_mfma_f32_16x16x32_bf16 v[16:19], v[188:191], v[212:215], v[16:19]
    ds_read_b64_tr_b16 v[170:171], v238 offset:1024
    v_mfma_f32_16x16x32_bf16 v[80:83], v[192:195], v[212:215], v[80:83]
    ds_read_b64_tr_b16 v[172:173], v239 offset:0
    v_mfma_f32_16x16x32_bf16 v[20:23], v[188:191], v[216:219], v[20:23]
    v_mfma_f32_16x16x32_bf16 v[84:87], v[192:195], v[216:219], v[84:87]
    ds_read_b64_tr_b16 v[174:175], v239 offset:1024
    v_mfma_f32_16x16x32_bf16 v[24:27], v[188:191], v[220:223], v[24:27]
    ds_read_b128 v[128:131], v230 offset:0
    v_mfma_f32_16x16x32_bf16 v[88:91], v[192:195], v[220:223], v[88:91]
    s_add_u32 m0, s68, 32768
    s_movk_i32 s76, 512
    buffer_load_dwordx4 v240, s[32:35], s76 offen offset:0 lds
    v_mfma_f32_16x16x32_bf16 v[28:31], v[188:191], v[224:227], v[28:31]
    ds_read_b128 v[132:135], v230 offset:2048
    s_cmp_eq_u32 s28, 3
    s_cbranch_scc1 Lgated_tch_9
Lgated_tch_9_r:
    v_mfma_f32_16x16x32_bf16 v[92:95], v[192:195], v[224:227], v[92:95]
    ds_read_b128 v[136:139], v230 offset:4096
    v_mfma_f32_16x16x32_bf16 v[32:35], v[196:199], v[212:215], v[32:35]
    v_mfma_f32_16x16x32_bf16 v[96:99], v[200:203], v[212:215], v[96:99]
    ds_read_b128 v[140:143], v230 offset:6144
    v_mfma_f32_16x16x32_bf16 v[36:39], v[196:199], v[216:219], v[36:39]
    ds_read_b128 v[144:147], v230 offset:8192
    v_mfma_f32_16x16x32_bf16 v[100:103], v[200:203], v[216:219], v[100:103]
    buffer_load_dwordx4 v241, s[32:35], s76 offen offset:1024 lds
    v_mfma_f32_16x16x32_bf16 v[40:43], v[196:199], v[220:223], v[40:43]
    ds_read_b128 v[148:151], v230 offset:10240
    v_mfma_f32_16x16x32_bf16 v[104:107], v[200:203], v[220:223], v[104:107]
    ds_read_b128 v[152:155], v230 offset:12288
    v_mfma_f32_16x16x32_bf16 v[44:47], v[196:199], v[224:227], v[44:47]
    v_mfma_f32_16x16x32_bf16 v[108:111], v[200:203], v[224:227], v[108:111]
    ds_read_b128 v[156:159], v230 offset:14336
    v_mfma_f32_16x16x32_bf16 v[48:51], v[204:207], v[212:215], v[48:51]
    v_mfma_f32_16x16x32_bf16 v[112:115], v[208:211], v[212:215], v[112:115]
    v_mfma_f32_16x16x32_bf16 v[52:55], v[204:207], v[216:219], v[52:55]
    v_mfma_f32_16x16x32_bf16 v[116:119], v[208:211], v[216:219], v[116:119]
    v_mfma_f32_16x16x32_bf16 v[56:59], v[204:207], v[220:223], v[56:59]
    v_mfma_f32_16x16x32_bf16 v[120:123], v[208:211], v[220:223], v[120:123]
    v_mfma_f32_16x16x32_bf16 v[60:63], v[204:207], v[224:227], v[60:63]
    v_mfma_f32_16x16x32_bf16 v[124:127], v[208:211], v[224:227], v[124:127]
    s_waitcnt vmcnt(10) lgkmcnt(0)
    s_barrier
    v_mfma_f32_16x16x32_bf16 v[0:3], v[128:131], v[160:163], v[0:3]
    ds_read_b64_tr_b16 v[212:213], v236 offset:16384
    v_mfma_f32_16x16x32_bf16 v[64:67], v[132:135], v[160:163], v[64:67]
    s_add_u32 m0, s69, 0
    s_mov_b32 s77, 2097152
    buffer_load_dwordx4 v244, s[40:43], s77 offen offset:0 lds
    v_mfma_f32_16x16x32_bf16 v[4:7], v[128:131], v[164:167], v[4:7]
    ds_read_b64_tr_b16 v[214:215], v236 offset:17408
    v_mfma_f32_16x16x32_bf16 v[68:71], v[132:135], v[164:167], v[68:71]
    ds_read_b64_tr_b16 v[216:217], v237 offset:16384
    v_mfma_f32_16x16x32_bf16 v[8:11], v[128:131], v[168:171], v[8:11]
    v_mfma_f32_16x16x32_bf16 v[72:75], v[132:135], v[168:171], v[72:75]
    ds_read_b64_tr_b16 v[218:219], v237 offset:17408
    v_mfma_f32_16x16x32_bf16 v[12:15], v[128:131], v[172:175], v[12:15]
    ds_read_b64_tr_b16 v[220:221], v238 offset:16384
    v_mfma_f32_16x16x32_bf16 v[76:79], v[132:135], v[172:175], v[76:79]
    buffer_load_dwordx4 v245, s[40:43], s77 offen offset:1024 lds
    v_mfma_f32_16x16x32_bf16 v[16:19], v[136:139], v[160:163], v[16:19]
    ds_read_b64_tr_b16 v[222:223], v238 offset:17408
    v_mfma_f32_16x16x32_bf16 v[80:83], v[140:143], v[160:163], v[80:83]
    ds_read_b64_tr_b16 v[224:225], v239 offset:16384
    v_mfma_f32_16x16x32_bf16 v[20:23], v[136:139], v[164:167], v[20:23]
    v_mfma_f32_16x16x32_bf16 v[84:87], v[140:143], v[164:167], v[84:87]
    ds_read_b64_tr_b16 v[226:227], v239 offset:17408
    v_mfma_f32_16x16x32_bf16 v[24:27], v[136:139], v[168:171], v[24:27]
    ds_read_b128 v[180:183], v231 offset:0
    v_mfma_f32_16x16x32_bf16 v[88:91], v[140:143], v[168:171], v[88:91]
    s_add_u32 m0, s68, 32768
    s_movk_i32 s76, 512
    buffer_load_dwordx4 v242, s[32:35], s76 offen offset:2048 lds
    v_mfma_f32_16x16x32_bf16 v[28:31], v[136:139], v[172:175], v[28:31]
    ds_read_b128 v[184:187], v231 offset:2048
    s_cmp_eq_u32 s28, 4
    s_cbranch_scc1 Lgated_tch_10
Lgated_tch_10_r:
    v_mfma_f32_16x16x32_bf16 v[92:95], v[140:143], v[172:175], v[92:95]
    ds_read_b128 v[188:191], v231 offset:4096
    v_mfma_f32_16x16x32_bf16 v[32:35], v[144:147], v[160:163], v[32:35]
    v_mfma_f32_16x16x32_bf16 v[96:99], v[148:151], v[160:163], v[96:99]
    ds_read_b128 v[192:195], v231 offset:6144
    v_mfma_f32_16x16x32_bf16 v[36:39], v[144:147], v[164:167], v[36:39]
    ds_read_b128 v[196:199], v231 offset:8192
    v_mfma_f32_16x16x32_bf16 v[100:103], v[148:151], v[164:167], v[100:103]
    buffer_load_dwordx4 v243, s[32:35], s76 offen offset:3072 lds
    v_mfma_f32_16x16x32_bf16 v[40:43], v[144:147], v[168:171], v[40:43]
    ds_read_b128 v[200:203], v231 offset:10240
    v_mfma_f32_16x16x32_bf16 v[104:107], v[148:151], v[168:171], v[104:107]
    ds_read_b128 v[204:207], v231 offset:12288
    v_mfma_f32_16x16x32_bf16 v[44:47], v[144:147], v[172:175], v[44:47]
    v_mfma_f32_16x16x32_bf16 v[108:111], v[148:151], v[172:175], v[108:111]
    ds_read_b128 v[208:211], v231 offset:14336
    v_mfma_f32_16x16x32_bf16 v[48:51], v[152:155], v[160:163], v[48:51]
    v_mfma_f32_16x16x32_bf16 v[112:115], v[156:159], v[160:163], v[112:115]
    v_mfma_f32_16x16x32_bf16 v[52:55], v[152:155], v[164:167], v[52:55]
    v_mfma_f32_16x16x32_bf16 v[116:119], v[156:159], v[164:167], v[116:119]
    v_mfma_f32_16x16x32_bf16 v[56:59], v[152:155], v[168:171], v[56:59]
    v_mfma_f32_16x16x32_bf16 v[120:123], v[156:159], v[168:171], v[120:123]
    v_mfma_f32_16x16x32_bf16 v[60:63], v[152:155], v[172:175], v[60:63]
    v_mfma_f32_16x16x32_bf16 v[124:127], v[156:159], v[172:175], v[124:127]
    s_waitcnt vmcnt(8) lgkmcnt(0)
    s_barrier
    v_mfma_f32_16x16x32_bf16 v[0:3], v[180:183], v[212:215], v[0:3]
    ds_read_b64_tr_b16 v[160:161], v236 offset:32768
    v_mfma_f32_16x16x32_bf16 v[64:67], v[184:187], v[212:215], v[64:67]
    s_add_u32 m0, s69, 16384
    s_mov_b32 s77, 2359296
    buffer_load_dwordx4 v244, s[40:43], s77 offen offset:0 lds
    v_mfma_f32_16x16x32_bf16 v[4:7], v[180:183], v[216:219], v[4:7]
    ds_read_b64_tr_b16 v[162:163], v236 offset:33792
    v_mfma_f32_16x16x32_bf16 v[68:71], v[184:187], v[216:219], v[68:71]
    ds_read_b64_tr_b16 v[164:165], v237 offset:32768
    v_mfma_f32_16x16x32_bf16 v[8:11], v[180:183], v[220:223], v[8:11]
    v_mfma_f32_16x16x32_bf16 v[72:75], v[184:187], v[220:223], v[72:75]
    ds_read_b64_tr_b16 v[166:167], v237 offset:33792
    v_mfma_f32_16x16x32_bf16 v[12:15], v[180:183], v[224:227], v[12:15]
    ds_read_b64_tr_b16 v[168:169], v238 offset:32768
    v_mfma_f32_16x16x32_bf16 v[76:79], v[184:187], v[224:227], v[76:79]
    buffer_load_dwordx4 v245, s[40:43], s77 offen offset:1024 lds
    v_mfma_f32_16x16x32_bf16 v[16:19], v[188:191], v[212:215], v[16:19]
    ds_read_b64_tr_b16 v[170:171], v238 offset:33792
    v_mfma_f32_16x16x32_bf16 v[80:83], v[192:195], v[212:215], v[80:83]
    ds_read_b64_tr_b16 v[172:173], v239 offset:32768
    v_mfma_f32_16x16x32_bf16 v[20:23], v[188:191], v[216:219], v[20:23]
    v_mfma_f32_16x16x32_bf16 v[84:87], v[192:195], v[216:219], v[84:87]
    ds_read_b64_tr_b16 v[174:175], v239 offset:33792
    v_mfma_f32_16x16x32_bf16 v[24:27], v[188:191], v[220:223], v[24:27]
    ds_read_b128 v[128:131], v228 offset:0
    v_mfma_f32_16x16x32_bf16 v[88:91], v[192:195], v[220:223], v[88:91]
    s_add_u32 m0, s68, 65536
    s_movk_i32 s76, 640
    buffer_load_dwordx4 v240, s[32:35], s76 offen offset:0 lds
    v_mfma_f32_16x16x32_bf16 v[28:31], v[188:191], v[224:227], v[28:31]
    ds_read_b128 v[132:135], v228 offset:2048
    s_cmp_eq_u32 s28, 5
    s_cbranch_scc1 Lgated_tch_11
Lgated_tch_11_r:
    v_mfma_f32_16x16x32_bf16 v[92:95], v[192:195], v[224:227], v[92:95]
    ds_read_b128 v[136:139], v228 offset:4096
    v_mfma_f32_16x16x32_bf16 v[32:35], v[196:199], v[212:215], v[32:35]
    v_mfma_f32_16x16x32_bf16 v[96:99], v[200:203], v[212:215], v[96:99]
    ds_read_b128 v[140:143], v228 offset:6144
    v_mfma_f32_16x16x32_bf16 v[36:39], v[196:199], v[216:219], v[36:39]
    ds_read_b128 v[144:147], v228 offset:8192
    v_mfma_f32_16x16x32_bf16 v[100:103], v[200:203], v[216:219], v[100:103]
    buffer_load_dwordx4 v241, s[32:35], s76 offen offset:1024 lds
    v_mfma_f32_16x16x32_bf16 v[40:43], v[196:199], v[220:223], v[40:43]
    ds_read_b128 v[148:151], v228 offset:10240
    v_mfma_f32_16x16x32_bf16 v[104:107], v[200:203], v[220:223], v[104:107]
    ds_read_b128 v[152:155], v228 offset:12288
    v_mfma_f32_16x16x32_bf16 v[44:47], v[196:199], v[224:227], v[44:47]
    v_mfma_f32_16x16x32_bf16 v[108:111], v[200:203], v[224:227], v[108:111]
    ds_read_b128 v[156:159], v228 offset:14336
    v_mfma_f32_16x16x32_bf16 v[48:51], v[204:207], v[212:215], v[48:51]
    v_mfma_f32_16x16x32_bf16 v[112:115], v[208:211], v[212:215], v[112:115]
    v_mfma_f32_16x16x32_bf16 v[52:55], v[204:207], v[216:219], v[52:55]
    v_mfma_f32_16x16x32_bf16 v[116:119], v[208:211], v[216:219], v[116:119]
    v_mfma_f32_16x16x32_bf16 v[56:59], v[204:207], v[220:223], v[56:59]
    v_mfma_f32_16x16x32_bf16 v[120:123], v[208:211], v[220:223], v[120:123]
    v_mfma_f32_16x16x32_bf16 v[60:63], v[204:207], v[224:227], v[60:63]
    v_mfma_f32_16x16x32_bf16 v[124:127], v[208:211], v[224:227], v[124:127]
    s_waitcnt vmcnt(10) lgkmcnt(0)
    s_barrier
    v_mfma_f32_16x16x32_bf16 v[0:3], v[128:131], v[160:163], v[0:3]
    ds_read_b64_tr_b16 v[212:213], v236 offset:49152
    v_mfma_f32_16x16x32_bf16 v[64:67], v[132:135], v[160:163], v[64:67]
    s_add_u32 m0, s69, 32768
    s_mov_b32 s77, 2621440
    buffer_load_dwordx4 v244, s[40:43], s77 offen offset:0 lds
    v_mfma_f32_16x16x32_bf16 v[4:7], v[128:131], v[164:167], v[4:7]
    ds_read_b64_tr_b16 v[214:215], v236 offset:50176
    v_mfma_f32_16x16x32_bf16 v[68:71], v[132:135], v[164:167], v[68:71]
    ds_read_b64_tr_b16 v[216:217], v237 offset:49152
    v_mfma_f32_16x16x32_bf16 v[8:11], v[128:131], v[168:171], v[8:11]
    v_mfma_f32_16x16x32_bf16 v[72:75], v[132:135], v[168:171], v[72:75]
    ds_read_b64_tr_b16 v[218:219], v237 offset:50176
    v_mfma_f32_16x16x32_bf16 v[12:15], v[128:131], v[172:175], v[12:15]
    ds_read_b64_tr_b16 v[220:221], v238 offset:49152
    v_mfma_f32_16x16x32_bf16 v[76:79], v[132:135], v[172:175], v[76:79]
    buffer_load_dwordx4 v245, s[40:43], s77 offen offset:1024 lds
    v_mfma_f32_16x16x32_bf16 v[16:19], v[136:139], v[160:163], v[16:19]
    ds_read_b64_tr_b16 v[222:223], v238 offset:50176
    v_mfma_f32_16x16x32_bf16 v[80:83], v[140:143], v[160:163], v[80:83]
    ds_read_b64_tr_b16 v[224:225], v239 offset:49152
    v_mfma_f32_16x16x32_bf16 v[20:23], v[136:139], v[164:167], v[20:23]
    v_mfma_f32_16x16x32_bf16 v[84:87], v[140:143], v[164:167], v[84:87]
    ds_read_b64_tr_b16 v[226:227], v239 offset:50176
    v_mfma_f32_16x16x32_bf16 v[24:27], v[136:139], v[168:171], v[24:27]
    ds_read_b128 v[180:183], v229 offset:0
    v_mfma_f32_16x16x32_bf16 v[88:91], v[140:143], v[168:171], v[88:91]
    s_add_u32 m0, s68, 65536
    s_movk_i32 s76, 640
    buffer_load_dwordx4 v242, s[32:35], s76 offen offset:2048 lds
    v_mfma_f32_16x16x32_bf16 v[28:31], v[136:139], v[172:175], v[28:31]
    ds_read_b128 v[184:187], v229 offset:2048
    s_cmp_eq_u32 s28, 6
    s_cbranch_scc1 Lgated_tch_12
Lgated_tch_12_r:
    v_mfma_f32_16x16x32_bf16 v[92:95], v[140:143], v[172:175], v[92:95]
    ds_read_b128 v[188:191], v229 offset:4096
    v_mfma_f32_16x16x32_bf16 v[32:35], v[144:147], v[160:163], v[32:35]
    v_mfma_f32_16x16x32_bf16 v[96:99], v[148:151], v[160:163], v[96:99]
    ds_read_b128 v[192:195], v229 offset:6144
    v_mfma_f32_16x16x32_bf16 v[36:39], v[144:147], v[164:167], v[36:39]
    ds_read_b128 v[196:199], v229 offset:8192
    v_mfma_f32_16x16x32_bf16 v[100:103], v[148:151], v[164:167], v[100:103]
    buffer_load_dwordx4 v243, s[32:35], s76 offen offset:3072 lds
    v_mfma_f32_16x16x32_bf16 v[40:43], v[144:147], v[168:171], v[40:43]
    ds_read_b128 v[200:203], v229 offset:10240
    v_mfma_f32_16x16x32_bf16 v[104:107], v[148:151], v[168:171], v[104:107]
    ds_read_b128 v[204:207], v229 offset:12288
    v_mfma_f32_16x16x32_bf16 v[44:47], v[144:147], v[172:175], v[44:47]
    v_mfma_f32_16x16x32_bf16 v[108:111], v[148:151], v[172:175], v[108:111]
    ds_read_b128 v[208:211], v229 offset:14336
    v_mfma_f32_16x16x32_bf16 v[48:51], v[152:155], v[160:163], v[48:51]
    v_mfma_f32_16x16x32_bf16 v[112:115], v[156:159], v[160:163], v[112:115]
    v_mfma_f32_16x16x32_bf16 v[52:55], v[152:155], v[164:167], v[52:55]
    v_mfma_f32_16x16x32_bf16 v[116:119], v[156:159], v[164:167], v[116:119]
    v_mfma_f32_16x16x32_bf16 v[56:59], v[152:155], v[168:171], v[56:59]
    v_mfma_f32_16x16x32_bf16 v[120:123], v[156:159], v[168:171], v[120:123]
    v_mfma_f32_16x16x32_bf16 v[60:63], v[152:155], v[172:175], v[60:63]
    v_mfma_f32_16x16x32_bf16 v[124:127], v[156:159], v[172:175], v[124:127]
    s_waitcnt vmcnt(8) lgkmcnt(0)
    s_barrier
    v_mfma_f32_16x16x32_bf16 v[0:3], v[180:183], v[212:215], v[0:3]
    ds_read_b64_tr_b16 v[160:161], v236 offset:0
    v_mfma_f32_16x16x32_bf16 v[64:67], v[184:187], v[212:215], v[64:67]
    s_add_u32 m0, s69, 49152
    s_mov_b32 s77, 2883584
    buffer_load_dwordx4 v244, s[40:43], s77 offen offset:0 lds
    v_mfma_f32_16x16x32_bf16 v[4:7], v[180:183], v[216:219], v[4:7]
    ds_read_b64_tr_b16 v[162:163], v236 offset:1024
    v_mfma_f32_16x16x32_bf16 v[68:71], v[184:187], v[216:219], v[68:71]
    ds_read_b64_tr_b16 v[164:165], v237 offset:0
    v_mfma_f32_16x16x32_bf16 v[8:11], v[180:183], v[220:223], v[8:11]
    v_mfma_f32_16x16x32_bf16 v[72:75], v[184:187], v[220:223], v[72:75]
    ds_read_b64_tr_b16 v[166:167], v237 offset:1024
    v_mfma_f32_16x16x32_bf16 v[12:15], v[180:183], v[224:227], v[12:15]
    ds_read_b64_tr_b16 v[168:169], v238 offset:0
    v_mfma_f32_16x16x32_bf16 v[76:79], v[184:187], v[224:227], v[76:79]
    buffer_load_dwordx4 v245, s[40:43], s77 offen offset:1024 lds
    v_mfma_f32_16x16x32_bf16 v[16:19], v[188:191], v[212:215], v[16:19]
    ds_read_b64_tr_b16 v[170:171], v238 offset:1024
    v_mfma_f32_16x16x32_bf16 v[80:83], v[192:195], v[212:215], v[80:83]
    ds_read_b64_tr_b16 v[172:173], v239 offset:0
    v_mfma_f32_16x16x32_bf16 v[20:23], v[188:191], v[216:219], v[20:23]
    v_mfma_f32_16x16x32_bf16 v[84:87], v[192:195], v[216:219], v[84:87]
    ds_read_b64_tr_b16 v[174:175], v239 offset:1024
    v_mfma_f32_16x16x32_bf16 v[24:27], v[188:191], v[220:223], v[24:27]
    ds_read_b128 v[128:131], v228 offset:32768
    v_mfma_f32_16x16x32_bf16 v[88:91], v[192:195], v[220:223], v[88:91]
    s_add_u32 m0, s68, 0
    s_movk_i32 s76, 768
    buffer_load_dwordx4 v240, s[32:35], s76 offen offset:0 lds
    v_mfma_f32_16x16x32_bf16 v[28:31], v[188:191], v[224:227], v[28:31]
    ds_read_b128 v[132:135], v228 offset:34816
    s_cmp_eq_u32 s28, 7
    s_cbranch_scc1 Lgated_tch_13
Lgated_tch_13_r:
    v_mfma_f32_16x16x32_bf16 v[92:95], v[192:195], v[224:227], v[92:95]
    ds_read_b128 v[136:139], v228 offset:36864
    v_mfma_f32_16x16x32_bf16 v[32:35], v[196:199], v[212:215], v[32:35]
    v_mfma_f32_16x16x32_bf16 v[96:99], v[200:203], v[212:215], v[96:99]
    ds_read_b128 v[140:143], v228 offset:38912
    v_mfma_f32_16x16x32_bf16 v[36:39], v[196:199], v[216:219], v[36:39]
    ds_read_b128 v[144:147], v228 offset:40960
    v_mfma_f32_16x16x32_bf16 v[100:103], v[200:203], v[216:219], v[100:103]
    buffer_load_dwordx4 v241, s[32:35], s76 offen offset:1024 lds
    v_mfma_f32_16x16x32_bf16 v[40:43], v[196:199], v[220:223], v[40:43]
    ds_read_b128 v[148:151], v228 offset:43008
    v_mfma_f32_16x16x32_bf16 v[104:107], v[200:203], v[220:223], v[104:107]
    ds_read_b128 v[152:155], v228 offset:45056
    v_mfma_f32_16x16x32_bf16 v[44:47], v[196:199], v[224:227], v[44:47]
    v_mfma_f32_16x16x32_bf16 v[108:111], v[200:203], v[224:227], v[108:111]
    ds_read_b128 v[156:159], v228 offset:47104
    v_mfma_f32_16x16x32_bf16 v[48:51], v[204:207], v[212:215], v[48:51]
    v_mfma_f32_16x16x32_bf16 v[112:115], v[208:211], v[212:215], v[112:115]
    v_mfma_f32_16x16x32_bf16 v[52:55], v[204:207], v[216:219], v[52:55]
    v_mfma_f32_16x16x32_bf16 v[116:119], v[208:211], v[216:219], v[116:119]
    v_mfma_f32_16x16x32_bf16 v[56:59], v[204:207], v[220:223], v[56:59]
    v_mfma_f32_16x16x32_bf16 v[120:123], v[208:211], v[220:223], v[120:123]
    v_mfma_f32_16x16x32_bf16 v[60:63], v[204:207], v[224:227], v[60:63]
    v_mfma_f32_16x16x32_bf16 v[124:127], v[208:211], v[224:227], v[124:127]
    s_waitcnt vmcnt(10) lgkmcnt(0)
    s_barrier
    v_mfma_f32_16x16x32_bf16 v[0:3], v[128:131], v[160:163], v[0:3]
    ds_read_b64_tr_b16 v[212:213], v236 offset:16384
    v_mfma_f32_16x16x32_bf16 v[64:67], v[132:135], v[160:163], v[64:67]
    s_add_u32 m0, s69, 0
    s_mov_b32 s77, 3145728
    buffer_load_dwordx4 v244, s[40:43], s77 offen offset:0 lds
    v_mfma_f32_16x16x32_bf16 v[4:7], v[128:131], v[164:167], v[4:7]
    ds_read_b64_tr_b16 v[214:215], v236 offset:17408
    v_mfma_f32_16x16x32_bf16 v[68:71], v[132:135], v[164:167], v[68:71]
    ds_read_b64_tr_b16 v[216:217], v237 offset:16384
    v_mfma_f32_16x16x32_bf16 v[8:11], v[128:131], v[168:171], v[8:11]
    v_mfma_f32_16x16x32_bf16 v[72:75], v[132:135], v[168:171], v[72:75]
    ds_read_b64_tr_b16 v[218:219], v237 offset:17408
    v_mfma_f32_16x16x32_bf16 v[12:15], v[128:131], v[172:175], v[12:15]
    ds_read_b64_tr_b16 v[220:221], v238 offset:16384
    v_mfma_f32_16x16x32_bf16 v[76:79], v[132:135], v[172:175], v[76:79]
    buffer_load_dwordx4 v245, s[40:43], s77 offen offset:1024 lds
    v_mfma_f32_16x16x32_bf16 v[16:19], v[136:139], v[160:163], v[16:19]
    ds_read_b64_tr_b16 v[222:223], v238 offset:17408
    v_mfma_f32_16x16x32_bf16 v[80:83], v[140:143], v[160:163], v[80:83]
    ds_read_b64_tr_b16 v[224:225], v239 offset:16384
    v_mfma_f32_16x16x32_bf16 v[20:23], v[136:139], v[164:167], v[20:23]
    v_mfma_f32_16x16x32_bf16 v[84:87], v[140:143], v[164:167], v[84:87]
    ds_read_b64_tr_b16 v[226:227], v239 offset:17408
    v_mfma_f32_16x16x32_bf16 v[24:27], v[136:139], v[168:171], v[24:27]
    ds_read_b128 v[180:183], v229 offset:32768
    v_mfma_f32_16x16x32_bf16 v[88:91], v[140:143], v[168:171], v[88:91]
    s_add_u32 m0, s68, 0
    s_movk_i32 s76, 768
    buffer_load_dwordx4 v242, s[32:35], s76 offen offset:2048 lds
    v_mfma_f32_16x16x32_bf16 v[28:31], v[136:139], v[172:175], v[28:31]
    ds_read_b128 v[184:187], v229 offset:34816
    s_cmp_eq_u32 s28, 8
    s_cbranch_scc1 Lgated_tch_14
Lgated_tch_14_r:
    v_mfma_f32_16x16x32_bf16 v[92:95], v[140:143], v[172:175], v[92:95]
    ds_read_b128 v[188:191], v229 offset:36864
    v_mfma_f32_16x16x32_bf16 v[32:35], v[144:147], v[160:163], v[32:35]
    v_mfma_f32_16x16x32_bf16 v[96:99], v[148:151], v[160:163], v[96:99]
    ds_read_b128 v[192:195], v229 offset:38912
    v_mfma_f32_16x16x32_bf16 v[36:39], v[144:147], v[164:167], v[36:39]
    ds_read_b128 v[196:199], v229 offset:40960
    v_mfma_f32_16x16x32_bf16 v[100:103], v[148:151], v[164:167], v[100:103]
    buffer_load_dwordx4 v243, s[32:35], s76 offen offset:3072 lds
    v_mfma_f32_16x16x32_bf16 v[40:43], v[144:147], v[168:171], v[40:43]
    ds_read_b128 v[200:203], v229 offset:43008
    v_mfma_f32_16x16x32_bf16 v[104:107], v[148:151], v[168:171], v[104:107]
    ds_read_b128 v[204:207], v229 offset:45056
    v_mfma_f32_16x16x32_bf16 v[44:47], v[144:147], v[172:175], v[44:47]
    v_mfma_f32_16x16x32_bf16 v[108:111], v[148:151], v[172:175], v[108:111]
    ds_read_b128 v[208:211], v229 offset:47104
    v_mfma_f32_16x16x32_bf16 v[48:51], v[152:155], v[160:163], v[48:51]
    v_mfma_f32_16x16x32_bf16 v[112:115], v[156:159], v[160:163], v[112:115]
    v_mfma_f32_16x16x32_bf16 v[52:55], v[152:155], v[164:167], v[52:55]
    v_mfma_f32_16x16x32_bf16 v[116:119], v[156:159], v[164:167], v[116:119]
    v_mfma_f32_16x16x32_bf16 v[56:59], v[152:155], v[168:171], v[56:59]
    v_mfma_f32_16x16x32_bf16 v[120:123], v[156:159], v[168:171], v[120:123]
    v_mfma_f32_16x16x32_bf16 v[60:63], v[152:155], v[172:175], v[60:63]
    v_mfma_f32_16x16x32_bf16 v[124:127], v[156:159], v[172:175], v[124:127]
    s_waitcnt vmcnt(8) lgkmcnt(0)
    s_barrier
    v_mfma_f32_16x16x32_bf16 v[0:3], v[180:183], v[212:215], v[0:3]
    ds_read_b64_tr_b16 v[160:161], v236 offset:32768
    v_mfma_f32_16x16x32_bf16 v[64:67], v[184:187], v[212:215], v[64:67]
    s_add_u32 m0, s69, 16384
    s_mov_b32 s77, 3407872
    buffer_load_dwordx4 v244, s[40:43], s77 offen offset:0 lds
    v_mfma_f32_16x16x32_bf16 v[4:7], v[180:183], v[216:219], v[4:7]
    ds_read_b64_tr_b16 v[162:163], v236 offset:33792
    v_mfma_f32_16x16x32_bf16 v[68:71], v[184:187], v[216:219], v[68:71]
    ds_read_b64_tr_b16 v[164:165], v237 offset:32768
    v_mfma_f32_16x16x32_bf16 v[8:11], v[180:183], v[220:223], v[8:11]
    v_mfma_f32_16x16x32_bf16 v[72:75], v[184:187], v[220:223], v[72:75]
    ds_read_b64_tr_b16 v[166:167], v237 offset:33792
    v_mfma_f32_16x16x32_bf16 v[12:15], v[180:183], v[224:227], v[12:15]
    ds_read_b64_tr_b16 v[168:169], v238 offset:32768
    v_mfma_f32_16x16x32_bf16 v[76:79], v[184:187], v[224:227], v[76:79]
    buffer_load_dwordx4 v245, s[40:43], s77 offen offset:1024 lds
    v_mfma_f32_16x16x32_bf16 v[16:19], v[188:191], v[212:215], v[16:19]
    ds_read_b64_tr_b16 v[170:171], v238 offset:33792
    v_mfma_f32_16x16x32_bf16 v[80:83], v[192:195], v[212:215], v[80:83]
    ds_read_b64_tr_b16 v[172:173], v239 offset:32768
    v_mfma_f32_16x16x32_bf16 v[20:23], v[188:191], v[216:219], v[20:23]
    v_mfma_f32_16x16x32_bf16 v[84:87], v[192:195], v[216:219], v[84:87]
    ds_read_b64_tr_b16 v[174:175], v239 offset:33792
    v_mfma_f32_16x16x32_bf16 v[24:27], v[188:191], v[220:223], v[24:27]
    ds_read_b128 v[128:131], v230 offset:0
    v_mfma_f32_16x16x32_bf16 v[88:91], v[192:195], v[220:223], v[88:91]
    s_add_u32 m0, s68, 32768
    s_movk_i32 s76, 896
    buffer_load_dwordx4 v240, s[32:35], s76 offen offset:0 lds
    v_mfma_f32_16x16x32_bf16 v[28:31], v[188:191], v[224:227], v[28:31]
    ds_read_b128 v[132:135], v230 offset:2048
    s_cmp_eq_u32 s28, 9
    s_cbranch_scc1 Lgated_tch_15
Lgated_tch_15_r:
    v_mfma_f32_16x16x32_bf16 v[92:95], v[192:195], v[224:227], v[92:95]
    ds_read_b128 v[136:139], v230 offset:4096
    v_mfma_f32_16x16x32_bf16 v[32:35], v[196:199], v[212:215], v[32:35]
    v_mfma_f32_16x16x32_bf16 v[96:99], v[200:203], v[212:215], v[96:99]
    ds_read_b128 v[140:143], v230 offset:6144
    v_mfma_f32_16x16x32_bf16 v[36:39], v[196:199], v[216:219], v[36:39]
    ds_read_b128 v[144:147], v230 offset:8192
    v_mfma_f32_16x16x32_bf16 v[100:103], v[200:203], v[216:219], v[100:103]
    buffer_load_dwordx4 v241, s[32:35], s76 offen offset:1024 lds
    v_mfma_f32_16x16x32_bf16 v[40:43], v[196:199], v[220:223], v[40:43]
    ds_read_b128 v[148:151], v230 offset:10240
    v_mfma_f32_16x16x32_bf16 v[104:107], v[200:203], v[220:223], v[104:107]
    ds_read_b128 v[152:155], v230 offset:12288
    v_mfma_f32_16x16x32_bf16 v[44:47], v[196:199], v[224:227], v[44:47]
    v_mfma_f32_16x16x32_bf16 v[108:111], v[200:203], v[224:227], v[108:111]
    ds_read_b128 v[156:159], v230 offset:14336
    v_mfma_f32_16x16x32_bf16 v[48:51], v[204:207], v[212:215], v[48:51]
    v_mfma_f32_16x16x32_bf16 v[112:115], v[208:211], v[212:215], v[112:115]
    v_mfma_f32_16x16x32_bf16 v[52:55], v[204:207], v[216:219], v[52:55]
    v_mfma_f32_16x16x32_bf16 v[116:119], v[208:211], v[216:219], v[116:119]
    v_mfma_f32_16x16x32_bf16 v[56:59], v[204:207], v[220:223], v[56:59]
    v_mfma_f32_16x16x32_bf16 v[120:123], v[208:211], v[220:223], v[120:123]
    v_mfma_f32_16x16x32_bf16 v[60:63], v[204:207], v[224:227], v[60:63]
    v_mfma_f32_16x16x32_bf16 v[124:127], v[208:211], v[224:227], v[124:127]
    s_waitcnt vmcnt(10) lgkmcnt(0)
    s_barrier
    v_mfma_f32_16x16x32_bf16 v[0:3], v[128:131], v[160:163], v[0:3]
    ds_read_b64_tr_b16 v[212:213], v236 offset:49152
    v_mfma_f32_16x16x32_bf16 v[64:67], v[132:135], v[160:163], v[64:67]
    s_add_u32 m0, s69, 32768
    s_mov_b32 s77, 3670016
    buffer_load_dwordx4 v244, s[40:43], s77 offen offset:0 lds
    v_mfma_f32_16x16x32_bf16 v[4:7], v[128:131], v[164:167], v[4:7]
    ds_read_b64_tr_b16 v[214:215], v236 offset:50176
    v_mfma_f32_16x16x32_bf16 v[68:71], v[132:135], v[164:167], v[68:71]
    ds_read_b64_tr_b16 v[216:217], v237 offset:49152
    v_mfma_f32_16x16x32_bf16 v[8:11], v[128:131], v[168:171], v[8:11]
    v_mfma_f32_16x16x32_bf16 v[72:75], v[132:135], v[168:171], v[72:75]
    ds_read_b64_tr_b16 v[218:219], v237 offset:50176
    v_mfma_f32_16x16x32_bf16 v[12:15], v[128:131], v[172:175], v[12:15]
    ds_read_b64_tr_b16 v[220:221], v238 offset:49152
    v_mfma_f32_16x16x32_bf16 v[76:79], v[132:135], v[172:175], v[76:79]
    buffer_load_dwordx4 v245, s[40:43], s77 offen offset:1024 lds
    v_mfma_f32_16x16x32_bf16 v[16:19], v[136:139], v[160:163], v[16:19]
    ds_read_b64_tr_b16 v[222:223], v238 offset:50176
    v_mfma_f32_16x16x32_bf16 v[80:83], v[140:143], v[160:163], v[80:83]
    ds_read_b64_tr_b16 v[224:225], v239 offset:49152
    v_mfma_f32_16x16x32_bf16 v[20:23], v[136:139], v[164:167], v[20:23]
    v_mfma_f32_16x16x32_bf16 v[84:87], v[140:143], v[164:167], v[84:87]
    ds_read_b64_tr_b16 v[226:227], v239 offset:50176
    v_mfma_f32_16x16x32_bf16 v[24:27], v[136:139], v[168:171], v[24:27]
    ds_read_b128 v[180:183], v231 offset:0
    v_mfma_f32_16x16x32_bf16 v[88:91], v[140:143], v[168:171], v[88:91]
    s_add_u32 m0, s68, 32768
    s_movk_i32 s76, 896
    buffer_load_dwordx4 v242, s[32:35], s76 offen offset:2048 lds
    v_mfma_f32_16x16x32_bf16 v[28:31], v[136:139], v[172:175], v[28:31]
    ds_read_b128 v[184:187], v231 offset:2048
    s_cmp_eq_u32 s28, 10
    s_cbranch_scc1 Lgated_tch_16
Lgated_tch_16_r:
    v_mfma_f32_16x16x32_bf16 v[92:95], v[140:143], v[172:175], v[92:95]
    ds_read_b128 v[188:191], v231 offset:4096
    v_mfma_f32_16x16x32_bf16 v[32:35], v[144:147], v[160:163], v[32:35]
    v_mfma_f32_16x16x32_bf16 v[96:99], v[148:151], v[160:163], v[96:99]
    ds_read_b128 v[192:195], v231 offset:6144
    v_mfma_f32_16x16x32_bf16 v[36:39], v[144:147], v[164:167], v[36:39]
    ds_read_b128 v[196:199], v231 offset:8192
    v_mfma_f32_16x16x32_bf16 v[100:103], v[148:151], v[164:167], v[100:103]
    buffer_load_dwordx4 v243, s[32:35], s76 offen offset:3072 lds
    v_mfma_f32_16x16x32_bf16 v[40:43], v[144:147], v[168:171], v[40:43]
    ds_read_b128 v[200:203], v231 offset:10240
    v_mfma_f32_16x16x32_bf16 v[104:107], v[148:151], v[168:171], v[104:107]
    ds_read_b128 v[204:207], v231 offset:12288
    v_mfma_f32_16x16x32_bf16 v[44:47], v[144:147], v[172:175], v[44:47]
    v_mfma_f32_16x16x32_bf16 v[108:111], v[148:151], v[172:175], v[108:111]
    ds_read_b128 v[208:211], v231 offset:14336
    v_mfma_f32_16x16x32_bf16 v[48:51], v[152:155], v[160:163], v[48:51]
    v_mfma_f32_16x16x32_bf16 v[112:115], v[156:159], v[160:163], v[112:115]
    v_mfma_f32_16x16x32_bf16 v[52:55], v[152:155], v[164:167], v[52:55]
    v_mfma_f32_16x16x32_bf16 v[116:119], v[156:159], v[164:167], v[116:119]
    v_mfma_f32_16x16x32_bf16 v[56:59], v[152:155], v[168:171], v[56:59]
    v_mfma_f32_16x16x32_bf16 v[120:123], v[156:159], v[168:171], v[120:123]
    v_mfma_f32_16x16x32_bf16 v[60:63], v[152:155], v[172:175], v[60:63]
    v_mfma_f32_16x16x32_bf16 v[124:127], v[156:159], v[172:175], v[124:127]
    s_waitcnt vmcnt(8) lgkmcnt(0)
    s_barrier
    v_mfma_f32_16x16x32_bf16 v[0:3], v[180:183], v[212:215], v[0:3]
    ds_read_b64_tr_b16 v[160:161], v236 offset:0
    v_mfma_f32_16x16x32_bf16 v[64:67], v[184:187], v[212:215], v[64:67]
    s_add_u32 m0, s69, 49152
    s_mov_b32 s77, 3932160
    buffer_load_dwordx4 v244, s[40:43], s77 offen offset:0 lds
    v_mfma_f32_16x16x32_bf16 v[4:7], v[180:183], v[216:219], v[4:7]
    ds_read_b64_tr_b16 v[162:163], v236 offset:1024
    v_mfma_f32_16x16x32_bf16 v[68:71], v[184:187], v[216:219], v[68:71]
    ds_read_b64_tr_b16 v[164:165], v237 offset:0
    v_mfma_f32_16x16x32_bf16 v[8:11], v[180:183], v[220:223], v[8:11]
    v_mfma_f32_16x16x32_bf16 v[72:75], v[184:187], v[220:223], v[72:75]
    ds_read_b64_tr_b16 v[166:167], v237 offset:1024
    v_mfma_f32_16x16x32_bf16 v[12:15], v[180:183], v[224:227], v[12:15]
    ds_read_b64_tr_b16 v[168:169], v238 offset:0
    v_mfma_f32_16x16x32_bf16 v[76:79], v[184:187], v[224:227], v[76:79]
    buffer_load_dwordx4 v245, s[40:43], s77 offen offset:1024 lds
    v_mfma_f32_16x16x32_bf16 v[16:19], v[188:191], v[212:215], v[16:19]
    ds_read_b64_tr_b16 v[170:171], v238 offset:1024
    v_mfma_f32_16x16x32_bf16 v[80:83], v[192:195], v[212:215], v[80:83]
    ds_read_b64_tr_b16 v[172:173], v239 offset:0
    v_mfma_f32_16x16x32_bf16 v[20:23], v[188:191], v[216:219], v[20:23]
    v_mfma_f32_16x16x32_bf16 v[84:87], v[192:195], v[216:219], v[84:87]
    ds_read_b64_tr_b16 v[174:175], v239 offset:1024
    v_mfma_f32_16x16x32_bf16 v[24:27], v[188:191], v[220:223], v[24:27]
    ds_read_b128 v[128:131], v228 offset:0
    v_mfma_f32_16x16x32_bf16 v[88:91], v[192:195], v[220:223], v[88:91]
    s_add_u32 m0, s68, 65536
    s_movk_i32 s76, 0
    buffer_load_dwordx4 v240, s[36:39], s76 offen offset:0 lds
    v_mfma_f32_16x16x32_bf16 v[28:31], v[188:191], v[224:227], v[28:31]
    ds_read_b128 v[132:135], v228 offset:2048
    v_mfma_f32_16x16x32_bf16 v[92:95], v[192:195], v[224:227], v[92:95]
    ds_read_b128 v[136:139], v228 offset:4096
    v_mfma_f32_16x16x32_bf16 v[32:35], v[196:199], v[212:215], v[32:35]
    v_mfma_f32_16x16x32_bf16 v[96:99], v[200:203], v[212:215], v[96:99]
    ds_read_b128 v[140:143], v228 offset:6144
    v_mfma_f32_16x16x32_bf16 v[36:39], v[196:199], v[216:219], v[36:39]
    ds_read_b128 v[144:147], v228 offset:8192
    v_mfma_f32_16x16x32_bf16 v[100:103], v[200:203], v[216:219], v[100:103]
    buffer_load_dwordx4 v241, s[36:39], s76 offen offset:1024 lds
    v_mfma_f32_16x16x32_bf16 v[40:43], v[196:199], v[220:223], v[40:43]
    ds_read_b128 v[148:151], v228 offset:10240
    v_mfma_f32_16x16x32_bf16 v[104:107], v[200:203], v[220:223], v[104:107]
    ds_read_b128 v[152:155], v228 offset:12288
    v_mfma_f32_16x16x32_bf16 v[44:47], v[196:199], v[224:227], v[44:47]
    v_mfma_f32_16x16x32_bf16 v[108:111], v[200:203], v[224:227], v[108:111]
    ds_read_b128 v[156:159], v228 offset:14336
    v_mfma_f32_16x16x32_bf16 v[48:51], v[204:207], v[212:215], v[48:51]
    v_mfma_f32_16x16x32_bf16 v[112:115], v[208:211], v[212:215], v[112:115]
    v_mfma_f32_16x16x32_bf16 v[52:55], v[204:207], v[216:219], v[52:55]
    v_mfma_f32_16x16x32_bf16 v[116:119], v[208:211], v[216:219], v[116:119]
    v_mfma_f32_16x16x32_bf16 v[56:59], v[204:207], v[220:223], v[56:59]
    v_mfma_f32_16x16x32_bf16 v[120:123], v[208:211], v[220:223], v[120:123]
    v_mfma_f32_16x16x32_bf16 v[60:63], v[204:207], v[224:227], v[60:63]
    v_mfma_f32_16x16x32_bf16 v[124:127], v[208:211], v[224:227], v[124:127]
    s_waitcnt vmcnt(10) lgkmcnt(0)
    s_barrier
    v_mfma_f32_16x16x32_bf16 v[0:3], v[128:131], v[160:163], v[0:3]
    ds_read_b64_tr_b16 v[212:213], v236 offset:16384
    v_mfma_f32_16x16x32_bf16 v[64:67], v[132:135], v[160:163], v[64:67]
    s_add_u32 m0, s69, 0
    s_mul_i32 s77, s70, 0
    buffer_load_dwordx4 v246, s[44:47], s77 offen offset:0 lds
    v_mfma_f32_16x16x32_bf16 v[4:7], v[128:131], v[164:167], v[4:7]
    ds_read_b64_tr_b16 v[214:215], v236 offset:17408
    v_mfma_f32_16x16x32_bf16 v[68:71], v[132:135], v[164:167], v[68:71]
    ds_read_b64_tr_b16 v[216:217], v237 offset:16384
    v_mfma_f32_16x16x32_bf16 v[8:11], v[128:131], v[168:171], v[8:11]
    v_mfma_f32_16x16x32_bf16 v[72:75], v[132:135], v[168:171], v[72:75]
    ds_read_b64_tr_b16 v[218:219], v237 offset:17408
    v_mfma_f32_16x16x32_bf16 v[12:15], v[128:131], v[172:175], v[12:15]
    ds_read_b64_tr_b16 v[220:221], v238 offset:16384
    v_mfma_f32_16x16x32_bf16 v[76:79], v[132:135], v[172:175], v[76:79]
    buffer_load_dwordx4 v247, s[44:47], s77 offen offset:1024 lds
    v_mfma_f32_16x16x32_bf16 v[16:19], v[136:139], v[160:163], v[16:19]
    ds_read_b64_tr_b16 v[222:223], v238 offset:17408
    v_mfma_f32_16x16x32_bf16 v[80:83], v[140:143], v[160:163], v[80:83]
    ds_read_b64_tr_b16 v[224:225], v239 offset:16384
    v_mfma_f32_16x16x32_bf16 v[20:23], v[136:139], v[164:167], v[20:23]
    v_mfma_f32_16x16x32_bf16 v[84:87], v[140:143], v[164:167], v[84:87]
    ds_read_b64_tr_b16 v[226:227], v239 offset:17408
    v_mfma_f32_16x16x32_bf16 v[24:27], v[136:139], v[168:171], v[24:27]
    ds_read_b128 v[180:183], v229 offset:0
    v_mfma_f32_16x16x32_bf16 v[88:91], v[140:143], v[168:171], v[88:91]
    s_add_u32 m0, s68, 65536
    s_movk_i32 s76, 0
    buffer_load_dwordx4 v242, s[36:39], s76 offen offset:2048 lds
    v_mfma_f32_16x16x32_bf16 v[28:31], v[136:139], v[172:175], v[28:31]
    ds_read_b128 v[184:187], v229 offset:2048
    v_mfma_f32_16x16x32_bf16 v[92:95], v[140:143], v[172:175], v[92:95]
    ds_read_b128 v[188:191], v229 offset:4096
    v_mfma_f32_16x16x32_bf16 v[32:35], v[144:147], v[160:163], v[32:35]
    v_mfma_f32_16x16x32_bf16 v[96:99], v[148:151], v[160:163], v[96:99]
    ds_read_b128 v[192:195], v229 offset:6144
    v_mfma_f32_16x16x32_bf16 v[36:39], v[144:147], v[164:167], v[36:39]
    ds_read_b128 v[196:199], v229 offset:8192
    v_mfma_f32_16x16x32_bf16 v[100:103], v[148:151], v[164:167], v[100:103]
    buffer_load_dwordx4 v243, s[36:39], s76 offen offset:3072 lds
    v_mfma_f32_16x16x32_bf16 v[40:43], v[144:147], v[168:171], v[40:43]
    ds_read_b128 v[200:203], v229 offset:10240
    v_mfma_f32_16x16x32_bf16 v[104:107], v[148:151], v[168:171], v[104:107]
    ds_read_b128 v[204:207], v229 offset:12288
    v_mfma_f32_16x16x32_bf16 v[44:47], v[144:147], v[172:175], v[44:47]
    v_mfma_f32_16x16x32_bf16 v[108:111], v[148:151], v[172:175], v[108:111]
    ds_read_b128 v[208:211], v229 offset:14336
    v_mfma_f32_16x16x32_bf16 v[48:51], v[152:155], v[160:163], v[48:51]
    v_mfma_f32_16x16x32_bf16 v[112:115], v[156:159], v[160:163], v[112:115]
    v_mfma_f32_16x16x32_bf16 v[52:55], v[152:155], v[164:167], v[52:55]
    v_mfma_f32_16x16x32_bf16 v[116:119], v[156:159], v[164:167], v[116:119]
    v_mfma_f32_16x16x32_bf16 v[56:59], v[152:155], v[168:171], v[56:59]
    v_mfma_f32_16x16x32_bf16 v[120:123], v[156:159], v[168:171], v[120:123]
    v_mfma_f32_16x16x32_bf16 v[60:63], v[152:155], v[172:175], v[60:63]
    v_mfma_f32_16x16x32_bf16 v[124:127], v[156:159], v[172:175], v[124:127]
    s_waitcnt vmcnt(8) lgkmcnt(0)
    s_barrier
    v_mfma_f32_16x16x32_bf16 v[0:3], v[180:183], v[212:215], v[0:3]
    ds_read_b64_tr_b16 v[160:161], v236 offset:32768
    v_mfma_f32_16x16x32_bf16 v[64:67], v[184:187], v[212:215], v[64:67]
    s_add_u32 m0, s69, 16384
    s_mul_i32 s77, s70, 1
    buffer_load_dwordx4 v246, s[44:47], s77 offen offset:0 lds
    v_mfma_f32_16x16x32_bf16 v[4:7], v[180:183], v[216:219], v[4:7]
    ds_read_b64_tr_b16 v[162:163], v236 offset:33792
    v_mfma_f32_16x16x32_bf16 v[68:71], v[184:187], v[216:219], v[68:71]
    ds_read_b64_tr_b16 v[164:165], v237 offset:32768
    v_mfma_f32_16x16x32_bf16 v[8:11], v[180:183], v[220:223], v[8:11]
    v_mfma_f32_16x16x32_bf16 v[72:75], v[184:187], v[220:223], v[72:75]
    ds_read_b64_tr_b16 v[166:167], v237 offset:33792
    v_mfma_f32_16x16x32_bf16 v[12:15], v[180:183], v[224:227], v[12:15]
    ds_read_b64_tr_b16 v[168:169], v238 offset:32768
    v_mfma_f32_16x16x32_bf16 v[76:79], v[184:187], v[224:227], v[76:79]
    buffer_load_dwordx4 v247, s[44:47], s77 offen offset:1024 lds
    v_mfma_f32_16x16x32_bf16 v[16:19], v[188:191], v[212:215], v[16:19]
    ds_read_b64_tr_b16 v[170:171], v238 offset:33792
    v_mfma_f32_16x16x32_bf16 v[80:83], v[192:195], v[212:215], v[80:83]
    ds_read_b64_tr_b16 v[172:173], v239 offset:32768
    v_mfma_f32_16x16x32_bf16 v[20:23], v[188:191], v[216:219], v[20:23]
    v_mfma_f32_16x16x32_bf16 v[84:87], v[192:195], v[216:219], v[84:87]
    ds_read_b64_tr_b16 v[174:175], v239 offset:33792
    v_mfma_f32_16x16x32_bf16 v[24:27], v[188:191], v[220:223], v[24:27]
    ds_read_b128 v[128:131], v228 offset:32768
    v_mfma_f32_16x16x32_bf16 v[88:91], v[192:195], v[220:223], v[88:91]
    s_add_u32 m0, s68, 0
    s_movk_i32 s76, 128
    buffer_load_dwordx4 v240, s[36:39], s76 offen offset:0 lds
    v_mfma_f32_16x16x32_bf16 v[28:31], v[188:191], v[224:227], v[28:31]
    ds_read_b128 v[132:135], v228 offset:34816
    v_mfma_f32_16x16x32_bf16 v[92:95], v[192:195], v[224:227], v[92:95]
    ds_read_b128 v[136:139], v228 offset:36864
    v_mfma_f32_16x16x32_bf16 v[32:35], v[196:199], v[212:215], v[32:35]
    v_mfma_f32_16x16x32_bf16 v[96:99], v[200:203], v[212:215], v[96:99]
    ds_read_b128 v[140:143], v228 offset:38912
    v_mfma_f32_16x16x32_bf16 v[36:39], v[196:199], v[216:219], v[36:39]
    ds_read_b128 v[144:147], v228 offset:40960
    v_mfma_f32_16x16x32_bf16 v[100:103], v[200:203], v[216:219], v[100:103]
    buffer_load_dwordx4 v241, s[36:39], s76 offen offset:1024 lds
    v_mfma_f32_16x16x32_bf16 v[40:43], v[196:199], v[220:223], v[40:43]
    ds_read_b128 v[148:151], v228 offset:43008
    v_mfma_f32_16x16x32_bf16 v[104:107], v[200:203], v[220:223], v[104:107]
    ds_read_b128 v[152:155], v228 offset:45056
    v_mfma_f32_16x16x32_bf16 v[44:47], v[196:199], v[224:227], v[44:47]
    v_mfma_f32_16x16x32_bf16 v[108:111], v[200:203], v[224:227], v[108:111]
    ds_read_b128 v[156:159], v228 offset:47104
    v_mfma_f32_16x16x32_bf16 v[48:51], v[204:207], v[212:215], v[48:51]
    v_mfma_f32_16x16x32_bf16 v[112:115], v[208:211], v[212:215], v[112:115]
    v_mfma_f32_16x16x32_bf16 v[52:55], v[204:207], v[216:219], v[52:55]
    v_mfma_f32_16x16x32_bf16 v[116:119], v[208:211], v[216:219], v[116:119]
    v_mfma_f32_16x16x32_bf16 v[56:59], v[204:207], v[220:223], v[56:59]
    v_mfma_f32_16x16x32_bf16 v[120:123], v[208:211], v[220:223], v[120:123]
    v_mfma_f32_16x16x32_bf16 v[60:63], v[204:207], v[224:227], v[60:63]
    v_mfma_f32_16x16x32_bf16 v[124:127], v[208:211], v[224:227], v[124:127]
    s_waitcnt vmcnt(10) lgkmcnt(0)
    s_barrier
    v_mfma_f32_16x16x32_bf16 v[0:3], v[128:131], v[160:163], v[0:3]
    ds_read_b64_tr_b16 v[212:213], v236 offset:49152
    v_mfma_f32_16x16x32_bf16 v[64:67], v[132:135], v[160:163], v[64:67]
    s_add_u32 m0, s69, 32768
    s_mul_i32 s77, s70, 2
    buffer_load_dwordx4 v246, s[44:47], s77 offen offset:0 lds
    v_mfma_f32_16x16x32_bf16 v[4:7], v[128:131], v[164:167], v[4:7]
    ds_read_b64_tr_b16 v[214:215], v236 offset:50176
    v_mfma_f32_16x16x32_bf16 v[68:71], v[132:135], v[164:167], v[68:71]
    ds_read_b64_tr_b16 v[216:217], v237 offset:49152
    v_mfma_f32_16x16x32_bf16 v[8:11], v[128:131], v[168:171], v[8:11]
    v_mfma_f32_16x16x32_bf16 v[72:75], v[132:135], v[168:171], v[72:75]
    ds_read_b64_tr_b16 v[218:219], v237 offset:50176
    v_mfma_f32_16x16x32_bf16 v[12:15], v[128:131], v[172:175], v[12:15]
    ds_read_b64_tr_b16 v[220:221], v238 offset:49152
    v_mfma_f32_16x16x32_bf16 v[76:79], v[132:135], v[172:175], v[76:79]
    buffer_load_dwordx4 v247, s[44:47], s77 offen offset:1024 lds
    v_mfma_f32_16x16x32_bf16 v[16:19], v[136:139], v[160:163], v[16:19]
    ds_read_b64_tr_b16 v[222:223], v238 offset:50176
    v_mfma_f32_16x16x32_bf16 v[80:83], v[140:143], v[160:163], v[80:83]
    ds_read_b64_tr_b16 v[224:225], v239 offset:49152
    v_mfma_f32_16x16x32_bf16 v[20:23], v[136:139], v[164:167], v[20:23]
    v_mfma_f32_16x16x32_bf16 v[84:87], v[140:143], v[164:167], v[84:87]
    ds_read_b64_tr_b16 v[226:227], v239 offset:50176
    v_mfma_f32_16x16x32_bf16 v[24:27], v[136:139], v[168:171], v[24:27]
    ds_read_b128 v[180:183], v229 offset:32768
    v_mfma_f32_16x16x32_bf16 v[88:91], v[140:143], v[168:171], v[88:91]
    s_add_u32 m0, s68, 0
    s_movk_i32 s76, 128
    buffer_load_dwordx4 v242, s[36:39], s76 offen offset:2048 lds
    v_mfma_f32_16x16x32_bf16 v[28:31], v[136:139], v[172:175], v[28:31]
    ds_read_b128 v[184:187], v229 offset:34816
    v_mfma_f32_16x16x32_bf16 v[92:95], v[140:143], v[172:175], v[92:95]
    ds_read_b128 v[188:191], v229 offset:36864
    v_mfma_f32_16x16x32_bf16 v[32:35], v[144:147], v[160:163], v[32:35]
    v_mfma_f32_16x16x32_bf16 v[96:99], v[148:151], v[160:163], v[96:99]
    ds_read_b128 v[192:195], v229 offset:38912
    v_mfma_f32_16x16x32_bf16 v[36:39], v[144:147], v[164:167], v[36:39]
    ds_read_b128 v[196:199], v229 offset:40960
    v_mfma_f32_16x16x32_bf16 v[100:103], v[148:151], v[164:167], v[100:103]
    buffer_load_dwordx4 v243, s[36:39], s76 offen offset:3072 lds
    v_mfma_f32_16x16x32_bf16 v[40:43], v[144:147], v[168:171], v[40:43]
    ds_read_b128 v[200:203], v229 offset:43008
    v_mfma_f32_16x16x32_bf16 v[104:107], v[148:151], v[168:171], v[104:107]
    ds_read_b128 v[204:207], v229 offset:45056
    v_mfma_f32_16x16x32_bf16 v[44:47], v[144:147], v[172:175], v[44:47]
    v_mfma_f32_16x16x32_bf16 v[108:111], v[148:151], v[172:175], v[108:111]
    ds_read_b128 v[208:211], v229 offset:47104
    v_mfma_f32_16x16x32_bf16 v[48:51], v[152:155], v[160:163], v[48:51]
    v_mfma_f32_16x16x32_bf16 v[112:115], v[156:159], v[160:163], v[112:115]
    v_mfma_f32_16x16x32_bf16 v[52:55], v[152:155], v[164:167], v[52:55]
    v_mfma_f32_16x16x32_bf16 v[116:119], v[156:159], v[164:167], v[116:119]
    v_mfma_f32_16x16x32_bf16 v[56:59], v[152:155], v[168:171], v[56:59]
    v_mfma_f32_16x16x32_bf16 v[120:123], v[156:159], v[168:171], v[120:123]
    v_mfma_f32_16x16x32_bf16 v[60:63], v[152:155], v[172:175], v[60:63]
    v_mfma_f32_16x16x32_bf16 v[124:127], v[156:159], v[172:175], v[124:127]
    s_waitcnt vmcnt(8) lgkmcnt(0)
    s_barrier
    v_mfma_f32_16x16x32_bf16 v[0:3], v[180:183], v[212:215], v[0:3]
    v_xor_b32 v236, 128, v254
    v_xor_b32 v237, 160, v254
    v_xor_b32 v238, 192, v254
    v_xor_b32 v239, 224, v254
    v_mfma_f32_16x16x32_bf16 v[64:67], v[184:187], v[212:215], v[64:67]
    ds_read_b128 v[172:175], v250 offset:0
    s_add_u32 m0, s69, 49152
    s_mul_i32 s77, s70, 3
    buffer_load_dwordx4 v246, s[44:47], s77 offen offset:0 lds
    v_mfma_f32_16x16x32_bf16 v[4:7], v[180:183], v[216:219], v[4:7]
    ds_read_b128 v[176:179], v250 offset:2048
    v_mfma_f32_16x16x32_bf16 v[68:71], v[184:187], v[216:219], v[68:71]
    ds_read_b64_tr_b16 v[128:129], v232 offset:0
    v_mfma_f32_16x16x32_bf16 v[8:11], v[180:183], v[220:223], v[8:11]
    ds_read_b64_tr_b16 v[130:131], v232 offset:1024
    buffer_load_dwordx4 v247, s[44:47], s77 offen offset:1024 lds
    v_mfma_f32_16x16x32_bf16 v[72:75], v[184:187], v[220:223], v[72:75]
    ds_read_b64_tr_b16 v[132:133], v233 offset:0
    v_mfma_f32_16x16x32_bf16 v[12:15], v[180:183], v[224:227], v[12:15]
    ds_read_b64_tr_b16 v[134:135], v233 offset:1024
    v_cvt_pk_bf16_f32 v67, v66, v67
    v_cvt_pk_bf16_f32 v66, v64, v65
    v_mfma_f32_16x16x32_bf16 v[76:79], v[184:187], v[224:227], v[76:79]
    ds_read_b64_tr_b16 v[136:137], v234 offset:0
    v_cvt_pk_bf16_f32 v64, v0, v1
    v_cvt_pk_bf16_f32 v65, v2, v3
    v_mfma_f32_16x16x32_bf16 v[16:19], v[188:191], v[212:215], v[16:19]
    ds_read_b64_tr_b16 v[138:139], v234 offset:1024
    s_add_u32 m0, s68, 32768
    s_movk_i32 s76, 256
    buffer_load_dwordx4 v240, s[36:39], s76 offen offset:0 lds
    v_mfma_f32_16x16x32_bf16 v[80:83], v[192:195], v[212:215], v[80:83]
    ds_read_b64_tr_b16 v[140:141], v235 offset:0
    v_cvt_pk_bf16_f32 v71, v70, v71
    v_cvt_pk_bf16_f32 v70, v68, v69
    v_mfma_f32_16x16x32_bf16 v[20:23], v[188:191], v[216:219], v[20:23]
    ds_read_b64_tr_b16 v[142:143], v235 offset:1024
    v_cvt_pk_bf16_f32 v68, v4, v5
    v_cvt_pk_bf16_f32 v69, v6, v7
    v_mfma_f32_16x16x32_bf16 v[84:87], v[192:195], v[216:219], v[84:87]
    ds_read_b64_tr_b16 v[144:145], v236 offset:0
    buffer_load_dwordx4 v241, s[36:39], s76 offen offset:1024 lds
    v_mfma_f32_16x16x32_bf16 v[24:27], v[188:191], v[220:223], v[24:27]
    ds_read_b64_tr_b16 v[146:147], v236 offset:1024
    v_cvt_pk_bf16_f32 v75, v74, v75
    v_cvt_pk_bf16_f32 v74, v72, v73
    v_mfma_f32_16x16x32_bf16 v[88:91], v[192:195], v[220:223], v[88:91]
    v_cvt_pk_bf16_f32 v72, v8, v9
    v_cvt_pk_bf16_f32 v73, v10, v11
    v_mfma_f32_16x16x32_bf16 v[28:31], v[188:191], v[224:227], v[28:31]
    ds_read_b64_tr_b16 v[148:149], v237 offset:0
    v_mfma_f32_16x16x32_bf16 v[92:95], v[192:195], v[224:227], v[92:95]
    ds_read_b64_tr_b16 v[150:151], v237 offset:1024
    v_cvt_pk_bf16_f32 v79, v78, v79
    v_cvt_pk_bf16_f32 v78, v76, v77
    v_mfma_f32_16x16x32_bf16 v[32:35], v[196:199], v[212:215], v[32:35]
    ds_read_b64_tr_b16 v[152:153], v238 offset:0
    v_cvt_pk_bf16_f32 v76, v12, v13
    v_cvt_pk_bf16_f32 v77, v14, v15
    v_mfma_f32_16x16x32_bf16 v[96:99], v[200:203], v[212:215], v[96:99]
    ds_read_b64_tr_b16 v[154:155], v238 offset:1024
    v_mfma_f32_16x16x32_bf16 v[36:39], v[196:199], v[216:219], v[36:39]
    ds_read_b64_tr_b16 v[156:157], v239 offset:0
    v_cvt_pk_bf16_f32 v83, v82, v83
    v_cvt_pk_bf16_f32 v82, v80, v81
    v_mfma_f32_16x16x32_bf16 v[100:103], v[200:203], v[216:219], v[100:103]
    ds_read_b64_tr_b16 v[158:159], v239 offset:1024
    v_cvt_pk_bf16_f32 v80, v16, v17
    v_cvt_pk_bf16_f32 v81, v18, v19
    v_mfma_f32_16x16x32_bf16 v[40:43], v[196:199], v[220:223], v[40:43]
    ds_read_b64_tr_b16 v[160:161], v232 offset:8192
    s_add_u32 s78, s73, 0
    buffer_store_dwordx4 v[64:67], v255, s[52:55], s78 offen offset:0 sc1
    v_mfma_f32_16x16x32_bf16 v[104:107], v[200:203], v[220:223], v[104:107]
    ds_read_b64_tr_b16 v[162:163], v232 offset:9216
    v_cvt_pk_bf16_f32 v87, v86, v87
    v_cvt_pk_bf16_f32 v86, v84, v85
    v_mfma_f32_16x16x32_bf16 v[44:47], v[196:199], v[224:227], v[44:47]
    ds_read_b64_tr_b16 v[164:165], v233 offset:8192
    v_cvt_pk_bf16_f32 v84, v20, v21
    v_cvt_pk_bf16_f32 v85, v22, v23
    s_add_u32 s78, s73, 0
    buffer_store_dwordx4 v[68:71], v255, s[52:55], s78 offen offset:1024 sc1
    v_mfma_f32_16x16x32_bf16 v[108:111], v[200:203], v[224:227], v[108:111]
    ds_read_b64_tr_b16 v[166:167], v233 offset:9216
    v_mfma_f32_16x16x32_bf16 v[48:51], v[204:207], v[212:215], v[48:51]
    ds_read_b64_tr_b16 v[168:169], v234 offset:8192
    v_cvt_pk_bf16_f32 v91, v90, v91
    v_cvt_pk_bf16_f32 v90, v88, v89
    s_add_u32 s78, s73, 0
    buffer_store_dwordx4 v[72:75], v255, s[52:55], s78 offen offset:2048 sc1
    v_mfma_f32_16x16x32_bf16 v[112:115], v[208:211], v[212:215], v[112:115]
    ds_read_b64_tr_b16 v[170:171], v234 offset:9216
    v_cvt_pk_bf16_f32 v88, v24, v25
    v_cvt_pk_bf16_f32 v89, v26, v27
    v_mfma_f32_16x16x32_bf16 v[52:55], v[204:207], v[216:219], v[52:55]
    s_add_u32 s78, s73, 0
    buffer_store_dwordx4 v[76:79], v255, s[52:55], s78 offen offset:3072 sc1
    v_mfma_f32_16x16x32_bf16 v[116:119], v[208:211], v[216:219], v[116:119]
    v_cvt_pk_bf16_f32 v95, v94, v95
    v_cvt_pk_bf16_f32 v94, v92, v93
    v_mfma_f32_16x16x32_bf16 v[56:59], v[204:207], v[220:223], v[56:59]
    v_cvt_pk_bf16_f32 v92, v28, v29
    v_cvt_pk_bf16_f32 v93, v30, v31
    v_mfma_f32_16x16x32_bf16 v[120:123], v[208:211], v[220:223], v[120:123]
    v_mfma_f32_16x16x32_bf16 v[60:63], v[204:207], v[224:227], v[60:63]
    v_mfma_f32_16x16x32_bf16 v[124:127], v[208:211], v[224:227], v[124:127]
    s_branch fmain_p2
Lgated_tch_1:
    buffer_load_dword v176, v178, s[44:47], 0 offen
    s_branch Lgated_tch_1_r
Lgated_tch_2:
    buffer_load_dword v176, v178, s[44:47], 0 offen
    s_branch Lgated_tch_2_r
Lgated_tch_3:
    buffer_load_dword v176, v178, s[44:47], 0 offen
    s_branch Lgated_tch_3_r
Lgated_tch_4:
    buffer_load_dword v176, v178, s[44:47], 0 offen
    s_branch Lgated_tch_4_r
Lgated_tch_5:
    buffer_load_dword v176, v178, s[44:47], 0 offen
    s_branch Lgated_tch_5_r
Lgated_tch_6:
    buffer_load_dword v176, v178, s[44:47], 0 offen
    s_branch Lgated_tch_6_r
Lgated_tch_7:
    buffer_load_dword v176, v178, s[44:47], 0 offen
    s_branch Lgated_tch_7_r
Lgated_tch_8:
    buffer_load_dword v176, v178, s[44:47], 0 offen
    s_branch Lgated_tch_8_r
Lgated_tch_9:
    s_cmp_eq_u32 s22, 4
    s_cbranch_scc1 Lgated_tch_9_a
    global_load_dword v176, v177, s[4:5]
    s_branch Lgated_tch_9_r
Lgated_tch_9_a:
    buffer_load_dword v176, v178, s[44:47], 0 offen
    s_branch Lgated_tch_9_r
Lgated_tch_10:
    s_cmp_eq_u32 s22, 4
    s_cbranch_scc1 Lgated_tch_10_a
    global_load_dword v176, v177, s[4:5]
    s_branch Lgated_tch_10_r
Lgated_tch_10_a:
    buffer_load_dword v176, v178, s[44:47], 0 offen
    s_branch Lgated_tch_10_r
Lgated_tch_11:
    s_cmp_eq_u32 s22, 4
    s_cbranch_scc1 Lgated_tch_11_a
    global_load_dword v176, v177, s[4:5]
    s_branch Lgated_tch_11_r
Lgated_tch_11_a:
    buffer_load_dword v176, v178, s[44:47], 0 offen
    s_branch Lgated_tch_11_r
Lgated_tch_12:
    s_cmp_eq_u32 s22, 4
    s_cbranch_scc1 Lgated_tch_12_a
    global_load_dword v176, v177, s[4:5]
    s_branch Lgated_tch_12_r
Lgated_tch_12_a:
    buffer_load_dword v176, v178, s[44:47], 0 offen
    s_branch Lgated_tch_12_r
Lgated_tch_13:
    s_cmp_eq_u32 s22, 4
    s_cbranch_scc1 Lgated_tch_13_a
    global_load_dword v176, v177, s[4:5]
    s_branch Lgated_tch_13_r
Lgated_tch_13_a:
    buffer_load_dword v176, v178, s[44:47], 0 offen
    s_branch Lgated_tch_13_r
Lgated_tch_14:
    s_cmp_eq_u32 s22, 4
    s_cbranch_scc1 Lgated_tch_14_a
    global_load_dword v176, v177, s[4:5]
    s_branch Lgated_tch_14_r
Lgated_tch_14_a:
    buffer_load_dword v176, v178, s[44:47], 0 offen
    s_branch Lgated_tch_14_r
Lgated_tch_15:
    s_cmp_eq_u32 s22, 4
    s_cbranch_scc1 Lgated_tch_15_a
    global_load_dword v176, v177, s[4:5]
    s_branch Lgated_tch_15_r
Lgated_tch_15_a:
    buffer_load_dword v176, v178, s[44:47], 0 offen
    s_branch Lgated_tch_15_r
Lgated_tch_16:
    s_cmp_eq_u32 s22, 4
    s_cbranch_scc1 Lgated_tch_16_a
    global_load_dword v176, v177, s[4:5]
    s_branch Lgated_tch_16_r
Lgated_tch_16_a:
    buffer_load_dword v176, v178, s[44:47], 0 offen
    s_branch Lgated_tch_16_r
fmain_p2:
    s_lshl_b32 s72, s22, 13
    s_add_u32 s72, s72, 73728
    v_mov_b32 v192, s18
    v_mov_b32 v193, s19
    v_lshrrev_b32 v194, 1, v255
    v_and_b32 v195, 0x38, v194
    s_waitcnt vmcnt(14) lgkmcnt(0)
    s_barrier
    v_mfma_f32_16x16x32_bf16 v[0:3], v[128:131], v[172:175], 0
    ds_read_b128 v[180:183], v251 offset:0
    ds_read_b128 v[184:187], v251 offset:2048
    v_mfma_f32_16x16x32_bf16 v[4:7], v[128:131], v[176:179], 0
    v_cvt_pk_bf16_f32 v99, v98, v99
    v_cvt_pk_bf16_f32 v98, v96, v97
    v_cvt_pk_bf16_f32 v96, v32, v33
    v_cvt_pk_bf16_f32 v97, v34, v35
    ds_read_b64_tr_b16 v[128:129], v232 offset:16384
    v_mfma_f32_16x16x32_bf16 v[8:11], v[132:135], v[172:175], 0
    v_cvt_pk_bf16_f32 v103, v102, v103
    v_cvt_pk_bf16_f32 v102, v100, v101
    v_cvt_pk_bf16_f32 v100, v36, v37
    v_cvt_pk_bf16_f32 v101, v38, v39
    ds_read_b64_tr_b16 v[130:131], v232 offset:17408
    s_add_u32 m0, s69, 0
    s_mul_i32 s77, s70, 4
    buffer_load_dwordx4 v246, s[44:47], s77 offen offset:0 lds
    v_mfma_f32_16x16x32_bf16 v[12:15], v[132:135], v[176:179], 0
    v_cvt_pk_bf16_f32 v107, v106, v107
    v_cvt_pk_bf16_f32 v106, v104, v105
    v_cvt_pk_bf16_f32 v104, v40, v41
    v_cvt_pk_bf16_f32 v105, v42, v43
    ds_read_b64_tr_b16 v[132:133], v233 offset:16384
    v_mfma_f32_16x16x32_bf16 v[16:19], v[136:139], v[172:175], 0
    v_cvt_pk_bf16_f32 v111, v110, v111
    v_cvt_pk_bf16_f32 v110, v108, v109
    v_cvt_pk_bf16_f32 v108, v44, v45
    v_cvt_pk_bf16_f32 v109, v46, v47
    ds_read_b64_tr_b16 v[134:135], v233 offset:17408
    v_mfma_f32_16x16x32_bf16 v[20:23], v[136:139], v[176:179], 0
    v_cvt_pk_bf16_f32 v115, v114, v115
    v_cvt_pk_bf16_f32 v114, v112, v113
    v_cvt_pk_bf16_f32 v112, v48, v49
    v_cvt_pk_bf16_f32 v113, v50, v51
    ds_read_b64_tr_b16 v[136:137], v234 offset:16384
    v_mfma_f32_16x16x32_bf16 v[24:27], v[140:143], v[172:175], 0
    v_cvt_pk_bf16_f32 v119, v118, v119
    v_cvt_pk_bf16_f32 v118, v116, v117
    v_cvt_pk_bf16_f32 v116, v52, v53
    v_cvt_pk_bf16_f32 v117, v54, v55
    ds_read_b64_tr_b16 v[138:139], v234 offset:17408
    buffer_load_dwordx4 v247, s[44:47], s77 offen offset:1024 lds
    v_mfma_f32_16x16x32_bf16 v[28:31], v[140:143], v[176:179], 0
    v_cvt_pk_bf16_f32 v123, v122, v123
    v_cvt_pk_bf16_f32 v122, v120, v121
    v_cvt_pk_bf16_f32 v120, v56, v57
    v_cvt_pk_bf16_f32 v121, v58, v59
    ds_read_b64_tr_b16 v[140:141], v235 offset:16384
    v_mfma_f32_16x16x32_bf16 v[32:35], v[144:147], v[172:175], 0
    v_cvt_pk_bf16_f32 v127, v126, v127
    v_cvt_pk_bf16_f32 v126, v124, v125
    v_cvt_pk_bf16_f32 v124, v60, v61
    v_cvt_pk_bf16_f32 v125, v62, v63
    ds_read_b64_tr_b16 v[142:143], v235 offset:17408
    v_mfma_f32_16x16x32_bf16 v[36:39], v[144:147], v[176:179], 0
    ds_read_b64_tr_b16 v[144:145], v236 offset:16384
    v_mfma_f32_16x16x32_bf16 v[40:43], v[148:151], v[172:175], 0
    ds_read_b64_tr_b16 v[146:147], v236 offset:17408
    s_add_u32 m0, s68, 32768
    s_movk_i32 s76, 256
    buffer_load_dwordx4 v242, s[36:39], s76 offen offset:2048 lds
    v_mfma_f32_16x16x32_bf16 v[44:47], v[148:151], v[176:179], 0
    ds_read_b64_tr_b16 v[148:149], v237 offset:16384
    v_mfma_f32_16x16x32_bf16 v[48:51], v[152:155], v[172:175], 0
    ds_read_b64_tr_b16 v[150:151], v237 offset:17408
    v_mfma_f32_16x16x32_bf16 v[52:55], v[152:155], v[176:179], 0
    ds_read_b64_tr_b16 v[152:153], v238 offset:16384
    v_mfma_f32_16x16x32_bf16 v[56:59], v[156:159], v[172:175], 0
    ds_read_b64_tr_b16 v[154:155], v238 offset:17408
    buffer_load_dwordx4 v243, s[36:39], s76 offen offset:3072 lds
    v_mfma_f32_16x16x32_bf16 v[60:63], v[156:159], v[176:179], 0
    ds_read_b64_tr_b16 v[156:157], v239 offset:16384
    v_mfma_f32_16x16x32_bf16 v[204:207], v[160:163], v[172:175], 0
    ds_read_b64_tr_b16 v[158:159], v239 offset:17408
    v_mfma_f32_16x16x32_bf16 v[208:211], v[160:163], v[176:179], 0
    ds_read_b64_tr_b16 v[160:161], v232 offset:24576
    v_mfma_f32_16x16x32_bf16 v[212:215], v[172:175], v[164:167], 0
    ds_read_b64_tr_b16 v[162:163], v232 offset:25600
    v_mfma_f32_16x16x32_bf16 v[216:219], v[176:179], v[164:167], 0
    ds_read_b64_tr_b16 v[164:165], v233 offset:24576
    v_mfma_f32_16x16x32_bf16 v[220:223], v[172:175], v[168:171], 0
    ds_read_b64_tr_b16 v[166:167], v233 offset:25600
    v_mfma_f32_16x16x32_bf16 v[224:227], v[176:179], v[168:171], 0
    ds_read_b64_tr_b16 v[168:169], v234 offset:24576
    ds_read_b64_tr_b16 v[170:171], v234 offset:25600
    s_waitcnt vmcnt(12) lgkmcnt(14)
    s_barrier
    v_mfma_f32_16x16x32_bf16 v[0:3], v[128:131], v[180:183], v[0:3]
    ds_read_b128 v[172:175], v248 offset:0
    ds_read_b128 v[176:179], v248 offset:2048
    v_mfma_f32_16x16x32_bf16 v[4:7], v[128:131], v[184:187], v[4:7]
    ds_read_b64_tr_b16 v[128:129], v232 offset:32768
    v_mfma_f32_16x16x32_bf16 v[8:11], v[132:135], v[180:183], v[8:11]
    ds_read_b64_tr_b16 v[130:131], v232 offset:33792
    s_and_b32 s17, s23, 7
    s_add_u32 m0, s68, 65536
    s_movk_i32 s76, 384
    buffer_load_dwordx4 v240, s[36:39], s76 offen offset:0 lds
    v_mfma_f32_16x16x32_bf16 v[12:15], v[132:135], v[184:187], v[12:15]
    ds_read_b64_tr_b16 v[132:133], v233 offset:32768
    s_lshr_b32 s14, s23, 3
    v_mfma_f32_16x16x32_bf16 v[16:19], v[136:139], v[180:183], v[16:19]
    ds_read_b64_tr_b16 v[134:135], v233 offset:33792
    s_and_b32 s78, s24, 1
    s_lshl_b32 s78, s78, 1
    s_xor_b32 s14, s14, s78
    v_mfma_f32_16x16x32_bf16 v[20:23], v[136:139], v[184:187], v[20:23]
    ds_read_b64_tr_b16 v[136:137], v234 offset:32768
    v_mfma_f32_16x16x32_bf16 v[24:27], v[140:143], v[180:183], v[24:27]
    ds_read_b64_tr_b16 v[138:139], v234 offset:33792
    s_sub_u32 s78, 15, s24
    v_mfma_f32_16x16x32_bf16 v[28:31], v[140:143], v[184:187], v[28:31]
    ds_read_b64_tr_b16 v[140:141], v235 offset:32768
    s_cmp_lt_u32 s14, 2
    s_cselect_b32 s78, s24, s78
    s_waitcnt lgkmcnt(13)
    v_mfma_f32_16x16x32_bf16 v[32:35], v[144:147], v[180:183], v[32:35]
    ds_read_b64_tr_b16 v[142:143], v235 offset:33792
    s_lshl_b32 s3, s78, 1
    v_mfma_f32_16x16x32_bf16 v[36:39], v[144:147], v[184:187], v[36:39]
    ds_read_b64_tr_b16 v[144:145], v236 offset:32768
    v_mfma_f32_16x16x32_bf16 v[40:43], v[148:151], v[180:183], v[40:43]
    ds_read_b64_tr_b16 v[146:147], v236 offset:33792
    s_and_b32 s78, s14, 1
    buffer_load_dwordx4 v241, s[36:39], s76 offen offset:1024 lds
    v_mfma_f32_16x16x32_bf16 v[44:47], v[148:151], v[184:187], v[44:47]
    ds_read_b64_tr_b16 v[148:149], v237 offset:32768
    s_add_u32 s3, s3, s78
    v_mfma_f32_16x16x32_bf16 v[48:51], v[152:155], v[180:183], v[48:51]
    ds_read_b64_tr_b16 v[150:151], v237 offset:33792
    s_lshl_b32 s78, s17, 7
    v_mfma_f32_16x16x32_bf16 v[52:55], v[152:155], v[184:187], v[52:55]
    ds_read_b64_tr_b16 v[152:153], v238 offset:32768
    v_mfma_f32_16x16x32_bf16 v[56:59], v[156:159], v[180:183], v[56:59]
    ds_read_b64_tr_b16 v[154:155], v238 offset:33792
    s_and_b32 s79, s22, 3
    v_mfma_f32_16x16x32_bf16 v[60:63], v[156:159], v[184:187], v[60:63]
    ds_read_b64_tr_b16 v[156:157], v239 offset:32768
    s_lshl_b32 s79, s79, 20
    s_waitcnt lgkmcnt(14)
    v_mfma_f32_16x16x32_bf16 v[204:207], v[160:163], v[180:183], v[204:207]
    ds_read_b64_tr_b16 v[158:159], v239 offset:33792
    s_add_u32 s79, s79, s78
    v_mfma_f32_16x16x32_bf16 v[208:211], v[160:163], v[184:187], v[208:211]
    ds_read_b64_tr_b16 v[160:161], v232 offset:40960
    v_mfma_f32_16x16x32_bf16 v[212:215], v[180:183], v[164:167], v[212:215]
    ds_read_b64_tr_b16 v[162:163], v232 offset:41984
    s_sub_u32 s42, 4194304, s79
    v_mfma_f32_16x16x32_bf16 v[216:219], v[184:187], v[164:167], v[216:219]
    ds_read_b64_tr_b16 v[164:165], v233 offset:40960
    s_add_u32 s40, s8, s79
    s_addc_u32 s41, s9, 0
    v_mfma_f32_16x16x32_bf16 v[220:223], v[180:183], v[168:171], v[220:223]
    ds_read_b64_tr_b16 v[166:167], v233 offset:41984
    v_mfma_f32_16x16x32_bf16 v[224:227], v[184:187], v[168:171], v[224:227]
    ds_read_b64_tr_b16 v[168:169], v234 offset:40960
    ds_read_b64_tr_b16 v[170:171], v234 offset:41984
    s_waitcnt vmcnt(12) lgkmcnt(14)
    s_barrier
    v_mfma_f32_16x16x32_bf16 v[0:3], v[128:131], v[172:175], v[0:3]
    ds_read_b128 v[180:183], v249 offset:0
    ds_read_b128 v[184:187], v249 offset:2048
    v_mfma_f32_16x16x32_bf16 v[4:7], v[128:131], v[176:179], v[4:7]
    ds_read_b64_tr_b16 v[128:129], v232 offset:49152
    v_mfma_f32_16x16x32_bf16 v[8:11], v[132:135], v[172:175], v[8:11]
    ds_read_b64_tr_b16 v[130:131], v232 offset:50176
    s_add_u32 m0, s69, 16384
    s_mul_i32 s77, s70, 5
    buffer_load_dwordx4 v246, s[44:47], s77 offen offset:0 lds
    v_mfma_f32_16x16x32_bf16 v[12:15], v[132:135], v[176:179], v[12:15]
    ds_read_b64_tr_b16 v[132:133], v233 offset:49152
    v_mfma_f32_16x16x32_bf16 v[16:19], v[136:139], v[172:175], v[16:19]
    ds_read_b64_tr_b16 v[134:135], v233 offset:50176
    v_mfma_f32_16x16x32_bf16 v[20:23], v[136:139], v[176:179], v[20:23]
    ds_read_b64_tr_b16 v[136:137], v234 offset:49152
    v_mfma_f32_16x16x32_bf16 v[24:27], v[140:143], v[172:175], v[24:27]
    ds_read_b64_tr_b16 v[138:139], v234 offset:50176
    buffer_load_dwordx4 v247, s[44:47], s77 offen offset:1024 lds
    v_mfma_f32_16x16x32_bf16 v[28:31], v[140:143], v[176:179], v[28:31]
    ds_read_b64_tr_b16 v[140:141], v235 offset:49152
    s_waitcnt lgkmcnt(13)
    v_mfma_f32_16x16x32_bf16 v[32:35], v[144:147], v[172:175], v[32:35]
    ds_read_b64_tr_b16 v[142:143], v235 offset:50176
    v_mfma_f32_16x16x32_bf16 v[36:39], v[144:147], v[176:179], v[36:39]
    ds_read_b64_tr_b16 v[144:145], v236 offset:49152
    v_mfma_f32_16x16x32_bf16 v[40:43], v[148:151], v[172:175], v[40:43]
    ds_read_b64_tr_b16 v[146:147], v236 offset:50176
    s_add_u32 m0, s68, 65536
    s_movk_i32 s76, 384
    buffer_load_dwordx4 v242, s[36:39], s76 offen offset:2048 lds
    v_mfma_f32_16x16x32_bf16 v[44:47], v[148:151], v[176:179], v[44:47]
    ds_read_b64_tr_b16 v[148:149], v237 offset:49152
    v_mfma_f32_16x16x32_bf16 v[48:51], v[152:155], v[172:175], v[48:51]
    ds_read_b64_tr_b16 v[150:151], v237 offset:50176
    v_mfma_f32_16x16x32_bf16 v[52:55], v[152:155], v[176:179], v[52:55]
    ds_read_b64_tr_b16 v[152:153], v238 offset:49152
    v_mfma_f32_16x16x32_bf16 v[56:59], v[156:159], v[172:175], v[56:59]
    ds_read_b64_tr_b16 v[154:155], v238 offset:50176
    buffer_load_dwordx4 v243, s[36:39], s76 offen offset:3072 lds
    v_mfma_f32_16x16x32_bf16 v[60:63], v[156:159], v[176:179], v[60:63]
    ds_read_b64_tr_b16 v[156:157], v239 offset:49152
    s_waitcnt lgkmcnt(14)
    v_mfma_f32_16x16x32_bf16 v[204:207], v[160:163], v[172:175], v[204:207]
    ds_read_b64_tr_b16 v[158:159], v239 offset:50176
    v_mfma_f32_16x16x32_bf16 v[208:211], v[160:163], v[176:179], v[208:211]
    ds_read_b64_tr_b16 v[160:161], v232 offset:57344
    v_mfma_f32_16x16x32_bf16 v[212:215], v[172:175], v[164:167], v[212:215]
    ds_read_b64_tr_b16 v[162:163], v232 offset:58368
    v_mfma_f32_16x16x32_bf16 v[216:219], v[176:179], v[164:167], v[216:219]
    ds_read_b64_tr_b16 v[164:165], v233 offset:57344
    v_mfma_f32_16x16x32_bf16 v[220:223], v[172:175], v[168:171], v[220:223]
    ds_read_b64_tr_b16 v[166:167], v233 offset:58368
    v_mfma_f32_16x16x32_bf16 v[224:227], v[176:179], v[168:171], v[224:227]
    ds_read_b64_tr_b16 v[168:169], v234 offset:57344
    ds_read_b64_tr_b16 v[170:171], v234 offset:58368
    s_waitcnt vmcnt(6) lgkmcnt(14)
    s_barrier
    v_mfma_f32_16x16x32_bf16 v[0:3], v[128:131], v[180:183], v[0:3]
    ds_read_b128 v[172:175], v248 offset:32768
    ds_read_b128 v[176:179], v248 offset:34816
    v_mfma_f32_16x16x32_bf16 v[4:7], v[128:131], v[184:187], v[4:7]
    ds_read_b64_tr_b16 v[128:129], v232 offset:0
    v_mfma_f32_16x16x32_bf16 v[8:11], v[132:135], v[180:183], v[8:11]
    ds_read_b64_tr_b16 v[130:131], v232 offset:1024
    s_add_u32 m0, s69, 32768
    s_mul_i32 s77, s70, 6
    buffer_load_dwordx4 v246, s[44:47], s77 offen offset:0 lds
    v_mfma_f32_16x16x32_bf16 v[12:15], v[132:135], v[184:187], v[12:15]
    ds_read_b64_tr_b16 v[132:133], v233 offset:0
    v_mfma_f32_16x16x32_bf16 v[16:19], v[136:139], v[180:183], v[16:19]
    ds_read_b64_tr_b16 v[134:135], v233 offset:1024
    v_mfma_f32_16x16x32_bf16 v[20:23], v[136:139], v[184:187], v[20:23]
    ds_read_b64_tr_b16 v[136:137], v234 offset:0
    v_mfma_f32_16x16x32_bf16 v[24:27], v[140:143], v[180:183], v[24:27]
    ds_read_b64_tr_b16 v[138:139], v234 offset:1024
    buffer_load_dwordx4 v247, s[44:47], s77 offen offset:1024 lds
    v_mfma_f32_16x16x32_bf16 v[28:31], v[140:143], v[184:187], v[28:31]
    ds_read_b64_tr_b16 v[140:141], v235 offset:0
    s_waitcnt lgkmcnt(13)
    v_mfma_f32_16x16x32_bf16 v[32:35], v[144:147], v[180:183], v[32:35]
    ds_read_b64_tr_b16 v[142:143], v235 offset:1024
    v_mfma_f32_16x16x32_bf16 v[36:39], v[144:147], v[184:187], v[36:39]
    ds_read_b64_tr_b16 v[144:145], v236 offset:0
    v_mfma_f32_16x16x32_bf16 v[40:43], v[148:151], v[180:183], v[40:43]
    ds_read_b64_tr_b16 v[146:147], v236 offset:1024
    s_add_u32 m0, s68, 0
    s_movk_i32 s76, 512
    buffer_load_dwordx4 v240, s[36:39], s76 offen offset:0 lds
    v_mfma_f32_16x16x32_bf16 v[44:47], v[148:151], v[184:187], v[44:47]
    ds_read_b64_tr_b16 v[148:149], v237 offset:0
    v_mfma_f32_16x16x32_bf16 v[48:51], v[152:155], v[180:183], v[48:51]
    ds_read_b64_tr_b16 v[150:151], v237 offset:1024
    v_mfma_f32_16x16x32_bf16 v[52:55], v[152:155], v[184:187], v[52:55]
    ds_read_b64_tr_b16 v[152:153], v238 offset:0
    v_mfma_f32_16x16x32_bf16 v[56:59], v[156:159], v[180:183], v[56:59]
    ds_read_b64_tr_b16 v[154:155], v238 offset:1024
    buffer_load_dwordx4 v241, s[36:39], s76 offen offset:1024 lds
    v_mfma_f32_16x16x32_bf16 v[60:63], v[156:159], v[184:187], v[60:63]
    ds_read_b64_tr_b16 v[156:157], v239 offset:0
    s_waitcnt lgkmcnt(14)
    v_mfma_f32_16x16x32_bf16 v[204:207], v[160:163], v[180:183], v[204:207]
    ds_read_b64_tr_b16 v[158:159], v239 offset:1024
    v_mfma_f32_16x16x32_bf16 v[208:211], v[160:163], v[184:187], v[208:211]
    ds_read_b64_tr_b16 v[160:161], v232 offset:8192
    v_mfma_f32_16x16x32_bf16 v[212:215], v[180:183], v[164:167], v[212:215]
    ds_read_b64_tr_b16 v[162:163], v232 offset:9216
    v_mfma_f32_16x16x32_bf16 v[216:219], v[184:187], v[164:167], v[216:219]
    ds_read_b64_tr_b16 v[164:165], v233 offset:8192
    v_mfma_f32_16x16x32_bf16 v[220:223], v[180:183], v[168:171], v[220:223]
    ds_read_b64_tr_b16 v[166:167], v233 offset:9216
    v_mfma_f32_16x16x32_bf16 v[224:227], v[184:187], v[168:171], v[224:227]
    ds_read_b64_tr_b16 v[168:169], v234 offset:8192
    ds_read_b64_tr_b16 v[170:171], v234 offset:9216
    s_waitcnt vmcnt(6) lgkmcnt(14)
    s_barrier
    v_mfma_f32_16x16x32_bf16 v[0:3], v[128:131], v[172:175], v[0:3]
    ds_read_b128 v[180:183], v249 offset:32768
    ds_read_b128 v[184:187], v249 offset:34816
    v_mfma_f32_16x16x32_bf16 v[4:7], v[128:131], v[176:179], v[4:7]
    ds_read_b64_tr_b16 v[128:129], v232 offset:16384
    v_mfma_f32_16x16x32_bf16 v[8:11], v[132:135], v[172:175], v[8:11]
    ds_read_b64_tr_b16 v[130:131], v232 offset:17408
    s_add_u32 m0, s69, 49152
    s_mul_i32 s77, s70, 7
    buffer_load_dwordx4 v246, s[44:47], s77 offen offset:0 lds
    v_mfma_f32_16x16x32_bf16 v[12:15], v[132:135], v[176:179], v[12:15]
    ds_read_b64_tr_b16 v[132:133], v233 offset:16384
    v_mfma_f32_16x16x32_bf16 v[16:19], v[136:139], v[172:175], v[16:19]
    ds_read_b64_tr_b16 v[134:135], v233 offset:17408
    v_mfma_f32_16x16x32_bf16 v[20:23], v[136:139], v[176:179], v[20:23]
    ds_read_b64_tr_b16 v[136:137], v234 offset:16384
    v_mfma_f32_16x16x32_bf16 v[24:27], v[140:143], v[172:175], v[24:27]
    ds_read_b64_tr_b16 v[138:139], v234 offset:17408
    buffer_load_dwordx4 v247, s[44:47], s77 offen offset:1024 lds
    v_mfma_f32_16x16x32_bf16 v[28:31], v[140:143], v[176:179], v[28:31]
    ds_read_b64_tr_b16 v[140:141], v235 offset:16384
    s_waitcnt lgkmcnt(13)
    v_mfma_f32_16x16x32_bf16 v[32:35], v[144:147], v[172:175], v[32:35]
    ds_read_b64_tr_b16 v[142:143], v235 offset:17408
    v_mfma_f32_16x16x32_bf16 v[36:39], v[144:147], v[176:179], v[36:39]
    ds_read_b64_tr_b16 v[144:145], v236 offset:16384
    v_mfma_f32_16x16x32_bf16 v[40:43], v[148:151], v[172:175], v[40:43]
    ds_read_b64_tr_b16 v[146:147], v236 offset:17408
    s_add_u32 m0, s68, 0
    s_movk_i32 s76, 512
    buffer_load_dwordx4 v242, s[36:39], s76 offen offset:2048 lds
    v_mfma_f32_16x16x32_bf16 v[44:47], v[148:151], v[176:179], v[44:47]
    ds_read_b64_tr_b16 v[148:149], v237 offset:16384
    v_mfma_f32_16x16x32_bf16 v[48:51], v[152:155], v[172:175], v[48:51]
    ds_read_b64_tr_b16 v[150:151], v237 offset:17408
    v_mfma_f32_16x16x32_bf16 v[52:55], v[152:155], v[176:179], v[52:55]
    ds_read_b64_tr_b16 v[152:153], v238 offset:16384
    v_mfma_f32_16x16x32_bf16 v[56:59], v[156:159], v[172:175], v[56:59]
    ds_read_b64_tr_b16 v[154:155], v238 offset:17408
    buffer_load_dwordx4 v243, s[36:39], s76 offen offset:3072 lds
    v_mfma_f32_16x16x32_bf16 v[60:63], v[156:159], v[176:179], v[60:63]
    ds_read_b64_tr_b16 v[156:157], v239 offset:16384
    s_waitcnt lgkmcnt(14)
    v_mfma_f32_16x16x32_bf16 v[204:207], v[160:163], v[172:175], v[204:207]
    ds_read_b64_tr_b16 v[158:159], v239 offset:17408
    v_mfma_f32_16x16x32_bf16 v[208:211], v[160:163], v[176:179], v[208:211]
    ds_read_b64_tr_b16 v[160:161], v232 offset:24576
    v_mfma_f32_16x16x32_bf16 v[212:215], v[172:175], v[164:167], v[212:215]
    ds_read_b64_tr_b16 v[162:163], v232 offset:25600
    v_mfma_f32_16x16x32_bf16 v[216:219], v[176:179], v[164:167], v[216:219]
    ds_read_b64_tr_b16 v[164:165], v233 offset:24576
    v_mfma_f32_16x16x32_bf16 v[220:223], v[172:175], v[168:171], v[220:223]
    ds_read_b64_tr_b16 v[166:167], v233 offset:25600
    s_lshl_b32 s76, s23, 11
    s_lshl_b32 s77, s24, 6
    s_add_u32 s76, s76, s77
    s_lshl_b32 s77, s22, 3
    s_add_u32 s76, s76, s77
    s_mov_b64 exec, 1
    buffer_store_dwordx2 v[192:193], v255, s[64:67], s76 offen offset:0 sc1
    s_mov_b64 exec, -1
    v_mfma_f32_16x16x32_bf16 v[224:227], v[176:179], v[168:171], v[224:227]
    ds_read_b64_tr_b16 v[168:169], v234 offset:24576
    ds_read_b64_tr_b16 v[170:171], v234 offset:25600
    s_waitcnt vmcnt(7) lgkmcnt(14)
    s_barrier
    v_mfma_f32_16x16x32_bf16 v[0:3], v[128:131], v[180:183], v[0:3]
    ds_read_b128 v[172:175], v250 offset:0
    ds_read_b128 v[176:179], v250 offset:2048
    v_mfma_f32_16x16x32_bf16 v[4:7], v[128:131], v[184:187], v[4:7]
    ds_read_b64_tr_b16 v[128:129], v232 offset:32768
    v_mfma_f32_16x16x32_bf16 v[8:11], v[132:135], v[180:183], v[8:11]
    ds_read_b64_tr_b16 v[130:131], v232 offset:33792
    s_add_u32 m0, s69, 0
    s_mul_i32 s77, s70, 8
    buffer_load_dwordx4 v246, s[44:47], s77 offen offset:0 lds
    v_mfma_f32_16x16x32_bf16 v[12:15], v[132:135], v[184:187], v[12:15]
    ds_read_b64_tr_b16 v[132:133], v233 offset:32768
    v_mfma_f32_16x16x32_bf16 v[16:19], v[136:139], v[180:183], v[16:19]
    ds_read_b64_tr_b16 v[134:135], v233 offset:33792
    v_mfma_f32_16x16x32_bf16 v[20:23], v[136:139], v[184:187], v[20:23]
    ds_read_b64_tr_b16 v[136:137], v234 offset:32768
    v_mfma_f32_16x16x32_bf16 v[24:27], v[140:143], v[180:183], v[24:27]
    ds_read_b64_tr_b16 v[138:139], v234 offset:33792
    buffer_load_dwordx4 v247, s[44:47], s77 offen offset:1024 lds
    v_mfma_f32_16x16x32_bf16 v[28:31], v[140:143], v[184:187], v[28:31]
    ds_read_b64_tr_b16 v[140:141], v235 offset:32768
    s_waitcnt lgkmcnt(13)
    v_mfma_f32_16x16x32_bf16 v[32:35], v[144:147], v[180:183], v[32:35]
    ds_read_b64_tr_b16 v[142:143], v235 offset:33792
    v_mfma_f32_16x16x32_bf16 v[36:39], v[144:147], v[184:187], v[36:39]
    ds_read_b64_tr_b16 v[144:145], v236 offset:32768
    v_mfma_f32_16x16x32_bf16 v[40:43], v[148:151], v[180:183], v[40:43]
    ds_read_b64_tr_b16 v[146:147], v236 offset:33792
    s_add_u32 m0, s68, 32768
    s_movk_i32 s76, 640
    buffer_load_dwordx4 v240, s[36:39], s76 offen offset:0 lds
    v_mfma_f32_16x16x32_bf16 v[44:47], v[148:151], v[184:187], v[44:47]
    ds_read_b64_tr_b16 v[148:149], v237 offset:32768
    v_mfma_f32_16x16x32_bf16 v[48:51], v[152:155], v[180:183], v[48:51]
    ds_read_b64_tr_b16 v[150:151], v237 offset:33792
    v_mfma_f32_16x16x32_bf16 v[52:55], v[152:155], v[184:187], v[52:55]
    ds_read_b64_tr_b16 v[152:153], v238 offset:32768
    v_mfma_f32_16x16x32_bf16 v[56:59], v[156:159], v[180:183], v[56:59]
    ds_read_b64_tr_b16 v[154:155], v238 offset:33792
    buffer_load_dwordx4 v241, s[36:39], s76 offen offset:1024 lds
    v_mfma_f32_16x16x32_bf16 v[60:63], v[156:159], v[184:187], v[60:63]
    ds_read_b64_tr_b16 v[156:157], v239 offset:32768
    s_waitcnt lgkmcnt(14)
    v_mfma_f32_16x16x32_bf16 v[204:207], v[160:163], v[180:183], v[204:207]
    ds_read_b64_tr_b16 v[158:159], v239 offset:33792
    v_mfma_f32_16x16x32_bf16 v[208:211], v[160:163], v[184:187], v[208:211]
    ds_read_b64_tr_b16 v[160:161], v232 offset:40960
    v_mfma_f32_16x16x32_bf16 v[212:215], v[180:183], v[164:167], v[212:215]
    ds_read_b64_tr_b16 v[162:163], v232 offset:41984
    v_mfma_f32_16x16x32_bf16 v[216:219], v[184:187], v[164:167], v[216:219]
    ds_read_b64_tr_b16 v[164:165], v233 offset:40960
    v_mfma_f32_16x16x32_bf16 v[220:223], v[180:183], v[168:171], v[220:223]
    ds_read_b64_tr_b16 v[166:167], v233 offset:41984
    v_mfma_f32_16x16x32_bf16 v[224:227], v[184:187], v[168:171], v[224:227]
    ds_read_b64_tr_b16 v[168:169], v234 offset:40960
    ds_read_b64_tr_b16 v[170:171], v234 offset:41984
    s_waitcnt vmcnt(7) lgkmcnt(14)
    s_barrier
    v_mfma_f32_16x16x32_bf16 v[0:3], v[128:131], v[172:175], v[0:3]
    ds_read_b128 v[180:183], v251 offset:0
    ds_read_b128 v[184:187], v251 offset:2048
    v_mfma_f32_16x16x32_bf16 v[4:7], v[128:131], v[176:179], v[4:7]
    ds_read_b64_tr_b16 v[128:129], v232 offset:49152
    v_mfma_f32_16x16x32_bf16 v[8:11], v[132:135], v[172:175], v[8:11]
    ds_read_b64_tr_b16 v[130:131], v232 offset:50176
    s_add_u32 m0, s69, 16384
    s_mul_i32 s77, s70, 9
    buffer_load_dwordx4 v246, s[44:47], s77 offen offset:0 lds
    v_mfma_f32_16x16x32_bf16 v[12:15], v[132:135], v[176:179], v[12:15]
    ds_read_b64_tr_b16 v[132:133], v233 offset:49152
    v_mfma_f32_16x16x32_bf16 v[16:19], v[136:139], v[172:175], v[16:19]
    ds_read_b64_tr_b16 v[134:135], v233 offset:50176
    v_mfma_f32_16x16x32_bf16 v[20:23], v[136:139], v[176:179], v[20:23]
    ds_read_b64_tr_b16 v[136:137], v234 offset:49152
    v_mfma_f32_16x16x32_bf16 v[24:27], v[140:143], v[172:175], v[24:27]
    ds_read_b64_tr_b16 v[138:139], v234 offset:50176
    buffer_load_dwordx4 v247, s[44:47], s77 offen offset:1024 lds
    v_mfma_f32_16x16x32_bf16 v[28:31], v[140:143], v[176:179], v[28:31]
    ds_read_b64_tr_b16 v[140:141], v235 offset:49152
    s_waitcnt lgkmcnt(13)
    v_mfma_f32_16x16x32_bf16 v[32:35], v[144:147], v[172:175], v[32:35]
    ds_read_b64_tr_b16 v[142:143], v235 offset:50176
    v_mfma_f32_16x16x32_bf16 v[36:39], v[144:147], v[176:179], v[36:39]
    ds_read_b64_tr_b16 v[144:145], v236 offset:49152
    v_mfma_f32_16x16x32_bf16 v[40:43], v[148:151], v[172:175], v[40:43]
    ds_read_b64_tr_b16 v[146:147], v236 offset:50176
    s_add_u32 m0, s68, 32768
    s_movk_i32 s76, 640
    buffer_load_dwordx4 v242, s[36:39], s76 offen offset:2048 lds
    v_mfma_f32_16x16x32_bf16 v[44:47], v[148:151], v[176:179], v[44:47]
    ds_read_b64_tr_b16 v[148:149], v237 offset:49152
    v_mfma_f32_16x16x32_bf16 v[48:51], v[152:155], v[172:175], v[48:51]
    ds_read_b64_tr_b16 v[150:151], v237 offset:50176
    v_mfma_f32_16x16x32_bf16 v[52:55], v[152:155], v[176:179], v[52:55]
    ds_read_b64_tr_b16 v[152:153], v238 offset:49152
    v_mfma_f32_16x16x32_bf16 v[56:59], v[156:159], v[172:175], v[56:59]
    ds_read_b64_tr_b16 v[154:155], v238 offset:50176
    buffer_load_dwordx4 v243, s[36:39], s76 offen offset:3072 lds
    v_mfma_f32_16x16x32_bf16 v[60:63], v[156:159], v[176:179], v[60:63]
    ds_read_b64_tr_b16 v[156:157], v239 offset:49152
    s_waitcnt lgkmcnt(14)
    v_mfma_f32_16x16x32_bf16 v[204:207], v[160:163], v[172:175], v[204:207]
    ds_read_b64_tr_b16 v[158:159], v239 offset:50176
    v_mfma_f32_16x16x32_bf16 v[208:211], v[160:163], v[176:179], v[208:211]
    ds_read_b64_tr_b16 v[160:161], v232 offset:57344
    v_mfma_f32_16x16x32_bf16 v[212:215], v[172:175], v[164:167], v[212:215]
    ds_read_b64_tr_b16 v[162:163], v232 offset:58368
    v_mfma_f32_16x16x32_bf16 v[216:219], v[176:179], v[164:167], v[216:219]
    ds_read_b64_tr_b16 v[164:165], v233 offset:57344
    v_mfma_f32_16x16x32_bf16 v[220:223], v[172:175], v[168:171], v[220:223]
    ds_read_b64_tr_b16 v[166:167], v233 offset:58368
    v_mfma_f32_16x16x32_bf16 v[224:227], v[176:179], v[168:171], v[224:227]
    ds_read_b64_tr_b16 v[168:169], v234 offset:57344
    ds_read_b64_tr_b16 v[170:171], v234 offset:58368
    s_waitcnt vmcnt(6) lgkmcnt(14)
    s_barrier
    v_mfma_f32_16x16x32_bf16 v[0:3], v[128:131], v[180:183], v[0:3]
    ds_read_b128 v[172:175], v248 offset:0
    ds_read_b128 v[176:179], v248 offset:2048
    v_mfma_f32_16x16x32_bf16 v[4:7], v[128:131], v[184:187], v[4:7]
    ds_read_b64_tr_b16 v[128:129], v232 offset:0
    v_mfma_f32_16x16x32_bf16 v[8:11], v[132:135], v[180:183], v[8:11]
    ds_read_b64_tr_b16 v[130:131], v232 offset:1024
    s_add_u32 m0, s69, 32768
    s_mul_i32 s77, s70, 10
    buffer_load_dwordx4 v246, s[44:47], s77 offen offset:0 lds
    v_mfma_f32_16x16x32_bf16 v[12:15], v[132:135], v[184:187], v[12:15]
    ds_read_b64_tr_b16 v[132:133], v233 offset:0
    v_mfma_f32_16x16x32_bf16 v[16:19], v[136:139], v[180:183], v[16:19]
    ds_read_b64_tr_b16 v[134:135], v233 offset:1024
    v_mfma_f32_16x16x32_bf16 v[20:23], v[136:139], v[184:187], v[20:23]
    ds_read_b64_tr_b16 v[136:137], v234 offset:0
    v_mfma_f32_16x16x32_bf16 v[24:27], v[140:143], v[180:183], v[24:27]
    ds_read_b64_tr_b16 v[138:139], v234 offset:1024
    buffer_load_dwordx4 v247, s[44:47], s77 offen offset:1024 lds
    v_mfma_f32_16x16x32_bf16 v[28:31], v[140:143], v[184:187], v[28:31]
    ds_read_b64_tr_b16 v[140:141], v235 offset:0
    s_waitcnt lgkmcnt(13)
    v_mfma_f32_16x16x32_bf16 v[32:35], v[144:147], v[180:183], v[32:35]
    ds_read_b64_tr_b16 v[142:143], v235 offset:1024
    v_mfma_f32_16x16x32_bf16 v[36:39], v[144:147], v[184:187], v[36:39]
    ds_read_b64_tr_b16 v[144:145], v236 offset:0
    v_mfma_f32_16x16x32_bf16 v[40:43], v[148:151], v[180:183], v[40:43]
    ds_read_b64_tr_b16 v[146:147], v236 offset:1024
    s_add_u32 m0, s68, 65536
    s_movk_i32 s76, 768
    buffer_load_dwordx4 v240, s[36:39], s76 offen offset:0 lds
    v_mfma_f32_16x16x32_bf16 v[44:47], v[148:151], v[184:187], v[44:47]
    ds_read_b64_tr_b16 v[148:149], v237 offset:0
    v_mfma_f32_16x16x32_bf16 v[48:51], v[152:155], v[180:183], v[48:51]
    ds_read_b64_tr_b16 v[150:151], v237 offset:1024
    v_mfma_f32_16x16x32_bf16 v[52:55], v[152:155], v[184:187], v[52:55]
    ds_read_b64_tr_b16 v[152:153], v238 offset:0
    v_mfma_f32_16x16x32_bf16 v[56:59], v[156:159], v[180:183], v[56:59]
    ds_read_b64_tr_b16 v[154:155], v238 offset:1024
    buffer_load_dwordx4 v241, s[36:39], s76 offen offset:1024 lds
    v_mfma_f32_16x16x32_bf16 v[60:63], v[156:159], v[184:187], v[60:63]
    ds_read_b64_tr_b16 v[156:157], v239 offset:0
    s_waitcnt lgkmcnt(14)
    v_mfma_f32_16x16x32_bf16 v[204:207], v[160:163], v[180:183], v[204:207]
    ds_read_b64_tr_b16 v[158:159], v239 offset:1024
    v_mfma_f32_16x16x32_bf16 v[208:211], v[160:163], v[184:187], v[208:211]
    ds_read_b64_tr_b16 v[160:161], v232 offset:8192
    v_mfma_f32_16x16x32_bf16 v[212:215], v[180:183], v[164:167], v[212:215]
    ds_read_b64_tr_b16 v[162:163], v232 offset:9216
    v_mfma_f32_16x16x32_bf16 v[216:219], v[184:187], v[164:167], v[216:219]
    ds_read_b64_tr_b16 v[164:165], v233 offset:8192
    v_mfma_f32_16x16x32_bf16 v[220:223], v[180:183], v[168:171], v[220:223]
    ds_read_b64_tr_b16 v[166:167], v233 offset:9216
    v_mfma_f32_16x16x32_bf16 v[224:227], v[184:187], v[168:171], v[224:227]
    ds_read_b64_tr_b16 v[168:169], v234 offset:8192
    ds_read_b64_tr_b16 v[170:171], v234 offset:9216
    s_waitcnt vmcnt(6) lgkmcnt(14)
    s_barrier
    v_mfma_f32_16x16x32_bf16 v[0:3], v[128:131], v[172:175], v[0:3]
    ds_read_b128 v[180:183], v249 offset:0
    ds_read_b128 v[184:187], v249 offset:2048
    v_mfma_f32_16x16x32_bf16 v[4:7], v[128:131], v[176:179], v[4:7]
    ds_read_b64_tr_b16 v[128:129], v232 offset:16384
    v_mfma_f32_16x16x32_bf16 v[8:11], v[132:135], v[172:175], v[8:11]
    ds_read_b64_tr_b16 v[130:131], v232 offset:17408
    s_add_u32 m0, s69, 49152
    s_mul_i32 s77, s70, 11
    buffer_load_dwordx4 v246, s[44:47], s77 offen offset:0 lds
    v_mfma_f32_16x16x32_bf16 v[12:15], v[132:135], v[176:179], v[12:15]
    ds_read_b64_tr_b16 v[132:133], v233 offset:16384
    v_mfma_f32_16x16x32_bf16 v[16:19], v[136:139], v[172:175], v[16:19]
    ds_read_b64_tr_b16 v[134:135], v233 offset:17408
    v_mfma_f32_16x16x32_bf16 v[20:23], v[136:139], v[176:179], v[20:23]
    ds_read_b64_tr_b16 v[136:137], v234 offset:16384
    v_mfma_f32_16x16x32_bf16 v[24:27], v[140:143], v[172:175], v[24:27]
    ds_read_b64_tr_b16 v[138:139], v234 offset:17408
    buffer_load_dwordx4 v247, s[44:47], s77 offen offset:1024 lds
    v_mfma_f32_16x16x32_bf16 v[28:31], v[140:143], v[176:179], v[28:31]
    ds_read_b64_tr_b16 v[140:141], v235 offset:16384
    s_waitcnt lgkmcnt(13)
    v_mfma_f32_16x16x32_bf16 v[32:35], v[144:147], v[172:175], v[32:35]
    ds_read_b64_tr_b16 v[142:143], v235 offset:17408
    v_mfma_f32_16x16x32_bf16 v[36:39], v[144:147], v[176:179], v[36:39]
    ds_read_b64_tr_b16 v[144:145], v236 offset:16384
    v_mfma_f32_16x16x32_bf16 v[40:43], v[148:151], v[172:175], v[40:43]
    ds_read_b64_tr_b16 v[146:147], v236 offset:17408
    s_add_u32 m0, s68, 65536
    s_movk_i32 s76, 768
    buffer_load_dwordx4 v242, s[36:39], s76 offen offset:2048 lds
    v_mfma_f32_16x16x32_bf16 v[44:47], v[148:151], v[176:179], v[44:47]
    ds_read_b64_tr_b16 v[148:149], v237 offset:16384
    v_mfma_f32_16x16x32_bf16 v[48:51], v[152:155], v[172:175], v[48:51]
    ds_read_b64_tr_b16 v[150:151], v237 offset:17408
    v_mfma_f32_16x16x32_bf16 v[52:55], v[152:155], v[176:179], v[52:55]
    ds_read_b64_tr_b16 v[152:153], v238 offset:16384
    v_mfma_f32_16x16x32_bf16 v[56:59], v[156:159], v[172:175], v[56:59]
    ds_read_b64_tr_b16 v[154:155], v238 offset:17408
    buffer_load_dwordx4 v243, s[36:39], s76 offen offset:3072 lds
    v_mfma_f32_16x16x32_bf16 v[60:63], v[156:159], v[176:179], v[60:63]
    ds_read_b64_tr_b16 v[156:157], v239 offset:16384
    s_waitcnt lgkmcnt(14)
    v_mfma_f32_16x16x32_bf16 v[204:207], v[160:163], v[172:175], v[204:207]
    ds_read_b64_tr_b16 v[158:159], v239 offset:17408
    v_mfma_f32_16x16x32_bf16 v[208:211], v[160:163], v[176:179], v[208:211]
    ds_read_b64_tr_b16 v[160:161], v232 offset:24576
    v_mfma_f32_16x16x32_bf16 v[212:215], v[172:175], v[164:167], v[212:215]
    ds_read_b64_tr_b16 v[162:163], v232 offset:25600
    v_mfma_f32_16x16x32_bf16 v[216:219], v[176:179], v[164:167], v[216:219]
    ds_read_b64_tr_b16 v[164:165], v233 offset:24576
    v_mfma_f32_16x16x32_bf16 v[220:223], v[172:175], v[168:171], v[220:223]
    ds_read_b64_tr_b16 v[166:167], v233 offset:25600
    v_mfma_f32_16x16x32_bf16 v[224:227], v[176:179], v[168:171], v[224:227]
    ds_read_b64_tr_b16 v[168:169], v234 offset:24576
    ds_read_b64_tr_b16 v[170:171], v234 offset:25600
    s_waitcnt vmcnt(6) lgkmcnt(14)
    s_barrier
    v_mfma_f32_16x16x32_bf16 v[0:3], v[128:131], v[180:183], v[0:3]
    ds_read_b128 v[172:175], v248 offset:32768
    ds_read_b128 v[176:179], v248 offset:34816
    v_mfma_f32_16x16x32_bf16 v[4:7], v[128:131], v[184:187], v[4:7]
    ds_read_b64_tr_b16 v[128:129], v232 offset:32768
    v_mfma_f32_16x16x32_bf16 v[8:11], v[132:135], v[180:183], v[8:11]
    ds_read_b64_tr_b16 v[130:131], v232 offset:33792
    s_add_u32 m0, s69, 0
    s_mul_i32 s77, s70, 12
    buffer_load_dwordx4 v246, s[44:47], s77 offen offset:0 lds
    v_mfma_f32_16x16x32_bf16 v[12:15], v[132:135], v[184:187], v[12:15]
    ds_read_b64_tr_b16 v[132:133], v233 offset:32768
    v_mfma_f32_16x16x32_bf16 v[16:19], v[136:139], v[180:183], v[16:19]
    ds_read_b64_tr_b16 v[134:135], v233 offset:33792
    v_mfma_f32_16x16x32_bf16 v[20:23], v[136:139], v[184:187], v[20:23]
    ds_read_b64_tr_b16 v[136:137], v234 offset:32768
    v_mfma_f32_16x16x32_bf16 v[24:27], v[140:143], v[180:183], v[24:27]
    ds_read_b64_tr_b16 v[138:139], v234 offset:33792
    buffer_load_dwordx4 v247, s[44:47], s77 offen offset:1024 lds
    v_mfma_f32_16x16x32_bf16 v[28:31], v[140:143], v[184:187], v[28:31]
    ds_read_b64_tr_b16 v[140:141], v235 offset:32768
    s_waitcnt lgkmcnt(13)
    v_mfma_f32_16x16x32_bf16 v[32:35], v[144:147], v[180:183], v[32:35]
    ds_read_b64_tr_b16 v[142:143], v235 offset:33792
    v_mfma_f32_16x16x32_bf16 v[36:39], v[144:147], v[184:187], v[36:39]
    ds_read_b64_tr_b16 v[144:145], v236 offset:32768
    v_mfma_f32_16x16x32_bf16 v[40:43], v[148:151], v[180:183], v[40:43]
    ds_read_b64_tr_b16 v[146:147], v236 offset:33792
    s_add_u32 m0, s68, 0
    s_movk_i32 s76, 896
    buffer_load_dwordx4 v240, s[36:39], s76 offen offset:0 lds
    v_mfma_f32_16x16x32_bf16 v[44:47], v[148:151], v[184:187], v[44:47]
    ds_read_b64_tr_b16 v[148:149], v237 offset:32768
    v_mfma_f32_16x16x32_bf16 v[48:51], v[152:155], v[180:183], v[48:51]
    ds_read_b64_tr_b16 v[150:151], v237 offset:33792
    v_mfma_f32_16x16x32_bf16 v[52:55], v[152:155], v[184:187], v[52:55]
    ds_read_b64_tr_b16 v[152:153], v238 offset:32768
    v_mfma_f32_16x16x32_bf16 v[56:59], v[156:159], v[180:183], v[56:59]
    ds_read_b64_tr_b16 v[154:155], v238 offset:33792
    buffer_load_dwordx4 v241, s[36:39], s76 offen offset:1024 lds
    v_mfma_f32_16x16x32_bf16 v[60:63], v[156:159], v[184:187], v[60:63]
    ds_read_b64_tr_b16 v[156:157], v239 offset:32768
    s_waitcnt lgkmcnt(14)
    v_mfma_f32_16x16x32_bf16 v[204:207], v[160:163], v[180:183], v[204:207]
    ds_read_b64_tr_b16 v[158:159], v239 offset:33792
    v_mfma_f32_16x16x32_bf16 v[208:211], v[160:163], v[184:187], v[208:211]
    ds_read_b64_tr_b16 v[160:161], v232 offset:40960
    v_mfma_f32_16x16x32_bf16 v[212:215], v[180:183], v[164:167], v[212:215]
    ds_read_b64_tr_b16 v[162:163], v232 offset:41984
    v_mfma_f32_16x16x32_bf16 v[216:219], v[184:187], v[164:167], v[216:219]
    ds_read_b64_tr_b16 v[164:165], v233 offset:40960
    v_mfma_f32_16x16x32_bf16 v[220:223], v[180:183], v[168:171], v[220:223]
    ds_read_b64_tr_b16 v[166:167], v233 offset:41984
    v_mfma_f32_16x16x32_bf16 v[224:227], v[184:187], v[168:171], v[224:227]
    ds_read_b64_tr_b16 v[168:169], v234 offset:40960
    ds_read_b64_tr_b16 v[170:171], v234 offset:41984
    s_waitcnt vmcnt(6) lgkmcnt(14)
    s_barrier
    v_mfma_f32_16x16x32_bf16 v[0:3], v[128:131], v[172:175], v[0:3]
    ds_read_b128 v[180:183], v249 offset:32768
    ds_read_b128 v[184:187], v249 offset:34816
    s_lshl_b32 s76, s23, 11
    buffer_load_dwordx2 v[196:197], v194, s[64:67], s76 offen offset:0 sc1
    v_mfma_f32_16x16x32_bf16 v[4:7], v[128:131], v[176:179], v[4:7]
    ds_read_b64_tr_b16 v[128:129], v232 offset:49152
    v_mfma_f32_16x16x32_bf16 v[8:11], v[132:135], v[172:175], v[8:11]
    ds_read_b64_tr_b16 v[130:131], v232 offset:50176
    s_add_u32 m0, s69, 16384
    s_mul_i32 s77, s70, 13
    buffer_load_dwordx4 v246, s[44:47], s77 offen offset:0 lds
    v_mfma_f32_16x16x32_bf16 v[12:15], v[132:135], v[176:179], v[12:15]
    ds_read_b64_tr_b16 v[132:133], v233 offset:49152
    v_mfma_f32_16x16x32_bf16 v[16:19], v[136:139], v[172:175], v[16:19]
    ds_read_b64_tr_b16 v[134:135], v233 offset:50176
    v_mfma_f32_16x16x32_bf16 v[20:23], v[136:139], v[176:179], v[20:23]
    ds_read_b64_tr_b16 v[136:137], v234 offset:49152
    v_mfma_f32_16x16x32_bf16 v[24:27], v[140:143], v[172:175], v[24:27]
    ds_read_b64_tr_b16 v[138:139], v234 offset:50176
    buffer_load_dwordx4 v247, s[44:47], s77 offen offset:1024 lds
    v_mfma_f32_16x16x32_bf16 v[28:31], v[140:143], v[176:179], v[28:31]
    ds_read_b64_tr_b16 v[140:141], v235 offset:49152
    s_waitcnt lgkmcnt(13)
    v_mfma_f32_16x16x32_bf16 v[32:35], v[144:147], v[172:175], v[32:35]
    ds_read_b64_tr_b16 v[142:143], v235 offset:50176
    v_mfma_f32_16x16x32_bf16 v[36:39], v[144:147], v[176:179], v[36:39]
    ds_read_b64_tr_b16 v[144:145], v236 offset:49152
    v_mfma_f32_16x16x32_bf16 v[40:43], v[148:151], v[172:175], v[40:43]
    ds_read_b64_tr_b16 v[146:147], v236 offset:50176
    s_add_u32 m0, s68, 0
    s_movk_i32 s76, 896
    buffer_load_dwordx4 v242, s[36:39], s76 offen offset:2048 lds
    v_mfma_f32_16x16x32_bf16 v[44:47], v[148:151], v[176:179], v[44:47]
    ds_read_b64_tr_b16 v[148:149], v237 offset:49152
    v_mfma_f32_16x16x32_bf16 v[48:51], v[152:155], v[172:175], v[48:51]
    ds_read_b64_tr_b16 v[150:151], v237 offset:50176
    v_mfma_f32_16x16x32_bf16 v[52:55], v[152:155], v[176:179], v[52:55]
    ds_read_b64_tr_b16 v[152:153], v238 offset:49152
    v_mfma_f32_16x16x32_bf16 v[56:59], v[156:159], v[172:175], v[56:59]
    ds_read_b64_tr_b16 v[154:155], v238 offset:50176
    buffer_load_dwordx4 v243, s[36:39], s76 offen offset:3072 lds
    v_mfma_f32_16x16x32_bf16 v[60:63], v[156:159], v[176:179], v[60:63]
    ds_read_b64_tr_b16 v[156:157], v239 offset:49152
    s_waitcnt lgkmcnt(14)
    v_mfma_f32_16x16x32_bf16 v[204:207], v[160:163], v[172:175], v[204:207]
    ds_read_b64_tr_b16 v[158:159], v239 offset:50176
    v_mfma_f32_16x16x32_bf16 v[208:211], v[160:163], v[176:179], v[208:211]
    ds_read_b64_tr_b16 v[160:161], v232 offset:57344
    v_mfma_f32_16x16x32_bf16 v[212:215], v[172:175], v[164:167], v[212:215]
    ds_read_b64_tr_b16 v[162:163], v232 offset:58368
    v_mfma_f32_16x16x32_bf16 v[216:219], v[176:179], v[164:167], v[216:219]
    ds_read_b64_tr_b16 v[164:165], v233 offset:57344
    v_mfma_f32_16x16x32_bf16 v[220:223], v[172:175], v[168:171], v[220:223]
    ds_read_b64_tr_b16 v[166:167], v233 offset:58368
    v_mfma_f32_16x16x32_bf16 v[224:227], v[176:179], v[168:171], v[224:227]
    ds_read_b64_tr_b16 v[168:169], v234 offset:57344
    ds_read_b64_tr_b16 v[170:171], v234 offset:58368
    s_waitcnt vmcnt(7) lgkmcnt(14)
    s_barrier
    v_mfma_f32_16x16x32_bf16 v[0:3], v[128:131], v[180:183], v[0:3]
    ds_read_b128 v[172:175], v250 offset:0
    ds_read_b128 v[176:179], v250 offset:2048
    v_mfma_f32_16x16x32_bf16 v[4:7], v[128:131], v[184:187], v[4:7]
    ds_read_b64_tr_b16 v[128:129], v232 offset:0
    v_mfma_f32_16x16x32_bf16 v[8:11], v[132:135], v[180:183], v[8:11]
    ds_read_b64_tr_b16 v[130:131], v232 offset:1024
    s_add_u32 m0, s69, 32768
    s_mul_i32 s77, s70, 14
    buffer_load_dwordx4 v246, s[44:47], s77 offen offset:0 lds
    v_mfma_f32_16x16x32_bf16 v[12:15], v[132:135], v[184:187], v[12:15]
    ds_read_b64_tr_b16 v[132:133], v233 offset:0
    v_mfma_f32_16x16x32_bf16 v[16:19], v[136:139], v[180:183], v[16:19]
    ds_read_b64_tr_b16 v[134:135], v233 offset:1024
    v_mfma_f32_16x16x32_bf16 v[20:23], v[136:139], v[184:187], v[20:23]
    ds_read_b64_tr_b16 v[136:137], v234 offset:0
    v_mfma_f32_16x16x32_bf16 v[24:27], v[140:143], v[180:183], v[24:27]
    ds_read_b64_tr_b16 v[138:139], v234 offset:1024
    v_mfma_f32_16x16x32_bf16 v[28:31], v[140:143], v[184:187], v[28:31]
    ds_read_b64_tr_b16 v[140:141], v235 offset:0
    s_waitcnt lgkmcnt(13)
    v_mfma_f32_16x16x32_bf16 v[32:35], v[144:147], v[180:183], v[32:35]
    ds_read_b64_tr_b16 v[142:143], v235 offset:1024
    v_mfma_f32_16x16x32_bf16 v[36:39], v[144:147], v[184:187], v[36:39]
    ds_read_b64_tr_b16 v[144:145], v236 offset:0
    v_mfma_f32_16x16x32_bf16 v[40:43], v[148:151], v[180:183], v[40:43]
    ds_read_b64_tr_b16 v[146:147], v236 offset:1024
    buffer_load_dwordx4 v247, s[44:47], s77 offen offset:1024 lds
    v_mfma_f32_16x16x32_bf16 v[44:47], v[148:151], v[184:187], v[44:47]
    ds_read_b64_tr_b16 v[148:149], v237 offset:0
    v_mfma_f32_16x16x32_bf16 v[48:51], v[152:155], v[180:183], v[48:51]
    ds_read_b64_tr_b16 v[150:151], v237 offset:1024
    v_mfma_f32_16x16x32_bf16 v[52:55], v[152:155], v[184:187], v[52:55]
    ds_read_b64_tr_b16 v[152:153], v238 offset:0
    v_mfma_f32_16x16x32_bf16 v[56:59], v[156:159], v[180:183], v[56:59]
    ds_read_b64_tr_b16 v[154:155], v238 offset:1024
    v_mfma_f32_16x16x32_bf16 v[60:63], v[156:159], v[184:187], v[60:63]
    ds_read_b64_tr_b16 v[156:157], v239 offset:0
    s_waitcnt lgkmcnt(14)
    v_mfma_f32_16x16x32_bf16 v[204:207], v[160:163], v[180:183], v[204:207]
    ds_read_b64_tr_b16 v[158:159], v239 offset:1024
    v_mfma_f32_16x16x32_bf16 v[208:211], v[160:163], v[184:187], v[208:211]
    ds_read_b64_tr_b16 v[160:161], v232 offset:8192
    v_mfma_f32_16x16x32_bf16 v[212:215], v[180:183], v[164:167], v[212:215]
    ds_read_b64_tr_b16 v[162:163], v232 offset:9216
    v_mfma_f32_16x16x32_bf16 v[216:219], v[184:187], v[164:167], v[216:219]
    ds_read_b64_tr_b16 v[164:165], v233 offset:8192
    v_mfma_f32_16x16x32_bf16 v[220:223], v[180:183], v[168:171], v[220:223]
    ds_read_b64_tr_b16 v[166:167], v233 offset:9216
    v_mfma_f32_16x16x32_bf16 v[224:227], v[184:187], v[168:171], v[224:227]
    ds_read_b64_tr_b16 v[168:169], v234 offset:8192
    ds_read_b64_tr_b16 v[170:171], v234 offset:9216
    s_waitcnt vmcnt(4) lgkmcnt(14)
    s_barrier
    v_cmp_ne_u64 vcc, s[18:19], v[196:197]
    s_cbranch_vccnz fmain_poll1
fmain_poll1_ok:
    v_mfma_f32_16x16x32_bf16 v[0:3], v[128:131], v[172:175], v[0:3]
    ds_read_b128 v[180:183], v251 offset:0
    ds_read_b128 v[184:187], v251 offset:2048
    v_mfma_f32_16x16x32_bf16 v[4:7], v[128:131], v[176:179], v[4:7]
    ds_read_b64_tr_b16 v[128:129], v232 offset:16384
    v_mfma_f32_16x16x32_bf16 v[8:11], v[132:135], v[172:175], v[8:11]
    ds_read_b64_tr_b16 v[130:131], v232 offset:17408
    s_add_u32 m0, s69, 49152
    s_mul_i32 s77, s70, 15
    buffer_load_dwordx4 v246, s[44:47], s77 offen offset:0 lds
    v_mfma_f32_16x16x32_bf16 v[12:15], v[132:135], v[176:179], v[12:15]
    ds_read_b64_tr_b16 v[132:133], v233 offset:16384
    v_mfma_f32_16x16x32_bf16 v[16:19], v[136:139], v[172:175], v[16:19]
    ds_read_b64_tr_b16 v[134:135], v233 offset:17408
    v_mfma_f32_16x16x32_bf16 v[20:23], v[136:139], v[176:179], v[20:23]
    ds_read_b64_tr_b16 v[136:137], v234 offset:16384
    buffer_load_dwordx4 v247, s[44:47], s77 offen offset:1024 lds
    v_mfma_f32_16x16x32_bf16 v[24:27], v[140:143], v[172:175], v[24:27]
    ds_read_b64_tr_b16 v[138:139], v234 offset:17408
    v_mfma_f32_16x16x32_bf16 v[28:31], v[140:143], v[176:179], v[28:31]
    ds_read_b64_tr_b16 v[140:141], v235 offset:16384
    s_waitcnt lgkmcnt(13)
    v_mfma_f32_16x16x32_bf16 v[32:35], v[144:147], v[172:175], v[32:35]
    ds_read_b64_tr_b16 v[142:143], v235 offset:17408
    s_add_u32 s71, s68, 32768
    s_and_b32 m0, s71, 0x1ffff
    s_sub_u32 s71, s71, 32768
    buffer_load_dwordx4 v255, s[48:51], s71 offen offset:0 sc1 lds
    v_mfma_f32_16x16x32_bf16 v[36:39], v[144:147], v[176:179], v[36:39]
    ds_read_b64_tr_b16 v[144:145], v236 offset:16384
    v_mfma_f32_16x16x32_bf16 v[40:43], v[148:151], v[172:175], v[40:43]
    ds_read_b64_tr_b16 v[146:147], v236 offset:17408
    v_mfma_f32_16x16x32_bf16 v[44:47], v[148:151], v[176:179], v[44:47]
    ds_read_b64_tr_b16 v[148:149], v237 offset:16384
    buffer_load_dwordx4 v255, s[48:51], s71 offen offset:1024 sc1 lds
    v_mfma_f32_16x16x32_bf16 v[48:51], v[152:155], v[172:175], v[48:51]
    ds_read_b64_tr_b16 v[150:151], v237 offset:17408
    v_mfma_f32_16x16x32_bf16 v[52:55], v[152:155], v[176:179], v[52:55]
    ds_read_b64_tr_b16 v[152:153], v238 offset:16384
    v_mfma_f32_16x16x32_bf16 v[56:59], v[156:159], v[172:175], v[56:59]
    ds_read_b64_tr_b16 v[154:155], v238 offset:17408
    buffer_load_dwordx4 v255, s[48:51], s71 offen offset:2048 sc1 lds
    v_mfma_f32_16x16x32_bf16 v[60:63], v[156:159], v[176:179], v[60:63]
    ds_read_b64_tr_b16 v[156:157], v239 offset:16384
    s_waitcnt lgkmcnt(14)
    v_mfma_f32_16x16x32_bf16 v[204:207], v[160:163], v[172:175], v[204:207]
    ds_read_b64_tr_b16 v[158:159], v239 offset:17408
    v_mfma_f32_16x16x32_bf16 v[208:211], v[160:163], v[176:179], v[208:211]
    ds_read_b64_tr_b16 v[160:161], v232 offset:24576
    buffer_load_dwordx4 v255, s[48:51], s71 offen offset:3072 sc1 lds
    v_mfma_f32_16x16x32_bf16 v[212:215], v[172:175], v[164:167], v[212:215]
    ds_read_b64_tr_b16 v[162:163], v232 offset:25600
    v_mfma_f32_16x16x32_bf16 v[216:219], v[176:179], v[164:167], v[216:219]
    ds_read_b64_tr_b16 v[164:165], v233 offset:24576
    v_mfma_f32_16x16x32_bf16 v[220:223], v[172:175], v[168:171], v[220:223]
    ds_read_b64_tr_b16 v[166:167], v233 offset:25600
    s_add_u32 s78, s73, 262144
    buffer_store_dwordx4 v[80:83], v255, s[52:55], s78 offen offset:0 sc1
    v_mfma_f32_16x16x32_bf16 v[224:227], v[176:179], v[168:171], v[224:227]
    ds_read_b64_tr_b16 v[168:169], v234 offset:24576
    ds_read_b64_tr_b16 v[170:171], v234 offset:25600
    s_waitcnt vmcnt(7) lgkmcnt(14)
    s_barrier
    v_mfma_f32_16x16x32_bf16 v[0:3], v[128:131], v[180:183], v[0:3]
    ds_read_b128 v[172:175], v248 offset:0
    ds_read_b128 v[176:179], v248 offset:2048
    s_mul_i32 s79, s22, 5120
    v_mfma_f32_16x16x32_bf16 v[4:7], v[128:131], v[184:187], v[4:7]
    ds_read_b64_tr_b16 v[128:129], v232 offset:32768
    v_mfma_f32_16x16x32_bf16 v[8:11], v[132:135], v[180:183], v[8:11]
    ds_read_b64_tr_b16 v[130:131], v232 offset:33792
    s_add_u32 s71, s79, 65536
    s_and_b32 m0, s71, 0x1ffff
    s_sub_u32 s71, s71, 32768
    buffer_load_dwordx4 v255, s[48:51], s71 offen offset:0 sc1 lds
    v_mfma_f32_16x16x32_bf16 v[12:15], v[132:135], v[184:187], v[12:15]
    ds_read_b64_tr_b16 v[132:133], v233 offset:32768
    v_mfma_f32_16x16x32_bf16 v[16:19], v[136:139], v[180:183], v[16:19]
    ds_read_b64_tr_b16 v[134:135], v233 offset:33792
    v_mfma_f32_16x16x32_bf16 v[20:23], v[136:139], v[184:187], v[20:23]
    ds_read_b64_tr_b16 v[136:137], v234 offset:32768
    v_mfma_f32_16x16x32_bf16 v[24:27], v[140:143], v[180:183], v[24:27]
    ds_read_b64_tr_b16 v[138:139], v234 offset:33792
    v_mfma_f32_16x16x32_bf16 v[28:31], v[140:143], v[184:187], v[28:31]
    ds_read_b64_tr_b16 v[140:141], v235 offset:32768
    buffer_load_dwordx4 v255, s[48:51], s71 offen offset:1024 sc1 lds
    s_waitcnt lgkmcnt(13)
    v_mfma_f32_16x16x32_bf16 v[32:35], v[144:147], v[180:183], v[32:35]
    ds_read_b64_tr_b16 v[142:143], v235 offset:33792
    v_mfma_f32_16x16x32_bf16 v[36:39], v[144:147], v[184:187], v[36:39]
    ds_read_b64_tr_b16 v[144:145], v236 offset:32768
    v_mfma_f32_16x16x32_bf16 v[40:43], v[148:151], v[180:183], v[40:43]
    ds_read_b64_tr_b16 v[146:147], v236 offset:33792
    v_mfma_f32_16x16x32_bf16 v[44:47], v[148:151], v[184:187], v[44:47]
    ds_read_b64_tr_b16 v[148:149], v237 offset:32768
    v_mfma_f32_16x16x32_bf16 v[48:51], v[152:155], v[180:183], v[48:51]
    ds_read_b64_tr_b16 v[150:151], v237 offset:33792
    buffer_load_dwordx4 v255, s[48:51], s71 offen offset:2048 sc1 lds
    v_mfma_f32_16x16x32_bf16 v[52:55], v[152:155], v[184:187], v[52:55]
    ds_read_b64_tr_b16 v[152:153], v238 offset:32768
    v_mfma_f32_16x16x32_bf16 v[56:59], v[156:159], v[180:183], v[56:59]
    ds_read_b64_tr_b16 v[154:155], v238 offset:33792
    v_mfma_f32_16x16x32_bf16 v[60:63], v[156:159], v[184:187], v[60:63]
    ds_read_b64_tr_b16 v[156:157], v239 offset:32768
    s_waitcnt lgkmcnt(14)
    v_mfma_f32_16x16x32_bf16 v[204:207], v[160:163], v[180:183], v[204:207]
    ds_read_b64_tr_b16 v[158:159], v239 offset:33792
    v_mfma_f32_16x16x32_bf16 v[208:211], v[160:163], v[184:187], v[208:211]
    ds_read_b64_tr_b16 v[160:161], v232 offset:40960
    v_mfma_f32_16x16x32_bf16 v[212:215], v[180:183], v[164:167], v[212:215]
    ds_read_b64_tr_b16 v[162:163], v232 offset:41984
    v_mfma_f32_16x16x32_bf16 v[216:219], v[184:187], v[164:167], v[216:219]
    ds_read_b64_tr_b16 v[164:165], v233 offset:40960
    v_mfma_f32_16x16x32_bf16 v[220:223], v[180:183], v[168:171], v[220:223]
    ds_read_b64_tr_b16 v[166:167], v233 offset:41984
    s_add_u32 s78, s73, 262144
    buffer_store_dwordx4 v[84:87], v255, s[52:55], s78 offen offset:1024 sc1
    v_mfma_f32_16x16x32_bf16 v[224:227], v[184:187], v[168:171], v[224:227]
    ds_read_b64_tr_b16 v[168:169], v234 offset:40960
    ds_read_b64_tr_b16 v[170:171], v234 offset:41984
    s_waitcnt vmcnt(9) lgkmcnt(14)
    s_barrier
    v_mfma_f32_16x16x32_bf16 v[0:3], v[128:131], v[172:175], v[0:3]
    ds_read_b128 v[180:183], v249 offset:0
    ds_read_b128 v[184:187], v249 offset:2048
    v_mfma_f32_16x16x32_bf16 v[4:7], v[128:131], v[176:179], v[4:7]
    ds_read_b64_tr_b16 v[128:129], v232 offset:49152
    v_mfma_f32_16x16x32_bf16 v[8:11], v[132:135], v[172:175], v[8:11]
    ds_read_b64_tr_b16 v[130:131], v232 offset:50176
    s_add_u32 s71, s79, 68608
    s_and_b32 m0, s71, 0x1ffff
    s_sub_u32 s71, s71, 32768
    buffer_load_dwordx4 v255, s[48:51], s71 offen offset:0 sc1 lds
    v_mfma_f32_16x16x32_bf16 v[12:15], v[132:135], v[176:179], v[12:15]
    ds_read_b64_tr_b16 v[132:133], v233 offset:49152
    v_mfma_f32_16x16x32_bf16 v[16:19], v[136:139], v[172:175], v[16:19]
    ds_read_b64_tr_b16 v[134:135], v233 offset:50176
    v_mfma_f32_16x16x32_bf16 v[20:23], v[136:139], v[176:179], v[20:23]
    ds_read_b64_tr_b16 v[136:137], v234 offset:49152
    v_mfma_f32_16x16x32_bf16 v[24:27], v[140:143], v[172:175], v[24:27]
    ds_read_b64_tr_b16 v[138:139], v234 offset:50176
    v_mfma_f32_16x16x32_bf16 v[28:31], v[140:143], v[176:179], v[28:31]
    ds_read_b64_tr_b16 v[140:141], v235 offset:49152
    s_waitcnt lgkmcnt(13)
    v_mfma_f32_16x16x32_bf16 v[32:35], v[144:147], v[172:175], v[32:35]
    ds_read_b64_tr_b16 v[142:143], v235 offset:50176
    buffer_load_dwordx4 v255, s[48:51], s71 offen offset:1024 sc1 lds
    v_mfma_f32_16x16x32_bf16 v[36:39], v[144:147], v[176:179], v[36:39]
    ds_read_b64_tr_b16 v[144:145], v236 offset:49152
    v_mfma_f32_16x16x32_bf16 v[40:43], v[148:151], v[172:175], v[40:43]
    ds_read_b64_tr_b16 v[146:147], v236 offset:50176
    v_mfma_f32_16x16x32_bf16 v[44:47], v[148:151], v[176:179], v[44:47]
    ds_read_b64_tr_b16 v[148:149], v237 offset:49152
    v_mfma_f32_16x16x32_bf16 v[48:51], v[152:155], v[172:175], v[48:51]
    ds_read_b64_tr_b16 v[150:151], v237 offset:50176
    v_mfma_f32_16x16x32_bf16 v[52:55], v[152:155], v[176:179], v[52:55]
    ds_read_b64_tr_b16 v[152:153], v238 offset:49152
    v_mfma_f32_16x16x32_bf16 v[56:59], v[156:159], v[172:175], v[56:59]
    ds_read_b64_tr_b16 v[154:155], v238 offset:50176
    v_mfma_f32_16x16x32_bf16 v[60:63], v[156:159], v[176:179], v[60:63]
    ds_read_b64_tr_b16 v[156:157], v239 offset:49152
    s_waitcnt lgkmcnt(14)
    v_mfma_f32_16x16x32_bf16 v[204:207], v[160:163], v[172:175], v[204:207]
    ds_read_b64_tr_b16 v[158:159], v239 offset:50176
    v_mfma_f32_16x16x32_bf16 v[208:211], v[160:163], v[176:179], v[208:211]
    ds_read_b64_tr_b16 v[160:161], v232 offset:57344
    v_mfma_f32_16x16x32_bf16 v[212:215], v[172:175], v[164:167], v[212:215]
    ds_read_b64_tr_b16 v[162:163], v232 offset:58368
    v_mfma_f32_16x16x32_bf16 v[216:219], v[176:179], v[164:167], v[216:219]
    ds_read_b64_tr_b16 v[164:165], v233 offset:57344
    v_mfma_f32_16x16x32_bf16 v[220:223], v[172:175], v[168:171], v[220:223]
    ds_read_b64_tr_b16 v[166:167], v233 offset:58368
    s_add_u32 s78, s73, 262144
    buffer_store_dwordx4 v[88:91], v255, s[52:55], s78 offen offset:2048 sc1
    v_mfma_f32_16x16x32_bf16 v[224:227], v[176:179], v[168:171], v[224:227]
    ds_read_b64_tr_b16 v[168:169], v234 offset:57344
    ds_read_b64_tr_b16 v[170:171], v234 offset:58368
    s_waitcnt lgkmcnt(0)
    s_barrier
    v_mfma_f32_16x16x32_bf16 v[212:215], v[180:183], v[164:167], v[212:215]
    s_add_u32 s78, s73, 262144
    buffer_store_dwordx4 v[92:95], v255, s[52:55], s78 offen offset:3072 sc1
    s_mov_b32 s78, 0x3fb8aa3b
    s_mov_b32 s79, 0x358637bd
    v_lshrrev_b32 v235, 2, v255
    s_lshl_b32 s76, s22, 8
    s_add_u32 s76, s76, 155648
    v_add_u32 v200, s76, v235
    s_and_b32 s76, s22, 3
    s_lshl_b32 s76, s76, 8
    v_mfma_f32_16x16x32_bf16 v[216:219], v[184:187], v[164:167], v[216:219]
    s_add_u32 s76, s76, 157696
    v_add_u32 v201, s76, v235
    v_mov_b32 v230, -2
    v_mov_b32 v188, 2
    ds_write_b32 v200, v230
    ds_write_b32 v201, v188
    v_lshrrev_b32 v235, 3, v195
    v_mfma_f32_16x16x32_bf16 v[220:223], v[180:183], v[168:171], v[220:223]
    v_mul_u32_u24 v229, 260, v235
    v_add_u32 v229, 155648, v229
    v_and_b32 v235, 3, v235
    v_mul_u32_u24 v228, 260, v235
    v_add_u32 v228, 157696, v228
    v_mov_b32 v254, 0
    v_mov_b32 v233, 0
    v_mov_b32 v234, 0
    v_mfma_f32_16x16x32_bf16 v[224:227], v[184:187], v[168:171], v[224:227]
    v_add_u32 v198, 0x10000, v255
    s_add_u32 s76, s26, 2
    s_and_b32 s76, s76, 7
    s_lshl_b32 s76, s76, 14
    s_add_u32 s76, s76, 8192
    v_add_u32 v199, s76, v255
    v_lshlrev_b32 v235, 2, v253
    v_sub_u32 v235, v252, v235
    v_mfma_f32_16x16x32_bf16 v[204:207], v[160:163], v[180:183], v[204:207]
    v_cmp_le_i32 s[80:81], 0, v235
    v_cmp_le_i32 s[82:83], 1, v235
    v_cmp_le_i32 s[84:85], 2, v235
    v_cmp_le_i32 s[86:87], 3, v235
    v_mov_b32 v244, 0x3f803f80
    v_mov_b32 v245, 0x3f803f80
    v_mov_b32 v246, 0x3f803f80
    v_mfma_f32_16x16x32_bf16 v[208:211], v[160:163], v[184:187], v[208:211]
    v_mov_b32 v247, 0x3f803f80
    s_lshl_b32 s76, s22, 11
    s_add_u32 s76, s76, 131072
    v_add_u32 v231, s76, v255
    s_lshl_b32 s76, s22, 10
    s_add_u32 s76, s76, 147456
    v_add_u32 v232, s76, v255
    s_mov_b32 s31, 0
    v_mfma_f32_16x16x32_bf16 v[0:3], v[128:131], v[180:183], v[0:3]
    v_cvt_pk_bf16_f32 v72, v212, v213
    v_cvt_pk_bf16_f32 v73, v214, v215
    v_cvt_pk_bf16_f32 v74, v216, v217
    v_cvt_pk_bf16_f32 v75, v218, v219
    v_lshlrev_b32 v212, 16, v72
    v_and_b32 v213, 0xffff0000, v72
    v_lshlrev_b32 v214, 16, v73
    v_and_b32 v215, 0xffff0000, v73
    v_mfma_f32_16x16x32_bf16 v[4:7], v[128:131], v[184:187], v[4:7]
    v_lshlrev_b32 v216, 16, v74
    v_and_b32 v217, 0xffff0000, v74
    v_lshlrev_b32 v218, 16, v75
    v_and_b32 v219, 0xffff0000, v75
    v_mul_f32 v64, s78, v212
    v_mul_f32 v65, s78, v213
    v_mul_f32 v66, s78, v214
    v_mul_f32 v67, s78, v215
    v_mfma_f32_16x16x32_bf16 v[8:11], v[132:135], v[180:183], v[8:11]
    v_mul_f32 v68, s78, v216
    v_mul_f32 v69, s78, v217
    v_mul_f32 v70, s78, v218
    v_mul_f32 v71, s78, v219
    v_exp_f32 v64, v64
    v_max_f32 v212, 0, v212
    v_exp_f32 v65, v65
    v_mfma_f32_16x16x32_bf16 v[12:15], v[132:135], v[184:187], v[12:15]
    v_max_f32 v213, 0, v213
    v_exp_f32 v66, v66
    v_max_f32 v214, 0, v214
    v_exp_f32 v67, v67
    v_max_f32 v215, 0, v215
    v_mfma_f32_16x16x32_bf16 v[16:19], v[136:139], v[180:183], v[16:19]
    v_exp_f32 v68, v68
    v_max_f32 v216, 0, v216
    v_exp_f32 v69, v69
    v_max_f32 v217, 0, v217
    v_exp_f32 v70, v70
    v_max_f32 v218, 0, v218
    v_mfma_f32_16x16x32_bf16 v[20:23], v[136:139], v[184:187], v[20:23]
    v_exp_f32 v71, v71
    v_max_f32 v219, 0, v219
    v_add_f32_e64 v64, s79, v64 clamp
    v_add_f32_e64 v65, s79, v65 clamp
    v_add_f32_e64 v66, s79, v66 clamp
    v_add_f32_e64 v67, s79, v67 clamp
    v_add_f32_e64 v68, s79, v68 clamp
    v_mfma_f32_16x16x32_bf16 v[24:27], v[140:143], v[180:183], v[24:27]
    v_add_f32_e64 v69, s79, v69 clamp
    v_add_f32_e64 v70, s79, v70 clamp
    v_add_f32_e64 v71, s79, v71 clamp
    v_add_f32 v212, v212, v64
    v_add_f32 v213, v213, v65
    v_add_f32 v214, v214, v66
    v_add_f32 v215, v215, v67
    v_add_f32 v216, v216, v68
    v_add_f32 v217, v217, v69
    v_mfma_f32_16x16x32_bf16 v[28:31], v[140:143], v[184:187], v[28:31]
    v_add_f32 v218, v218, v70
    v_add_f32 v219, v219, v71
    v_cvt_pk_bf16_f32 v76, v212, v213
    v_cvt_pk_bf16_f32 v77, v214, v215
    v_cvt_pk_bf16_f32 v78, v216, v217
    v_cvt_pk_bf16_f32 v79, v218, v219
    v_cvt_pk_bf16_f32 v236, v220, v221
    v_cvt_pk_bf16_f32 v237, v222, v223
    v_mfma_f32_16x16x32_bf16 v[32:35], v[144:147], v[180:183], v[32:35]
    v_cvt_pk_bf16_f32 v238, v224, v225
    v_cvt_pk_bf16_f32 v239, v226, v227
    v_cvt_pk_bf16_f32 v72, v204, v205
    v_cvt_pk_bf16_f32 v73, v206, v207
    v_cvt_pk_bf16_f32 v74, v208, v209
    v_cvt_pk_bf16_f32 v75, v210, v211
    v_lshlrev_b32 v204, 16, v72
    v_and_b32 v205, 0xffff0000, v72
    v_mfma_f32_16x16x32_bf16 v[36:39], v[144:147], v[184:187], v[36:39]
    v_lshlrev_b32 v206, 16, v73
    v_and_b32 v207, 0xffff0000, v73
    v_lshlrev_b32 v208, 16, v74
    v_and_b32 v209, 0xffff0000, v74
    v_lshlrev_b32 v210, 16, v75
    v_and_b32 v211, 0xffff0000, v75
    v_mul_f32 v64, s78, v204
    v_mul_f32 v65, s78, v205
    v_mfma_f32_16x16x32_bf16 v[40:43], v[148:151], v[180:183], v[40:43]
    v_mul_f32 v66, s78, v206
    v_mul_f32 v67, s78, v207
    v_mul_f32 v68, s78, v208
    v_mul_f32 v69, s78, v209
    v_mul_f32 v70, s78, v210
    v_mul_f32 v71, s78, v211
    v_exp_f32 v64, v64
    v_max_f32 v204, 0, v204
    v_mfma_f32_16x16x32_bf16 v[44:47], v[148:151], v[184:187], v[44:47]
    v_exp_f32 v65, v65
    v_max_f32 v205, 0, v205
    v_exp_f32 v66, v66
    v_max_f32 v206, 0, v206
    v_exp_f32 v67, v67
    v_mfma_f32_16x16x32_bf16 v[48:51], v[152:155], v[180:183], v[48:51]
    v_max_f32 v207, 0, v207
    v_exp_f32 v68, v68
    v_max_f32 v208, 0, v208
    v_exp_f32 v69, v69
    v_max_f32 v209, 0, v209
    v_exp_f32 v70, v70
    v_mfma_f32_16x16x32_bf16 v[52:55], v[152:155], v[184:187], v[52:55]
    v_max_f32 v210, 0, v210
    v_exp_f32 v71, v71
    v_max_f32 v211, 0, v211
    v_add_f32_e64 v64, s79, v64 clamp
    v_add_f32_e64 v65, s79, v65 clamp
    v_add_f32_e64 v66, s79, v66 clamp
    v_mfma_f32_16x16x32_bf16 v[56:59], v[156:159], v[180:183], v[56:59]
    v_add_f32_e64 v67, s79, v67 clamp
    v_add_f32_e64 v68, s79, v68 clamp
    v_add_f32_e64 v69, s79, v69 clamp
    v_add_f32_e64 v70, s79, v70 clamp
    v_add_f32_e64 v71, s79, v71 clamp
    v_add_f32 v204, v204, v64
    v_add_f32 v205, v205, v65
    v_add_f32 v206, v206, v66
    v_add_f32 v207, v207, v67
    v_mfma_f32_16x16x32_bf16 v[60:63], v[156:159], v[184:187], v[60:63]
    v_add_f32 v208, v208, v68
    v_add_f32 v209, v209, v69
    v_add_f32 v210, v210, v70
    v_add_f32 v211, v211, v71
    v_cvt_pk_bf16_f32 v248, v204, v205
    v_cvt_pk_bf16_f32 v249, v206, v207
    v_cvt_pk_bf16_f32 v250, v208, v209
    v_cvt_pk_bf16_f32 v251, v210, v211
    s_nop 1
    v_mfma_f32_16x16x32_bf16 v[212:215], v[76:79], v[236:239], 0
    v_mfma_f32_16x16x32_bf16 v[220:223], v[76:79], v[244:247], 0
    ds_write_b128 v232, v[248:251]
    s_mov_b32 s78, 0x3e0293ee
    s_mov_b32 s79, 0x3e0293ee
    v_pk_mul_f32 v[0:1], v[0:1], s[78:79]
    v_pk_mul_f32 v[2:3], v[2:3], s[78:79]
    v_pk_mul_f32 v[8:9], v[8:9], s[78:79]
    v_pk_mul_f32 v[10:11], v[10:11], s[78:79]
    v_cvt_pk_bf16_f32 v160, v0, v1
    v_cvt_pk_bf16_f32 v161, v2, v3
    v_cvt_pk_bf16_f32 v162, v8, v9
    v_cvt_pk_bf16_f32 v163, v10, v11
    v_pk_mul_f32 v[4:5], v[4:5], s[78:79]
    v_pk_mul_f32 v[6:7], v[6:7], s[78:79]
    v_pk_mul_f32 v[12:13], v[12:13], s[78:79]
    v_pk_mul_f32 v[14:15], v[14:15], s[78:79]
    v_cvt_pk_bf16_f32 v176, v4, v5
    v_cvt_pk_bf16_f32 v177, v6, v7
    v_cvt_pk_bf16_f32 v178, v12, v13
    v_cvt_pk_bf16_f32 v179, v14, v15
    v_pk_mul_f32 v[16:17], v[16:17], s[78:79]
    v_pk_mul_f32 v[18:19], v[18:19], s[78:79]
    v_pk_mul_f32 v[24:25], v[24:25], s[78:79]
    v_pk_mul_f32 v[26:27], v[26:27], s[78:79]
    v_cvt_pk_bf16_f32 v164, v16, v17
    v_cvt_pk_bf16_f32 v165, v18, v19
    v_cvt_pk_bf16_f32 v166, v24, v25
    v_cvt_pk_bf16_f32 v167, v26, v27
    ds_write_b128 v231, v[212:215]
    ds_write_b128 v231, v[220:223] offset:1024
    v_pk_mul_f32 v[20:21], v[20:21], s[78:79]
    v_pk_mul_f32 v[22:23], v[22:23], s[78:79]
    v_pk_mul_f32 v[28:29], v[28:29], s[78:79]
    v_pk_mul_f32 v[30:31], v[30:31], s[78:79]
    v_cvt_pk_bf16_f32 v180, v20, v21
    v_cvt_pk_bf16_f32 v181, v22, v23
    v_cvt_pk_bf16_f32 v182, v28, v29
    v_cvt_pk_bf16_f32 v183, v30, v31
    v_pk_mul_f32 v[32:33], v[32:33], s[78:79]
    v_pk_mul_f32 v[34:35], v[34:35], s[78:79]
    v_pk_mul_f32 v[40:41], v[40:41], s[78:79]
    v_pk_mul_f32 v[42:43], v[42:43], s[78:79]
    v_cvt_pk_bf16_f32 v168, v32, v33
    v_cvt_pk_bf16_f32 v169, v34, v35
    v_cvt_pk_bf16_f32 v170, v40, v41
    v_cvt_pk_bf16_f32 v171, v42, v43
    v_pk_mul_f32 v[36:37], v[36:37], s[78:79]
    v_pk_mul_f32 v[38:39], v[38:39], s[78:79]
    v_pk_mul_f32 v[44:45], v[44:45], s[78:79]
    v_pk_mul_f32 v[46:47], v[46:47], s[78:79]
    v_cvt_pk_bf16_f32 v184, v36, v37
    v_cvt_pk_bf16_f32 v185, v38, v39
    v_cvt_pk_bf16_f32 v186, v44, v45
    v_cvt_pk_bf16_f32 v187, v46, v47
    v_pk_mul_f32 v[48:49], v[48:49], s[78:79]
    v_pk_mul_f32 v[50:51], v[50:51], s[78:79]
    v_pk_mul_f32 v[56:57], v[56:57], s[78:79]
    v_pk_mul_f32 v[58:59], v[58:59], s[78:79]
    v_cvt_pk_bf16_f32 v172, v48, v49
    v_cvt_pk_bf16_f32 v173, v50, v51
    v_cvt_pk_bf16_f32 v174, v56, v57
    v_cvt_pk_bf16_f32 v175, v58, v59
    v_pk_mul_f32 v[52:53], v[52:53], s[78:79]
    v_pk_mul_f32 v[54:55], v[54:55], s[78:79]
    v_pk_mul_f32 v[60:61], v[60:61], s[78:79]
    v_pk_mul_f32 v[62:63], v[62:63], s[78:79]
    v_cvt_pk_bf16_f32 v188, v52, v53
    v_cvt_pk_bf16_f32 v189, v54, v55
    v_cvt_pk_bf16_f32 v190, v60, v61
    v_cvt_pk_bf16_f32 v191, v62, v63
    s_waitcnt vmcnt(0)
    s_lshl_b32 s76, s23, 11
    s_lshl_b32 s77, s24, 6
    s_add_u32 s76, s76, s77
    s_lshl_b32 s77, s22, 3
    s_add_u32 s76, s76, s77
    s_mov_b64 exec, 1
    buffer_store_dwordx2 v[192:193], v255, s[64:67], s76 offen offset:512 sc1
    s_mov_b64 exec, -1
    s_waitcnt lgkmcnt(0)
    s_barrier
    s_cmp_eq_u32 s29, 1
    s_cbranch_scc1 fmain_nold1
    s_add_u32 s71, s72, 32768
    s_and_b32 m0, s71, 0x1ffff
    s_sub_u32 s71, s71, 32768
    buffer_load_dwordx4 v255, s[48:51], s71 offen offset:0 sc1 lds
    buffer_load_dwordx4 v255, s[48:51], s71 offen offset:1024 sc1 lds
    buffer_load_dwordx4 v255, s[48:51], s71 offen offset:2048 sc1 lds
    buffer_load_dwordx4 v255, s[48:51], s71 offen offset:3072 sc1 lds
    s_add_u32 s71, s72, 36864
    s_and_b32 m0, s71, 0x1ffff
    s_sub_u32 s71, s71, 32768
    buffer_load_dwordx4 v255, s[48:51], s71 offen offset:0 sc1 lds
    buffer_load_dwordx4 v255, s[48:51], s71 offen offset:1024 sc1 lds
    buffer_load_dwordx4 v255, s[48:51], s71 offen offset:2048 sc1 lds
    buffer_load_dwordx4 v255, s[48:51], s71 offen offset:3072 sc1 lds
fmain_nold1:
    s_add_u32 s72, s72, 32768
    ds_read_b128 v[128:131], v255 offset:32768
    ds_read_b128 v[132:135], v255 offset:33792
    ds_read_b128 v[136:139], v255 offset:36864
    ds_read_b128 v[140:143], v255 offset:37888
    ds_read_b128 v[144:147], v255 offset:34816
    ds_read_b128 v[148:151], v255 offset:35840
    ds_read_b128 v[152:155], v255 offset:38912
    ds_read_b128 v[156:159], v255 offset:39936
    s_cmp_lg_u32 s22, 7
    s_cbranch_scc1 fmain_nored
    v_add_u32 v214, 131072, v255
    ds_read_b128 v[64:67], v214 offset:0
    ds_read_b128 v[68:71], v214 offset:2048
    ds_read_b128 v[72:75], v214 offset:4096
    ds_read_b128 v[76:79], v214 offset:6144
    ds_read_b128 v[80:83], v214 offset:8192
    ds_read_b128 v[84:87], v214 offset:10240
    ds_read_b128 v[88:91], v214 offset:12288
    ds_read_b128 v[92:95], v214 offset:14336
    s_waitcnt lgkmcnt(0)
    v_pk_add_f32 v[64:65], v[64:65], v[80:81]
    v_pk_add_f32 v[66:67], v[66:67], v[82:83]
    v_pk_add_f32 v[68:69], v[68:69], v[84:85]
    v_pk_add_f32 v[70:71], v[70:71], v[86:87]
    v_pk_add_f32 v[72:73], v[72:73], v[88:89]
    v_pk_add_f32 v[74:75], v[74:75], v[90:91]
    v_pk_add_f32 v[76:77], v[76:77], v[92:93]
    v_pk_add_f32 v[78:79], v[78:79], v[94:95]
    v_pk_add_f32 v[64:65], v[64:65], v[72:73]
    v_pk_add_f32 v[66:67], v[66:67], v[74:75]
    v_pk_add_f32 v[68:69], v[68:69], v[76:77]
    v_pk_add_f32 v[70:71], v[70:71], v[78:79]
    v_pk_add_f32 v[220:221], v[64:65], v[68:69]
    v_pk_add_f32 v[222:223], v[66:67], v[70:71]
    ds_read_b128 v[64:67], v214 offset:1024
    ds_read_b128 v[68:71], v214 offset:3072
    ds_read_b128 v[72:75], v214 offset:5120
    ds_read_b128 v[76:79], v214 offset:7168
    ds_read_b128 v[80:83], v214 offset:9216
    ds_read_b128 v[84:87], v214 offset:11264
    ds_read_b128 v[88:91], v214 offset:13312
    ds_read_b128 v[92:95], v214 offset:15360
    s_waitcnt lgkmcnt(0)
    v_pk_add_f32 v[64:65], v[64:65], v[80:81]
    v_pk_add_f32 v[66:67], v[66:67], v[82:83]
    v_pk_add_f32 v[68:69], v[68:69], v[84:85]
    v_pk_add_f32 v[70:71], v[70:71], v[86:87]
    v_pk_add_f32 v[72:73], v[72:73], v[88:89]
    v_pk_add_f32 v[74:75], v[74:75], v[90:91]
    v_pk_add_f32 v[76:77], v[76:77], v[92:93]
    v_pk_add_f32 v[78:79], v[78:79], v[94:95]
    v_pk_add_f32 v[64:65], v[64:65], v[72:73]
    v_pk_add_f32 v[66:67], v[66:67], v[74:75]
    v_pk_add_f32 v[68:69], v[68:69], v[76:77]
    v_pk_add_f32 v[70:71], v[70:71], v[78:79]
    v_pk_add_f32 v[224:225], v[64:65], v[68:69]
    v_pk_add_f32 v[226:227], v[66:67], v[70:71]
    s_lshl_b32 s76, s23, 3
    s_add_u32 s76, s76, s24
    s_lshl_b32 s76, s76, 11
    buffer_store_dwordx4 v[220:223], v255, s[60:63], s76 offen sc1
    buffer_store_dwordx4 v[224:227], v255, s[60:63], s76 offen offset:1024 sc1
fmain_nored:
    s_waitcnt lgkmcnt(4)
    v_mfma_f32_16x16x32_bf16 v[64:67], v[128:131], v[160:163], 0
    v_mfma_f32_16x16x32_bf16 v[68:71], v[128:131], v[176:179], 0
    ds_read_b128 v[128:131], v255 offset:49152
    v_mfma_f32_16x16x32_bf16 v[64:67], v[132:135], v[164:167], v[64:67]
    v_mfma_f32_16x16x32_bf16 v[68:71], v[132:135], v[180:183], v[68:71]
    ds_read_b128 v[132:135], v255 offset:50176
    v_mfma_f32_16x16x32_bf16 v[64:67], v[136:139], v[168:171], v[64:67]
    v_mfma_f32_16x16x32_bf16 v[68:71], v[136:139], v[184:187], v[68:71]
    ds_read_b128 v[136:139], v255 offset:53248
    v_mfma_f32_16x16x32_bf16 v[64:67], v[140:143], v[172:175], v[64:67]
    v_mfma_f32_16x16x32_bf16 v[68:71], v[140:143], v[188:191], v[68:71]
    ds_read_b128 v[140:143], v255 offset:54272
    s_waitcnt lgkmcnt(4)
    v_mfma_f32_16x16x32_bf16 v[72:75], v[144:147], v[160:163], 0
    v_mfma_f32_16x16x32_bf16 v[76:79], v[144:147], v[176:179], 0
    ds_read_b128 v[144:147], v255 offset:51200
    v_mfma_f32_16x16x32_bf16 v[72:75], v[148:151], v[164:167], v[72:75]
    v_add_u32 v230, 2, v230
    ds_write_b32 v200, v230
    v_mfma_f32_16x16x32_bf16 v[76:79], v[148:151], v[180:183], v[76:79]
    ds_read_b128 v[148:151], v255 offset:52224
    v_mfma_f32_16x16x32_bf16 v[72:75], v[152:155], v[168:171], v[72:75]
    v_mfma_f32_16x16x32_bf16 v[76:79], v[152:155], v[184:187], v[76:79]
    ds_read_b128 v[152:155], v255 offset:55296
    v_mfma_f32_16x16x32_bf16 v[72:75], v[156:159], v[172:175], v[72:75]
    v_mfma_f32_16x16x32_bf16 v[76:79], v[156:159], v[188:191], v[76:79]
    ds_read_b128 v[156:159], v255 offset:56320
    s_nop 5
    s_cmp_lg_u32 s26, 0
    s_cbranch_scc1 fmain_nomask0
    v_mov_b32 v214, 0xff800000
    v_mov_b32 v72, 0xff800000
    v_mov_b32 v73, 0xff800000
    v_mov_b32 v74, 0xff800000
    v_mov_b32 v75, 0xff800000
    v_cndmask_b32 v64, v214, v64, s[80:81]
    v_cndmask_b32 v65, v214, v65, s[82:83]
    v_cndmask_b32 v66, v214, v66, s[84:85]
    v_cndmask_b32 v67, v214, v67, s[86:87]
    v_cndmask_b32 v76, v214, v76, s[80:81]
    v_cndmask_b32 v77, v214, v77, s[82:83]
    v_cndmask_b32 v78, v214, v78, s[84:85]
    v_cndmask_b32 v79, v214, v79, s[86:87]
fmain_nomask0:
    v_max3_f32 v215, v64, v65, v66
    v_max3_f32 v216, v68, v69, v70
    v_max3_f32 v217, v67, v72, v73
    v_max3_f32 v218, v71, v76, v77
    v_max3_f32 v215, v215, v74, v75
    v_max3_f32 v216, v216, v78, v79
    v_max_f32 v215, v215, v217
    v_max_f32 v216, v216, v218
    v_mov_b32 v217, v215
    v_mov_b32 v218, v216
    s_nop 0
    v_permlane16_swap_b32 v215, v217
    v_permlane16_swap_b32 v216, v218
    s_nop 0
    v_max_f32 v215, v215, v217
    v_max_f32 v216, v216, v218
    v_mov_b32 v217, v215
    v_mov_b32 v218, v216
    s_nop 0
    v_permlane32_swap_b32 v215, v217
    v_permlane32_swap_b32 v216, v218
    s_nop 0
    v_max_f32 v215, v215, v217
    v_max_f32 v216, v216, v218
    v_sub_f32 v64, v64, v215
    v_sub_f32 v68, v68, v216
    v_sub_f32 v65, v65, v215
    v_sub_f32 v69, v69, v216
    v_sub_f32 v66, v66, v215
    v_sub_f32 v70, v70, v216
    v_sub_f32 v67, v67, v215
    v_sub_f32 v71, v71, v216
    v_sub_f32 v72, v72, v215
    v_sub_f32 v76, v76, v216
    v_sub_f32 v73, v73, v215
    v_sub_f32 v77, v77, v216
    v_sub_f32 v74, v74, v215
    v_sub_f32 v78, v78, v216
    v_sub_f32 v75, v75, v215
    v_sub_f32 v79, v79, v216
    v_sub_f32 v204, 0, v215
    v_sub_f32 v205, 0, v215
    v_sub_f32 v206, 0, v215
    v_sub_f32 v207, 0, v215
    v_sub_f32 v208, 0, v216
    v_sub_f32 v209, 0, v216
    v_sub_f32 v210, 0, v216
    v_sub_f32 v211, 0, v216
    s_setprio 1
    s_mov_b32 s28, 0
    s_cmp_eq_u32 s22, 7
    s_cselect_b32 s27, 23, -1
    s_cmp_eq_u32 s22, 6
    s_cselect_b32 s27, 15, s27
    s_cmp_eq_u32 s26, 0
    s_cbranch_scc1 fmain_tail00
    s_cmp_eq_u32 s29, 0
    s_cbranch_scc1 fmain_first0
fmain_first1:
    v_exp_f32 v64, v64
    v_exp_f32 v65, v65
    v_exp_f32 v66, v66
    v_cvt_pk_bf16_f32 v64, v64, v65
    v_exp_f32 v67, v67
    v_exp_f32 v68, v68
    v_cvt_pk_bf16_f32 v65, v66, v67
    v_exp_f32 v69, v69
    v_exp_f32 v70, v70
    v_cvt_pk_bf16_f32 v68, v68, v69
    v_exp_f32 v71, v71
    v_exp_f32 v72, v72
    v_cvt_pk_bf16_f32 v69, v70, v71
    v_exp_f32 v73, v73
    s_waitcnt lgkmcnt(4)
    v_mfma_f32_16x16x32_bf16 v[80:83], v[128:131], v[160:163], v[204:207]
    v_exp_f32 v74, v74
    v_mfma_f32_16x16x32_bf16 v[84:87], v[128:131], v[176:179], v[208:211]
    ds_read_b128 v[128:131], v255 offset:40960
    v_cvt_pk_bf16_f32 v66, v72, v73
    v_mfma_f32_16x16x32_bf16 v[80:83], v[132:135], v[164:167], v[80:83]
    v_exp_f32 v75, v75
    v_mfma_f32_16x16x32_bf16 v[84:87], v[132:135], v[180:183], v[84:87]
    ds_read_b128 v[132:135], v255 offset:41984
    v_mfma_f32_16x16x32_bf16 v[80:83], v[136:139], v[168:171], v[80:83]
    v_exp_f32 v76, v76
    v_mfma_f32_16x16x32_bf16 v[84:87], v[136:139], v[184:187], v[84:87]
    ds_read_b128 v[136:139], v255 offset:43008
    v_cvt_pk_bf16_f32 v67, v74, v75
    v_mfma_f32_16x16x32_bf16 v[80:83], v[140:143], v[172:175], v[80:83]
    v_exp_f32 v77, v77
    v_mfma_f32_16x16x32_bf16 v[84:87], v[140:143], v[188:191], v[84:87]
    ds_read_b128 v[140:143], v255 offset:44032
    s_waitcnt lgkmcnt(4)
    v_mfma_f32_16x16x32_bf16 v[88:91], v[144:147], v[160:163], v[204:207]
    v_exp_f32 v78, v78
    v_mfma_f32_16x16x32_bf16 v[92:95], v[144:147], v[176:179], v[208:211]
    ds_read_b128 v[144:147], v255 offset:45056
    v_cvt_pk_bf16_f32 v70, v76, v77
    v_mfma_f32_16x16x32_bf16 v[88:91], v[148:151], v[164:167], v[88:91]
    v_exp_f32 v79, v79
    v_mfma_f32_16x16x32_bf16 v[92:95], v[148:151], v[180:183], v[92:95]
    ds_read_b128 v[148:151], v255 offset:46080
    v_mfma_f32_16x16x32_bf16 v[88:91], v[152:155], v[168:171], v[88:91]
    s_add_u32 s28, s28, 1
    s_cmp_eq_u32 s28, s26
    v_mfma_f32_16x16x32_bf16 v[92:95], v[152:155], v[184:187], v[92:95]
    ds_read_b128 v[152:155], v255 offset:47104
    v_cvt_pk_bf16_f32 v71, v78, v79
    v_mfma_f32_16x16x32_bf16 v[88:91], v[156:159], v[172:175], v[88:91]
    v_mfma_f32_16x16x32_bf16 v[92:95], v[156:159], v[188:191], v[92:95]
    ds_read_b128 v[156:159], v255 offset:48128
    s_cbranch_scc1 fmain_tail1_1
    v_mfma_f32_16x16x32_bf16 v[236:239], v[244:247], v[64:67], 0
    v_exp_f32 v80, v80
    v_mfma_f32_16x16x32_bf16 v[240:243], v[244:247], v[68:71], 0
    v_exp_f32 v81, v81
    s_waitcnt lgkmcnt(4)
    v_mfma_f32_16x16x32_bf16 v[0:3], v[128:131], v[64:67], 0
    v_exp_f32 v82, v82
    v_mfma_f32_16x16x32_bf16 v[4:7], v[128:131], v[68:71], 0
    ds_read_b128 v[128:131], v198 offset:0
    v_cvt_pk_bf16_f32 v80, v80, v81
    v_mfma_f32_16x16x32_bf16 v[8:11], v[132:135], v[64:67], 0
    v_exp_f32 v83, v83
    v_mfma_f32_16x16x32_bf16 v[12:15], v[132:135], v[68:71], 0
    ds_read_b128 v[132:135], v198 offset:1024
    v_mfma_f32_16x16x32_bf16 v[16:19], v[136:139], v[64:67], 0
    v_exp_f32 v84, v84
    v_mfma_f32_16x16x32_bf16 v[20:23], v[136:139], v[68:71], 0
    ds_read_b128 v[136:139], v198 offset:4096
    v_cvt_pk_bf16_f32 v81, v82, v83
    v_mfma_f32_16x16x32_bf16 v[24:27], v[140:143], v[64:67], 0
    v_exp_f32 v85, v85
    v_mfma_f32_16x16x32_bf16 v[28:31], v[140:143], v[68:71], 0
    ds_read_b128 v[140:143], v198 offset:5120
    s_waitcnt lgkmcnt(4)
    v_mfma_f32_16x16x32_bf16 v[32:35], v[144:147], v[64:67], 0
    v_exp_f32 v86, v86
    v_mfma_f32_16x16x32_bf16 v[36:39], v[144:147], v[68:71], 0
    ds_read_b128 v[144:147], v198 offset:2048
    v_cvt_pk_bf16_f32 v84, v84, v85
    v_mfma_f32_16x16x32_bf16 v[40:43], v[148:151], v[64:67], 0
    v_exp_f32 v87, v87
    v_mfma_f32_16x16x32_bf16 v[44:47], v[148:151], v[68:71], 0
    ds_read_b128 v[148:151], v198 offset:3072
    v_mfma_f32_16x16x32_bf16 v[48:51], v[152:155], v[64:67], 0
    v_exp_f32 v88, v88
    v_mfma_f32_16x16x32_bf16 v[52:55], v[152:155], v[68:71], 0
    ds_read_b128 v[152:155], v198 offset:6144
    v_cvt_pk_bf16_f32 v85, v86, v87
    v_mfma_f32_16x16x32_bf16 v[56:59], v[156:159], v[64:67], 0
    v_exp_f32 v89, v89
    v_mfma_f32_16x16x32_bf16 v[60:63], v[156:159], v[68:71], 0
    ds_read_b128 v[156:159], v198 offset:7168
    s_add_u32 s78, s73, 524288
    buffer_store_dwordx4 v[96:99], v255, s[52:55], s78 offen offset:0 sc1
    s_waitcnt lgkmcnt(4)
    v_mfma_f32_16x16x32_bf16 v[64:67], v[128:131], v[160:163], v[204:207]
    ds_read_b32 v231, v228
    v_exp_f32 v90, v90
    v_mfma_f32_16x16x32_bf16 v[68:71], v[128:131], v[176:179], v[208:211]
    ds_read_b128 v[128:131], v255 offset:57344
    v_cvt_pk_bf16_f32 v82, v88, v89
    v_mfma_f32_16x16x32_bf16 v[64:67], v[132:135], v[164:167], v[64:67]
    v_exp_f32 v91, v91
    v_mfma_f32_16x16x32_bf16 v[68:71], v[132:135], v[180:183], v[68:71]
    ds_read_b128 v[132:135], v255 offset:58368
    v_add_u32 v230, 2, v230
    v_mfma_f32_16x16x32_bf16 v[64:67], v[136:139], v[168:171], v[64:67]
    v_exp_f32 v92, v92
    v_mfma_f32_16x16x32_bf16 v[68:71], v[136:139], v[184:187], v[68:71]
    ds_read_b128 v[136:139], v255 offset:59392
    v_cvt_pk_bf16_f32 v83, v90, v91
    v_mfma_f32_16x16x32_bf16 v[64:67], v[140:143], v[172:175], v[64:67]
    v_exp_f32 v93, v93
    v_mfma_f32_16x16x32_bf16 v[68:71], v[140:143], v[188:191], v[68:71]
    ds_read_b128 v[140:143], v255 offset:60416
    s_waitcnt lgkmcnt(4)
    v_mfma_f32_16x16x32_bf16 v[72:75], v[144:147], v[160:163], v[204:207]
    v_exp_f32 v94, v94
    v_mfma_f32_16x16x32_bf16 v[76:79], v[144:147], v[176:179], v[208:211]
    ds_read_b128 v[144:147], v255 offset:61440
    v_cvt_pk_bf16_f32 v86, v92, v93
    v_mfma_f32_16x16x32_bf16 v[72:75], v[148:151], v[164:167], v[72:75]
    v_exp_f32 v95, v95
    v_mfma_f32_16x16x32_bf16 v[76:79], v[148:151], v[180:183], v[76:79]
    ds_read_b128 v[148:151], v255 offset:62464
    v_cmp_ge_i32 vcc, s28, v231
    s_add_u32 s78, s73, 524288
    buffer_store_dwordx4 v[100:103], v255, s[52:55], s78 offen offset:1024 sc1
    v_mfma_f32_16x16x32_bf16 v[72:75], v[152:155], v[168:171], v[72:75]
    s_add_u32 s28, s28, 1
    s_cmp_eq_u32 s28, s26
    v_mfma_f32_16x16x32_bf16 v[76:79], v[152:155], v[184:187], v[76:79]
    ds_read_b128 v[152:155], v255 offset:63488
    v_cvt_pk_bf16_f32 v87, v94, v95
    v_mfma_f32_16x16x32_bf16 v[72:75], v[156:159], v[172:175], v[72:75]
    s_cbranch_vccnz Lgated_wr_17
Lgated_wr_17_r:
    v_mfma_f32_16x16x32_bf16 v[76:79], v[156:159], v[188:191], v[76:79]
    ds_read_b128 v[156:159], v255 offset:64512
    s_cbranch_scc1 fmain_tail1_0
    v_mfma_f32_16x16x32_bf16 v[236:239], v[244:247], v[80:83], v[236:239]
    v_exp_f32 v64, v64
    v_mfma_f32_16x16x32_bf16 v[240:243], v[244:247], v[84:87], v[240:243]
    v_exp_f32 v65, v65
    s_waitcnt lgkmcnt(4)
    v_mfma_f32_16x16x32_bf16 v[0:3], v[128:131], v[80:83], v[0:3]
    v_exp_f32 v66, v66
    v_mfma_f32_16x16x32_bf16 v[4:7], v[128:131], v[84:87], v[4:7]
    ds_read_b128 v[128:131], v198 offset:16384
    v_cvt_pk_bf16_f32 v64, v64, v65
    v_mfma_f32_16x16x32_bf16 v[8:11], v[132:135], v[80:83], v[8:11]
    v_exp_f32 v67, v67
    v_mfma_f32_16x16x32_bf16 v[12:15], v[132:135], v[84:87], v[12:15]
    ds_read_b128 v[132:135], v198 offset:17408
    v_mfma_f32_16x16x32_bf16 v[16:19], v[136:139], v[80:83], v[16:19]
    v_exp_f32 v68, v68
    v_mfma_f32_16x16x32_bf16 v[20:23], v[136:139], v[84:87], v[20:23]
    ds_read_b128 v[136:139], v198 offset:20480
    v_cvt_pk_bf16_f32 v65, v66, v67
    v_mfma_f32_16x16x32_bf16 v[24:27], v[140:143], v[80:83], v[24:27]
    v_exp_f32 v69, v69
    v_mfma_f32_16x16x32_bf16 v[28:31], v[140:143], v[84:87], v[28:31]
    ds_read_b128 v[140:143], v198 offset:21504
    s_waitcnt lgkmcnt(4)
    v_mfma_f32_16x16x32_bf16 v[32:35], v[144:147], v[80:83], v[32:35]
    v_exp_f32 v70, v70
    v_mfma_f32_16x16x32_bf16 v[36:39], v[144:147], v[84:87], v[36:39]
    ds_read_b128 v[144:147], v198 offset:18432
    v_cvt_pk_bf16_f32 v68, v68, v69
    v_mfma_f32_16x16x32_bf16 v[40:43], v[148:151], v[80:83], v[40:43]
    v_exp_f32 v71, v71
    v_mfma_f32_16x16x32_bf16 v[44:47], v[148:151], v[84:87], v[44:47]
    ds_read_b128 v[148:151], v198 offset:19456
    ds_write_b32 v200, v230
    v_mfma_f32_16x16x32_bf16 v[48:51], v[152:155], v[80:83], v[48:51]
    v_exp_f32 v72, v72
    v_mfma_f32_16x16x32_bf16 v[52:55], v[152:155], v[84:87], v[52:55]
    ds_read_b128 v[152:155], v198 offset:22528
    v_cvt_pk_bf16_f32 v69, v70, v71
    v_mfma_f32_16x16x32_bf16 v[56:59], v[156:159], v[80:83], v[56:59]
    v_exp_f32 v73, v73
    v_mfma_f32_16x16x32_bf16 v[60:63], v[156:159], v[84:87], v[60:63]
    ds_read_b128 v[156:159], v198 offset:23552
    s_waitcnt lgkmcnt(4)
    v_mfma_f32_16x16x32_bf16 v[80:83], v[128:131], v[160:163], v[204:207]
    v_exp_f32 v74, v74
    v_mfma_f32_16x16x32_bf16 v[84:87], v[128:131], v[176:179], v[208:211]
    ds_read_b128 v[128:131], v198 offset:8192
    v_cvt_pk_bf16_f32 v66, v72, v73
    v_mfma_f32_16x16x32_bf16 v[80:83], v[132:135], v[164:167], v[80:83]
    v_exp_f32 v75, v75
    v_mfma_f32_16x16x32_bf16 v[84:87], v[132:135], v[180:183], v[84:87]
    ds_read_b128 v[132:135], v198 offset:9216
    v_mfma_f32_16x16x32_bf16 v[80:83], v[136:139], v[168:171], v[80:83]
    v_exp_f32 v76, v76
    v_mfma_f32_16x16x32_bf16 v[84:87], v[136:139], v[184:187], v[84:87]
    ds_read_b128 v[136:139], v198 offset:10240
    v_cvt_pk_bf16_f32 v67, v74, v75
    v_mfma_f32_16x16x32_bf16 v[80:83], v[140:143], v[172:175], v[80:83]
    v_exp_f32 v77, v77
    v_mfma_f32_16x16x32_bf16 v[84:87], v[140:143], v[188:191], v[84:87]
    ds_read_b128 v[140:143], v198 offset:11264
    s_waitcnt lgkmcnt(4)
    v_mfma_f32_16x16x32_bf16 v[88:91], v[144:147], v[160:163], v[204:207]
    v_exp_f32 v78, v78
    v_mfma_f32_16x16x32_bf16 v[92:95], v[144:147], v[176:179], v[208:211]
    ds_read_b128 v[144:147], v198 offset:12288
    v_cvt_pk_bf16_f32 v70, v76, v77
    v_mfma_f32_16x16x32_bf16 v[88:91], v[148:151], v[164:167], v[88:91]
    v_exp_f32 v79, v79
    s_cmp_lg_u32 s22, 7
    s_cbranch_scc1 Lgated_npa_18
    s_waitcnt vmcnt(2)
    s_lshl_b32 s76, s23, 11
    s_lshl_b32 s77, s24, 3
    s_add_u32 s76, s76, s77
    s_mov_b64 exec, 1
    buffer_store_dwordx2 v[192:193], v255, s[64:67], s76 offen offset:1536 sc1
    s_mov_b64 exec, -1
Lgated_npa_18:
    v_mfma_f32_16x16x32_bf16 v[92:95], v[148:151], v[180:183], v[92:95]
    ds_read_b128 v[148:151], v198 offset:13312
    s_add_u32 s78, s73, 524288
    buffer_store_dwordx4 v[104:107], v255, s[52:55], s78 offen offset:2048 sc1
    v_mfma_f32_16x16x32_bf16 v[88:91], v[152:155], v[168:171], v[88:91]
    s_add_u32 s28, s28, 1
    s_cmp_eq_u32 s28, s26
    v_mfma_f32_16x16x32_bf16 v[92:95], v[152:155], v[184:187], v[92:95]
    ds_read_b128 v[152:155], v198 offset:14336
    v_cvt_pk_bf16_f32 v71, v78, v79
    v_mfma_f32_16x16x32_bf16 v[88:91], v[156:159], v[172:175], v[88:91]
    v_mfma_f32_16x16x32_bf16 v[92:95], v[156:159], v[188:191], v[92:95]
    ds_read_b128 v[156:159], v198 offset:15360
    s_cbranch_scc1 fmain_tail1_1
    v_mfma_f32_16x16x32_bf16 v[236:239], v[244:247], v[64:67], v[236:239]
    v_exp_f32 v80, v80
    v_mfma_f32_16x16x32_bf16 v[240:243], v[244:247], v[68:71], v[240:243]
    v_exp_f32 v81, v81
    s_waitcnt lgkmcnt(4)
    v_mfma_f32_16x16x32_bf16 v[0:3], v[128:131], v[64:67], v[0:3]
    v_exp_f32 v82, v82
    v_mfma_f32_16x16x32_bf16 v[4:7], v[128:131], v[68:71], v[4:7]
    ds_read_b128 v[128:131], v198 offset:32768
    v_cvt_pk_bf16_f32 v80, v80, v81
    v_mfma_f32_16x16x32_bf16 v[8:11], v[132:135], v[64:67], v[8:11]
    v_exp_f32 v83, v83
    v_mfma_f32_16x16x32_bf16 v[12:15], v[132:135], v[68:71], v[12:15]
    ds_read_b128 v[132:135], v198 offset:33792
    v_mfma_f32_16x16x32_bf16 v[16:19], v[136:139], v[64:67], v[16:19]
    v_exp_f32 v84, v84
    v_mfma_f32_16x16x32_bf16 v[20:23], v[136:139], v[68:71], v[20:23]
    ds_read_b128 v[136:139], v198 offset:36864
    v_cvt_pk_bf16_f32 v81, v82, v83
    v_mfma_f32_16x16x32_bf16 v[24:27], v[140:143], v[64:67], v[24:27]
    v_exp_f32 v85, v85
    v_mfma_f32_16x16x32_bf16 v[28:31], v[140:143], v[68:71], v[28:31]
    ds_read_b128 v[140:143], v198 offset:37888
    s_waitcnt lgkmcnt(4)
    v_mfma_f32_16x16x32_bf16 v[32:35], v[144:147], v[64:67], v[32:35]
    v_exp_f32 v86, v86
    v_mfma_f32_16x16x32_bf16 v[36:39], v[144:147], v[68:71], v[36:39]
    ds_read_b128 v[144:147], v198 offset:34816
    v_cvt_pk_bf16_f32 v84, v84, v85
    v_mfma_f32_16x16x32_bf16 v[40:43], v[148:151], v[64:67], v[40:43]
    v_exp_f32 v87, v87
    v_mfma_f32_16x16x32_bf16 v[44:47], v[148:151], v[68:71], v[44:47]
    ds_read_b128 v[148:151], v198 offset:35840
    v_mfma_f32_16x16x32_bf16 v[48:51], v[152:155], v[64:67], v[48:51]
    v_exp_f32 v88, v88
    v_mfma_f32_16x16x32_bf16 v[52:55], v[152:155], v[68:71], v[52:55]
    ds_read_b128 v[152:155], v198 offset:38912
    v_cvt_pk_bf16_f32 v85, v86, v87
    v_mfma_f32_16x16x32_bf16 v[56:59], v[156:159], v[64:67], v[56:59]
    v_exp_f32 v89, v89
    v_mfma_f32_16x16x32_bf16 v[60:63], v[156:159], v[68:71], v[60:63]
    ds_read_b128 v[156:159], v198 offset:39936
    s_add_u32 s78, s73, 524288
    buffer_store_dwordx4 v[108:111], v255, s[52:55], s78 offen offset:3072 sc1
    s_waitcnt lgkmcnt(4)
    v_mfma_f32_16x16x32_bf16 v[64:67], v[128:131], v[160:163], v[204:207]
    ds_read_b32 v231, v228
    v_exp_f32 v90, v90
    v_mfma_f32_16x16x32_bf16 v[68:71], v[128:131], v[176:179], v[208:211]
    ds_read_b128 v[128:131], v198 offset:24576
    v_cvt_pk_bf16_f32 v82, v88, v89
    v_mfma_f32_16x16x32_bf16 v[64:67], v[132:135], v[164:167], v[64:67]
    v_exp_f32 v91, v91
    v_mfma_f32_16x16x32_bf16 v[68:71], v[132:135], v[180:183], v[68:71]
    ds_read_b128 v[132:135], v198 offset:25600
    v_add_u32 v230, 2, v230
    v_mfma_f32_16x16x32_bf16 v[64:67], v[136:139], v[168:171], v[64:67]
    v_exp_f32 v92, v92
    v_mfma_f32_16x16x32_bf16 v[68:71], v[136:139], v[184:187], v[68:71]
    ds_read_b128 v[136:139], v198 offset:26624
    v_cvt_pk_bf16_f32 v83, v90, v91
    v_mfma_f32_16x16x32_bf16 v[64:67], v[140:143], v[172:175], v[64:67]
    v_exp_f32 v93, v93
    v_mfma_f32_16x16x32_bf16 v[68:71], v[140:143], v[188:191], v[68:71]
    ds_read_b128 v[140:143], v198 offset:27648
    s_waitcnt lgkmcnt(4)
    v_mfma_f32_16x16x32_bf16 v[72:75], v[144:147], v[160:163], v[204:207]
    v_exp_f32 v94, v94
    v_mfma_f32_16x16x32_bf16 v[76:79], v[144:147], v[176:179], v[208:211]
    ds_read_b128 v[144:147], v198 offset:28672
    v_cvt_pk_bf16_f32 v86, v92, v93
    v_mfma_f32_16x16x32_bf16 v[72:75], v[148:151], v[164:167], v[72:75]
    v_exp_f32 v95, v95
    v_mfma_f32_16x16x32_bf16 v[76:79], v[148:151], v[180:183], v[76:79]
    ds_read_b128 v[148:151], v198 offset:29696
    v_cmp_ge_i32 vcc, s28, v231
    v_mfma_f32_16x16x32_bf16 v[72:75], v[152:155], v[168:171], v[72:75]
    s_add_u32 s28, s28, 1
    s_cmp_eq_u32 s28, s26
    v_mfma_f32_16x16x32_bf16 v[76:79], v[152:155], v[184:187], v[76:79]
    ds_read_b128 v[152:155], v198 offset:30720
    v_cvt_pk_bf16_f32 v87, v94, v95
    v_mfma_f32_16x16x32_bf16 v[72:75], v[156:159], v[172:175], v[72:75]
    s_cbranch_vccnz Lgated_wr_19
Lgated_wr_19_r:
    v_mfma_f32_16x16x32_bf16 v[76:79], v[156:159], v[188:191], v[76:79]
    ds_read_b128 v[156:159], v198 offset:31744
    s_cbranch_scc1 fmain_tail1_0
    v_mfma_f32_16x16x32_bf16 v[236:239], v[244:247], v[80:83], v[236:239]
    v_exp_f32 v64, v64
    v_mfma_f32_16x16x32_bf16 v[240:243], v[244:247], v[84:87], v[240:243]
    v_exp_f32 v65, v65
    s_waitcnt lgkmcnt(4)
    v_mfma_f32_16x16x32_bf16 v[0:3], v[128:131], v[80:83], v[0:3]
    v_exp_f32 v66, v66
    v_mfma_f32_16x16x32_bf16 v[4:7], v[128:131], v[84:87], v[4:7]
    ds_read_b128 v[128:131], v198 offset:49152
    v_cvt_pk_bf16_f32 v64, v64, v65
    v_mfma_f32_16x16x32_bf16 v[8:11], v[132:135], v[80:83], v[8:11]
    v_exp_f32 v67, v67
    v_mfma_f32_16x16x32_bf16 v[12:15], v[132:135], v[84:87], v[12:15]
    ds_read_b128 v[132:135], v198 offset:50176
    v_mfma_f32_16x16x32_bf16 v[16:19], v[136:139], v[80:83], v[16:19]
    v_exp_f32 v68, v68
    v_mfma_f32_16x16x32_bf16 v[20:23], v[136:139], v[84:87], v[20:23]
    ds_read_b128 v[136:139], v198 offset:53248
    v_cvt_pk_bf16_f32 v65, v66, v67
    v_mfma_f32_16x16x32_bf16 v[24:27], v[140:143], v[80:83], v[24:27]
    v_exp_f32 v69, v69
    v_mfma_f32_16x16x32_bf16 v[28:31], v[140:143], v[84:87], v[28:31]
    ds_read_b128 v[140:143], v198 offset:54272
    s_waitcnt lgkmcnt(4)
    v_mfma_f32_16x16x32_bf16 v[32:35], v[144:147], v[80:83], v[32:35]
    v_exp_f32 v70, v70
    v_mfma_f32_16x16x32_bf16 v[36:39], v[144:147], v[84:87], v[36:39]
    ds_read_b128 v[144:147], v198 offset:51200
    v_cvt_pk_bf16_f32 v68, v68, v69
    v_mfma_f32_16x16x32_bf16 v[40:43], v[148:151], v[80:83], v[40:43]
    v_exp_f32 v71, v71
    v_mfma_f32_16x16x32_bf16 v[44:47], v[148:151], v[84:87], v[44:47]
    ds_read_b128 v[148:151], v198 offset:52224
    ds_write_b32 v200, v230
    v_mfma_f32_16x16x32_bf16 v[48:51], v[152:155], v[80:83], v[48:51]
    v_exp_f32 v72, v72
    v_mfma_f32_16x16x32_bf16 v[52:55], v[152:155], v[84:87], v[52:55]
    ds_read_b128 v[152:155], v198 offset:55296
    v_cvt_pk_bf16_f32 v69, v70, v71
    v_mfma_f32_16x16x32_bf16 v[56:59], v[156:159], v[80:83], v[56:59]
    v_exp_f32 v73, v73
    v_mfma_f32_16x16x32_bf16 v[60:63], v[156:159], v[84:87], v[60:63]
    ds_read_b128 v[156:159], v198 offset:56320
    s_add_u32 s78, s73, 786432
    buffer_store_dwordx4 v[112:115], v255, s[52:55], s78 offen offset:0 sc1
    s_waitcnt lgkmcnt(4)
    v_mfma_f32_16x16x32_bf16 v[80:83], v[128:131], v[160:163], v[204:207]
    v_exp_f32 v74, v74
    v_mfma_f32_16x16x32_bf16 v[84:87], v[128:131], v[176:179], v[208:211]
    ds_read_b128 v[128:131], v198 offset:40960
    v_cvt_pk_bf16_f32 v66, v72, v73
    v_mfma_f32_16x16x32_bf16 v[80:83], v[132:135], v[164:167], v[80:83]
    v_exp_f32 v75, v75
    v_mfma_f32_16x16x32_bf16 v[84:87], v[132:135], v[180:183], v[84:87]
    ds_read_b128 v[132:135], v198 offset:41984
    v_mfma_f32_16x16x32_bf16 v[80:83], v[136:139], v[168:171], v[80:83]
    v_exp_f32 v76, v76
    v_mfma_f32_16x16x32_bf16 v[84:87], v[136:139], v[184:187], v[84:87]
    ds_read_b128 v[136:139], v198 offset:43008
    v_cvt_pk_bf16_f32 v67, v74, v75
    v_mfma_f32_16x16x32_bf16 v[80:83], v[140:143], v[172:175], v[80:83]
    v_exp_f32 v77, v77
    v_mfma_f32_16x16x32_bf16 v[84:87], v[140:143], v[188:191], v[84:87]
    ds_read_b128 v[140:143], v198 offset:44032
    s_waitcnt lgkmcnt(4)
    v_mfma_f32_16x16x32_bf16 v[88:91], v[144:147], v[160:163], v[204:207]
    v_exp_f32 v78, v78
    v_mfma_f32_16x16x32_bf16 v[92:95], v[144:147], v[176:179], v[208:211]
    ds_read_b128 v[144:147], v198 offset:45056
    v_cvt_pk_bf16_f32 v70, v76, v77
    v_mfma_f32_16x16x32_bf16 v[88:91], v[148:151], v[164:167], v[88:91]
    v_exp_f32 v79, v79
    v_mfma_f32_16x16x32_bf16 v[92:95], v[148:151], v[180:183], v[92:95]
    ds_read_b128 v[148:151], v198 offset:46080
    s_add_u32 s78, s73, 786432
    buffer_store_dwordx4 v[116:119], v255, s[52:55], s78 offen offset:1024 sc1
    v_mfma_f32_16x16x32_bf16 v[88:91], v[152:155], v[168:171], v[88:91]
    s_add_u32 s28, s28, 1
    s_cmp_eq_u32 s28, s26
    v_mfma_f32_16x16x32_bf16 v[92:95], v[152:155], v[184:187], v[92:95]
    ds_read_b128 v[152:155], v198 offset:47104
    v_cvt_pk_bf16_f32 v71, v78, v79
    v_mfma_f32_16x16x32_bf16 v[88:91], v[156:159], v[172:175], v[88:91]
    v_mfma_f32_16x16x32_bf16 v[92:95], v[156:159], v[188:191], v[92:95]
    ds_read_b128 v[156:159], v198 offset:48128
    s_cbranch_scc1 fmain_tail1_1
    v_mfma_f32_16x16x32_bf16 v[236:239], v[244:247], v[64:67], v[236:239]
    v_exp_f32 v80, v80
    v_mfma_f32_16x16x32_bf16 v[240:243], v[244:247], v[68:71], v[240:243]
    v_exp_f32 v81, v81
    s_waitcnt lgkmcnt(4)
    v_mfma_f32_16x16x32_bf16 v[0:3], v[128:131], v[64:67], v[0:3]
    v_exp_f32 v82, v82
    v_mfma_f32_16x16x32_bf16 v[4:7], v[128:131], v[68:71], v[4:7]
    ds_read_b128 v[128:131], v255 offset:0
    v_cvt_pk_bf16_f32 v80, v80, v81
    v_mfma_f32_16x16x32_bf16 v[8:11], v[132:135], v[64:67], v[8:11]
    v_exp_f32 v83, v83
    v_mfma_f32_16x16x32_bf16 v[12:15], v[132:135], v[68:71], v[12:15]
    ds_read_b128 v[132:135], v255 offset:1024
    v_mfma_f32_16x16x32_bf16 v[16:19], v[136:139], v[64:67], v[16:19]
    v_exp_f32 v84, v84
    v_mfma_f32_16x16x32_bf16 v[20:23], v[136:139], v[68:71], v[20:23]
    ds_read_b128 v[136:139], v255 offset:4096
    v_cvt_pk_bf16_f32 v81, v82, v83
    v_mfma_f32_16x16x32_bf16 v[24:27], v[140:143], v[64:67], v[24:27]
    v_exp_f32 v85, v85
    v_mfma_f32_16x16x32_bf16 v[28:31], v[140:143], v[68:71], v[28:31]
    ds_read_b128 v[140:143], v255 offset:5120
    s_waitcnt lgkmcnt(4)
    v_mfma_f32_16x16x32_bf16 v[32:35], v[144:147], v[64:67], v[32:35]
    v_exp_f32 v86, v86
    v_mfma_f32_16x16x32_bf16 v[36:39], v[144:147], v[68:71], v[36:39]
    ds_read_b128 v[144:147], v255 offset:2048
    v_cvt_pk_bf16_f32 v84, v84, v85
    v_mfma_f32_16x16x32_bf16 v[40:43], v[148:151], v[64:67], v[40:43]
    v_exp_f32 v87, v87
    v_mfma_f32_16x16x32_bf16 v[44:47], v[148:151], v[68:71], v[44:47]
    ds_read_b128 v[148:151], v255 offset:3072
    v_mfma_f32_16x16x32_bf16 v[48:51], v[152:155], v[64:67], v[48:51]
    v_exp_f32 v88, v88
    v_mfma_f32_16x16x32_bf16 v[52:55], v[152:155], v[68:71], v[52:55]
    ds_read_b128 v[152:155], v255 offset:6144
    v_cvt_pk_bf16_f32 v85, v86, v87
    v_mfma_f32_16x16x32_bf16 v[56:59], v[156:159], v[64:67], v[56:59]
    v_exp_f32 v89, v89
    v_mfma_f32_16x16x32_bf16 v[60:63], v[156:159], v[68:71], v[60:63]
    ds_read_b128 v[156:159], v255 offset:7168
    s_add_u32 s78, s73, 786432
    buffer_store_dwordx4 v[120:123], v255, s[52:55], s78 offen offset:2048 sc1
    s_waitcnt lgkmcnt(4)
    v_mfma_f32_16x16x32_bf16 v[64:67], v[128:131], v[160:163], v[204:207]
    ds_read_b32 v231, v228
    v_exp_f32 v90, v90
    v_mfma_f32_16x16x32_bf16 v[68:71], v[128:131], v[176:179], v[208:211]
    ds_read_b128 v[128:131], v198 offset:57344
    v_cvt_pk_bf16_f32 v82, v88, v89
    v_mfma_f32_16x16x32_bf16 v[64:67], v[132:135], v[164:167], v[64:67]
    v_exp_f32 v91, v91
    v_mfma_f32_16x16x32_bf16 v[68:71], v[132:135], v[180:183], v[68:71]
    ds_read_b128 v[132:135], v198 offset:58368
    v_add_u32 v230, 2, v230
    v_mfma_f32_16x16x32_bf16 v[64:67], v[136:139], v[168:171], v[64:67]
    v_exp_f32 v92, v92
    v_mfma_f32_16x16x32_bf16 v[68:71], v[136:139], v[184:187], v[68:71]
    ds_read_b128 v[136:139], v198 offset:59392
    v_cvt_pk_bf16_f32 v83, v90, v91
    v_mfma_f32_16x16x32_bf16 v[64:67], v[140:143], v[172:175], v[64:67]
    v_exp_f32 v93, v93
    v_mfma_f32_16x16x32_bf16 v[68:71], v[140:143], v[188:191], v[68:71]
    ds_read_b128 v[140:143], v198 offset:60416
    s_waitcnt lgkmcnt(4)
    v_mfma_f32_16x16x32_bf16 v[72:75], v[144:147], v[160:163], v[204:207]
    v_exp_f32 v94, v94
    v_mfma_f32_16x16x32_bf16 v[76:79], v[144:147], v[176:179], v[208:211]
    ds_read_b128 v[144:147], v198 offset:61440
    v_cvt_pk_bf16_f32 v86, v92, v93
    v_mfma_f32_16x16x32_bf16 v[72:75], v[148:151], v[164:167], v[72:75]
    v_exp_f32 v95, v95
    v_mfma_f32_16x16x32_bf16 v[76:79], v[148:151], v[180:183], v[76:79]
    ds_read_b128 v[148:151], v198 offset:62464
    v_cmp_ge_i32 vcc, s28, v231
    s_add_u32 s78, s73, 786432
    buffer_store_dwordx4 v[124:127], v255, s[52:55], s78 offen offset:3072 sc1
    v_mfma_f32_16x16x32_bf16 v[72:75], v[152:155], v[168:171], v[72:75]
    s_add_u32 s28, s28, 1
    s_cmp_eq_u32 s28, s26
    v_mfma_f32_16x16x32_bf16 v[76:79], v[152:155], v[184:187], v[76:79]
    ds_read_b128 v[152:155], v198 offset:63488
    v_cvt_pk_bf16_f32 v87, v94, v95
    v_mfma_f32_16x16x32_bf16 v[72:75], v[156:159], v[172:175], v[72:75]
    s_cbranch_vccnz Lgated_wr_20
Lgated_wr_20_r:
    v_mfma_f32_16x16x32_bf16 v[76:79], v[156:159], v[188:191], v[76:79]
    ds_read_b128 v[156:159], v198 offset:64512
    s_cbranch_scc1 fmain_tail1_0
    v_mfma_f32_16x16x32_bf16 v[236:239], v[244:247], v[80:83], v[236:239]
    v_exp_f32 v64, v64
    v_mfma_f32_16x16x32_bf16 v[240:243], v[244:247], v[84:87], v[240:243]
    v_exp_f32 v65, v65
    s_waitcnt lgkmcnt(4)
    v_mfma_f32_16x16x32_bf16 v[0:3], v[128:131], v[80:83], v[0:3]
    v_exp_f32 v66, v66
    v_mfma_f32_16x16x32_bf16 v[4:7], v[128:131], v[84:87], v[4:7]
    ds_read_b128 v[128:131], v255 offset:16384
    v_cvt_pk_bf16_f32 v64, v64, v65
    v_mfma_f32_16x16x32_bf16 v[8:11], v[132:135], v[80:83], v[8:11]
    v_exp_f32 v67, v67
    v_mfma_f32_16x16x32_bf16 v[12:15], v[132:135], v[84:87], v[12:15]
    ds_read_b128 v[132:135], v255 offset:17408
    s_cmp_ge_u32 s22, 6
    s_cbranch_scc1 fmain_svcB5
fmain_svcB5_ret:
    v_mfma_f32_16x16x32_bf16 v[16:19], v[136:139], v[80:83], v[16:19]
    v_exp_f32 v68, v68
    v_mfma_f32_16x16x32_bf16 v[20:23], v[136:139], v[84:87], v[20:23]
    ds_read_b128 v[136:139], v255 offset:20480
    v_cvt_pk_bf16_f32 v65, v66, v67
    v_mfma_f32_16x16x32_bf16 v[24:27], v[140:143], v[80:83], v[24:27]
    v_exp_f32 v69, v69
    v_mfma_f32_16x16x32_bf16 v[28:31], v[140:143], v[84:87], v[28:31]
    ds_read_b128 v[140:143], v255 offset:21504
    s_waitcnt lgkmcnt(4)
    v_mfma_f32_16x16x32_bf16 v[32:35], v[144:147], v[80:83], v[32:35]
    v_exp_f32 v70, v70
    v_mfma_f32_16x16x32_bf16 v[36:39], v[144:147], v[84:87], v[36:39]
    ds_read_b128 v[144:147], v255 offset:18432
    v_cvt_pk_bf16_f32 v68, v68, v69
    v_mfma_f32_16x16x32_bf16 v[40:43], v[148:151], v[80:83], v[40:43]
    v_exp_f32 v71, v71
    v_mfma_f32_16x16x32_bf16 v[44:47], v[148:151], v[84:87], v[44:47]
    ds_read_b128 v[148:151], v255 offset:19456
    ds_write_b32 v200, v230
    v_mfma_f32_16x16x32_bf16 v[48:51], v[152:155], v[80:83], v[48:51]
    v_exp_f32 v72, v72
    v_mfma_f32_16x16x32_bf16 v[52:55], v[152:155], v[84:87], v[52:55]
    ds_read_b128 v[152:155], v255 offset:22528
    v_cvt_pk_bf16_f32 v69, v70, v71
    v_mfma_f32_16x16x32_bf16 v[56:59], v[156:159], v[80:83], v[56:59]
    v_exp_f32 v73, v73
    v_mfma_f32_16x16x32_bf16 v[60:63], v[156:159], v[84:87], v[60:63]
    ds_read_b128 v[156:159], v255 offset:23552
    s_waitcnt lgkmcnt(4)
    v_mfma_f32_16x16x32_bf16 v[80:83], v[128:131], v[160:163], v[204:207]
    v_exp_f32 v74, v74
    v_mfma_f32_16x16x32_bf16 v[84:87], v[128:131], v[176:179], v[208:211]
    ds_read_b128 v[128:131], v255 offset:8192
    v_cvt_pk_bf16_f32 v66, v72, v73
    v_mfma_f32_16x16x32_bf16 v[80:83], v[132:135], v[164:167], v[80:83]
    v_exp_f32 v75, v75
    v_mfma_f32_16x16x32_bf16 v[84:87], v[132:135], v[180:183], v[84:87]
    ds_read_b128 v[132:135], v255 offset:9216
    v_mfma_f32_16x16x32_bf16 v[80:83], v[136:139], v[168:171], v[80:83]
    v_exp_f32 v76, v76
    v_mfma_f32_16x16x32_bf16 v[84:87], v[136:139], v[184:187], v[84:87]
    ds_read_b128 v[136:139], v255 offset:10240
    v_cvt_pk_bf16_f32 v67, v74, v75
    v_mfma_f32_16x16x32_bf16 v[80:83], v[140:143], v[172:175], v[80:83]
    v_exp_f32 v77, v77
    v_mfma_f32_16x16x32_bf16 v[84:87], v[140:143], v[188:191], v[84:87]
    ds_read_b128 v[140:143], v255 offset:11264
    s_waitcnt lgkmcnt(4)
    v_mfma_f32_16x16x32_bf16 v[88:91], v[144:147], v[160:163], v[204:207]
    v_exp_f32 v78, v78
    v_mfma_f32_16x16x32_bf16 v[92:95], v[144:147], v[176:179], v[208:211]
    ds_read_b128 v[144:147], v255 offset:12288
    v_cvt_pk_bf16_f32 v70, v76, v77
    v_mfma_f32_16x16x32_bf16 v[88:91], v[148:151], v[164:167], v[88:91]
    v_exp_f32 v79, v79
    v_mfma_f32_16x16x32_bf16 v[92:95], v[148:151], v[180:183], v[92:95]
    ds_read_b128 v[148:151], v255 offset:13312
    v_mfma_f32_16x16x32_bf16 v[88:91], v[152:155], v[168:171], v[88:91]
    s_add_u32 s28, s28, 1
    s_cmp_eq_u32 s28, s26
    v_mfma_f32_16x16x32_bf16 v[92:95], v[152:155], v[184:187], v[92:95]
    ds_read_b128 v[152:155], v255 offset:14336
    v_cvt_pk_bf16_f32 v71, v78, v79
    v_mfma_f32_16x16x32_bf16 v[88:91], v[156:159], v[172:175], v[88:91]
    v_mfma_f32_16x16x32_bf16 v[92:95], v[156:159], v[188:191], v[92:95]
    ds_read_b128 v[156:159], v255 offset:15360
    s_cbranch_scc1 fmain_tail1_1
    v_mfma_f32_16x16x32_bf16 v[236:239], v[244:247], v[64:67], v[236:239]
    v_exp_f32 v80, v80
    v_mfma_f32_16x16x32_bf16 v[240:243], v[244:247], v[68:71], v[240:243]
    v_exp_f32 v81, v81
    s_waitcnt lgkmcnt(4)
    v_mfma_f32_16x16x32_bf16 v[0:3], v[128:131], v[64:67], v[0:3]
    v_exp_f32 v82, v82
    v_mfma_f32_16x16x32_bf16 v[4:7], v[128:131], v[68:71], v[4:7]
    ds_read_b128 v[128:131], v255 offset:32768
    v_cvt_pk_bf16_f32 v80, v80, v81
    v_mfma_f32_16x16x32_bf16 v[8:11], v[132:135], v[64:67], v[8:11]
    v_exp_f32 v83, v83
    v_mfma_f32_16x16x32_bf16 v[12:15], v[132:135], v[68:71], v[12:15]
    ds_read_b128 v[132:135], v255 offset:33792
    v_mfma_f32_16x16x32_bf16 v[16:19], v[136:139], v[64:67], v[16:19]
    v_exp_f32 v84, v84
    v_mfma_f32_16x16x32_bf16 v[20:23], v[136:139], v[68:71], v[20:23]
    ds_read_b128 v[136:139], v255 offset:36864
    v_cvt_pk_bf16_f32 v81, v82, v83
    v_mfma_f32_16x16x32_bf16 v[24:27], v[140:143], v[64:67], v[24:27]
    v_exp_f32 v85, v85
    v_mfma_f32_16x16x32_bf16 v[28:31], v[140:143], v[68:71], v[28:31]
    ds_read_b128 v[140:143], v255 offset:37888
    s_waitcnt lgkmcnt(4)
    v_mfma_f32_16x16x32_bf16 v[32:35], v[144:147], v[64:67], v[32:35]
    v_exp_f32 v86, v86
    v_mfma_f32_16x16x32_bf16 v[36:39], v[144:147], v[68:71], v[36:39]
    ds_read_b128 v[144:147], v255 offset:34816
    v_cvt_pk_bf16_f32 v84, v84, v85
    v_mfma_f32_16x16x32_bf16 v[40:43], v[148:151], v[64:67], v[40:43]
    v_exp_f32 v87, v87
    v_mfma_f32_16x16x32_bf16 v[44:47], v[148:151], v[68:71], v[44:47]
    ds_read_b128 v[148:151], v255 offset:35840
    v_mfma_f32_16x16x32_bf16 v[48:51], v[152:155], v[64:67], v[48:51]
    v_exp_f32 v88, v88
    v_mfma_f32_16x16x32_bf16 v[52:55], v[152:155], v[68:71], v[52:55]
    ds_read_b128 v[152:155], v255 offset:38912
    v_cvt_pk_bf16_f32 v85, v86, v87
    v_mfma_f32_16x16x32_bf16 v[56:59], v[156:159], v[64:67], v[56:59]
    v_exp_f32 v89, v89
    v_mfma_f32_16x16x32_bf16 v[60:63], v[156:159], v[68:71], v[60:63]
    ds_read_b128 v[156:159], v255 offset:39936
    s_waitcnt lgkmcnt(4)
    v_mfma_f32_16x16x32_bf16 v[64:67], v[128:131], v[160:163], v[204:207]
    ds_read_b32 v231, v228
    v_exp_f32 v90, v90
    v_mfma_f32_16x16x32_bf16 v[68:71], v[128:131], v[176:179], v[208:211]
    ds_read_b128 v[128:131], v255 offset:24576
    v_cvt_pk_bf16_f32 v82, v88, v89
    v_mfma_f32_16x16x32_bf16 v[64:67], v[132:135], v[164:167], v[64:67]
    v_exp_f32 v91, v91
    v_mfma_f32_16x16x32_bf16 v[68:71], v[132:135], v[180:183], v[68:71]
    ds_read_b128 v[132:135], v255 offset:25600
    v_add_u32 v230, 2, v230
    v_mfma_f32_16x16x32_bf16 v[64:67], v[136:139], v[168:171], v[64:67]
    v_exp_f32 v92, v92
    v_mfma_f32_16x16x32_bf16 v[68:71], v[136:139], v[184:187], v[68:71]
    ds_read_b128 v[136:139], v255 offset:26624
    v_cvt_pk_bf16_f32 v83, v90, v91
    v_mfma_f32_16x16x32_bf16 v[64:67], v[140:143], v[172:175], v[64:67]
    v_exp_f32 v93, v93
    v_mfma_f32_16x16x32_bf16 v[68:71], v[140:143], v[188:191], v[68:71]
    ds_read_b128 v[140:143], v255 offset:27648
    s_waitcnt lgkmcnt(4)
    v_mfma_f32_16x16x32_bf16 v[72:75], v[144:147], v[160:163], v[204:207]
    v_exp_f32 v94, v94
    v_mfma_f32_16x16x32_bf16 v[76:79], v[144:147], v[176:179], v[208:211]
    ds_read_b128 v[144:147], v255 offset:28672
    v_cvt_pk_bf16_f32 v86, v92, v93
    v_mfma_f32_16x16x32_bf16 v[72:75], v[148:151], v[164:167], v[72:75]
    v_exp_f32 v95, v95
    s_waitcnt vmcnt(0)
    s_lshl_b32 s76, s23, 11
    s_lshl_b32 s77, s24, 6
    s_add_u32 s76, s76, s77
    s_lshl_b32 s77, s22, 3
    s_add_u32 s76, s76, s77
    s_mov_b64 exec, 1
    buffer_store_dwordx2 v[192:193], v255, s[64:67], s76 offen offset:1024 sc1
    s_mov_b64 exec, -1
    v_mfma_f32_16x16x32_bf16 v[76:79], v[148:151], v[180:183], v[76:79]
    ds_read_b128 v[148:151], v255 offset:29696
    v_cmp_ge_i32 vcc, s28, v231
    v_mfma_f32_16x16x32_bf16 v[72:75], v[152:155], v[168:171], v[72:75]
    s_add_u32 s28, s28, 1
    s_cmp_eq_u32 s28, s26
    v_mfma_f32_16x16x32_bf16 v[76:79], v[152:155], v[184:187], v[76:79]
    ds_read_b128 v[152:155], v255 offset:30720
    v_cvt_pk_bf16_f32 v87, v94, v95
    v_mfma_f32_16x16x32_bf16 v[72:75], v[156:159], v[172:175], v[72:75]
    s_cbranch_vccnz Lgated_wr_21
Lgated_wr_21_r:
    v_mfma_f32_16x16x32_bf16 v[76:79], v[156:159], v[188:191], v[76:79]
    ds_read_b128 v[156:159], v255 offset:31744
    s_cbranch_scc1 fmain_tail1_0
    v_mfma_f32_16x16x32_bf16 v[236:239], v[244:247], v[80:83], v[236:239]
    v_exp_f32 v64, v64
    v_mfma_f32_16x16x32_bf16 v[240:243], v[244:247], v[84:87], v[240:243]
    v_exp_f32 v65, v65
    s_waitcnt lgkmcnt(4)
    v_mfma_f32_16x16x32_bf16 v[0:3], v[128:131], v[80:83], v[0:3]
    v_exp_f32 v66, v66
    v_mfma_f32_16x16x32_bf16 v[4:7], v[128:131], v[84:87], v[4:7]
    ds_read_b128 v[128:131], v255 offset:49152
    v_cvt_pk_bf16_f32 v64, v64, v65
    v_mfma_f32_16x16x32_bf16 v[8:11], v[132:135], v[80:83], v[8:11]
    v_exp_f32 v67, v67
    v_mfma_f32_16x16x32_bf16 v[12:15], v[132:135], v[84:87], v[12:15]
    ds_read_b128 v[132:135], v255 offset:50176
    s_cmp_ge_u32 s22, 6
    s_cbranch_scc1 fmain_svcB7
fmain_svcB7_ret:
    v_mfma_f32_16x16x32_bf16 v[16:19], v[136:139], v[80:83], v[16:19]
    v_exp_f32 v68, v68
    v_mfma_f32_16x16x32_bf16 v[20:23], v[136:139], v[84:87], v[20:23]
    ds_read_b128 v[136:139], v255 offset:53248
    v_cvt_pk_bf16_f32 v65, v66, v67
    v_mfma_f32_16x16x32_bf16 v[24:27], v[140:143], v[80:83], v[24:27]
    v_exp_f32 v69, v69
    v_mfma_f32_16x16x32_bf16 v[28:31], v[140:143], v[84:87], v[28:31]
    ds_read_b128 v[140:143], v255 offset:54272
    s_waitcnt lgkmcnt(4)
    v_mfma_f32_16x16x32_bf16 v[32:35], v[144:147], v[80:83], v[32:35]
    v_exp_f32 v70, v70
    v_mfma_f32_16x16x32_bf16 v[36:39], v[144:147], v[84:87], v[36:39]
    ds_read_b128 v[144:147], v255 offset:51200
    v_cvt_pk_bf16_f32 v68, v68, v69
    v_mfma_f32_16x16x32_bf16 v[40:43], v[148:151], v[80:83], v[40:43]
    v_exp_f32 v71, v71
    v_mfma_f32_16x16x32_bf16 v[44:47], v[148:151], v[84:87], v[44:47]
    ds_read_b128 v[148:151], v255 offset:52224
    ds_write_b32 v200, v230
    v_mfma_f32_16x16x32_bf16 v[48:51], v[152:155], v[80:83], v[48:51]
    v_exp_f32 v72, v72
    v_mfma_f32_16x16x32_bf16 v[52:55], v[152:155], v[84:87], v[52:55]
    ds_read_b128 v[152:155], v255 offset:55296
    v_cvt_pk_bf16_f32 v69, v70, v71
    v_mfma_f32_16x16x32_bf16 v[56:59], v[156:159], v[80:83], v[56:59]
    v_exp_f32 v73, v73
    v_mfma_f32_16x16x32_bf16 v[60:63], v[156:159], v[84:87], v[60:63]
    ds_read_b128 v[156:159], v255 offset:56320
    .p2align 3
fmain_loop1:
    s_waitcnt lgkmcnt(4)
    v_mfma_f32_16x16x32_bf16 v[80:83], v[128:131], v[160:163], v[204:207]
    v_exp_f32 v74, v74
    v_mfma_f32_16x16x32_bf16 v[84:87], v[128:131], v[176:179], v[208:211]
    ds_read_b128 v[128:131], v255 offset:40960
    v_cvt_pk_bf16_f32 v66, v72, v73
    v_mfma_f32_16x16x32_bf16 v[80:83], v[132:135], v[164:167], v[80:83]
    v_exp_f32 v75, v75
    v_mfma_f32_16x16x32_bf16 v[84:87], v[132:135], v[180:183], v[84:87]
    ds_read_b128 v[132:135], v255 offset:41984
    v_mfma_f32_16x16x32_bf16 v[80:83], v[136:139], v[168:171], v[80:83]
    v_exp_f32 v76, v76
    v_mfma_f32_16x16x32_bf16 v[84:87], v[136:139], v[184:187], v[84:87]
    ds_read_b128 v[136:139], v255 offset:43008
    v_cvt_pk_bf16_f32 v67, v74, v75
    v_mfma_f32_16x16x32_bf16 v[80:83], v[140:143], v[172:175], v[80:83]
    v_exp_f32 v77, v77
    v_mfma_f32_16x16x32_bf16 v[84:87], v[140:143], v[188:191], v[84:87]
    ds_read_b128 v[140:143], v255 offset:44032
    s_waitcnt lgkmcnt(4)
    v_mfma_f32_16x16x32_bf16 v[88:91], v[144:147], v[160:163], v[204:207]
    v_exp_f32 v78, v78
    v_mfma_f32_16x16x32_bf16 v[92:95], v[144:147], v[176:179], v[208:211]
    ds_read_b128 v[144:147], v255 offset:45056
    v_cvt_pk_bf16_f32 v70, v76, v77
    v_mfma_f32_16x16x32_bf16 v[88:91], v[148:151], v[164:167], v[88:91]
    v_exp_f32 v79, v79
    v_mfma_f32_16x16x32_bf16 v[92:95], v[148:151], v[180:183], v[92:95]
    ds_read_b128 v[148:151], v255 offset:46080
    v_mfma_f32_16x16x32_bf16 v[88:91], v[152:155], v[168:171], v[88:91]
    s_add_u32 s28, s28, 1
    s_cmp_eq_u32 s28, s26
    v_mfma_f32_16x16x32_bf16 v[92:95], v[152:155], v[184:187], v[92:95]
    ds_read_b128 v[152:155], v255 offset:47104
    v_cvt_pk_bf16_f32 v71, v78, v79
    v_mfma_f32_16x16x32_bf16 v[88:91], v[156:159], v[172:175], v[88:91]
    v_mfma_f32_16x16x32_bf16 v[92:95], v[156:159], v[188:191], v[92:95]
    ds_read_b128 v[156:159], v255 offset:48128
    s_cbranch_scc1 fmain_tail1_1
    v_mfma_f32_16x16x32_bf16 v[236:239], v[244:247], v[64:67], v[236:239]
    v_exp_f32 v80, v80
    v_mfma_f32_16x16x32_bf16 v[240:243], v[244:247], v[68:71], v[240:243]
    v_exp_f32 v81, v81
    s_waitcnt lgkmcnt(4)
    v_mfma_f32_16x16x32_bf16 v[0:3], v[128:131], v[64:67], v[0:3]
    v_exp_f32 v82, v82
    v_mfma_f32_16x16x32_bf16 v[4:7], v[128:131], v[68:71], v[4:7]
    ds_read_b128 v[128:131], v198 offset:0
    v_cvt_pk_bf16_f32 v80, v80, v81
    v_mfma_f32_16x16x32_bf16 v[8:11], v[132:135], v[64:67], v[8:11]
    v_exp_f32 v83, v83
    v_mfma_f32_16x16x32_bf16 v[12:15], v[132:135], v[68:71], v[12:15]
    ds_read_b128 v[132:135], v198 offset:1024
    v_mfma_f32_16x16x32_bf16 v[16:19], v[136:139], v[64:67], v[16:19]
    v_exp_f32 v84, v84
    v_mfma_f32_16x16x32_bf16 v[20:23], v[136:139], v[68:71], v[20:23]
    ds_read_b128 v[136:139], v198 offset:4096
    v_cvt_pk_bf16_f32 v81, v82, v83
    v_mfma_f32_16x16x32_bf16 v[24:27], v[140:143], v[64:67], v[24:27]
    v_exp_f32 v85, v85
    v_mfma_f32_16x16x32_bf16 v[28:31], v[140:143], v[68:71], v[28:31]
    ds_read_b128 v[140:143], v198 offset:5120
    s_waitcnt lgkmcnt(4)
    v_mfma_f32_16x16x32_bf16 v[32:35], v[144:147], v[64:67], v[32:35]
    v_exp_f32 v86, v86
    v_mfma_f32_16x16x32_bf16 v[36:39], v[144:147], v[68:71], v[36:39]
    ds_read_b128 v[144:147], v198 offset:2048
    v_cvt_pk_bf16_f32 v84, v84, v85
    v_mfma_f32_16x16x32_bf16 v[40:43], v[148:151], v[64:67], v[40:43]
    v_exp_f32 v87, v87
    v_mfma_f32_16x16x32_bf16 v[44:47], v[148:151], v[68:71], v[44:47]
    ds_read_b128 v[148:151], v198 offset:3072
    v_mfma_f32_16x16x32_bf16 v[48:51], v[152:155], v[64:67], v[48:51]
    v_exp_f32 v88, v88
    v_mfma_f32_16x16x32_bf16 v[52:55], v[152:155], v[68:71], v[52:55]
    ds_read_b128 v[152:155], v198 offset:6144
    v_cvt_pk_bf16_f32 v85, v86, v87
    v_mfma_f32_16x16x32_bf16 v[56:59], v[156:159], v[64:67], v[56:59]
    v_exp_f32 v89, v89
    v_mfma_f32_16x16x32_bf16 v[60:63], v[156:159], v[68:71], v[60:63]
    ds_read_b128 v[156:159], v198 offset:7168
    s_waitcnt lgkmcnt(4)
    v_mfma_f32_16x16x32_bf16 v[64:67], v[128:131], v[160:163], v[204:207]
    ds_read_b32 v231, v228
    v_exp_f32 v90, v90
    v_mfma_f32_16x16x32_bf16 v[68:71], v[128:131], v[176:179], v[208:211]
    ds_read_b128 v[128:131], v255 offset:57344
    v_cvt_pk_bf16_f32 v82, v88, v89
    v_mfma_f32_16x16x32_bf16 v[64:67], v[132:135], v[164:167], v[64:67]
    v_exp_f32 v91, v91
    v_mfma_f32_16x16x32_bf16 v[68:71], v[132:135], v[180:183], v[68:71]
    ds_read_b128 v[132:135], v255 offset:58368
    v_add_u32 v230, 2, v230
    v_mfma_f32_16x16x32_bf16 v[64:67], v[136:139], v[168:171], v[64:67]
    v_exp_f32 v92, v92
    v_mfma_f32_16x16x32_bf16 v[68:71], v[136:139], v[184:187], v[68:71]
    ds_read_b128 v[136:139], v255 offset:59392
    v_cvt_pk_bf16_f32 v83, v90, v91
    v_mfma_f32_16x16x32_bf16 v[64:67], v[140:143], v[172:175], v[64:67]
    v_exp_f32 v93, v93
    v_mfma_f32_16x16x32_bf16 v[68:71], v[140:143], v[188:191], v[68:71]
    ds_read_b128 v[140:143], v255 offset:60416
    s_waitcnt lgkmcnt(4)
    v_mfma_f32_16x16x32_bf16 v[72:75], v[144:147], v[160:163], v[204:207]
    v_exp_f32 v94, v94
    v_mfma_f32_16x16x32_bf16 v[76:79], v[144:147], v[176:179], v[208:211]
    ds_read_b128 v[144:147], v255 offset:61440
    v_cvt_pk_bf16_f32 v86, v92, v93
    v_mfma_f32_16x16x32_bf16 v[72:75], v[148:151], v[164:167], v[72:75]
    v_exp_f32 v95, v95
    v_mfma_f32_16x16x32_bf16 v[76:79], v[148:151], v[180:183], v[76:79]
    ds_read_b128 v[148:151], v255 offset:62464
    v_cmp_ge_i32 vcc, s28, v231
    v_mfma_f32_16x16x32_bf16 v[72:75], v[152:155], v[168:171], v[72:75]
    s_add_u32 s28, s28, 1
    s_cmp_eq_u32 s28, s26
    v_mfma_f32_16x16x32_bf16 v[76:79], v[152:155], v[184:187], v[76:79]
    ds_read_b128 v[152:155], v255 offset:63488
    v_cvt_pk_bf16_f32 v87, v94, v95
    v_mfma_f32_16x16x32_bf16 v[72:75], v[156:159], v[172:175], v[72:75]
    s_cbranch_vccnz Lgated_wr_22
Lgated_wr_22_r:
    v_mfma_f32_16x16x32_bf16 v[76:79], v[156:159], v[188:191], v[76:79]
    ds_read_b128 v[156:159], v255 offset:64512
    s_cbranch_scc1 fmain_tail1_0
    v_mfma_f32_16x16x32_bf16 v[236:239], v[244:247], v[80:83], v[236:239]
    v_exp_f32 v64, v64
    v_mfma_f32_16x16x32_bf16 v[240:243], v[244:247], v[84:87], v[240:243]
    v_exp_f32 v65, v65
    s_waitcnt lgkmcnt(4)
    v_mfma_f32_16x16x32_bf16 v[0:3], v[128:131], v[80:83], v[0:3]
    v_exp_f32 v66, v66
    v_mfma_f32_16x16x32_bf16 v[4:7], v[128:131], v[84:87], v[4:7]
    ds_read_b128 v[128:131], v198 offset:16384
    v_cvt_pk_bf16_f32 v64, v64, v65
    v_mfma_f32_16x16x32_bf16 v[8:11], v[132:135], v[80:83], v[8:11]
    v_exp_f32 v67, v67
    v_mfma_f32_16x16x32_bf16 v[12:15], v[132:135], v[84:87], v[12:15]
    ds_read_b128 v[132:135], v198 offset:17408
    v_mfma_f32_16x16x32_bf16 v[16:19], v[136:139], v[80:83], v[16:19]
    v_exp_f32 v68, v68
    v_mfma_f32_16x16x32_bf16 v[20:23], v[136:139], v[84:87], v[20:23]
    ds_read_b128 v[136:139], v198 offset:20480
    v_cvt_pk_bf16_f32 v65, v66, v67
    v_mfma_f32_16x16x32_bf16 v[24:27], v[140:143], v[80:83], v[24:27]
    v_exp_f32 v69, v69
    v_mfma_f32_16x16x32_bf16 v[28:31], v[140:143], v[84:87], v[28:31]
    ds_read_b128 v[140:143], v198 offset:21504
    s_waitcnt lgkmcnt(4)
    v_mfma_f32_16x16x32_bf16 v[32:35], v[144:147], v[80:83], v[32:35]
    v_exp_f32 v70, v70
    v_mfma_f32_16x16x32_bf16 v[36:39], v[144:147], v[84:87], v[36:39]
    ds_read_b128 v[144:147], v198 offset:18432
    v_cvt_pk_bf16_f32 v68, v68, v69
    v_mfma_f32_16x16x32_bf16 v[40:43], v[148:151], v[80:83], v[40:43]
    v_exp_f32 v71, v71
    v_mfma_f32_16x16x32_bf16 v[44:47], v[148:151], v[84:87], v[44:47]
    ds_read_b128 v[148:151], v198 offset:19456
    ds_write_b32 v200, v230
    v_mfma_f32_16x16x32_bf16 v[48:51], v[152:155], v[80:83], v[48:51]
    v_exp_f32 v72, v72
    v_mfma_f32_16x16x32_bf16 v[52:55], v[152:155], v[84:87], v[52:55]
    ds_read_b128 v[152:155], v198 offset:22528
    v_cvt_pk_bf16_f32 v69, v70, v71
    v_mfma_f32_16x16x32_bf16 v[56:59], v[156:159], v[80:83], v[56:59]
    v_exp_f32 v73, v73
    v_mfma_f32_16x16x32_bf16 v[60:63], v[156:159], v[84:87], v[60:63]
    ds_read_b128 v[156:159], v198 offset:23552
    s_waitcnt lgkmcnt(4)
    v_mfma_f32_16x16x32_bf16 v[80:83], v[128:131], v[160:163], v[204:207]
    v_exp_f32 v74, v74
    v_mfma_f32_16x16x32_bf16 v[84:87], v[128:131], v[176:179], v[208:211]
    ds_read_b128 v[128:131], v198 offset:8192
    v_cvt_pk_bf16_f32 v66, v72, v73
    v_mfma_f32_16x16x32_bf16 v[80:83], v[132:135], v[164:167], v[80:83]
    v_exp_f32 v75, v75
    v_mfma_f32_16x16x32_bf16 v[84:87], v[132:135], v[180:183], v[84:87]
    ds_read_b128 v[132:135], v198 offset:9216
    v_mfma_f32_16x16x32_bf16 v[80:83], v[136:139], v[168:171], v[80:83]
    v_exp_f32 v76, v76
    v_mfma_f32_16x16x32_bf16 v[84:87], v[136:139], v[184:187], v[84:87]
    ds_read_b128 v[136:139], v198 offset:10240
    v_cvt_pk_bf16_f32 v67, v74, v75
    v_mfma_f32_16x16x32_bf16 v[80:83], v[140:143], v[172:175], v[80:83]
    v_exp_f32 v77, v77
    v_mfma_f32_16x16x32_bf16 v[84:87], v[140:143], v[188:191], v[84:87]
    ds_read_b128 v[140:143], v198 offset:11264
    s_waitcnt lgkmcnt(4)
    v_mfma_f32_16x16x32_bf16 v[88:91], v[144:147], v[160:163], v[204:207]
    v_exp_f32 v78, v78
    v_mfma_f32_16x16x32_bf16 v[92:95], v[144:147], v[176:179], v[208:211]
    ds_read_b128 v[144:147], v198 offset:12288
    v_cvt_pk_bf16_f32 v70, v76, v77
    v_mfma_f32_16x16x32_bf16 v[88:91], v[148:151], v[164:167], v[88:91]
    v_exp_f32 v79, v79
    v_mfma_f32_16x16x32_bf16 v[92:95], v[148:151], v[180:183], v[92:95]
    ds_read_b128 v[148:151], v198 offset:13312
    v_mfma_f32_16x16x32_bf16 v[88:91], v[152:155], v[168:171], v[88:91]
    s_add_u32 s28, s28, 1
    s_cmp_eq_u32 s28, s26
    v_mfma_f32_16x16x32_bf16 v[92:95], v[152:155], v[184:187], v[92:95]
    ds_read_b128 v[152:155], v198 offset:14336
    v_cvt_pk_bf16_f32 v71, v78, v79
    v_mfma_f32_16x16x32_bf16 v[88:91], v[156:159], v[172:175], v[88:91]
    v_mfma_f32_16x16x32_bf16 v[92:95], v[156:159], v[188:191], v[92:95]
    ds_read_b128 v[156:159], v198 offset:15360
    s_cbranch_scc1 fmain_tail1_1
    v_mfma_f32_16x16x32_bf16 v[236:239], v[244:247], v[64:67], v[236:239]
    v_exp_f32 v80, v80
    v_mfma_f32_16x16x32_bf16 v[240:243], v[244:247], v[68:71], v[240:243]
    v_exp_f32 v81, v81
    s_waitcnt lgkmcnt(4)
    v_mfma_f32_16x16x32_bf16 v[0:3], v[128:131], v[64:67], v[0:3]
    v_exp_f32 v82, v82
    v_mfma_f32_16x16x32_bf16 v[4:7], v[128:131], v[68:71], v[4:7]
    ds_read_b128 v[128:131], v198 offset:32768
    v_cvt_pk_bf16_f32 v80, v80, v81
    v_mfma_f32_16x16x32_bf16 v[8:11], v[132:135], v[64:67], v[8:11]
    v_exp_f32 v83, v83
    v_mfma_f32_16x16x32_bf16 v[12:15], v[132:135], v[68:71], v[12:15]
    ds_read_b128 v[132:135], v198 offset:33792
    v_mfma_f32_16x16x32_bf16 v[16:19], v[136:139], v[64:67], v[16:19]
    v_exp_f32 v84, v84
    v_mfma_f32_16x16x32_bf16 v[20:23], v[136:139], v[68:71], v[20:23]
    ds_read_b128 v[136:139], v198 offset:36864
    v_cvt_pk_bf16_f32 v81, v82, v83
    v_mfma_f32_16x16x32_bf16 v[24:27], v[140:143], v[64:67], v[24:27]
    v_exp_f32 v85, v85
    v_mfma_f32_16x16x32_bf16 v[28:31], v[140:143], v[68:71], v[28:31]
    ds_read_b128 v[140:143], v198 offset:37888
    s_waitcnt lgkmcnt(4)
    v_mfma_f32_16x16x32_bf16 v[32:35], v[144:147], v[64:67], v[32:35]
    v_exp_f32 v86, v86
    v_mfma_f32_16x16x32_bf16 v[36:39], v[144:147], v[68:71], v[36:39]
    ds_read_b128 v[144:147], v198 offset:34816
    v_cvt_pk_bf16_f32 v84, v84, v85
    v_mfma_f32_16x16x32_bf16 v[40:43], v[148:151], v[64:67], v[40:43]
    v_exp_f32 v87, v87
    v_mfma_f32_16x16x32_bf16 v[44:47], v[148:151], v[68:71], v[44:47]
    ds_read_b128 v[148:151], v198 offset:35840
    v_mfma_f32_16x16x32_bf16 v[48:51], v[152:155], v[64:67], v[48:51]
    v_exp_f32 v88, v88
    v_mfma_f32_16x16x32_bf16 v[52:55], v[152:155], v[68:71], v[52:55]
    ds_read_b128 v[152:155], v198 offset:38912
    v_cvt_pk_bf16_f32 v85, v86, v87
    v_mfma_f32_16x16x32_bf16 v[56:59], v[156:159], v[64:67], v[56:59]
    v_exp_f32 v89, v89
    v_mfma_f32_16x16x32_bf16 v[60:63], v[156:159], v[68:71], v[60:63]
    ds_read_b128 v[156:159], v198 offset:39936
    s_waitcnt lgkmcnt(4)
    v_mfma_f32_16x16x32_bf16 v[64:67], v[128:131], v[160:163], v[204:207]
    ds_read_b32 v231, v228
    v_exp_f32 v90, v90
    v_mfma_f32_16x16x32_bf16 v[68:71], v[128:131], v[176:179], v[208:211]
    ds_read_b128 v[128:131], v198 offset:24576
    v_cvt_pk_bf16_f32 v82, v88, v89
    v_mfma_f32_16x16x32_bf16 v[64:67], v[132:135], v[164:167], v[64:67]
    v_exp_f32 v91, v91
    v_mfma_f32_16x16x32_bf16 v[68:71], v[132:135], v[180:183], v[68:71]
    ds_read_b128 v[132:135], v198 offset:25600
    v_add_u32 v230, 2, v230
    v_mfma_f32_16x16x32_bf16 v[64:67], v[136:139], v[168:171], v[64:67]
    v_exp_f32 v92, v92
    v_mfma_f32_16x16x32_bf16 v[68:71], v[136:139], v[184:187], v[68:71]
    ds_read_b128 v[136:139], v198 offset:26624
    v_cvt_pk_bf16_f32 v83, v90, v91
    v_mfma_f32_16x16x32_bf16 v[64:67], v[140:143], v[172:175], v[64:67]
    v_exp_f32 v93, v93
    v_mfma_f32_16x16x32_bf16 v[68:71], v[140:143], v[188:191], v[68:71]
    ds_read_b128 v[140:143], v198 offset:27648
    s_waitcnt lgkmcnt(4)
    v_mfma_f32_16x16x32_bf16 v[72:75], v[144:147], v[160:163], v[204:207]
    v_exp_f32 v94, v94
    v_mfma_f32_16x16x32_bf16 v[76:79], v[144:147], v[176:179], v[208:211]
    ds_read_b128 v[144:147], v198 offset:28672
    v_cvt_pk_bf16_f32 v86, v92, v93
    v_mfma_f32_16x16x32_bf16 v[72:75], v[148:151], v[164:167], v[72:75]
    v_exp_f32 v95, v95
    v_mfma_f32_16x16x32_bf16 v[76:79], v[148:151], v[180:183], v[76:79]
    ds_read_b128 v[148:151], v198 offset:29696
    v_cmp_ge_i32 vcc, s28, v231
    v_mfma_f32_16x16x32_bf16 v[72:75], v[152:155], v[168:171], v[72:75]
    s_add_u32 s28, s28, 1
    s_cmp_eq_u32 s28, s26
    v_mfma_f32_16x16x32_bf16 v[76:79], v[152:155], v[184:187], v[76:79]
    ds_read_b128 v[152:155], v198 offset:30720
    v_cvt_pk_bf16_f32 v87, v94, v95
    v_mfma_f32_16x16x32_bf16 v[72:75], v[156:159], v[172:175], v[72:75]
    s_cbranch_vccnz Lgated_wr_23
Lgated_wr_23_r:
    v_mfma_f32_16x16x32_bf16 v[76:79], v[156:159], v[188:191], v[76:79]
    ds_read_b128 v[156:159], v198 offset:31744
    s_cbranch_scc1 fmain_tail1_0
    v_mfma_f32_16x16x32_bf16 v[236:239], v[244:247], v[80:83], v[236:239]
    v_exp_f32 v64, v64
    v_mfma_f32_16x16x32_bf16 v[240:243], v[244:247], v[84:87], v[240:243]
    v_exp_f32 v65, v65
    s_waitcnt lgkmcnt(4)
    v_mfma_f32_16x16x32_bf16 v[0:3], v[128:131], v[80:83], v[0:3]
    v_exp_f32 v66, v66
    v_mfma_f32_16x16x32_bf16 v[4:7], v[128:131], v[84:87], v[4:7]
    ds_read_b128 v[128:131], v198 offset:49152
    v_cvt_pk_bf16_f32 v64, v64, v65
    v_mfma_f32_16x16x32_bf16 v[8:11], v[132:135], v[80:83], v[8:11]
    v_exp_f32 v67, v67
    v_mfma_f32_16x16x32_bf16 v[12:15], v[132:135], v[84:87], v[12:15]
    ds_read_b128 v[132:135], v198 offset:50176
    v_mfma_f32_16x16x32_bf16 v[16:19], v[136:139], v[80:83], v[16:19]
    v_exp_f32 v68, v68
    v_mfma_f32_16x16x32_bf16 v[20:23], v[136:139], v[84:87], v[20:23]
    ds_read_b128 v[136:139], v198 offset:53248
    v_cvt_pk_bf16_f32 v65, v66, v67
    v_mfma_f32_16x16x32_bf16 v[24:27], v[140:143], v[80:83], v[24:27]
    v_exp_f32 v69, v69
    v_mfma_f32_16x16x32_bf16 v[28:31], v[140:143], v[84:87], v[28:31]
    ds_read_b128 v[140:143], v198 offset:54272
    s_waitcnt lgkmcnt(4)
    v_mfma_f32_16x16x32_bf16 v[32:35], v[144:147], v[80:83], v[32:35]
    v_exp_f32 v70, v70
    v_mfma_f32_16x16x32_bf16 v[36:39], v[144:147], v[84:87], v[36:39]
    ds_read_b128 v[144:147], v198 offset:51200
    v_cvt_pk_bf16_f32 v68, v68, v69
    v_mfma_f32_16x16x32_bf16 v[40:43], v[148:151], v[80:83], v[40:43]
    v_exp_f32 v71, v71
    v_mfma_f32_16x16x32_bf16 v[44:47], v[148:151], v[84:87], v[44:47]
    ds_read_b128 v[148:151], v198 offset:52224
    ds_write_b32 v200, v230
    v_mfma_f32_16x16x32_bf16 v[48:51], v[152:155], v[80:83], v[48:51]
    v_exp_f32 v72, v72
    v_mfma_f32_16x16x32_bf16 v[52:55], v[152:155], v[84:87], v[52:55]
    ds_read_b128 v[152:155], v198 offset:55296
    v_cvt_pk_bf16_f32 v69, v70, v71
    v_mfma_f32_16x16x32_bf16 v[56:59], v[156:159], v[80:83], v[56:59]
    v_exp_f32 v73, v73
    v_mfma_f32_16x16x32_bf16 v[60:63], v[156:159], v[84:87], v[60:63]
    ds_read_b128 v[156:159], v198 offset:56320
    s_waitcnt lgkmcnt(4)
    v_mfma_f32_16x16x32_bf16 v[80:83], v[128:131], v[160:163], v[204:207]
    v_exp_f32 v74, v74
    v_mfma_f32_16x16x32_bf16 v[84:87], v[128:131], v[176:179], v[208:211]
    ds_read_b128 v[128:131], v198 offset:40960
    v_cvt_pk_bf16_f32 v66, v72, v73
    v_mfma_f32_16x16x32_bf16 v[80:83], v[132:135], v[164:167], v[80:83]
    v_exp_f32 v75, v75
    v_mfma_f32_16x16x32_bf16 v[84:87], v[132:135], v[180:183], v[84:87]
    ds_read_b128 v[132:135], v198 offset:41984
    v_mfma_f32_16x16x32_bf16 v[80:83], v[136:139], v[168:171], v[80:83]
    v_exp_f32 v76, v76
    v_mfma_f32_16x16x32_bf16 v[84:87], v[136:139], v[184:187], v[84:87]
    ds_read_b128 v[136:139], v198 offset:43008
    v_cvt_pk_bf16_f32 v67, v74, v75
    v_mfma_f32_16x16x32_bf16 v[80:83], v[140:143], v[172:175], v[80:83]
    v_exp_f32 v77, v77
    v_mfma_f32_16x16x32_bf16 v[84:87], v[140:143], v[188:191], v[84:87]
    ds_read_b128 v[140:143], v198 offset:44032
    s_waitcnt lgkmcnt(4)
    v_mfma_f32_16x16x32_bf16 v[88:91], v[144:147], v[160:163], v[204:207]
    v_exp_f32 v78, v78
    v_mfma_f32_16x16x32_bf16 v[92:95], v[144:147], v[176:179], v[208:211]
    ds_read_b128 v[144:147], v198 offset:45056
    v_cvt_pk_bf16_f32 v70, v76, v77
    v_mfma_f32_16x16x32_bf16 v[88:91], v[148:151], v[164:167], v[88:91]
    v_exp_f32 v79, v79
    v_mfma_f32_16x16x32_bf16 v[92:95], v[148:151], v[180:183], v[92:95]
    ds_read_b128 v[148:151], v198 offset:46080
    v_mfma_f32_16x16x32_bf16 v[88:91], v[152:155], v[168:171], v[88:91]
    s_add_u32 s28, s28, 1
    s_cmp_eq_u32 s28, s26
    v_mfma_f32_16x16x32_bf16 v[92:95], v[152:155], v[184:187], v[92:95]
    ds_read_b128 v[152:155], v198 offset:47104
    v_cvt_pk_bf16_f32 v71, v78, v79
    v_mfma_f32_16x16x32_bf16 v[88:91], v[156:159], v[172:175], v[88:91]
    v_mfma_f32_16x16x32_bf16 v[92:95], v[156:159], v[188:191], v[92:95]
    ds_read_b128 v[156:159], v198 offset:48128
    s_cbranch_scc1 fmain_tail1_1
    v_mfma_f32_16x16x32_bf16 v[236:239], v[244:247], v[64:67], v[236:239]
    v_exp_f32 v80, v80
    v_mfma_f32_16x16x32_bf16 v[240:243], v[244:247], v[68:71], v[240:243]
    v_exp_f32 v81, v81
    s_waitcnt lgkmcnt(4)
    v_mfma_f32_16x16x32_bf16 v[0:3], v[128:131], v[64:67], v[0:3]
    v_exp_f32 v82, v82
    v_mfma_f32_16x16x32_bf16 v[4:7], v[128:131], v[68:71], v[4:7]
    ds_read_b128 v[128:131], v255 offset:0
    v_cvt_pk_bf16_f32 v80, v80, v81
    v_mfma_f32_16x16x32_bf16 v[8:11], v[132:135], v[64:67], v[8:11]
    v_exp_f32 v83, v83
    v_mfma_f32_16x16x32_bf16 v[12:15], v[132:135], v[68:71], v[12:15]
    ds_read_b128 v[132:135], v255 offset:1024
    v_mfma_f32_16x16x32_bf16 v[16:19], v[136:139], v[64:67], v[16:19]
    v_exp_f32 v84, v84
    v_mfma_f32_16x16x32_bf16 v[20:23], v[136:139], v[68:71], v[20:23]
    ds_read_b128 v[136:139], v255 offset:4096
    v_cvt_pk_bf16_f32 v81, v82, v83
    v_mfma_f32_16x16x32_bf16 v[24:27], v[140:143], v[64:67], v[24:27]
    v_exp_f32 v85, v85
    v_mfma_f32_16x16x32_bf16 v[28:31], v[140:143], v[68:71], v[28:31]
    ds_read_b128 v[140:143], v255 offset:5120
    s_waitcnt lgkmcnt(4)
    v_mfma_f32_16x16x32_bf16 v[32:35], v[144:147], v[64:67], v[32:35]
    v_exp_f32 v86, v86
    v_mfma_f32_16x16x32_bf16 v[36:39], v[144:147], v[68:71], v[36:39]
    ds_read_b128 v[144:147], v255 offset:2048
    v_cvt_pk_bf16_f32 v84, v84, v85
    v_mfma_f32_16x16x32_bf16 v[40:43], v[148:151], v[64:67], v[40:43]
    v_exp_f32 v87, v87
    v_mfma_f32_16x16x32_bf16 v[44:47], v[148:151], v[68:71], v[44:47]
    ds_read_b128 v[148:151], v255 offset:3072
    v_mfma_f32_16x16x32_bf16 v[48:51], v[152:155], v[64:67], v[48:51]
    v_exp_f32 v88, v88
    v_mfma_f32_16x16x32_bf16 v[52:55], v[152:155], v[68:71], v[52:55]
    ds_read_b128 v[152:155], v255 offset:6144
    v_cvt_pk_bf16_f32 v85, v86, v87
    v_mfma_f32_16x16x32_bf16 v[56:59], v[156:159], v[64:67], v[56:59]
    v_exp_f32 v89, v89
    v_mfma_f32_16x16x32_bf16 v[60:63], v[156:159], v[68:71], v[60:63]
    ds_read_b128 v[156:159], v255 offset:7168
    s_waitcnt lgkmcnt(4)
    v_mfma_f32_16x16x32_bf16 v[64:67], v[128:131], v[160:163], v[204:207]
    ds_read_b32 v231, v228
    v_exp_f32 v90, v90
    v_mfma_f32_16x16x32_bf16 v[68:71], v[128:131], v[176:179], v[208:211]
    ds_read_b128 v[128:131], v198 offset:57344
    v_cvt_pk_bf16_f32 v82, v88, v89
    v_mfma_f32_16x16x32_bf16 v[64:67], v[132:135], v[164:167], v[64:67]
    v_exp_f32 v91, v91
    v_mfma_f32_16x16x32_bf16 v[68:71], v[132:135], v[180:183], v[68:71]
    ds_read_b128 v[132:135], v198 offset:58368
    v_add_u32 v230, 2, v230
    v_mfma_f32_16x16x32_bf16 v[64:67], v[136:139], v[168:171], v[64:67]
    v_exp_f32 v92, v92
    v_mfma_f32_16x16x32_bf16 v[68:71], v[136:139], v[184:187], v[68:71]
    ds_read_b128 v[136:139], v198 offset:59392
    v_cvt_pk_bf16_f32 v83, v90, v91
    v_mfma_f32_16x16x32_bf16 v[64:67], v[140:143], v[172:175], v[64:67]
    v_exp_f32 v93, v93
    v_mfma_f32_16x16x32_bf16 v[68:71], v[140:143], v[188:191], v[68:71]
    ds_read_b128 v[140:143], v198 offset:60416
    s_waitcnt lgkmcnt(4)
    v_mfma_f32_16x16x32_bf16 v[72:75], v[144:147], v[160:163], v[204:207]
    v_exp_f32 v94, v94
    v_mfma_f32_16x16x32_bf16 v[76:79], v[144:147], v[176:179], v[208:211]
    ds_read_b128 v[144:147], v198 offset:61440
    v_cvt_pk_bf16_f32 v86, v92, v93
    v_mfma_f32_16x16x32_bf16 v[72:75], v[148:151], v[164:167], v[72:75]
    v_exp_f32 v95, v95
    v_mfma_f32_16x16x32_bf16 v[76:79], v[148:151], v[180:183], v[76:79]
    ds_read_b128 v[148:151], v198 offset:62464
    v_cmp_ge_i32 vcc, s28, v231
    v_mfma_f32_16x16x32_bf16 v[72:75], v[152:155], v[168:171], v[72:75]
    s_add_u32 s28, s28, 1
    s_cmp_eq_u32 s28, s26
    v_mfma_f32_16x16x32_bf16 v[76:79], v[152:155], v[184:187], v[76:79]
    ds_read_b128 v[152:155], v198 offset:63488
    v_cvt_pk_bf16_f32 v87, v94, v95
    v_mfma_f32_16x16x32_bf16 v[72:75], v[156:159], v[172:175], v[72:75]
    s_cbranch_vccnz Lgated_wr_24
Lgated_wr_24_r:
    v_mfma_f32_16x16x32_bf16 v[76:79], v[156:159], v[188:191], v[76:79]
    ds_read_b128 v[156:159], v198 offset:64512
    s_cbranch_scc1 fmain_tail1_0
    v_mfma_f32_16x16x32_bf16 v[236:239], v[244:247], v[80:83], v[236:239]
    v_exp_f32 v64, v64
    v_mfma_f32_16x16x32_bf16 v[240:243], v[244:247], v[84:87], v[240:243]
    v_exp_f32 v65, v65
    s_waitcnt lgkmcnt(4)
    v_mfma_f32_16x16x32_bf16 v[0:3], v[128:131], v[80:83], v[0:3]
    v_exp_f32 v66, v66
    v_mfma_f32_16x16x32_bf16 v[4:7], v[128:131], v[84:87], v[4:7]
    ds_read_b128 v[128:131], v255 offset:16384
    v_cvt_pk_bf16_f32 v64, v64, v65
    v_mfma_f32_16x16x32_bf16 v[8:11], v[132:135], v[80:83], v[8:11]
    v_exp_f32 v67, v67
    v_mfma_f32_16x16x32_bf16 v[12:15], v[132:135], v[84:87], v[12:15]
    ds_read_b128 v[132:135], v255 offset:17408
    v_mfma_f32_16x16x32_bf16 v[16:19], v[136:139], v[80:83], v[16:19]
    v_exp_f32 v68, v68
    v_mfma_f32_16x16x32_bf16 v[20:23], v[136:139], v[84:87], v[20:23]
    ds_read_b128 v[136:139], v255 offset:20480
    v_cvt_pk_bf16_f32 v65, v66, v67
    v_mfma_f32_16x16x32_bf16 v[24:27], v[140:143], v[80:83], v[24:27]
    v_exp_f32 v69, v69
    v_mfma_f32_16x16x32_bf16 v[28:31], v[140:143], v[84:87], v[28:31]
    ds_read_b128 v[140:143], v255 offset:21504
    s_waitcnt lgkmcnt(4)
    v_mfma_f32_16x16x32_bf16 v[32:35], v[144:147], v[80:83], v[32:35]
    v_exp_f32 v70, v70
    v_mfma_f32_16x16x32_bf16 v[36:39], v[144:147], v[84:87], v[36:39]
    ds_read_b128 v[144:147], v255 offset:18432
    v_cvt_pk_bf16_f32 v68, v68, v69
    v_mfma_f32_16x16x32_bf16 v[40:43], v[148:151], v[80:83], v[40:43]
    v_exp_f32 v71, v71
    v_mfma_f32_16x16x32_bf16 v[44:47], v[148:151], v[84:87], v[44:47]
    ds_read_b128 v[148:151], v255 offset:19456
    ds_write_b32 v200, v230
    v_mfma_f32_16x16x32_bf16 v[48:51], v[152:155], v[80:83], v[48:51]
    v_exp_f32 v72, v72
    v_mfma_f32_16x16x32_bf16 v[52:55], v[152:155], v[84:87], v[52:55]
    ds_read_b128 v[152:155], v255 offset:22528
    v_cvt_pk_bf16_f32 v69, v70, v71
    v_mfma_f32_16x16x32_bf16 v[56:59], v[156:159], v[80:83], v[56:59]
    v_exp_f32 v73, v73
    v_mfma_f32_16x16x32_bf16 v[60:63], v[156:159], v[84:87], v[60:63]
    ds_read_b128 v[156:159], v255 offset:23552
    s_waitcnt lgkmcnt(4)
    v_mfma_f32_16x16x32_bf16 v[80:83], v[128:131], v[160:163], v[204:207]
    v_exp_f32 v74, v74
    v_mfma_f32_16x16x32_bf16 v[84:87], v[128:131], v[176:179], v[208:211]
    ds_read_b128 v[128:131], v255 offset:8192
    v_cvt_pk_bf16_f32 v66, v72, v73
    v_mfma_f32_16x16x32_bf16 v[80:83], v[132:135], v[164:167], v[80:83]
    v_exp_f32 v75, v75
    v_mfma_f32_16x16x32_bf16 v[84:87], v[132:135], v[180:183], v[84:87]
    ds_read_b128 v[132:135], v255 offset:9216
    v_mfma_f32_16x16x32_bf16 v[80:83], v[136:139], v[168:171], v[80:83]
    v_exp_f32 v76, v76
    v_mfma_f32_16x16x32_bf16 v[84:87], v[136:139], v[184:187], v[84:87]
    ds_read_b128 v[136:139], v255 offset:10240
    v_cvt_pk_bf16_f32 v67, v74, v75
    v_mfma_f32_16x16x32_bf16 v[80:83], v[140:143], v[172:175], v[80:83]
    v_exp_f32 v77, v77
    v_mfma_f32_16x16x32_bf16 v[84:87], v[140:143], v[188:191], v[84:87]
    ds_read_b128 v[140:143], v255 offset:11264
    s_waitcnt lgkmcnt(4)
    v_mfma_f32_16x16x32_bf16 v[88:91], v[144:147], v[160:163], v[204:207]
    v_exp_f32 v78, v78
    v_mfma_f32_16x16x32_bf16 v[92:95], v[144:147], v[176:179], v[208:211]
    ds_read_b128 v[144:147], v255 offset:12288
    v_cvt_pk_bf16_f32 v70, v76, v77
    v_mfma_f32_16x16x32_bf16 v[88:91], v[148:151], v[164:167], v[88:91]
    v_exp_f32 v79, v79
    v_mfma_f32_16x16x32_bf16 v[92:95], v[148:151], v[180:183], v[92:95]
    ds_read_b128 v[148:151], v255 offset:13312
    v_mfma_f32_16x16x32_bf16 v[88:91], v[152:155], v[168:171], v[88:91]
    s_add_u32 s28, s28, 1
    s_cmp_eq_u32 s28, s26
    v_mfma_f32_16x16x32_bf16 v[92:95], v[152:155], v[184:187], v[92:95]
    ds_read_b128 v[152:155], v255 offset:14336
    v_cvt_pk_bf16_f32 v71, v78, v79
    v_mfma_f32_16x16x32_bf16 v[88:91], v[156:159], v[172:175], v[88:91]
    v_mfma_f32_16x16x32_bf16 v[92:95], v[156:159], v[188:191], v[92:95]
    ds_read_b128 v[156:159], v255 offset:15360
    s_cbranch_scc1 fmain_tail1_1
    v_mfma_f32_16x16x32_bf16 v[236:239], v[244:247], v[64:67], v[236:239]
    v_exp_f32 v80, v80
    v_mfma_f32_16x16x32_bf16 v[240:243], v[244:247], v[68:71], v[240:243]
    v_exp_f32 v81, v81
    s_waitcnt lgkmcnt(4)
    v_mfma_f32_16x16x32_bf16 v[0:3], v[128:131], v[64:67], v[0:3]
    v_exp_f32 v82, v82
    v_mfma_f32_16x16x32_bf16 v[4:7], v[128:131], v[68:71], v[4:7]
    ds_read_b128 v[128:131], v255 offset:32768
    v_cvt_pk_bf16_f32 v80, v80, v81
    v_mfma_f32_16x16x32_bf16 v[8:11], v[132:135], v[64:67], v[8:11]
    v_exp_f32 v83, v83
    v_mfma_f32_16x16x32_bf16 v[12:15], v[132:135], v[68:71], v[12:15]
    ds_read_b128 v[132:135], v255 offset:33792
    s_cmp_eq_u32 s28, s27
    s_cbranch_scc1 fmain_svcC6
fmain_svcC6_ret:
    v_mfma_f32_16x16x32_bf16 v[16:19], v[136:139], v[64:67], v[16:19]
    v_exp_f32 v84, v84
    v_mfma_f32_16x16x32_bf16 v[20:23], v[136:139], v[68:71], v[20:23]
    ds_read_b128 v[136:139], v255 offset:36864
    v_cvt_pk_bf16_f32 v81, v82, v83
    v_mfma_f32_16x16x32_bf16 v[24:27], v[140:143], v[64:67], v[24:27]
    v_exp_f32 v85, v85
    v_mfma_f32_16x16x32_bf16 v[28:31], v[140:143], v[68:71], v[28:31]
    ds_read_b128 v[140:143], v255 offset:37888
    s_waitcnt lgkmcnt(4)
    v_mfma_f32_16x16x32_bf16 v[32:35], v[144:147], v[64:67], v[32:35]
    v_exp_f32 v86, v86
    v_mfma_f32_16x16x32_bf16 v[36:39], v[144:147], v[68:71], v[36:39]
    ds_read_b128 v[144:147], v255 offset:34816
    v_cvt_pk_bf16_f32 v84, v84, v85
    v_mfma_f32_16x16x32_bf16 v[40:43], v[148:151], v[64:67], v[40:43]
    v_exp_f32 v87, v87
    v_mfma_f32_16x16x32_bf16 v[44:47], v[148:151], v[68:71], v[44:47]
    ds_read_b128 v[148:151], v255 offset:35840
    v_mfma_f32_16x16x32_bf16 v[48:51], v[152:155], v[64:67], v[48:51]
    v_exp_f32 v88, v88
    v_mfma_f32_16x16x32_bf16 v[52:55], v[152:155], v[68:71], v[52:55]
    ds_read_b128 v[152:155], v255 offset:38912
    v_cvt_pk_bf16_f32 v85, v86, v87
    v_mfma_f32_16x16x32_bf16 v[56:59], v[156:159], v[64:67], v[56:59]
    v_exp_f32 v89, v89
    v_mfma_f32_16x16x32_bf16 v[60:63], v[156:159], v[68:71], v[60:63]
    ds_read_b128 v[156:159], v255 offset:39936
    s_waitcnt lgkmcnt(4)
    v_mfma_f32_16x16x32_bf16 v[64:67], v[128:131], v[160:163], v[204:207]
    ds_read_b32 v231, v228
    v_exp_f32 v90, v90
    v_mfma_f32_16x16x32_bf16 v[68:71], v[128:131], v[176:179], v[208:211]
    ds_read_b128 v[128:131], v255 offset:24576
    v_cvt_pk_bf16_f32 v82, v88, v89
    v_mfma_f32_16x16x32_bf16 v[64:67], v[132:135], v[164:167], v[64:67]
    v_exp_f32 v91, v91
    v_mfma_f32_16x16x32_bf16 v[68:71], v[132:135], v[180:183], v[68:71]
    ds_read_b128 v[132:135], v255 offset:25600
    v_add_u32 v230, 2, v230
    v_mfma_f32_16x16x32_bf16 v[64:67], v[136:139], v[168:171], v[64:67]
    v_exp_f32 v92, v92
    v_mfma_f32_16x16x32_bf16 v[68:71], v[136:139], v[184:187], v[68:71]
    ds_read_b128 v[136:139], v255 offset:26624
    v_cvt_pk_bf16_f32 v83, v90, v91
    v_mfma_f32_16x16x32_bf16 v[64:67], v[140:143], v[172:175], v[64:67]
    v_exp_f32 v93, v93
    v_mfma_f32_16x16x32_bf16 v[68:71], v[140:143], v[188:191], v[68:71]
    ds_read_b128 v[140:143], v255 offset:27648
    s_waitcnt lgkmcnt(4)
    v_mfma_f32_16x16x32_bf16 v[72:75], v[144:147], v[160:163], v[204:207]
    v_exp_f32 v94, v94
    v_mfma_f32_16x16x32_bf16 v[76:79], v[144:147], v[176:179], v[208:211]
    ds_read_b128 v[144:147], v255 offset:28672
    v_cvt_pk_bf16_f32 v86, v92, v93
    v_mfma_f32_16x16x32_bf16 v[72:75], v[148:151], v[164:167], v[72:75]
    v_exp_f32 v95, v95
    v_mfma_f32_16x16x32_bf16 v[76:79], v[148:151], v[180:183], v[76:79]
    ds_read_b128 v[148:151], v255 offset:29696
    v_cmp_ge_i32 vcc, s28, v231
    v_mfma_f32_16x16x32_bf16 v[72:75], v[152:155], v[168:171], v[72:75]
    s_add_u32 s28, s28, 1
    s_cmp_eq_u32 s28, s26
    v_mfma_f32_16x16x32_bf16 v[76:79], v[152:155], v[184:187], v[76:79]
    ds_read_b128 v[152:155], v255 offset:30720
    v_cvt_pk_bf16_f32 v87, v94, v95
    v_mfma_f32_16x16x32_bf16 v[72:75], v[156:159], v[172:175], v[72:75]
    s_cbranch_vccnz Lgated_wr_25
Lgated_wr_25_r:
    v_mfma_f32_16x16x32_bf16 v[76:79], v[156:159], v[188:191], v[76:79]
    ds_read_b128 v[156:159], v255 offset:31744
    s_cbranch_scc1 fmain_tail1_0
    v_mfma_f32_16x16x32_bf16 v[236:239], v[244:247], v[80:83], v[236:239]
    v_exp_f32 v64, v64
    v_mfma_f32_16x16x32_bf16 v[240:243], v[244:247], v[84:87], v[240:243]
    v_exp_f32 v65, v65
    s_waitcnt lgkmcnt(4)
    v_mfma_f32_16x16x32_bf16 v[0:3], v[128:131], v[80:83], v[0:3]
    v_exp_f32 v66, v66
    v_mfma_f32_16x16x32_bf16 v[4:7], v[128:131], v[84:87], v[4:7]
    ds_read_b128 v[128:131], v255 offset:49152
    v_cvt_pk_bf16_f32 v64, v64, v65
    v_mfma_f32_16x16x32_bf16 v[8:11], v[132:135], v[80:83], v[8:11]
    v_exp_f32 v67, v67
    v_mfma_f32_16x16x32_bf16 v[12:15], v[132:135], v[84:87], v[12:15]
    ds_read_b128 v[132:135], v255 offset:50176
    s_cmp_eq_u32 s28, s27
    s_cbranch_scc1 fmain_svcC7
fmain_svcC7_ret:
    v_mfma_f32_16x16x32_bf16 v[16:19], v[136:139], v[80:83], v[16:19]
    v_exp_f32 v68, v68
    v_mfma_f32_16x16x32_bf16 v[20:23], v[136:139], v[84:87], v[20:23]
    ds_read_b128 v[136:139], v255 offset:53248
    v_cvt_pk_bf16_f32 v65, v66, v67
    v_mfma_f32_16x16x32_bf16 v[24:27], v[140:143], v[80:83], v[24:27]
    v_exp_f32 v69, v69
    v_mfma_f32_16x16x32_bf16 v[28:31], v[140:143], v[84:87], v[28:31]
    ds_read_b128 v[140:143], v255 offset:54272
    s_waitcnt lgkmcnt(4)
    v_mfma_f32_16x16x32_bf16 v[32:35], v[144:147], v[80:83], v[32:35]
    v_exp_f32 v70, v70
    v_mfma_f32_16x16x32_bf16 v[36:39], v[144:147], v[84:87], v[36:39]
    ds_read_b128 v[144:147], v255 offset:51200
    v_cvt_pk_bf16_f32 v68, v68, v69
    v_mfma_f32_16x16x32_bf16 v[40:43], v[148:151], v[80:83], v[40:43]
    v_exp_f32 v71, v71
    v_mfma_f32_16x16x32_bf16 v[44:47], v[148:151], v[84:87], v[44:47]
    ds_read_b128 v[148:151], v255 offset:52224
    ds_write_b32 v200, v230
    v_mfma_f32_16x16x32_bf16 v[48:51], v[152:155], v[80:83], v[48:51]
    v_exp_f32 v72, v72
    v_mfma_f32_16x16x32_bf16 v[52:55], v[152:155], v[84:87], v[52:55]
    ds_read_b128 v[152:155], v255 offset:55296
    v_cvt_pk_bf16_f32 v69, v70, v71
    v_mfma_f32_16x16x32_bf16 v[56:59], v[156:159], v[80:83], v[56:59]
    v_exp_f32 v73, v73
    v_mfma_f32_16x16x32_bf16 v[60:63], v[156:159], v[84:87], v[60:63]
    ds_read_b128 v[156:159], v255 offset:56320
    s_branch fmain_loop1
fmain_tail1_1:
    s_nop 4
    v_mov_b32 v214, 0xff800000
    v_mov_b32 v88, 0xff800000
    v_mov_b32 v89, 0xff800000
    v_mov_b32 v90, 0xff800000
    v_mov_b32 v91, 0xff800000
    v_cndmask_b32 v80, v214, v80, s[80:81]
    v_cndmask_b32 v81, v214, v81, s[82:83]
    v_cndmask_b32 v82, v214, v82, s[84:85]
    v_cndmask_b32 v83, v214, v83, s[86:87]
    v_cndmask_b32 v92, v214, v92, s[80:81]
    v_cndmask_b32 v93, v214, v93, s[82:83]
    v_cndmask_b32 v94, v214, v94, s[84:85]
    v_cndmask_b32 v95, v214, v95, s[86:87]
    v_mfma_f32_16x16x32_bf16 v[236:239], v[244:247], v[64:67], v[236:239]
    v_exp_f32 v80, v80
    v_mfma_f32_16x16x32_bf16 v[240:243], v[244:247], v[68:71], v[240:243]
    v_exp_f32 v81, v81
    s_waitcnt lgkmcnt(4)
    v_mfma_f32_16x16x32_bf16 v[0:3], v[128:131], v[64:67], v[0:3]
    v_exp_f32 v82, v82
    v_cvt_pk_bf16_f32 v80, v80, v81
    v_mfma_f32_16x16x32_bf16 v[4:7], v[128:131], v[68:71], v[4:7]
    ds_read_b128 v[128:131], v199 offset:0
    v_exp_f32 v83, v83
    v_mfma_f32_16x16x32_bf16 v[8:11], v[132:135], v[64:67], v[8:11]
    v_exp_f32 v84, v84
    v_cvt_pk_bf16_f32 v81, v82, v83
    v_mfma_f32_16x16x32_bf16 v[12:15], v[132:135], v[68:71], v[12:15]
    ds_read_b128 v[132:135], v199 offset:1024
    v_exp_f32 v85, v85
    v_mfma_f32_16x16x32_bf16 v[16:19], v[136:139], v[64:67], v[16:19]
    v_exp_f32 v86, v86
    v_cvt_pk_bf16_f32 v84, v84, v85
    v_mfma_f32_16x16x32_bf16 v[20:23], v[136:139], v[68:71], v[20:23]
    ds_read_b128 v[136:139], v199 offset:2048
    v_exp_f32 v87, v87
    v_mfma_f32_16x16x32_bf16 v[24:27], v[140:143], v[64:67], v[24:27]
    v_exp_f32 v88, v88
    v_cvt_pk_bf16_f32 v85, v86, v87
    v_mfma_f32_16x16x32_bf16 v[28:31], v[140:143], v[68:71], v[28:31]
    ds_read_b128 v[140:143], v199 offset:3072
    v_exp_f32 v89, v89
    s_waitcnt lgkmcnt(4)
    v_mfma_f32_16x16x32_bf16 v[32:35], v[144:147], v[64:67], v[32:35]
    v_exp_f32 v90, v90
    v_cvt_pk_bf16_f32 v82, v88, v89
    v_mfma_f32_16x16x32_bf16 v[36:39], v[144:147], v[68:71], v[36:39]
    ds_read_b128 v[144:147], v199 offset:4096
    v_exp_f32 v91, v91
    v_mfma_f32_16x16x32_bf16 v[40:43], v[148:151], v[64:67], v[40:43]
    v_exp_f32 v92, v92
    v_mfma_f32_16x16x32_bf16 v[44:47], v[148:151], v[68:71], v[44:47]
    ds_read_b128 v[148:151], v199 offset:5120
    v_cvt_pk_bf16_f32 v83, v90, v91
    v_exp_f32 v93, v93
    v_mfma_f32_16x16x32_bf16 v[48:51], v[152:155], v[64:67], v[48:51]
    v_exp_f32 v94, v94
    v_mfma_f32_16x16x32_bf16 v[52:55], v[152:155], v[68:71], v[52:55]
    ds_read_b128 v[152:155], v199 offset:6144
    v_cvt_pk_bf16_f32 v86, v92, v93
    v_exp_f32 v95, v95
    v_mfma_f32_16x16x32_bf16 v[56:59], v[156:159], v[64:67], v[56:59]
    s_nop 0
    v_cvt_pk_bf16_f32 v87, v94, v95
    v_mfma_f32_16x16x32_bf16 v[60:63], v[156:159], v[68:71], v[60:63]
    ds_read_b128 v[156:159], v199 offset:7168
    s_nop 1
    v_mfma_f32_16x16x32_bf16 v[236:239], v[244:247], v[80:83], v[236:239]
    v_mfma_f32_16x16x32_bf16 v[240:243], v[244:247], v[84:87], v[240:243]
    s_waitcnt lgkmcnt(4)
    v_mfma_f32_16x16x32_bf16 v[0:3], v[128:131], v[80:83], v[0:3]
    v_mfma_f32_16x16x32_bf16 v[4:7], v[128:131], v[84:87], v[4:7]
    v_mfma_f32_16x16x32_bf16 v[8:11], v[132:135], v[80:83], v[8:11]
    v_mfma_f32_16x16x32_bf16 v[12:15], v[132:135], v[84:87], v[12:15]
    v_mfma_f32_16x16x32_bf16 v[16:19], v[136:139], v[80:83], v[16:19]
    v_mfma_f32_16x16x32_bf16 v[20:23], v[136:139], v[84:87], v[20:23]
    v_mfma_f32_16x16x32_bf16 v[24:27], v[140:143], v[80:83], v[24:27]
    v_mfma_f32_16x16x32_bf16 v[28:31], v[140:143], v[84:87], v[28:31]
    s_waitcnt lgkmcnt(0)
    v_mfma_f32_16x16x32_bf16 v[32:35], v[144:147], v[80:83], v[32:35]
    v_mfma_f32_16x16x32_bf16 v[36:39], v[144:147], v[84:87], v[36:39]
    v_mfma_f32_16x16x32_bf16 v[40:43], v[148:151], v[80:83], v[40:43]
    v_mfma_f32_16x16x32_bf16 v[44:47], v[148:151], v[84:87], v[44:47]
    v_mfma_f32_16x16x32_bf16 v[48:51], v[152:155], v[80:83], v[48:51]
    v_mfma_f32_16x16x32_bf16 v[52:55], v[152:155], v[84:87], v[52:55]
    v_mfma_f32_16x16x32_bf16 v[56:59], v[156:159], v[80:83], v[56:59]
    v_mfma_f32_16x16x32_bf16 v[60:63], v[156:159], v[84:87], v[60:63]
    s_branch fmain_done1
fmain_tail1_0:
    s_nop 4
    v_mov_b32 v214, 0xff800000
    v_mov_b32 v72, 0xff800000
    v_mov_b32 v73, 0xff800000
    v_mov_b32 v74, 0xff800000
    v_mov_b32 v75, 0xff800000
    v_cndmask_b32 v64, v214, v64, s[80:81]
    v_cndmask_b32 v65, v214, v65, s[82:83]
    v_cndmask_b32 v66, v214, v66, s[84:85]
    v_cndmask_b32 v67, v214, v67, s[86:87]
    v_cndmask_b32 v76, v214, v76, s[80:81]
    v_cndmask_b32 v77, v214, v77, s[82:83]
    v_cndmask_b32 v78, v214, v78, s[84:85]
    v_cndmask_b32 v79, v214, v79, s[86:87]
    v_mfma_f32_16x16x32_bf16 v[236:239], v[244:247], v[80:83], v[236:239]
    v_exp_f32 v64, v64
    v_mfma_f32_16x16x32_bf16 v[240:243], v[244:247], v[84:87], v[240:243]
    v_exp_f32 v65, v65
    s_waitcnt lgkmcnt(4)
    v_mfma_f32_16x16x32_bf16 v[0:3], v[128:131], v[80:83], v[0:3]
    v_exp_f32 v66, v66
    v_cvt_pk_bf16_f32 v64, v64, v65
    v_mfma_f32_16x16x32_bf16 v[4:7], v[128:131], v[84:87], v[4:7]
    ds_read_b128 v[128:131], v199 offset:0
    v_exp_f32 v67, v67
    v_mfma_f32_16x16x32_bf16 v[8:11], v[132:135], v[80:83], v[8:11]
    v_exp_f32 v68, v68
    v_cvt_pk_bf16_f32 v65, v66, v67
    v_mfma_f32_16x16x32_bf16 v[12:15], v[132:135], v[84:87], v[12:15]
    ds_read_b128 v[132:135], v199 offset:1024
    v_exp_f32 v69, v69
    v_mfma_f32_16x16x32_bf16 v[16:19], v[136:139], v[80:83], v[16:19]
    v_exp_f32 v70, v70
    v_cvt_pk_bf16_f32 v68, v68, v69
    v_mfma_f32_16x16x32_bf16 v[20:23], v[136:139], v[84:87], v[20:23]
    ds_read_b128 v[136:139], v199 offset:2048
    v_exp_f32 v71, v71
    v_mfma_f32_16x16x32_bf16 v[24:27], v[140:143], v[80:83], v[24:27]
    v_exp_f32 v72, v72
    v_cvt_pk_bf16_f32 v69, v70, v71
    v_mfma_f32_16x16x32_bf16 v[28:31], v[140:143], v[84:87], v[28:31]
    ds_read_b128 v[140:143], v199 offset:3072
    v_exp_f32 v73, v73
    s_waitcnt lgkmcnt(4)
    v_mfma_f32_16x16x32_bf16 v[32:35], v[144:147], v[80:83], v[32:35]
    v_exp_f32 v74, v74
    v_cvt_pk_bf16_f32 v66, v72, v73
    v_mfma_f32_16x16x32_bf16 v[36:39], v[144:147], v[84:87], v[36:39]
    ds_read_b128 v[144:147], v199 offset:4096
    v_exp_f32 v75, v75
    v_mfma_f32_16x16x32_bf16 v[40:43], v[148:151], v[80:83], v[40:43]
    v_exp_f32 v76, v76
    v_mfma_f32_16x16x32_bf16 v[44:47], v[148:151], v[84:87], v[44:47]
    ds_read_b128 v[148:151], v199 offset:5120
    v_cvt_pk_bf16_f32 v67, v74, v75
    v_exp_f32 v77, v77
    v_mfma_f32_16x16x32_bf16 v[48:51], v[152:155], v[80:83], v[48:51]
    v_exp_f32 v78, v78
    v_mfma_f32_16x16x32_bf16 v[52:55], v[152:155], v[84:87], v[52:55]
    ds_read_b128 v[152:155], v199 offset:6144
    v_cvt_pk_bf16_f32 v70, v76, v77
    v_exp_f32 v79, v79
    v_mfma_f32_16x16x32_bf16 v[56:59], v[156:159], v[80:83], v[56:59]
    s_nop 0
    v_cvt_pk_bf16_f32 v71, v78, v79
    v_mfma_f32_16x16x32_bf16 v[60:63], v[156:159], v[84:87], v[60:63]
    ds_read_b128 v[156:159], v199 offset:7168
    s_nop 1
    v_mfma_f32_16x16x32_bf16 v[236:239], v[244:247], v[64:67], v[236:239]
    v_mfma_f32_16x16x32_bf16 v[240:243], v[244:247], v[68:71], v[240:243]
    s_waitcnt lgkmcnt(4)
    v_mfma_f32_16x16x32_bf16 v[0:3], v[128:131], v[64:67], v[0:3]
    v_mfma_f32_16x16x32_bf16 v[4:7], v[128:131], v[68:71], v[4:7]
    v_mfma_f32_16x16x32_bf16 v[8:11], v[132:135], v[64:67], v[8:11]
    v_mfma_f32_16x16x32_bf16 v[12:15], v[132:135], v[68:71], v[12:15]
    v_mfma_f32_16x16x32_bf16 v[16:19], v[136:139], v[64:67], v[16:19]
    v_mfma_f32_16x16x32_bf16 v[20:23], v[136:139], v[68:71], v[20:23]
    v_mfma_f32_16x16x32_bf16 v[24:27], v[140:143], v[64:67], v[24:27]
    v_mfma_f32_16x16x32_bf16 v[28:31], v[140:143], v[68:71], v[28:31]
    s_waitcnt lgkmcnt(0)
    v_mfma_f32_16x16x32_bf16 v[32:35], v[144:147], v[64:67], v[32:35]
    v_mfma_f32_16x16x32_bf16 v[36:39], v[144:147], v[68:71], v[36:39]
    v_mfma_f32_16x16x32_bf16 v[40:43], v[148:151], v[64:67], v[40:43]
    v_mfma_f32_16x16x32_bf16 v[44:47], v[148:151], v[68:71], v[44:47]
    v_mfma_f32_16x16x32_bf16 v[48:51], v[152:155], v[64:67], v[48:51]
    v_mfma_f32_16x16x32_bf16 v[52:55], v[152:155], v[68:71], v[52:55]
    v_mfma_f32_16x16x32_bf16 v[56:59], v[156:159], v[64:67], v[56:59]
    v_mfma_f32_16x16x32_bf16 v[60:63], v[156:159], v[68:71], v[60:63]
    s_branch fmain_done1
Lgated_wr_17:
    s_mov_b32 s79, 0
    s_setprio 0
Lgated_wr_17_l:
    s_sleep 2
    ds_read_b32 v231, v228
    s_add_u32 s79, s79, 1
    s_cmp_ge_u32 s79, 67108864
    s_cbranch_scc1 Lgated_wr_17_x
    s_waitcnt lgkmcnt(0)
    v_cmp_gt_i32 vcc, s28, v231
    s_cbranch_vccnz Lgated_wr_17_l
Lgated_wr_17_x:
    s_waitcnt lgkmcnt(0)
    s_cmp_eq_u32 s28, s26
    s_setprio 1
    s_branch Lgated_wr_17_r
Lgated_wr_19:
    s_mov_b32 s79, 0
    s_setprio 0
Lgated_wr_19_l:
    s_sleep 2
    ds_read_b32 v231, v228
    s_add_u32 s79, s79, 1
    s_cmp_ge_u32 s79, 67108864
    s_cbranch_scc1 Lgated_wr_19_x
    s_waitcnt lgkmcnt(0)
    v_cmp_gt_i32 vcc, s28, v231
    s_cbranch_vccnz Lgated_wr_19_l
Lgated_wr_19_x:
    s_waitcnt lgkmcnt(0)
    s_cmp_eq_u32 s28, s26
    s_setprio 1
    s_branch Lgated_wr_19_r
Lgated_wr_20:
    s_mov_b32 s79, 0
    s_setprio 0
Lgated_wr_20_l:
    s_sleep 2
    ds_read_b32 v231, v228
    s_add_u32 s79, s79, 1
    s_cmp_ge_u32 s79, 67108864
    s_cbranch_scc1 Lgated_wr_20_x
    s_waitcnt lgkmcnt(0)
    v_cmp_gt_i32 vcc, s28, v231
    s_cbranch_vccnz Lgated_wr_20_l
Lgated_wr_20_x:
    s_waitcnt lgkmcnt(0)
    s_cmp_eq_u32 s28, s26
    s_setprio 1
    s_branch Lgated_wr_20_r
Lgated_wr_21:
    s_mov_b32 s79, 0
    s_setprio 0
Lgated_wr_21_l:
    s_sleep 2
    ds_read_b32 v231, v228
    s_add_u32 s79, s79, 1
    s_cmp_ge_u32 s79, 67108864
    s_cbranch_scc1 Lgated_wr_21_x
    s_waitcnt lgkmcnt(0)
    v_cmp_gt_i32 vcc, s28, v231
    s_cbranch_vccnz Lgated_wr_21_l
Lgated_wr_21_x:
    s_waitcnt lgkmcnt(0)
    s_cmp_eq_u32 s28, s26
    s_setprio 1
    s_branch Lgated_wr_21_r
Lgated_wr_22:
    s_mov_b32 s79, 0
    s_setprio 0
Lgated_wr_22_l:
    s_sleep 2
    ds_read_b32 v231, v228
    s_add_u32 s79, s79, 1
    s_cmp_ge_u32 s79, 67108864
    s_cbranch_scc1 Lgated_wr_22_x
    s_waitcnt lgkmcnt(0)
    v_cmp_gt_i32 vcc, s28, v231
    s_cbranch_vccnz Lgated_wr_22_l
Lgated_wr_22_x:
    s_waitcnt lgkmcnt(0)
    s_cmp_eq_u32 s28, s26
    s_setprio 1
    s_branch Lgated_wr_22_r
Lgated_wr_23:
    s_mov_b32 s79, 0
    s_setprio 0
Lgated_wr_23_l:
    s_sleep 2
    ds_read_b32 v231, v228
    s_add_u32 s79, s79, 1
    s_cmp_ge_u32 s79, 67108864
    s_cbranch_scc1 Lgated_wr_23_x
    s_waitcnt lgkmcnt(0)
    v_cmp_gt_i32 vcc, s28, v231
    s_cbranch_vccnz Lgated_wr_23_l
Lgated_wr_23_x:
    s_waitcnt lgkmcnt(0)
    s_cmp_eq_u32 s28, s26
    s_setprio 1
    s_branch Lgated_wr_23_r
Lgated_wr_24:
    s_mov_b32 s79, 0
    s_setprio 0
Lgated_wr_24_l:
    s_sleep 2
    ds_read_b32 v231, v228
    s_add_u32 s79, s79, 1
    s_cmp_ge_u32 s79, 67108864
    s_cbranch_scc1 Lgated_wr_24_x
    s_waitcnt lgkmcnt(0)
    v_cmp_gt_i32 vcc, s28, v231
    s_cbranch_vccnz Lgated_wr_24_l
Lgated_wr_24_x:
    s_waitcnt lgkmcnt(0)
    s_cmp_eq_u32 s28, s26
    s_setprio 1
    s_branch Lgated_wr_24_r
Lgated_wr_25:
    s_mov_b32 s79, 0
    s_setprio 0
Lgated_wr_25_l:
    s_sleep 2
    ds_read_b32 v231, v228
    s_add_u32 s79, s79, 1
    s_cmp_ge_u32 s79, 67108864
    s_cbranch_scc1 Lgated_wr_25_x
    s_waitcnt lgkmcnt(0)
    v_cmp_gt_i32 vcc, s28, v231
    s_cbranch_vccnz Lgated_wr_25_l
Lgated_wr_25_x:
    s_waitcnt lgkmcnt(0)
    s_cmp_eq_u32 s28, s26
    s_setprio 1
    s_branch Lgated_wr_25_r
fmain_first0:
    v_exp_f32 v64, v64
    v_exp_f32 v65, v65
    v_exp_f32 v66, v66
    v_cvt_pk_bf16_f32 v64, v64, v65
    v_exp_f32 v67, v67
    v_exp_f32 v68, v68
    v_cvt_pk_bf16_f32 v65, v66, v67
    v_exp_f32 v69, v69
    v_exp_f32 v70, v70
    v_cvt_pk_bf16_f32 v68, v68, v69
    v_exp_f32 v71, v71
    v_exp_f32 v72, v72
    v_cvt_pk_bf16_f32 v69, v70, v71
    v_exp_f32 v73, v73
    s_waitcnt lgkmcnt(4)
    v_mfma_f32_16x16x32_bf16 v[80:83], v[128:131], v[160:163], v[204:207]
    ds_read_b32 v232, v229
    v_exp_f32 v74, v74
    v_mfma_f32_16x16x32_bf16 v[84:87], v[128:131], v[176:179], v[208:211]
    ds_read_b128 v[128:131], v255 offset:40960
    v_cvt_pk_bf16_f32 v66, v72, v73
    v_mfma_f32_16x16x32_bf16 v[80:83], v[132:135], v[164:167], v[80:83]
    v_exp_f32 v75, v75
    v_mfma_f32_16x16x32_bf16 v[84:87], v[132:135], v[180:183], v[84:87]
    ds_read_b128 v[132:135], v255 offset:41984
    s_waitcnt vmcnt(9)
    v_add_u32 v254, 2, v254
    ds_write_b32 v201, v254
    v_mfma_f32_16x16x32_bf16 v[80:83], v[136:139], v[168:171], v[80:83]
    v_exp_f32 v76, v76
    v_mfma_f32_16x16x32_bf16 v[84:87], v[136:139], v[184:187], v[84:87]
    ds_read_b128 v[136:139], v255 offset:43008
    v_cvt_pk_bf16_f32 v67, v74, v75
    v_mfma_f32_16x16x32_bf16 v[80:83], v[140:143], v[172:175], v[80:83]
    v_exp_f32 v77, v77
    v_mfma_f32_16x16x32_bf16 v[84:87], v[140:143], v[188:191], v[84:87]
    ds_read_b128 v[140:143], v255 offset:44032
    s_waitcnt lgkmcnt(4)
    v_mfma_f32_16x16x32_bf16 v[88:91], v[144:147], v[160:163], v[204:207]
    v_exp_f32 v78, v78
    v_cmp_gt_i32 vcc, s28, v232
    v_mfma_f32_16x16x32_bf16 v[92:95], v[144:147], v[176:179], v[208:211]
    ds_read_b128 v[144:147], v255 offset:45056
    v_cvt_pk_bf16_f32 v70, v76, v77
    v_mfma_f32_16x16x32_bf16 v[88:91], v[148:151], v[164:167], v[88:91]
    v_exp_f32 v79, v79
    v_mfma_f32_16x16x32_bf16 v[92:95], v[148:151], v[180:183], v[92:95]
    ds_read_b128 v[148:151], v255 offset:46080
    s_cbranch_vccnz Lgated_wp_26
Lgated_wp_26_r:
    v_mfma_f32_16x16x32_bf16 v[88:91], v[152:155], v[168:171], v[88:91]
    s_add_u32 s28, s28, 1
    s_cmp_eq_u32 s28, s26
    v_mfma_f32_16x16x32_bf16 v[92:95], v[152:155], v[184:187], v[92:95]
    ds_read_b128 v[152:155], v255 offset:47104
    v_cvt_pk_bf16_f32 v71, v78, v79
    v_mfma_f32_16x16x32_bf16 v[88:91], v[156:159], v[172:175], v[88:91]
    v_mfma_f32_16x16x32_bf16 v[92:95], v[156:159], v[188:191], v[92:95]
    ds_read_b128 v[156:159], v255 offset:48128
    s_cbranch_scc1 fmain_x0_0
    v_mfma_f32_16x16x32_bf16 v[236:239], v[244:247], v[64:67], 0
    v_exp_f32 v80, v80
    v_mfma_f32_16x16x32_bf16 v[240:243], v[244:247], v[68:71], 0
    v_exp_f32 v81, v81
    s_waitcnt lgkmcnt(4)
    v_mfma_f32_16x16x32_bf16 v[0:3], v[128:131], v[64:67], 0
    v_exp_f32 v82, v82
    v_mfma_f32_16x16x32_bf16 v[4:7], v[128:131], v[68:71], 0
    ds_read_b128 v[128:131], v198 offset:0
    v_cvt_pk_bf16_f32 v80, v80, v81
    s_add_u32 s71, s72, 32768
    s_and_b32 m0, s71, 0x1ffff
    s_sub_u32 s71, s71, 32768
    buffer_load_dwordx4 v255, s[48:51], s71 offen offset:0 sc1 lds
    v_mfma_f32_16x16x32_bf16 v[8:11], v[132:135], v[64:67], 0
    v_exp_f32 v83, v83
    v_mfma_f32_16x16x32_bf16 v[12:15], v[132:135], v[68:71], 0
    ds_read_b128 v[132:135], v198 offset:1024
    v_mfma_f32_16x16x32_bf16 v[16:19], v[136:139], v[64:67], 0
    v_exp_f32 v84, v84
    v_mfma_f32_16x16x32_bf16 v[20:23], v[136:139], v[68:71], 0
    ds_read_b128 v[136:139], v198 offset:4096
    v_cvt_pk_bf16_f32 v81, v82, v83
    buffer_load_dwordx4 v255, s[48:51], s71 offen offset:1024 sc1 lds
    v_mfma_f32_16x16x32_bf16 v[24:27], v[140:143], v[64:67], 0
    v_exp_f32 v85, v85
    v_mfma_f32_16x16x32_bf16 v[28:31], v[140:143], v[68:71], 0
    ds_read_b128 v[140:143], v198 offset:5120
    s_waitcnt lgkmcnt(4)
    v_mfma_f32_16x16x32_bf16 v[32:35], v[144:147], v[64:67], 0
    v_exp_f32 v86, v86
    v_mfma_f32_16x16x32_bf16 v[36:39], v[144:147], v[68:71], 0
    ds_read_b128 v[144:147], v198 offset:2048
    v_cvt_pk_bf16_f32 v84, v84, v85
    buffer_load_dwordx4 v255, s[48:51], s71 offen offset:2048 sc1 lds
    v_mfma_f32_16x16x32_bf16 v[40:43], v[148:151], v[64:67], 0
    v_exp_f32 v87, v87
    v_mfma_f32_16x16x32_bf16 v[44:47], v[148:151], v[68:71], 0
    ds_read_b128 v[148:151], v198 offset:3072
    v_mfma_f32_16x16x32_bf16 v[48:51], v[152:155], v[64:67], 0
    v_exp_f32 v88, v88
    v_mfma_f32_16x16x32_bf16 v[52:55], v[152:155], v[68:71], 0
    ds_read_b128 v[152:155], v198 offset:6144
    v_cvt_pk_bf16_f32 v85, v86, v87
    buffer_load_dwordx4 v255, s[48:51], s71 offen offset:3072 sc1 lds
    v_mfma_f32_16x16x32_bf16 v[56:59], v[156:159], v[64:67], 0
    v_exp_f32 v89, v89
    v_mfma_f32_16x16x32_bf16 v[60:63], v[156:159], v[68:71], 0
    ds_read_b128 v[156:159], v198 offset:7168
    s_add_u32 s78, s73, 524288
    buffer_store_dwordx4 v[96:99], v255, s[52:55], s78 offen offset:0 sc1
    s_waitcnt lgkmcnt(4)
    v_mfma_f32_16x16x32_bf16 v[64:67], v[128:131], v[160:163], v[204:207]
    ds_read_b32 v231, v228
    v_exp_f32 v90, v90
    v_mfma_f32_16x16x32_bf16 v[68:71], v[128:131], v[176:179], v[208:211]
    ds_read_b128 v[128:131], v255 offset:57344
    v_cvt_pk_bf16_f32 v82, v88, v89
    s_add_u32 s71, s72, 36864
    s_and_b32 m0, s71, 0x1ffff
    s_sub_u32 s71, s71, 32768
    buffer_load_dwordx4 v255, s[48:51], s71 offen offset:0 sc1 lds
    v_mfma_f32_16x16x32_bf16 v[64:67], v[132:135], v[164:167], v[64:67]
    v_exp_f32 v91, v91
    v_mfma_f32_16x16x32_bf16 v[68:71], v[132:135], v[180:183], v[68:71]
    ds_read_b128 v[132:135], v255 offset:58368
    v_add_u32 v230, 2, v230
    v_mfma_f32_16x16x32_bf16 v[64:67], v[136:139], v[168:171], v[64:67]
    v_exp_f32 v92, v92
    buffer_load_dwordx4 v255, s[48:51], s71 offen offset:1024 sc1 lds
    v_mfma_f32_16x16x32_bf16 v[68:71], v[136:139], v[184:187], v[68:71]
    ds_read_b128 v[136:139], v255 offset:59392
    v_cvt_pk_bf16_f32 v83, v90, v91
    v_mfma_f32_16x16x32_bf16 v[64:67], v[140:143], v[172:175], v[64:67]
    v_exp_f32 v93, v93
    v_mfma_f32_16x16x32_bf16 v[68:71], v[140:143], v[188:191], v[68:71]
    ds_read_b128 v[140:143], v255 offset:60416
    buffer_load_dwordx4 v255, s[48:51], s71 offen offset:2048 sc1 lds
    s_waitcnt lgkmcnt(4)
    v_mfma_f32_16x16x32_bf16 v[72:75], v[144:147], v[160:163], v[204:207]
    v_exp_f32 v94, v94
    v_mfma_f32_16x16x32_bf16 v[76:79], v[144:147], v[176:179], v[208:211]
    ds_read_b128 v[144:147], v255 offset:61440
    v_cvt_pk_bf16_f32 v86, v92, v93
    v_mfma_f32_16x16x32_bf16 v[72:75], v[148:151], v[164:167], v[72:75]
    v_exp_f32 v95, v95
    buffer_load_dwordx4 v255, s[48:51], s71 offen offset:3072 sc1 lds
    s_add_u32 s72, s72, 32768
    v_mfma_f32_16x16x32_bf16 v[76:79], v[148:151], v[180:183], v[76:79]
    ds_read_b128 v[148:151], v255 offset:62464
    v_cmp_ge_i32 vcc, s28, v231
    s_add_u32 s78, s73, 524288
    buffer_store_dwordx4 v[100:103], v255, s[52:55], s78 offen offset:1024 sc1
    v_mfma_f32_16x16x32_bf16 v[72:75], v[152:155], v[168:171], v[72:75]
    s_add_u32 s28, s28, 1
    s_cmp_eq_u32 s28, s26
    v_mfma_f32_16x16x32_bf16 v[76:79], v[152:155], v[184:187], v[76:79]
    ds_read_b128 v[152:155], v255 offset:63488
    v_cvt_pk_bf16_f32 v87, v94, v95
    v_mfma_f32_16x16x32_bf16 v[72:75], v[156:159], v[172:175], v[72:75]
    s_cbranch_vccnz Lgated_wr_27
Lgated_wr_27_r:
    v_mfma_f32_16x16x32_bf16 v[76:79], v[156:159], v[188:191], v[76:79]
    ds_read_b128 v[156:159], v255 offset:64512
    s_cbranch_scc1 fmain_tail0_0
    v_mfma_f32_16x16x32_bf16 v[236:239], v[244:247], v[80:83], v[236:239]
    v_exp_f32 v64, v64
    v_mfma_f32_16x16x32_bf16 v[240:243], v[244:247], v[84:87], v[240:243]
    v_exp_f32 v65, v65
    s_waitcnt lgkmcnt(4)
    v_mfma_f32_16x16x32_bf16 v[0:3], v[128:131], v[80:83], v[0:3]
    v_exp_f32 v66, v66
    v_mfma_f32_16x16x32_bf16 v[4:7], v[128:131], v[84:87], v[4:7]
    ds_read_b128 v[128:131], v198 offset:16384
    v_cvt_pk_bf16_f32 v64, v64, v65
    v_mfma_f32_16x16x32_bf16 v[8:11], v[132:135], v[80:83], v[8:11]
    v_exp_f32 v67, v67
    v_mfma_f32_16x16x32_bf16 v[12:15], v[132:135], v[84:87], v[12:15]
    ds_read_b128 v[132:135], v198 offset:17408
    v_mfma_f32_16x16x32_bf16 v[16:19], v[136:139], v[80:83], v[16:19]
    v_exp_f32 v68, v68
    v_mfma_f32_16x16x32_bf16 v[20:23], v[136:139], v[84:87], v[20:23]
    ds_read_b128 v[136:139], v198 offset:20480
    v_cvt_pk_bf16_f32 v65, v66, v67
    v_mfma_f32_16x16x32_bf16 v[24:27], v[140:143], v[80:83], v[24:27]
    v_exp_f32 v69, v69
    v_mfma_f32_16x16x32_bf16 v[28:31], v[140:143], v[84:87], v[28:31]
    ds_read_b128 v[140:143], v198 offset:21504
    s_waitcnt lgkmcnt(4)
    v_mfma_f32_16x16x32_bf16 v[32:35], v[144:147], v[80:83], v[32:35]
    v_exp_f32 v70, v70
    v_mfma_f32_16x16x32_bf16 v[36:39], v[144:147], v[84:87], v[36:39]
    ds_read_b128 v[144:147], v198 offset:18432
    v_cvt_pk_bf16_f32 v68, v68, v69
    v_mfma_f32_16x16x32_bf16 v[40:43], v[148:151], v[80:83], v[40:43]
    v_exp_f32 v71, v71
    v_mfma_f32_16x16x32_bf16 v[44:47], v[148:151], v[84:87], v[44:47]
    ds_read_b128 v[148:151], v198 offset:19456
    ds_write_b32 v200, v230
    v_mfma_f32_16x16x32_bf16 v[48:51], v[152:155], v[80:83], v[48:51]
    v_exp_f32 v72, v72
    v_mfma_f32_16x16x32_bf16 v[52:55], v[152:155], v[84:87], v[52:55]
    ds_read_b128 v[152:155], v198 offset:22528
    v_cvt_pk_bf16_f32 v69, v70, v71
    v_mfma_f32_16x16x32_bf16 v[56:59], v[156:159], v[80:83], v[56:59]
    v_exp_f32 v73, v73
    v_mfma_f32_16x16x32_bf16 v[60:63], v[156:159], v[84:87], v[60:63]
    ds_read_b128 v[156:159], v198 offset:23552
    s_waitcnt lgkmcnt(4)
    v_mfma_f32_16x16x32_bf16 v[80:83], v[128:131], v[160:163], v[204:207]
    ds_read_b32 v232, v229
    v_exp_f32 v74, v74
    v_mfma_f32_16x16x32_bf16 v[84:87], v[128:131], v[176:179], v[208:211]
    ds_read_b128 v[128:131], v198 offset:8192
    v_cvt_pk_bf16_f32 v66, v72, v73
    v_mfma_f32_16x16x32_bf16 v[80:83], v[132:135], v[164:167], v[80:83]
    v_exp_f32 v75, v75
    v_mfma_f32_16x16x32_bf16 v[84:87], v[132:135], v[180:183], v[84:87]
    ds_read_b128 v[132:135], v198 offset:9216
    s_waitcnt vmcnt(10)
    v_add_u32 v254, 2, v254
    ds_write_b32 v201, v254
    v_mfma_f32_16x16x32_bf16 v[80:83], v[136:139], v[168:171], v[80:83]
    v_exp_f32 v76, v76
    v_mfma_f32_16x16x32_bf16 v[84:87], v[136:139], v[184:187], v[84:87]
    ds_read_b128 v[136:139], v198 offset:10240
    v_cvt_pk_bf16_f32 v67, v74, v75
    v_mfma_f32_16x16x32_bf16 v[80:83], v[140:143], v[172:175], v[80:83]
    v_exp_f32 v77, v77
    v_mfma_f32_16x16x32_bf16 v[84:87], v[140:143], v[188:191], v[84:87]
    ds_read_b128 v[140:143], v198 offset:11264
    s_waitcnt lgkmcnt(4)
    v_mfma_f32_16x16x32_bf16 v[88:91], v[144:147], v[160:163], v[204:207]
    v_exp_f32 v78, v78
    v_cmp_gt_i32 vcc, s28, v232
    v_mfma_f32_16x16x32_bf16 v[92:95], v[144:147], v[176:179], v[208:211]
    ds_read_b128 v[144:147], v198 offset:12288
    v_cvt_pk_bf16_f32 v70, v76, v77
    v_mfma_f32_16x16x32_bf16 v[88:91], v[148:151], v[164:167], v[88:91]
    v_exp_f32 v79, v79
    v_mfma_f32_16x16x32_bf16 v[92:95], v[148:151], v[180:183], v[92:95]
    ds_read_b128 v[148:151], v198 offset:13312
    s_cbranch_vccnz Lgated_wp_28
Lgated_wp_28_r:
    s_add_u32 s78, s73, 524288
    buffer_store_dwordx4 v[104:107], v255, s[52:55], s78 offen offset:2048 sc1
    v_mfma_f32_16x16x32_bf16 v[88:91], v[152:155], v[168:171], v[88:91]
    s_add_u32 s28, s28, 1
    s_cmp_eq_u32 s28, s26
    v_mfma_f32_16x16x32_bf16 v[92:95], v[152:155], v[184:187], v[92:95]
    ds_read_b128 v[152:155], v198 offset:14336
    v_cvt_pk_bf16_f32 v71, v78, v79
    v_mfma_f32_16x16x32_bf16 v[88:91], v[156:159], v[172:175], v[88:91]
    v_mfma_f32_16x16x32_bf16 v[92:95], v[156:159], v[188:191], v[92:95]
    ds_read_b128 v[156:159], v198 offset:15360
    s_cbranch_scc1 fmain_tail0_1
    v_mfma_f32_16x16x32_bf16 v[236:239], v[244:247], v[64:67], v[236:239]
    v_exp_f32 v80, v80
    v_mfma_f32_16x16x32_bf16 v[240:243], v[244:247], v[68:71], v[240:243]
    v_exp_f32 v81, v81
    s_waitcnt lgkmcnt(4)
    v_mfma_f32_16x16x32_bf16 v[0:3], v[128:131], v[64:67], v[0:3]
    v_exp_f32 v82, v82
    v_mfma_f32_16x16x32_bf16 v[4:7], v[128:131], v[68:71], v[4:7]
    ds_read_b128 v[128:131], v198 offset:32768
    v_cvt_pk_bf16_f32 v80, v80, v81
    s_add_u32 s71, s72, 32768
    s_and_b32 m0, s71, 0x1ffff
    s_sub_u32 s71, s71, 32768
    buffer_load_dwordx4 v255, s[48:51], s71 offen offset:0 sc1 lds
    v_mfma_f32_16x16x32_bf16 v[8:11], v[132:135], v[64:67], v[8:11]
    v_exp_f32 v83, v83
    v_mfma_f32_16x16x32_bf16 v[12:15], v[132:135], v[68:71], v[12:15]
    ds_read_b128 v[132:135], v198 offset:33792
    v_mfma_f32_16x16x32_bf16 v[16:19], v[136:139], v[64:67], v[16:19]
    v_exp_f32 v84, v84
    v_mfma_f32_16x16x32_bf16 v[20:23], v[136:139], v[68:71], v[20:23]
    ds_read_b128 v[136:139], v198 offset:36864
    v_cvt_pk_bf16_f32 v81, v82, v83
    buffer_load_dwordx4 v255, s[48:51], s71 offen offset:1024 sc1 lds
    v_mfma_f32_16x16x32_bf16 v[24:27], v[140:143], v[64:67], v[24:27]
    v_exp_f32 v85, v85
    v_mfma_f32_16x16x32_bf16 v[28:31], v[140:143], v[68:71], v[28:31]
    ds_read_b128 v[140:143], v198 offset:37888
    s_waitcnt lgkmcnt(4)
    v_mfma_f32_16x16x32_bf16 v[32:35], v[144:147], v[64:67], v[32:35]
    v_exp_f32 v86, v86
    v_mfma_f32_16x16x32_bf16 v[36:39], v[144:147], v[68:71], v[36:39]
    ds_read_b128 v[144:147], v198 offset:34816
    v_cvt_pk_bf16_f32 v84, v84, v85
    buffer_load_dwordx4 v255, s[48:51], s71 offen offset:2048 sc1 lds
    v_mfma_f32_16x16x32_bf16 v[40:43], v[148:151], v[64:67], v[40:43]
    v_exp_f32 v87, v87
    v_mfma_f32_16x16x32_bf16 v[44:47], v[148:151], v[68:71], v[44:47]
    ds_read_b128 v[148:151], v198 offset:35840
    v_mfma_f32_16x16x32_bf16 v[48:51], v[152:155], v[64:67], v[48:51]
    v_exp_f32 v88, v88
    v_mfma_f32_16x16x32_bf16 v[52:55], v[152:155], v[68:71], v[52:55]
    ds_read_b128 v[152:155], v198 offset:38912
    v_cvt_pk_bf16_f32 v85, v86, v87
    buffer_load_dwordx4 v255, s[48:51], s71 offen offset:3072 sc1 lds
    v_mfma_f32_16x16x32_bf16 v[56:59], v[156:159], v[64:67], v[56:59]
    v_exp_f32 v89, v89
    v_mfma_f32_16x16x32_bf16 v[60:63], v[156:159], v[68:71], v[60:63]
    ds_read_b128 v[156:159], v198 offset:39936
    s_add_u32 s78, s73, 524288
    buffer_store_dwordx4 v[108:111], v255, s[52:55], s78 offen offset:3072 sc1
    s_waitcnt lgkmcnt(4)
    v_mfma_f32_16x16x32_bf16 v[64:67], v[128:131], v[160:163], v[204:207]
    ds_read_b32 v231, v228
    v_exp_f32 v90, v90
    v_mfma_f32_16x16x32_bf16 v[68:71], v[128:131], v[176:179], v[208:211]
    ds_read_b128 v[128:131], v198 offset:24576
    v_cvt_pk_bf16_f32 v82, v88, v89
    s_add_u32 s71, s72, 36864
    s_and_b32 m0, s71, 0x1ffff
    s_sub_u32 s71, s71, 32768
    buffer_load_dwordx4 v255, s[48:51], s71 offen offset:0 sc1 lds
    v_mfma_f32_16x16x32_bf16 v[64:67], v[132:135], v[164:167], v[64:67]
    v_exp_f32 v91, v91
    v_mfma_f32_16x16x32_bf16 v[68:71], v[132:135], v[180:183], v[68:71]
    ds_read_b128 v[132:135], v198 offset:25600
    v_add_u32 v230, 2, v230
    v_mfma_f32_16x16x32_bf16 v[64:67], v[136:139], v[168:171], v[64:67]
    v_exp_f32 v92, v92
    buffer_load_dwordx4 v255, s[48:51], s71 offen offset:1024 sc1 lds
    v_mfma_f32_16x16x32_bf16 v[68:71], v[136:139], v[184:187], v[68:71]
    ds_read_b128 v[136:139], v198 offset:26624
    v_cvt_pk_bf16_f32 v83, v90, v91
    v_mfma_f32_16x16x32_bf16 v[64:67], v[140:143], v[172:175], v[64:67]
    v_exp_f32 v93, v93
    v_mfma_f32_16x16x32_bf16 v[68:71], v[140:143], v[188:191], v[68:71]
    ds_read_b128 v[140:143], v198 offset:27648
    buffer_load_dwordx4 v255, s[48:51], s71 offen offset:2048 sc1 lds
    s_waitcnt lgkmcnt(4)
    v_mfma_f32_16x16x32_bf16 v[72:75], v[144:147], v[160:163], v[204:207]
    v_exp_f32 v94, v94
    v_mfma_f32_16x16x32_bf16 v[76:79], v[144:147], v[176:179], v[208:211]
    ds_read_b128 v[144:147], v198 offset:28672
    v_cvt_pk_bf16_f32 v86, v92, v93
    v_mfma_f32_16x16x32_bf16 v[72:75], v[148:151], v[164:167], v[72:75]
    v_exp_f32 v95, v95
    buffer_load_dwordx4 v255, s[48:51], s71 offen offset:3072 sc1 lds
    s_add_u32 s72, s72, 32768
    v_mfma_f32_16x16x32_bf16 v[76:79], v[148:151], v[180:183], v[76:79]
    ds_read_b128 v[148:151], v198 offset:29696
    v_cmp_ge_i32 vcc, s28, v231
    v_mfma_f32_16x16x32_bf16 v[72:75], v[152:155], v[168:171], v[72:75]
    s_add_u32 s28, s28, 1
    s_cmp_eq_u32 s28, s26
    v_mfma_f32_16x16x32_bf16 v[76:79], v[152:155], v[184:187], v[76:79]
    ds_read_b128 v[152:155], v198 offset:30720
    v_cvt_pk_bf16_f32 v87, v94, v95
    v_mfma_f32_16x16x32_bf16 v[72:75], v[156:159], v[172:175], v[72:75]
    s_cbranch_vccnz Lgated_wr_29
Lgated_wr_29_r:
    v_mfma_f32_16x16x32_bf16 v[76:79], v[156:159], v[188:191], v[76:79]
    ds_read_b128 v[156:159], v198 offset:31744
    s_cbranch_scc1 fmain_tail0_0
    v_mfma_f32_16x16x32_bf16 v[236:239], v[244:247], v[80:83], v[236:239]
    v_exp_f32 v64, v64
    v_mfma_f32_16x16x32_bf16 v[240:243], v[244:247], v[84:87], v[240:243]
    v_exp_f32 v65, v65
    s_waitcnt lgkmcnt(4)
    v_mfma_f32_16x16x32_bf16 v[0:3], v[128:131], v[80:83], v[0:3]
    v_exp_f32 v66, v66
    v_mfma_f32_16x16x32_bf16 v[4:7], v[128:131], v[84:87], v[4:7]
    ds_read_b128 v[128:131], v198 offset:49152
    v_cvt_pk_bf16_f32 v64, v64, v65
    v_mfma_f32_16x16x32_bf16 v[8:11], v[132:135], v[80:83], v[8:11]
    v_exp_f32 v67, v67
    v_mfma_f32_16x16x32_bf16 v[12:15], v[132:135], v[84:87], v[12:15]
    ds_read_b128 v[132:135], v198 offset:50176
    v_mfma_f32_16x16x32_bf16 v[16:19], v[136:139], v[80:83], v[16:19]
    v_exp_f32 v68, v68
    v_mfma_f32_16x16x32_bf16 v[20:23], v[136:139], v[84:87], v[20:23]
    ds_read_b128 v[136:139], v198 offset:53248
    v_cvt_pk_bf16_f32 v65, v66, v67
    v_mfma_f32_16x16x32_bf16 v[24:27], v[140:143], v[80:83], v[24:27]
    v_exp_f32 v69, v69
    v_mfma_f32_16x16x32_bf16 v[28:31], v[140:143], v[84:87], v[28:31]
    ds_read_b128 v[140:143], v198 offset:54272
    s_waitcnt lgkmcnt(4)
    v_mfma_f32_16x16x32_bf16 v[32:35], v[144:147], v[80:83], v[32:35]
    v_exp_f32 v70, v70
    v_mfma_f32_16x16x32_bf16 v[36:39], v[144:147], v[84:87], v[36:39]
    ds_read_b128 v[144:147], v198 offset:51200
    v_cvt_pk_bf16_f32 v68, v68, v69
    v_mfma_f32_16x16x32_bf16 v[40:43], v[148:151], v[80:83], v[40:43]
    v_exp_f32 v71, v71
    v_mfma_f32_16x16x32_bf16 v[44:47], v[148:151], v[84:87], v[44:47]
    ds_read_b128 v[148:151], v198 offset:52224
    ds_write_b32 v200, v230
    v_mfma_f32_16x16x32_bf16 v[48:51], v[152:155], v[80:83], v[48:51]
    v_exp_f32 v72, v72
    v_mfma_f32_16x16x32_bf16 v[52:55], v[152:155], v[84:87], v[52:55]
    ds_read_b128 v[152:155], v198 offset:55296
    v_cvt_pk_bf16_f32 v69, v70, v71
    v_mfma_f32_16x16x32_bf16 v[56:59], v[156:159], v[80:83], v[56:59]
    v_exp_f32 v73, v73
    v_mfma_f32_16x16x32_bf16 v[60:63], v[156:159], v[84:87], v[60:63]
    ds_read_b128 v[156:159], v198 offset:56320
    s_add_u32 s78, s73, 786432
    buffer_store_dwordx4 v[112:115], v255, s[52:55], s78 offen offset:0 sc1
    s_waitcnt lgkmcnt(4)
    v_mfma_f32_16x16x32_bf16 v[80:83], v[128:131], v[160:163], v[204:207]
    ds_read_b32 v232, v229
    v_exp_f32 v74, v74
    v_mfma_f32_16x16x32_bf16 v[84:87], v[128:131], v[176:179], v[208:211]
    ds_read_b128 v[128:131], v198 offset:40960
    v_cvt_pk_bf16_f32 v66, v72, v73
    v_mfma_f32_16x16x32_bf16 v[80:83], v[132:135], v[164:167], v[80:83]
    v_exp_f32 v75, v75
    v_mfma_f32_16x16x32_bf16 v[84:87], v[132:135], v[180:183], v[84:87]
    ds_read_b128 v[132:135], v198 offset:41984
    s_waitcnt vmcnt(12)
    v_add_u32 v254, 2, v254
    ds_write_b32 v201, v254
    v_mfma_f32_16x16x32_bf16 v[80:83], v[136:139], v[168:171], v[80:83]
    v_exp_f32 v76, v76
    v_mfma_f32_16x16x32_bf16 v[84:87], v[136:139], v[184:187], v[84:87]
    ds_read_b128 v[136:139], v198 offset:43008
    v_cvt_pk_bf16_f32 v67, v74, v75
    v_mfma_f32_16x16x32_bf16 v[80:83], v[140:143], v[172:175], v[80:83]
    v_exp_f32 v77, v77
    v_mfma_f32_16x16x32_bf16 v[84:87], v[140:143], v[188:191], v[84:87]
    ds_read_b128 v[140:143], v198 offset:44032
    s_waitcnt lgkmcnt(4)
    v_mfma_f32_16x16x32_bf16 v[88:91], v[144:147], v[160:163], v[204:207]
    v_exp_f32 v78, v78
    v_cmp_gt_i32 vcc, s28, v232
    v_mfma_f32_16x16x32_bf16 v[92:95], v[144:147], v[176:179], v[208:211]
    ds_read_b128 v[144:147], v198 offset:45056
    v_cvt_pk_bf16_f32 v70, v76, v77
    v_mfma_f32_16x16x32_bf16 v[88:91], v[148:151], v[164:167], v[88:91]
    v_exp_f32 v79, v79
    v_mfma_f32_16x16x32_bf16 v[92:95], v[148:151], v[180:183], v[92:95]
    ds_read_b128 v[148:151], v198 offset:46080
    s_cbranch_vccnz Lgated_wp_30
Lgated_wp_30_r:
    s_add_u32 s78, s73, 786432
    buffer_store_dwordx4 v[116:119], v255, s[52:55], s78 offen offset:1024 sc1
    v_mfma_f32_16x16x32_bf16 v[88:91], v[152:155], v[168:171], v[88:91]
    s_add_u32 s28, s28, 1
    s_cmp_eq_u32 s28, s26
    v_mfma_f32_16x16x32_bf16 v[92:95], v[152:155], v[184:187], v[92:95]
    ds_read_b128 v[152:155], v198 offset:47104
    v_cvt_pk_bf16_f32 v71, v78, v79
    v_mfma_f32_16x16x32_bf16 v[88:91], v[156:159], v[172:175], v[88:91]
    v_mfma_f32_16x16x32_bf16 v[92:95], v[156:159], v[188:191], v[92:95]
    ds_read_b128 v[156:159], v198 offset:48128
    s_cbranch_scc1 fmain_tail0_1
    v_mfma_f32_16x16x32_bf16 v[236:239], v[244:247], v[64:67], v[236:239]
    v_exp_f32 v80, v80
    v_mfma_f32_16x16x32_bf16 v[240:243], v[244:247], v[68:71], v[240:243]
    v_exp_f32 v81, v81
    s_waitcnt lgkmcnt(4)
    v_mfma_f32_16x16x32_bf16 v[0:3], v[128:131], v[64:67], v[0:3]
    v_exp_f32 v82, v82
    v_mfma_f32_16x16x32_bf16 v[4:7], v[128:131], v[68:71], v[4:7]
    ds_read_b128 v[128:131], v255 offset:0
    v_cvt_pk_bf16_f32 v80, v80, v81
    s_add_u32 s71, s72, 32768
    s_and_b32 m0, s71, 0x1ffff
    s_sub_u32 s71, s71, 32768
    buffer_load_dwordx4 v255, s[48:51], s71 offen offset:0 sc1 lds
    v_mfma_f32_16x16x32_bf16 v[8:11], v[132:135], v[64:67], v[8:11]
    v_exp_f32 v83, v83
    v_mfma_f32_16x16x32_bf16 v[12:15], v[132:135], v[68:71], v[12:15]
    ds_read_b128 v[132:135], v255 offset:1024
    v_mfma_f32_16x16x32_bf16 v[16:19], v[136:139], v[64:67], v[16:19]
    v_exp_f32 v84, v84
    v_mfma_f32_16x16x32_bf16 v[20:23], v[136:139], v[68:71], v[20:23]
    ds_read_b128 v[136:139], v255 offset:4096
    v_cvt_pk_bf16_f32 v81, v82, v83
    buffer_load_dwordx4 v255, s[48:51], s71 offen offset:1024 sc1 lds
    v_mfma_f32_16x16x32_bf16 v[24:27], v[140:143], v[64:67], v[24:27]
    v_exp_f32 v85, v85
    v_mfma_f32_16x16x32_bf16 v[28:31], v[140:143], v[68:71], v[28:31]
    ds_read_b128 v[140:143], v255 offset:5120
    s_waitcnt lgkmcnt(4)
    v_mfma_f32_16x16x32_bf16 v[32:35], v[144:147], v[64:67], v[32:35]
    v_exp_f32 v86, v86
    v_mfma_f32_16x16x32_bf16 v[36:39], v[144:147], v[68:71], v[36:39]
    ds_read_b128 v[144:147], v255 offset:2048
    v_cvt_pk_bf16_f32 v84, v84, v85
    buffer_load_dwordx4 v255, s[48:51], s71 offen offset:2048 sc1 lds
    v_mfma_f32_16x16x32_bf16 v[40:43], v[148:151], v[64:67], v[40:43]
    v_exp_f32 v87, v87
    v_mfma_f32_16x16x32_bf16 v[44:47], v[148:151], v[68:71], v[44:47]
    ds_read_b128 v[148:151], v255 offset:3072
    v_mfma_f32_16x16x32_bf16 v[48:51], v[152:155], v[64:67], v[48:51]
    v_exp_f32 v88, v88
    v_mfma_f32_16x16x32_bf16 v[52:55], v[152:155], v[68:71], v[52:55]
    ds_read_b128 v[152:155], v255 offset:6144
    v_cvt_pk_bf16_f32 v85, v86, v87
    buffer_load_dwordx4 v255, s[48:51], s71 offen offset:3072 sc1 lds
    v_mfma_f32_16x16x32_bf16 v[56:59], v[156:159], v[64:67], v[56:59]
    v_exp_f32 v89, v89
    v_mfma_f32_16x16x32_bf16 v[60:63], v[156:159], v[68:71], v[60:63]
    ds_read_b128 v[156:159], v255 offset:7168
    s_add_u32 s78, s73, 786432
    buffer_store_dwordx4 v[120:123], v255, s[52:55], s78 offen offset:2048 sc1
    s_waitcnt lgkmcnt(4)
    v_mfma_f32_16x16x32_bf16 v[64:67], v[128:131], v[160:163], v[204:207]
    ds_read_b32 v231, v228
    v_exp_f32 v90, v90
    v_mfma_f32_16x16x32_bf16 v[68:71], v[128:131], v[176:179], v[208:211]
    ds_read_b128 v[128:131], v198 offset:57344
    v_cvt_pk_bf16_f32 v82, v88, v89
    s_add_u32 s71, s72, 36864
    s_and_b32 m0, s71, 0x1ffff
    s_sub_u32 s71, s71, 32768
    buffer_load_dwordx4 v255, s[48:51], s71 offen offset:0 sc1 lds
    v_mfma_f32_16x16x32_bf16 v[64:67], v[132:135], v[164:167], v[64:67]
    v_exp_f32 v91, v91
    v_mfma_f32_16x16x32_bf16 v[68:71], v[132:135], v[180:183], v[68:71]
    ds_read_b128 v[132:135], v198 offset:58368
    v_add_u32 v230, 2, v230
    v_mfma_f32_16x16x32_bf16 v[64:67], v[136:139], v[168:171], v[64:67]
    v_exp_f32 v92, v92
    buffer_load_dwordx4 v255, s[48:51], s71 offen offset:1024 sc1 lds
    v_mfma_f32_16x16x32_bf16 v[68:71], v[136:139], v[184:187], v[68:71]
    ds_read_b128 v[136:139], v198 offset:59392
    v_cvt_pk_bf16_f32 v83, v90, v91
    v_mfma_f32_16x16x32_bf16 v[64:67], v[140:143], v[172:175], v[64:67]
    v_exp_f32 v93, v93
    v_mfma_f32_16x16x32_bf16 v[68:71], v[140:143], v[188:191], v[68:71]
    ds_read_b128 v[140:143], v198 offset:60416
    buffer_load_dwordx4 v255, s[48:51], s71 offen offset:2048 sc1 lds
    s_waitcnt lgkmcnt(4)
    v_mfma_f32_16x16x32_bf16 v[72:75], v[144:147], v[160:163], v[204:207]
    v_exp_f32 v94, v94
    v_mfma_f32_16x16x32_bf16 v[76:79], v[144:147], v[176:179], v[208:211]
    ds_read_b128 v[144:147], v198 offset:61440
    v_cvt_pk_bf16_f32 v86, v92, v93
    v_mfma_f32_16x16x32_bf16 v[72:75], v[148:151], v[164:167], v[72:75]
    v_exp_f32 v95, v95
    buffer_load_dwordx4 v255, s[48:51], s71 offen offset:3072 sc1 lds
    s_add_u32 s72, s72, 32768
    v_mfma_f32_16x16x32_bf16 v[76:79], v[148:151], v[180:183], v[76:79]
    ds_read_b128 v[148:151], v198 offset:62464
    v_cmp_ge_i32 vcc, s28, v231
    s_add_u32 s78, s73, 786432
    buffer_store_dwordx4 v[124:127], v255, s[52:55], s78 offen offset:3072 sc1
    v_mfma_f32_16x16x32_bf16 v[72:75], v[152:155], v[168:171], v[72:75]
    s_add_u32 s28, s28, 1
    s_cmp_eq_u32 s28, s26
    v_mfma_f32_16x16x32_bf16 v[76:79], v[152:155], v[184:187], v[76:79]
    ds_read_b128 v[152:155], v198 offset:63488
    v_cvt_pk_bf16_f32 v87, v94, v95
    v_mfma_f32_16x16x32_bf16 v[72:75], v[156:159], v[172:175], v[72:75]
    s_cbranch_vccnz Lgated_wr_31
Lgated_wr_31_r:
    v_mfma_f32_16x16x32_bf16 v[76:79], v[156:159], v[188:191], v[76:79]
    ds_read_b128 v[156:159], v198 offset:64512
    s_cbranch_scc1 fmain_tail0_0
    v_mfma_f32_16x16x32_bf16 v[236:239], v[244:247], v[80:83], v[236:239]
    v_exp_f32 v64, v64
    v_mfma_f32_16x16x32_bf16 v[240:243], v[244:247], v[84:87], v[240:243]
    v_exp_f32 v65, v65
    s_waitcnt lgkmcnt(4)
    v_mfma_f32_16x16x32_bf16 v[0:3], v[128:131], v[80:83], v[0:3]
    v_exp_f32 v66, v66
    v_mfma_f32_16x16x32_bf16 v[4:7], v[128:131], v[84:87], v[4:7]
    ds_read_b128 v[128:131], v255 offset:16384
    v_cvt_pk_bf16_f32 v64, v64, v65
    v_mfma_f32_16x16x32_bf16 v[8:11], v[132:135], v[80:83], v[8:11]
    v_exp_f32 v67, v67
    v_mfma_f32_16x16x32_bf16 v[12:15], v[132:135], v[84:87], v[12:15]
    ds_read_b128 v[132:135], v255 offset:17408
    v_mfma_f32_16x16x32_bf16 v[16:19], v[136:139], v[80:83], v[16:19]
    v_exp_f32 v68, v68
    v_mfma_f32_16x16x32_bf16 v[20:23], v[136:139], v[84:87], v[20:23]
    ds_read_b128 v[136:139], v255 offset:20480
    v_cvt_pk_bf16_f32 v65, v66, v67
    v_mfma_f32_16x16x32_bf16 v[24:27], v[140:143], v[80:83], v[24:27]
    v_exp_f32 v69, v69
    v_mfma_f32_16x16x32_bf16 v[28:31], v[140:143], v[84:87], v[28:31]
    ds_read_b128 v[140:143], v255 offset:21504
    s_waitcnt lgkmcnt(4)
    v_mfma_f32_16x16x32_bf16 v[32:35], v[144:147], v[80:83], v[32:35]
    v_exp_f32 v70, v70
    v_mfma_f32_16x16x32_bf16 v[36:39], v[144:147], v[84:87], v[36:39]
    ds_read_b128 v[144:147], v255 offset:18432
    v_cvt_pk_bf16_f32 v68, v68, v69
    v_mfma_f32_16x16x32_bf16 v[40:43], v[148:151], v[80:83], v[40:43]
    v_exp_f32 v71, v71
    v_mfma_f32_16x16x32_bf16 v[44:47], v[148:151], v[84:87], v[44:47]
    ds_read_b128 v[148:151], v255 offset:19456
    ds_write_b32 v200, v230
    v_mfma_f32_16x16x32_bf16 v[48:51], v[152:155], v[80:83], v[48:51]
    v_exp_f32 v72, v72
    v_mfma_f32_16x16x32_bf16 v[52:55], v[152:155], v[84:87], v[52:55]
    ds_read_b128 v[152:155], v255 offset:22528
    v_cvt_pk_bf16_f32 v69, v70, v71
    v_mfma_f32_16x16x32_bf16 v[56:59], v[156:159], v[80:83], v[56:59]
    v_exp_f32 v73, v73
    v_mfma_f32_16x16x32_bf16 v[60:63], v[156:159], v[84:87], v[60:63]
    ds_read_b128 v[156:159], v255 offset:23552
    s_waitcnt lgkmcnt(4)
    v_mfma_f32_16x16x32_bf16 v[80:83], v[128:131], v[160:163], v[204:207]
    ds_read_b32 v232, v229
    v_exp_f32 v74, v74
    v_mfma_f32_16x16x32_bf16 v[84:87], v[128:131], v[176:179], v[208:211]
    ds_read_b128 v[128:131], v255 offset:8192
    v_cvt_pk_bf16_f32 v66, v72, v73
    v_mfma_f32_16x16x32_bf16 v[80:83], v[132:135], v[164:167], v[80:83]
    v_exp_f32 v75, v75
    v_mfma_f32_16x16x32_bf16 v[84:87], v[132:135], v[180:183], v[84:87]
    ds_read_b128 v[132:135], v255 offset:9216
    s_waitcnt vmcnt(12)
    v_add_u32 v254, 2, v254
    ds_write_b32 v201, v254
    v_mfma_f32_16x16x32_bf16 v[80:83], v[136:139], v[168:171], v[80:83]
    v_exp_f32 v76, v76
    v_mfma_f32_16x16x32_bf16 v[84:87], v[136:139], v[184:187], v[84:87]
    ds_read_b128 v[136:139], v255 offset:10240
    v_cvt_pk_bf16_f32 v67, v74, v75
    v_mfma_f32_16x16x32_bf16 v[80:83], v[140:143], v[172:175], v[80:83]
    v_exp_f32 v77, v77
    v_mfma_f32_16x16x32_bf16 v[84:87], v[140:143], v[188:191], v[84:87]
    ds_read_b128 v[140:143], v255 offset:11264
    s_waitcnt lgkmcnt(4)
    v_mfma_f32_16x16x32_bf16 v[88:91], v[144:147], v[160:163], v[204:207]
    v_exp_f32 v78, v78
    v_cmp_gt_i32 vcc, s28, v232
    v_mfma_f32_16x16x32_bf16 v[92:95], v[144:147], v[176:179], v[208:211]
    ds_read_b128 v[144:147], v255 offset:12288
    v_cvt_pk_bf16_f32 v70, v76, v77
    v_mfma_f32_16x16x32_bf16 v[88:91], v[148:151], v[164:167], v[88:91]
    v_exp_f32 v79, v79
    v_mfma_f32_16x16x32_bf16 v[92:95], v[148:151], v[180:183], v[92:95]
    ds_read_b128 v[148:151], v255 offset:13312
    s_cbranch_vccnz Lgated_wp_32
Lgated_wp_32_r:
    v_mfma_f32_16x16x32_bf16 v[88:91], v[152:155], v[168:171], v[88:91]
    s_add_u32 s28, s28, 1
    s_cmp_eq_u32 s28, s26
    v_mfma_f32_16x16x32_bf16 v[92:95], v[152:155], v[184:187], v[92:95]
    ds_read_b128 v[152:155], v255 offset:14336
    v_cvt_pk_bf16_f32 v71, v78, v79
    v_mfma_f32_16x16x32_bf16 v[88:91], v[156:159], v[172:175], v[88:91]
    v_mfma_f32_16x16x32_bf16 v[92:95], v[156:159], v[188:191], v[92:95]
    ds_read_b128 v[156:159], v255 offset:15360
    s_cbranch_scc1 fmain_tail0_1
    v_mfma_f32_16x16x32_bf16 v[236:239], v[244:247], v[64:67], v[236:239]
    v_exp_f32 v80, v80
    v_mfma_f32_16x16x32_bf16 v[240:243], v[244:247], v[68:71], v[240:243]
    v_exp_f32 v81, v81
    s_waitcnt lgkmcnt(4)
    v_mfma_f32_16x16x32_bf16 v[0:3], v[128:131], v[64:67], v[0:3]
    v_exp_f32 v82, v82
    v_mfma_f32_16x16x32_bf16 v[4:7], v[128:131], v[68:71], v[4:7]
    ds_read_b128 v[128:131], v255 offset:32768
    v_cvt_pk_bf16_f32 v80, v80, v81
    s_add_u32 s71, s72, 32768
    s_and_b32 m0, s71, 0x1ffff
    s_sub_u32 s71, s71, 32768
    buffer_load_dwordx4 v255, s[48:51], s71 offen offset:0 sc1 lds
    v_mfma_f32_16x16x32_bf16 v[8:11], v[132:135], v[64:67], v[8:11]
    v_exp_f32 v83, v83
    v_mfma_f32_16x16x32_bf16 v[12:15], v[132:135], v[68:71], v[12:15]
    ds_read_b128 v[132:135], v255 offset:33792
    v_mfma_f32_16x16x32_bf16 v[16:19], v[136:139], v[64:67], v[16:19]
    v_exp_f32 v84, v84
    v_mfma_f32_16x16x32_bf16 v[20:23], v[136:139], v[68:71], v[20:23]
    ds_read_b128 v[136:139], v255 offset:36864
    v_cvt_pk_bf16_f32 v81, v82, v83
    buffer_load_dwordx4 v255, s[48:51], s71 offen offset:1024 sc1 lds
    v_mfma_f32_16x16x32_bf16 v[24:27], v[140:143], v[64:67], v[24:27]
    v_exp_f32 v85, v85
    v_mfma_f32_16x16x32_bf16 v[28:31], v[140:143], v[68:71], v[28:31]
    ds_read_b128 v[140:143], v255 offset:37888
    s_waitcnt lgkmcnt(4)
    v_mfma_f32_16x16x32_bf16 v[32:35], v[144:147], v[64:67], v[32:35]
    v_exp_f32 v86, v86
    v_mfma_f32_16x16x32_bf16 v[36:39], v[144:147], v[68:71], v[36:39]
    ds_read_b128 v[144:147], v255 offset:34816
    v_cvt_pk_bf16_f32 v84, v84, v85
    buffer_load_dwordx4 v255, s[48:51], s71 offen offset:2048 sc1 lds
    v_mfma_f32_16x16x32_bf16 v[40:43], v[148:151], v[64:67], v[40:43]
    v_exp_f32 v87, v87
    v_mfma_f32_16x16x32_bf16 v[44:47], v[148:151], v[68:71], v[44:47]
    ds_read_b128 v[148:151], v255 offset:35840
    v_mfma_f32_16x16x32_bf16 v[48:51], v[152:155], v[64:67], v[48:51]
    v_exp_f32 v88, v88
    v_mfma_f32_16x16x32_bf16 v[52:55], v[152:155], v[68:71], v[52:55]
    ds_read_b128 v[152:155], v255 offset:38912
    v_cvt_pk_bf16_f32 v85, v86, v87
    buffer_load_dwordx4 v255, s[48:51], s71 offen offset:3072 sc1 lds
    v_mfma_f32_16x16x32_bf16 v[56:59], v[156:159], v[64:67], v[56:59]
    v_exp_f32 v89, v89
    v_mfma_f32_16x16x32_bf16 v[60:63], v[156:159], v[68:71], v[60:63]
    ds_read_b128 v[156:159], v255 offset:39936
    s_waitcnt lgkmcnt(4)
    v_mfma_f32_16x16x32_bf16 v[64:67], v[128:131], v[160:163], v[204:207]
    ds_read_b32 v231, v228
    v_exp_f32 v90, v90
    v_mfma_f32_16x16x32_bf16 v[68:71], v[128:131], v[176:179], v[208:211]
    ds_read_b128 v[128:131], v255 offset:24576
    v_cvt_pk_bf16_f32 v82, v88, v89
    s_add_u32 s71, s72, 36864
    s_and_b32 m0, s71, 0x1ffff
    s_sub_u32 s71, s71, 32768
    buffer_load_dwordx4 v255, s[48:51], s71 offen offset:0 sc1 lds
    v_mfma_f32_16x16x32_bf16 v[64:67], v[132:135], v[164:167], v[64:67]
    v_exp_f32 v91, v91
    v_mfma_f32_16x16x32_bf16 v[68:71], v[132:135], v[180:183], v[68:71]
    ds_read_b128 v[132:135], v255 offset:25600
    v_add_u32 v230, 2, v230
    v_mfma_f32_16x16x32_bf16 v[64:67], v[136:139], v[168:171], v[64:67]
    v_exp_f32 v92, v92
    buffer_load_dwordx4 v255, s[48:51], s71 offen offset:1024 sc1 lds
    v_mfma_f32_16x16x32_bf16 v[68:71], v[136:139], v[184:187], v[68:71]
    ds_read_b128 v[136:139], v255 offset:26624
    v_cvt_pk_bf16_f32 v83, v90, v91
    v_mfma_f32_16x16x32_bf16 v[64:67], v[140:143], v[172:175], v[64:67]
    v_exp_f32 v93, v93
    v_mfma_f32_16x16x32_bf16 v[68:71], v[140:143], v[188:191], v[68:71]
    ds_read_b128 v[140:143], v255 offset:27648
    buffer_load_dwordx4 v255, s[48:51], s71 offen offset:2048 sc1 lds
    s_waitcnt lgkmcnt(4)
    v_mfma_f32_16x16x32_bf16 v[72:75], v[144:147], v[160:163], v[204:207]
    v_exp_f32 v94, v94
    v_mfma_f32_16x16x32_bf16 v[76:79], v[144:147], v[176:179], v[208:211]
    ds_read_b128 v[144:147], v255 offset:28672
    v_cvt_pk_bf16_f32 v86, v92, v93
    v_mfma_f32_16x16x32_bf16 v[72:75], v[148:151], v[164:167], v[72:75]
    v_exp_f32 v95, v95
    buffer_load_dwordx4 v255, s[48:51], s71 offen offset:3072 sc1 lds
    s_add_u32 s72, s72, 32768
    s_waitcnt vmcnt(8)
    s_lshl_b32 s76, s23, 11
    s_lshl_b32 s77, s24, 6
    s_add_u32 s76, s76, s77
    s_lshl_b32 s77, s22, 3
    s_add_u32 s76, s76, s77
    s_mov_b64 exec, 1
    buffer_store_dwordx2 v[192:193], v255, s[64:67], s76 offen offset:1024 sc1
    s_mov_b64 exec, -1
    v_mfma_f32_16x16x32_bf16 v[76:79], v[148:151], v[180:183], v[76:79]
    ds_read_b128 v[148:151], v255 offset:29696
    v_cmp_ge_i32 vcc, s28, v231
    v_mfma_f32_16x16x32_bf16 v[72:75], v[152:155], v[168:171], v[72:75]
    s_add_u32 s28, s28, 1
    s_cmp_eq_u32 s28, s26
    v_mfma_f32_16x16x32_bf16 v[76:79], v[152:155], v[184:187], v[76:79]
    ds_read_b128 v[152:155], v255 offset:30720
    v_cvt_pk_bf16_f32 v87, v94, v95
    v_mfma_f32_16x16x32_bf16 v[72:75], v[156:159], v[172:175], v[72:75]
    s_cbranch_vccnz Lgated_wr_33
Lgated_wr_33_r:
    v_mfma_f32_16x16x32_bf16 v[76:79], v[156:159], v[188:191], v[76:79]
    ds_read_b128 v[156:159], v255 offset:31744
    s_cbranch_scc1 fmain_tail0_0
    v_mfma_f32_16x16x32_bf16 v[236:239], v[244:247], v[80:83], v[236:239]
    v_exp_f32 v64, v64
    v_mfma_f32_16x16x32_bf16 v[240:243], v[244:247], v[84:87], v[240:243]
    v_exp_f32 v65, v65
    s_waitcnt lgkmcnt(4)
    v_mfma_f32_16x16x32_bf16 v[0:3], v[128:131], v[80:83], v[0:3]
    v_exp_f32 v66, v66
    v_mfma_f32_16x16x32_bf16 v[4:7], v[128:131], v[84:87], v[4:7]
    ds_read_b128 v[128:131], v255 offset:49152
    v_cvt_pk_bf16_f32 v64, v64, v65
    v_mfma_f32_16x16x32_bf16 v[8:11], v[132:135], v[80:83], v[8:11]
    v_exp_f32 v67, v67
    v_mfma_f32_16x16x32_bf16 v[12:15], v[132:135], v[84:87], v[12:15]
    ds_read_b128 v[132:135], v255 offset:50176
    v_mfma_f32_16x16x32_bf16 v[16:19], v[136:139], v[80:83], v[16:19]
    v_exp_f32 v68, v68
    v_mfma_f32_16x16x32_bf16 v[20:23], v[136:139], v[84:87], v[20:23]
    ds_read_b128 v[136:139], v255 offset:53248
    v_cvt_pk_bf16_f32 v65, v66, v67
    v_mfma_f32_16x16x32_bf16 v[24:27], v[140:143], v[80:83], v[24:27]
    v_exp_f32 v69, v69
    v_mfma_f32_16x16x32_bf16 v[28:31], v[140:143], v[84:87], v[28:31]
    ds_read_b128 v[140:143], v255 offset:54272
    s_waitcnt lgkmcnt(4)
    v_mfma_f32_16x16x32_bf16 v[32:35], v[144:147], v[80:83], v[32:35]
    v_exp_f32 v70, v70
    v_mfma_f32_16x16x32_bf16 v[36:39], v[144:147], v[84:87], v[36:39]
    ds_read_b128 v[144:147], v255 offset:51200
    v_cvt_pk_bf16_f32 v68, v68, v69
    v_mfma_f32_16x16x32_bf16 v[40:43], v[148:151], v[80:83], v[40:43]
    v_exp_f32 v71, v71
    v_mfma_f32_16x16x32_bf16 v[44:47], v[148:151], v[84:87], v[44:47]
    ds_read_b128 v[148:151], v255 offset:52224
    ds_write_b32 v200, v230
    v_mfma_f32_16x16x32_bf16 v[48:51], v[152:155], v[80:83], v[48:51]
    v_exp_f32 v72, v72
    v_mfma_f32_16x16x32_bf16 v[52:55], v[152:155], v[84:87], v[52:55]
    ds_read_b128 v[152:155], v255 offset:55296
    v_cvt_pk_bf16_f32 v69, v70, v71
    v_mfma_f32_16x16x32_bf16 v[56:59], v[156:159], v[80:83], v[56:59]
    v_exp_f32 v73, v73
    v_mfma_f32_16x16x32_bf16 v[60:63], v[156:159], v[84:87], v[60:63]
    ds_read_b128 v[156:159], v255 offset:56320
    .p2align 3
fmain_loop0:
    s_waitcnt lgkmcnt(4)
    v_mfma_f32_16x16x32_bf16 v[80:83], v[128:131], v[160:163], v[204:207]
    ds_read_b32 v232, v229
    v_exp_f32 v74, v74
    v_mfma_f32_16x16x32_bf16 v[84:87], v[128:131], v[176:179], v[208:211]
    ds_read_b128 v[128:131], v255 offset:40960
    v_cvt_pk_bf16_f32 v66, v72, v73
    v_mfma_f32_16x16x32_bf16 v[80:83], v[132:135], v[164:167], v[80:83]
    v_exp_f32 v75, v75
    v_mfma_f32_16x16x32_bf16 v[84:87], v[132:135], v[180:183], v[84:87]
    ds_read_b128 v[132:135], v255 offset:41984
    s_waitcnt vmcnt(8)
    v_add_u32 v254, 2, v254
    ds_write_b32 v201, v254
    v_mfma_f32_16x16x32_bf16 v[80:83], v[136:139], v[168:171], v[80:83]
    v_exp_f32 v76, v76
    v_mfma_f32_16x16x32_bf16 v[84:87], v[136:139], v[184:187], v[84:87]
    ds_read_b128 v[136:139], v255 offset:43008
    v_cvt_pk_bf16_f32 v67, v74, v75
    v_mfma_f32_16x16x32_bf16 v[80:83], v[140:143], v[172:175], v[80:83]
    v_exp_f32 v77, v77
    v_mfma_f32_16x16x32_bf16 v[84:87], v[140:143], v[188:191], v[84:87]
    ds_read_b128 v[140:143], v255 offset:44032
    s_waitcnt lgkmcnt(4)
    v_mfma_f32_16x16x32_bf16 v[88:91], v[144:147], v[160:163], v[204:207]
    v_exp_f32 v78, v78
    v_cmp_gt_i32 vcc, s28, v232
    v_mfma_f32_16x16x32_bf16 v[92:95], v[144:147], v[176:179], v[208:211]
    ds_read_b128 v[144:147], v255 offset:45056
    v_cvt_pk_bf16_f32 v70, v76, v77
    v_mfma_f32_16x16x32_bf16 v[88:91], v[148:151], v[164:167], v[88:91]
    v_exp_f32 v79, v79
    v_mfma_f32_16x16x32_bf16 v[92:95], v[148:151], v[180:183], v[92:95]
    ds_read_b128 v[148:151], v255 offset:46080
    s_cbranch_vccnz Lgated_wp_34
Lgated_wp_34_r:
    v_mfma_f32_16x16x32_bf16 v[88:91], v[152:155], v[168:171], v[88:91]
    s_add_u32 s28, s28, 1
    s_cmp_eq_u32 s28, s26
    v_mfma_f32_16x16x32_bf16 v[92:95], v[152:155], v[184:187], v[92:95]
    ds_read_b128 v[152:155], v255 offset:47104
    v_cvt_pk_bf16_f32 v71, v78, v79
    v_mfma_f32_16x16x32_bf16 v[88:91], v[156:159], v[172:175], v[88:91]
    v_mfma_f32_16x16x32_bf16 v[92:95], v[156:159], v[188:191], v[92:95]
    ds_read_b128 v[156:159], v255 offset:48128
    s_cbranch_scc1 fmain_tail0_1
    v_mfma_f32_16x16x32_bf16 v[236:239], v[244:247], v[64:67], v[236:239]
    v_exp_f32 v80, v80
    v_mfma_f32_16x16x32_bf16 v[240:243], v[244:247], v[68:71], v[240:243]
    v_exp_f32 v81, v81
    s_waitcnt lgkmcnt(4)
    v_mfma_f32_16x16x32_bf16 v[0:3], v[128:131], v[64:67], v[0:3]
    v_exp_f32 v82, v82
    v_mfma_f32_16x16x32_bf16 v[4:7], v[128:131], v[68:71], v[4:7]
    ds_read_b128 v[128:131], v198 offset:0
    v_cvt_pk_bf16_f32 v80, v80, v81
    s_add_u32 s71, s72, 32768
    s_and_b32 m0, s71, 0x1ffff
    s_sub_u32 s71, s71, 32768
    buffer_load_dwordx4 v255, s[48:51], s71 offen offset:0 sc1 lds
    v_mfma_f32_16x16x32_bf16 v[8:11], v[132:135], v[64:67], v[8:11]
    v_exp_f32 v83, v83
    v_mfma_f32_16x16x32_bf16 v[12:15], v[132:135], v[68:71], v[12:15]
    ds_read_b128 v[132:135], v198 offset:1024
    v_mfma_f32_16x16x32_bf16 v[16:19], v[136:139], v[64:67], v[16:19]
    v_exp_f32 v84, v84
    v_mfma_f32_16x16x32_bf16 v[20:23], v[136:139], v[68:71], v[20:23]
    ds_read_b128 v[136:139], v198 offset:4096
    v_cvt_pk_bf16_f32 v81, v82, v83
    buffer_load_dwordx4 v255, s[48:51], s71 offen offset:1024 sc1 lds
    v_mfma_f32_16x16x32_bf16 v[24:27], v[140:143], v[64:67], v[24:27]
    v_exp_f32 v85, v85
    v_mfma_f32_16x16x32_bf16 v[28:31], v[140:143], v[68:71], v[28:31]
    ds_read_b128 v[140:143], v198 offset:5120
    s_waitcnt lgkmcnt(4)
    v_mfma_f32_16x16x32_bf16 v[32:35], v[144:147], v[64:67], v[32:35]
    v_exp_f32 v86, v86
    v_mfma_f32_16x16x32_bf16 v[36:39], v[144:147], v[68:71], v[36:39]
    ds_read_b128 v[144:147], v198 offset:2048
    v_cvt_pk_bf16_f32 v84, v84, v85
    buffer_load_dwordx4 v255, s[48:51], s71 offen offset:2048 sc1 lds
    v_mfma_f32_16x16x32_bf16 v[40:43], v[148:151], v[64:67], v[40:43]
    v_exp_f32 v87, v87
    v_mfma_f32_16x16x32_bf16 v[44:47], v[148:151], v[68:71], v[44:47]
    ds_read_b128 v[148:151], v198 offset:3072
    v_mfma_f32_16x16x32_bf16 v[48:51], v[152:155], v[64:67], v[48:51]
    v_exp_f32 v88, v88
    v_mfma_f32_16x16x32_bf16 v[52:55], v[152:155], v[68:71], v[52:55]
    ds_read_b128 v[152:155], v198 offset:6144
    v_cvt_pk_bf16_f32 v85, v86, v87
    buffer_load_dwordx4 v255, s[48:51], s71 offen offset:3072 sc1 lds
    v_mfma_f32_16x16x32_bf16 v[56:59], v[156:159], v[64:67], v[56:59]
    v_exp_f32 v89, v89
    v_mfma_f32_16x16x32_bf16 v[60:63], v[156:159], v[68:71], v[60:63]
    ds_read_b128 v[156:159], v198 offset:7168
    s_waitcnt lgkmcnt(4)
    v_mfma_f32_16x16x32_bf16 v[64:67], v[128:131], v[160:163], v[204:207]
    ds_read_b32 v231, v228
    v_exp_f32 v90, v90
    v_mfma_f32_16x16x32_bf16 v[68:71], v[128:131], v[176:179], v[208:211]
    ds_read_b128 v[128:131], v255 offset:57344
    v_cvt_pk_bf16_f32 v82, v88, v89
    s_add_u32 s71, s72, 36864
    s_and_b32 m0, s71, 0x1ffff
    s_sub_u32 s71, s71, 32768
    buffer_load_dwordx4 v255, s[48:51], s71 offen offset:0 sc1 lds
    v_mfma_f32_16x16x32_bf16 v[64:67], v[132:135], v[164:167], v[64:67]
    v_exp_f32 v91, v91
    v_mfma_f32_16x16x32_bf16 v[68:71], v[132:135], v[180:183], v[68:71]
    ds_read_b128 v[132:135], v255 offset:58368
    v_add_u32 v230, 2, v230
    v_mfma_f32_16x16x32_bf16 v[64:67], v[136:139], v[168:171], v[64:67]
    v_exp_f32 v92, v92
    buffer_load_dwordx4 v255, s[48:51], s71 offen offset:1024 sc1 lds
    v_mfma_f32_16x16x32_bf16 v[68:71], v[136:139], v[184:187], v[68:71]
    ds_read_b128 v[136:139], v255 offset:59392
    v_cvt_pk_bf16_f32 v83, v90, v91
    v_mfma_f32_16x16x32_bf16 v[64:67], v[140:143], v[172:175], v[64:67]
    v_exp_f32 v93, v93
    v_mfma_f32_16x16x32_bf16 v[68:71], v[140:143], v[188:191], v[68:71]
    ds_read_b128 v[140:143], v255 offset:60416
    buffer_load_dwordx4 v255, s[48:51], s71 offen offset:2048 sc1 lds
    s_waitcnt lgkmcnt(4)
    v_mfma_f32_16x16x32_bf16 v[72:75], v[144:147], v[160:163], v[204:207]
    v_exp_f32 v94, v94
    v_mfma_f32_16x16x32_bf16 v[76:79], v[144:147], v[176:179], v[208:211]
    ds_read_b128 v[144:147], v255 offset:61440
    v_cvt_pk_bf16_f32 v86, v92, v93
    v_mfma_f32_16x16x32_bf16 v[72:75], v[148:151], v[164:167], v[72:75]
    v_exp_f32 v95, v95
    buffer_load_dwordx4 v255, s[48:51], s71 offen offset:3072 sc1 lds
    s_add_u32 s72, s72, 32768
    v_mfma_f32_16x16x32_bf16 v[76:79], v[148:151], v[180:183], v[76:79]
    ds_read_b128 v[148:151], v255 offset:62464
    v_cmp_ge_i32 vcc, s28, v231
    v_mfma_f32_16x16x32_bf16 v[72:75], v[152:155], v[168:171], v[72:75]
    s_add_u32 s28, s28, 1
    s_cmp_eq_u32 s28, s26
    v_mfma_f32_16x16x32_bf16 v[76:79], v[152:155], v[184:187], v[76:79]
    ds_read_b128 v[152:155], v255 offset:63488
    v_cvt_pk_bf16_f32 v87, v94, v95
    v_mfma_f32_16x16x32_bf16 v[72:75], v[156:159], v[172:175], v[72:75]
    s_cbranch_vccnz Lgated_wr_35
Lgated_wr_35_r:
    v_mfma_f32_16x16x32_bf16 v[76:79], v[156:159], v[188:191], v[76:79]
    ds_read_b128 v[156:159], v255 offset:64512
    s_cbranch_scc1 fmain_tail0_0
    v_mfma_f32_16x16x32_bf16 v[236:239], v[244:247], v[80:83], v[236:239]
    v_exp_f32 v64, v64
    v_mfma_f32_16x16x32_bf16 v[240:243], v[244:247], v[84:87], v[240:243]
    v_exp_f32 v65, v65
    s_waitcnt lgkmcnt(4)
    v_mfma_f32_16x16x32_bf16 v[0:3], v[128:131], v[80:83], v[0:3]
    v_exp_f32 v66, v66
    v_mfma_f32_16x16x32_bf16 v[4:7], v[128:131], v[84:87], v[4:7]
    ds_read_b128 v[128:131], v198 offset:16384
    v_cvt_pk_bf16_f32 v64, v64, v65
    v_mfma_f32_16x16x32_bf16 v[8:11], v[132:135], v[80:83], v[8:11]
    v_exp_f32 v67, v67
    v_mfma_f32_16x16x32_bf16 v[12:15], v[132:135], v[84:87], v[12:15]
    ds_read_b128 v[132:135], v198 offset:17408
    v_mfma_f32_16x16x32_bf16 v[16:19], v[136:139], v[80:83], v[16:19]
    v_exp_f32 v68, v68
    v_mfma_f32_16x16x32_bf16 v[20:23], v[136:139], v[84:87], v[20:23]
    ds_read_b128 v[136:139], v198 offset:20480
    v_cvt_pk_bf16_f32 v65, v66, v67
    v_mfma_f32_16x16x32_bf16 v[24:27], v[140:143], v[80:83], v[24:27]
    v_exp_f32 v69, v69
    v_mfma_f32_16x16x32_bf16 v[28:31], v[140:143], v[84:87], v[28:31]
    ds_read_b128 v[140:143], v198 offset:21504
    s_waitcnt lgkmcnt(4)
    v_mfma_f32_16x16x32_bf16 v[32:35], v[144:147], v[80:83], v[32:35]
    v_exp_f32 v70, v70
    v_mfma_f32_16x16x32_bf16 v[36:39], v[144:147], v[84:87], v[36:39]
    ds_read_b128 v[144:147], v198 offset:18432
    v_cvt_pk_bf16_f32 v68, v68, v69
    v_mfma_f32_16x16x32_bf16 v[40:43], v[148:151], v[80:83], v[40:43]
    v_exp_f32 v71, v71
    v_mfma_f32_16x16x32_bf16 v[44:47], v[148:151], v[84:87], v[44:47]
    ds_read_b128 v[148:151], v198 offset:19456
    ds_write_b32 v200, v230
    v_mfma_f32_16x16x32_bf16 v[48:51], v[152:155], v[80:83], v[48:51]
    v_exp_f32 v72, v72
    v_mfma_f32_16x16x32_bf16 v[52:55], v[152:155], v[84:87], v[52:55]
    ds_read_b128 v[152:155], v198 offset:22528
    v_cvt_pk_bf16_f32 v69, v70, v71
    v_mfma_f32_16x16x32_bf16 v[56:59], v[156:159], v[80:83], v[56:59]
    v_exp_f32 v73, v73
    v_mfma_f32_16x16x32_bf16 v[60:63], v[156:159], v[84:87], v[60:63]
    ds_read_b128 v[156:159], v198 offset:23552
    s_waitcnt lgkmcnt(4)
    v_mfma_f32_16x16x32_bf16 v[80:83], v[128:131], v[160:163], v[204:207]
    ds_read_b32 v232, v229
    v_exp_f32 v74, v74
    v_mfma_f32_16x16x32_bf16 v[84:87], v[128:131], v[176:179], v[208:211]
    ds_read_b128 v[128:131], v198 offset:8192
    v_cvt_pk_bf16_f32 v66, v72, v73
    v_mfma_f32_16x16x32_bf16 v[80:83], v[132:135], v[164:167], v[80:83]
    v_exp_f32 v75, v75
    v_mfma_f32_16x16x32_bf16 v[84:87], v[132:135], v[180:183], v[84:87]
    ds_read_b128 v[132:135], v198 offset:9216
    s_waitcnt vmcnt(8)
    v_add_u32 v254, 2, v254
    ds_write_b32 v201, v254
    v_mfma_f32_16x16x32_bf16 v[80:83], v[136:139], v[168:171], v[80:83]
    v_exp_f32 v76, v76
    v_mfma_f32_16x16x32_bf16 v[84:87], v[136:139], v[184:187], v[84:87]
    ds_read_b128 v[136:139], v198 offset:10240
    v_cvt_pk_bf16_f32 v67, v74, v75
    v_mfma_f32_16x16x32_bf16 v[80:83], v[140:143], v[172:175], v[80:83]
    v_exp_f32 v77, v77
    v_mfma_f32_16x16x32_bf16 v[84:87], v[140:143], v[188:191], v[84:87]
    ds_read_b128 v[140:143], v198 offset:11264
    s_waitcnt lgkmcnt(4)
    v_mfma_f32_16x16x32_bf16 v[88:91], v[144:147], v[160:163], v[204:207]
    v_exp_f32 v78, v78
    v_cmp_gt_i32 vcc, s28, v232
    v_mfma_f32_16x16x32_bf16 v[92:95], v[144:147], v[176:179], v[208:211]
    ds_read_b128 v[144:147], v198 offset:12288
    v_cvt_pk_bf16_f32 v70, v76, v77
    v_mfma_f32_16x16x32_bf16 v[88:91], v[148:151], v[164:167], v[88:91]
    v_exp_f32 v79, v79
    v_mfma_f32_16x16x32_bf16 v[92:95], v[148:151], v[180:183], v[92:95]
    ds_read_b128 v[148:151], v198 offset:13312
    s_cbranch_vccnz Lgated_wp_36
Lgated_wp_36_r:
    v_mfma_f32_16x16x32_bf16 v[88:91], v[152:155], v[168:171], v[88:91]
    s_add_u32 s28, s28, 1
    s_cmp_eq_u32 s28, s26
    v_mfma_f32_16x16x32_bf16 v[92:95], v[152:155], v[184:187], v[92:95]
    ds_read_b128 v[152:155], v198 offset:14336
    v_cvt_pk_bf16_f32 v71, v78, v79
    v_mfma_f32_16x16x32_bf16 v[88:91], v[156:159], v[172:175], v[88:91]
    v_mfma_f32_16x16x32_bf16 v[92:95], v[156:159], v[188:191], v[92:95]
    ds_read_b128 v[156:159], v198 offset:15360
    s_cbranch_scc1 fmain_tail0_1
    v_mfma_f32_16x16x32_bf16 v[236:239], v[244:247], v[64:67], v[236:239]
    v_exp_f32 v80, v80
    v_mfma_f32_16x16x32_bf16 v[240:243], v[244:247], v[68:71], v[240:243]
    v_exp_f32 v81, v81
    s_waitcnt lgkmcnt(4)
    v_mfma_f32_16x16x32_bf16 v[0:3], v[128:131], v[64:67], v[0:3]
    v_exp_f32 v82, v82
    v_mfma_f32_16x16x32_bf16 v[4:7], v[128:131], v[68:71], v[4:7]
    ds_read_b128 v[128:131], v198 offset:32768
    v_cvt_pk_bf16_f32 v80, v80, v81
    s_add_u32 s71, s72, 32768
    s_and_b32 m0, s71, 0x1ffff
    s_sub_u32 s71, s71, 32768
    buffer_load_dwordx4 v255, s[48:51], s71 offen offset:0 sc1 lds
    v_mfma_f32_16x16x32_bf16 v[8:11], v[132:135], v[64:67], v[8:11]
    v_exp_f32 v83, v83
    v_mfma_f32_16x16x32_bf16 v[12:15], v[132:135], v[68:71], v[12:15]
    ds_read_b128 v[132:135], v198 offset:33792
    v_mfma_f32_16x16x32_bf16 v[16:19], v[136:139], v[64:67], v[16:19]
    v_exp_f32 v84, v84
    v_mfma_f32_16x16x32_bf16 v[20:23], v[136:139], v[68:71], v[20:23]
    ds_read_b128 v[136:139], v198 offset:36864
    v_cvt_pk_bf16_f32 v81, v82, v83
    buffer_load_dwordx4 v255, s[48:51], s71 offen offset:1024 sc1 lds
    v_mfma_f32_16x16x32_bf16 v[24:27], v[140:143], v[64:67], v[24:27]
    v_exp_f32 v85, v85
    v_mfma_f32_16x16x32_bf16 v[28:31], v[140:143], v[68:71], v[28:31]
    ds_read_b128 v[140:143], v198 offset:37888
    s_waitcnt lgkmcnt(4)
    v_mfma_f32_16x16x32_bf16 v[32:35], v[144:147], v[64:67], v[32:35]
    v_exp_f32 v86, v86
    v_mfma_f32_16x16x32_bf16 v[36:39], v[144:147], v[68:71], v[36:39]
    ds_read_b128 v[144:147], v198 offset:34816
    v_cvt_pk_bf16_f32 v84, v84, v85
    buffer_load_dwordx4 v255, s[48:51], s71 offen offset:2048 sc1 lds
    v_mfma_f32_16x16x32_bf16 v[40:43], v[148:151], v[64:67], v[40:43]
    v_exp_f32 v87, v87
    v_mfma_f32_16x16x32_bf16 v[44:47], v[148:151], v[68:71], v[44:47]
    ds_read_b128 v[148:151], v198 offset:35840
    v_mfma_f32_16x16x32_bf16 v[48:51], v[152:155], v[64:67], v[48:51]
    v_exp_f32 v88, v88
    v_mfma_f32_16x16x32_bf16 v[52:55], v[152:155], v[68:71], v[52:55]
    ds_read_b128 v[152:155], v198 offset:38912
    v_cvt_pk_bf16_f32 v85, v86, v87
    buffer_load_dwordx4 v255, s[48:51], s71 offen offset:3072 sc1 lds
    v_mfma_f32_16x16x32_bf16 v[56:59], v[156:159], v[64:67], v[56:59]
    v_exp_f32 v89, v89
    v_mfma_f32_16x16x32_bf16 v[60:63], v[156:159], v[68:71], v[60:63]
    ds_read_b128 v[156:159], v198 offset:39936
    s_waitcnt lgkmcnt(4)
    v_mfma_f32_16x16x32_bf16 v[64:67], v[128:131], v[160:163], v[204:207]
    ds_read_b32 v231, v228
    v_exp_f32 v90, v90
    v_mfma_f32_16x16x32_bf16 v[68:71], v[128:131], v[176:179], v[208:211]
    ds_read_b128 v[128:131], v198 offset:24576
    v_cvt_pk_bf16_f32 v82, v88, v89
    s_add_u32 s71, s72, 36864
    s_and_b32 m0, s71, 0x1ffff
    s_sub_u32 s71, s71, 32768
    buffer_load_dwordx4 v255, s[48:51], s71 offen offset:0 sc1 lds
    v_mfma_f32_16x16x32_bf16 v[64:67], v[132:135], v[164:167], v[64:67]
    v_exp_f32 v91, v91
    v_mfma_f32_16x16x32_bf16 v[68:71], v[132:135], v[180:183], v[68:71]
    ds_read_b128 v[132:135], v198 offset:25600
    v_add_u32 v230, 2, v230
    v_mfma_f32_16x16x32_bf16 v[64:67], v[136:139], v[168:171], v[64:67]
    v_exp_f32 v92, v92
    buffer_load_dwordx4 v255, s[48:51], s71 offen offset:1024 sc1 lds
    v_mfma_f32_16x16x32_bf16 v[68:71], v[136:139], v[184:187], v[68:71]
    ds_read_b128 v[136:139], v198 offset:26624
    v_cvt_pk_bf16_f32 v83, v90, v91
    v_mfma_f32_16x16x32_bf16 v[64:67], v[140:143], v[172:175], v[64:67]
    v_exp_f32 v93, v93
    v_mfma_f32_16x16x32_bf16 v[68:71], v[140:143], v[188:191], v[68:71]
    ds_read_b128 v[140:143], v198 offset:27648
    buffer_load_dwordx4 v255, s[48:51], s71 offen offset:2048 sc1 lds
    s_waitcnt lgkmcnt(4)
    v_mfma_f32_16x16x32_bf16 v[72:75], v[144:147], v[160:163], v[204:207]
    v_exp_f32 v94, v94
    v_mfma_f32_16x16x32_bf16 v[76:79], v[144:147], v[176:179], v[208:211]
    ds_read_b128 v[144:147], v198 offset:28672
    v_cvt_pk_bf16_f32 v86, v92, v93
    v_mfma_f32_16x16x32_bf16 v[72:75], v[148:151], v[164:167], v[72:75]
    v_exp_f32 v95, v95
    buffer_load_dwordx4 v255, s[48:51], s71 offen offset:3072 sc1 lds
    s_add_u32 s72, s72, 32768
    v_mfma_f32_16x16x32_bf16 v[76:79], v[148:151], v[180:183], v[76:79]
    ds_read_b128 v[148:151], v198 offset:29696
    v_cmp_ge_i32 vcc, s28, v231
    v_mfma_f32_16x16x32_bf16 v[72:75], v[152:155], v[168:171], v[72:75]
    s_add_u32 s28, s28, 1
    s_cmp_eq_u32 s28, s26
    v_mfma_f32_16x16x32_bf16 v[76:79], v[152:155], v[184:187], v[76:79]
    ds_read_b128 v[152:155], v198 offset:30720
    v_cvt_pk_bf16_f32 v87, v94, v95
    v_mfma_f32_16x16x32_bf16 v[72:75], v[156:159], v[172:175], v[72:75]
    s_cbranch_vccnz Lgated_wr_37
Lgated_wr_37_r:
    v_mfma_f32_16x16x32_bf16 v[76:79], v[156:159], v[188:191], v[76:79]
    ds_read_b128 v[156:159], v198 offset:31744
    s_cbranch_scc1 fmain_tail0_0
    v_mfma_f32_16x16x32_bf16 v[236:239], v[244:247], v[80:83], v[236:239]
    v_exp_f32 v64, v64
    v_mfma_f32_16x16x32_bf16 v[240:243], v[244:247], v[84:87], v[240:243]
    v_exp_f32 v65, v65
    s_waitcnt lgkmcnt(4)
    v_mfma_f32_16x16x32_bf16 v[0:3], v[128:131], v[80:83], v[0:3]
    v_exp_f32 v66, v66
    v_mfma_f32_16x16x32_bf16 v[4:7], v[128:131], v[84:87], v[4:7]
    ds_read_b128 v[128:131], v198 offset:49152
    v_cvt_pk_bf16_f32 v64, v64, v65
    v_mfma_f32_16x16x32_bf16 v[8:11], v[132:135], v[80:83], v[8:11]
    v_exp_f32 v67, v67
    v_mfma_f32_16x16x32_bf16 v[12:15], v[132:135], v[84:87], v[12:15]
    ds_read_b128 v[132:135], v198 offset:50176
    v_mfma_f32_16x16x32_bf16 v[16:19], v[136:139], v[80:83], v[16:19]
    v_exp_f32 v68, v68
    v_mfma_f32_16x16x32_bf16 v[20:23], v[136:139], v[84:87], v[20:23]
    ds_read_b128 v[136:139], v198 offset:53248
    v_cvt_pk_bf16_f32 v65, v66, v67
    v_mfma_f32_16x16x32_bf16 v[24:27], v[140:143], v[80:83], v[24:27]
    v_exp_f32 v69, v69
    v_mfma_f32_16x16x32_bf16 v[28:31], v[140:143], v[84:87], v[28:31]
    ds_read_b128 v[140:143], v198 offset:54272
    s_waitcnt lgkmcnt(4)
    v_mfma_f32_16x16x32_bf16 v[32:35], v[144:147], v[80:83], v[32:35]
    v_exp_f32 v70, v70
    v_mfma_f32_16x16x32_bf16 v[36:39], v[144:147], v[84:87], v[36:39]
    ds_read_b128 v[144:147], v198 offset:51200
    v_cvt_pk_bf16_f32 v68, v68, v69
    v_mfma_f32_16x16x32_bf16 v[40:43], v[148:151], v[80:83], v[40:43]
    v_exp_f32 v71, v71
    v_mfma_f32_16x16x32_bf16 v[44:47], v[148:151], v[84:87], v[44:47]
    ds_read_b128 v[148:151], v198 offset:52224
    ds_write_b32 v200, v230
    v_mfma_f32_16x16x32_bf16 v[48:51], v[152:155], v[80:83], v[48:51]
    v_exp_f32 v72, v72
    v_mfma_f32_16x16x32_bf16 v[52:55], v[152:155], v[84:87], v[52:55]
    ds_read_b128 v[152:155], v198 offset:55296
    v_cvt_pk_bf16_f32 v69, v70, v71
    v_mfma_f32_16x16x32_bf16 v[56:59], v[156:159], v[80:83], v[56:59]
    v_exp_f32 v73, v73
    v_mfma_f32_16x16x32_bf16 v[60:63], v[156:159], v[84:87], v[60:63]
    ds_read_b128 v[156:159], v198 offset:56320
    s_waitcnt lgkmcnt(4)
    v_mfma_f32_16x16x32_bf16 v[80:83], v[128:131], v[160:163], v[204:207]
    ds_read_b32 v232, v229
    v_exp_f32 v74, v74
    v_mfma_f32_16x16x32_bf16 v[84:87], v[128:131], v[176:179], v[208:211]
    ds_read_b128 v[128:131], v198 offset:40960
    v_cvt_pk_bf16_f32 v66, v72, v73
    v_mfma_f32_16x16x32_bf16 v[80:83], v[132:135], v[164:167], v[80:83]
    v_exp_f32 v75, v75
    v_mfma_f32_16x16x32_bf16 v[84:87], v[132:135], v[180:183], v[84:87]
    ds_read_b128 v[132:135], v198 offset:41984
    s_waitcnt vmcnt(8)
    v_add_u32 v254, 2, v254
    ds_write_b32 v201, v254
    v_mfma_f32_16x16x32_bf16 v[80:83], v[136:139], v[168:171], v[80:83]
    v_exp_f32 v76, v76
    v_mfma_f32_16x16x32_bf16 v[84:87], v[136:139], v[184:187], v[84:87]
    ds_read_b128 v[136:139], v198 offset:43008
    v_cvt_pk_bf16_f32 v67, v74, v75
    v_mfma_f32_16x16x32_bf16 v[80:83], v[140:143], v[172:175], v[80:83]
    v_exp_f32 v77, v77
    v_mfma_f32_16x16x32_bf16 v[84:87], v[140:143], v[188:191], v[84:87]
    ds_read_b128 v[140:143], v198 offset:44032
    s_waitcnt lgkmcnt(4)
    v_mfma_f32_16x16x32_bf16 v[88:91], v[144:147], v[160:163], v[204:207]
    v_exp_f32 v78, v78
    v_cmp_gt_i32 vcc, s28, v232
    v_mfma_f32_16x16x32_bf16 v[92:95], v[144:147], v[176:179], v[208:211]
    ds_read_b128 v[144:147], v198 offset:45056
    v_cvt_pk_bf16_f32 v70, v76, v77
    v_mfma_f32_16x16x32_bf16 v[88:91], v[148:151], v[164:167], v[88:91]
    v_exp_f32 v79, v79
    v_mfma_f32_16x16x32_bf16 v[92:95], v[148:151], v[180:183], v[92:95]
    ds_read_b128 v[148:151], v198 offset:46080
    s_cbranch_vccnz Lgated_wp_38
Lgated_wp_38_r:
    v_mfma_f32_16x16x32_bf16 v[88:91], v[152:155], v[168:171], v[88:91]
    s_add_u32 s28, s28, 1
    s_cmp_eq_u32 s28, s26
    v_mfma_f32_16x16x32_bf16 v[92:95], v[152:155], v[184:187], v[92:95]
    ds_read_b128 v[152:155], v198 offset:47104
    v_cvt_pk_bf16_f32 v71, v78, v79
    v_mfma_f32_16x16x32_bf16 v[88:91], v[156:159], v[172:175], v[88:91]
    v_mfma_f32_16x16x32_bf16 v[92:95], v[156:159], v[188:191], v[92:95]
    ds_read_b128 v[156:159], v198 offset:48128
    s_cbranch_scc1 fmain_tail0_1
    v_mfma_f32_16x16x32_bf16 v[236:239], v[244:247], v[64:67], v[236:239]
    v_exp_f32 v80, v80
    v_mfma_f32_16x16x32_bf16 v[240:243], v[244:247], v[68:71], v[240:243]
    v_exp_f32 v81, v81
    s_waitcnt lgkmcnt(4)
    v_mfma_f32_16x16x32_bf16 v[0:3], v[128:131], v[64:67], v[0:3]
    v_exp_f32 v82, v82
    v_mfma_f32_16x16x32_bf16 v[4:7], v[128:131], v[68:71], v[4:7]
    ds_read_b128 v[128:131], v255 offset:0
    v_cvt_pk_bf16_f32 v80, v80, v81
    s_add_u32 s71, s72, 32768
    s_and_b32 m0, s71, 0x1ffff
    s_sub_u32 s71, s71, 32768
    buffer_load_dwordx4 v255, s[48:51], s71 offen offset:0 sc1 lds
    v_mfma_f32_16x16x32_bf16 v[8:11], v[132:135], v[64:67], v[8:11]
    v_exp_f32 v83, v83
    v_mfma_f32_16x16x32_bf16 v[12:15], v[132:135], v[68:71], v[12:15]
    ds_read_b128 v[132:135], v255 offset:1024
    v_mfma_f32_16x16x32_bf16 v[16:19], v[136:139], v[64:67], v[16:19]
    v_exp_f32 v84, v84
    v_mfma_f32_16x16x32_bf16 v[20:23], v[136:139], v[68:71], v[20:23]
    ds_read_b128 v[136:139], v255 offset:4096
    v_cvt_pk_bf16_f32 v81, v82, v83
    buffer_load_dwordx4 v255, s[48:51], s71 offen offset:1024 sc1 lds
    v_mfma_f32_16x16x32_bf16 v[24:27], v[140:143], v[64:67], v[24:27]
    v_exp_f32 v85, v85
    v_mfma_f32_16x16x32_bf16 v[28:31], v[140:143], v[68:71], v[28:31]
    ds_read_b128 v[140:143], v255 offset:5120
    s_waitcnt lgkmcnt(4)
    v_mfma_f32_16x16x32_bf16 v[32:35], v[144:147], v[64:67], v[32:35]
    v_exp_f32 v86, v86
    v_mfma_f32_16x16x32_bf16 v[36:39], v[144:147], v[68:71], v[36:39]
    ds_read_b128 v[144:147], v255 offset:2048
    v_cvt_pk_bf16_f32 v84, v84, v85
    buffer_load_dwordx4 v255, s[48:51], s71 offen offset:2048 sc1 lds
    v_mfma_f32_16x16x32_bf16 v[40:43], v[148:151], v[64:67], v[40:43]
    v_exp_f32 v87, v87
    v_mfma_f32_16x16x32_bf16 v[44:47], v[148:151], v[68:71], v[44:47]
    ds_read_b128 v[148:151], v255 offset:3072
    v_mfma_f32_16x16x32_bf16 v[48:51], v[152:155], v[64:67], v[48:51]
    v_exp_f32 v88, v88
    v_mfma_f32_16x16x32_bf16 v[52:55], v[152:155], v[68:71], v[52:55]
    ds_read_b128 v[152:155], v255 offset:6144
    v_cvt_pk_bf16_f32 v85, v86, v87
    buffer_load_dwordx4 v255, s[48:51], s71 offen offset:3072 sc1 lds
    v_mfma_f32_16x16x32_bf16 v[56:59], v[156:159], v[64:67], v[56:59]
    v_exp_f32 v89, v89
    v_mfma_f32_16x16x32_bf16 v[60:63], v[156:159], v[68:71], v[60:63]
    ds_read_b128 v[156:159], v255 offset:7168
    s_waitcnt lgkmcnt(4)
    v_mfma_f32_16x16x32_bf16 v[64:67], v[128:131], v[160:163], v[204:207]
    ds_read_b32 v231, v228
    v_exp_f32 v90, v90
    v_mfma_f32_16x16x32_bf16 v[68:71], v[128:131], v[176:179], v[208:211]
    ds_read_b128 v[128:131], v198 offset:57344
    v_cvt_pk_bf16_f32 v82, v88, v89
    s_add_u32 s71, s72, 36864
    s_and_b32 m0, s71, 0x1ffff
    s_sub_u32 s71, s71, 32768
    buffer_load_dwordx4 v255, s[48:51], s71 offen offset:0 sc1 lds
    v_mfma_f32_16x16x32_bf16 v[64:67], v[132:135], v[164:167], v[64:67]
    v_exp_f32 v91, v91
    v_mfma_f32_16x16x32_bf16 v[68:71], v[132:135], v[180:183], v[68:71]
    ds_read_b128 v[132:135], v198 offset:58368
    v_add_u32 v230, 2, v230
    v_mfma_f32_16x16x32_bf16 v[64:67], v[136:139], v[168:171], v[64:67]
    v_exp_f32 v92, v92
    buffer_load_dwordx4 v255, s[48:51], s71 offen offset:1024 sc1 lds
    v_mfma_f32_16x16x32_bf16 v[68:71], v[136:139], v[184:187], v[68:71]
    ds_read_b128 v[136:139], v198 offset:59392
    v_cvt_pk_bf16_f32 v83, v90, v91
    v_mfma_f32_16x16x32_bf16 v[64:67], v[140:143], v[172:175], v[64:67]
    v_exp_f32 v93, v93
    v_mfma_f32_16x16x32_bf16 v[68:71], v[140:143], v[188:191], v[68:71]
    ds_read_b128 v[140:143], v198 offset:60416
    buffer_load_dwordx4 v255, s[48:51], s71 offen offset:2048 sc1 lds
    s_waitcnt lgkmcnt(4)
    v_mfma_f32_16x16x32_bf16 v[72:75], v[144:147], v[160:163], v[204:207]
    v_exp_f32 v94, v94
    v_mfma_f32_16x16x32_bf16 v[76:79], v[144:147], v[176:179], v[208:211]
    ds_read_b128 v[144:147], v198 offset:61440
    v_cvt_pk_bf16_f32 v86, v92, v93
    v_mfma_f32_16x16x32_bf16 v[72:75], v[148:151], v[164:167], v[72:75]
    v_exp_f32 v95, v95
    buffer_load_dwordx4 v255, s[48:51], s71 offen offset:3072 sc1 lds
    s_add_u32 s72, s72, 32768
    v_mfma_f32_16x16x32_bf16 v[76:79], v[148:151], v[180:183], v[76:79]
    ds_read_b128 v[148:151], v198 offset:62464
    v_cmp_ge_i32 vcc, s28, v231
    v_mfma_f32_16x16x32_bf16 v[72:75], v[152:155], v[168:171], v[72:75]
    s_add_u32 s28, s28, 1
    s_cmp_eq_u32 s28, s26
    v_mfma_f32_16x16x32_bf16 v[76:79], v[152:155], v[184:187], v[76:79]
    ds_read_b128 v[152:155], v198 offset:63488
    v_cvt_pk_bf16_f32 v87, v94, v95
    v_mfma_f32_16x16x32_bf16 v[72:75], v[156:159], v[172:175], v[72:75]
    s_cbranch_vccnz Lgated_wr_39
Lgated_wr_39_r:
    v_mfma_f32_16x16x32_bf16 v[76:79], v[156:159], v[188:191], v[76:79]
    ds_read_b128 v[156:159], v198 offset:64512
    s_cbranch_scc1 fmain_tail0_0
    v_mfma_f32_16x16x32_bf16 v[236:239], v[244:247], v[80:83], v[236:239]
    v_exp_f32 v64, v64
    v_mfma_f32_16x16x32_bf16 v[240:243], v[244:247], v[84:87], v[240:243]
    v_exp_f32 v65, v65
    s_waitcnt lgkmcnt(4)
    v_mfma_f32_16x16x32_bf16 v[0:3], v[128:131], v[80:83], v[0:3]
    v_exp_f32 v66, v66
    v_mfma_f32_16x16x32_bf16 v[4:7], v[128:131], v[84:87], v[4:7]
    ds_read_b128 v[128:131], v255 offset:16384
    v_cvt_pk_bf16_f32 v64, v64, v65
    v_mfma_f32_16x16x32_bf16 v[8:11], v[132:135], v[80:83], v[8:11]
    v_exp_f32 v67, v67
    v_mfma_f32_16x16x32_bf16 v[12:15], v[132:135], v[84:87], v[12:15]
    ds_read_b128 v[132:135], v255 offset:17408
    v_mfma_f32_16x16x32_bf16 v[16:19], v[136:139], v[80:83], v[16:19]
    v_exp_f32 v68, v68
    v_mfma_f32_16x16x32_bf16 v[20:23], v[136:139], v[84:87], v[20:23]
    ds_read_b128 v[136:139], v255 offset:20480
    v_cvt_pk_bf16_f32 v65, v66, v67
    v_mfma_f32_16x16x32_bf16 v[24:27], v[140:143], v[80:83], v[24:27]
    v_exp_f32 v69, v69
    v_mfma_f32_16x16x32_bf16 v[28:31], v[140:143], v[84:87], v[28:31]
    ds_read_b128 v[140:143], v255 offset:21504
    s_waitcnt lgkmcnt(4)
    v_mfma_f32_16x16x32_bf16 v[32:35], v[144:147], v[80:83], v[32:35]
    v_exp_f32 v70, v70
    v_mfma_f32_16x16x32_bf16 v[36:39], v[144:147], v[84:87], v[36:39]
    ds_read_b128 v[144:147], v255 offset:18432
    v_cvt_pk_bf16_f32 v68, v68, v69
    v_mfma_f32_16x16x32_bf16 v[40:43], v[148:151], v[80:83], v[40:43]
    v_exp_f32 v71, v71
    v_mfma_f32_16x16x32_bf16 v[44:47], v[148:151], v[84:87], v[44:47]
    ds_read_b128 v[148:151], v255 offset:19456
    ds_write_b32 v200, v230
    v_mfma_f32_16x16x32_bf16 v[48:51], v[152:155], v[80:83], v[48:51]
    v_exp_f32 v72, v72
    v_mfma_f32_16x16x32_bf16 v[52:55], v[152:155], v[84:87], v[52:55]
    ds_read_b128 v[152:155], v255 offset:22528
    v_cvt_pk_bf16_f32 v69, v70, v71
    v_mfma_f32_16x16x32_bf16 v[56:59], v[156:159], v[80:83], v[56:59]
    v_exp_f32 v73, v73
    v_mfma_f32_16x16x32_bf16 v[60:63], v[156:159], v[84:87], v[60:63]
    ds_read_b128 v[156:159], v255 offset:23552
    s_waitcnt lgkmcnt(4)
    v_mfma_f32_16x16x32_bf16 v[80:83], v[128:131], v[160:163], v[204:207]
    ds_read_b32 v232, v229
    v_exp_f32 v74, v74
    v_mfma_f32_16x16x32_bf16 v[84:87], v[128:131], v[176:179], v[208:211]
    ds_read_b128 v[128:131], v255 offset:8192
    v_cvt_pk_bf16_f32 v66, v72, v73
    v_mfma_f32_16x16x32_bf16 v[80:83], v[132:135], v[164:167], v[80:83]
    v_exp_f32 v75, v75
    v_mfma_f32_16x16x32_bf16 v[84:87], v[132:135], v[180:183], v[84:87]
    ds_read_b128 v[132:135], v255 offset:9216
    s_waitcnt vmcnt(8)
    v_add_u32 v254, 2, v254
    ds_write_b32 v201, v254
    v_mfma_f32_16x16x32_bf16 v[80:83], v[136:139], v[168:171], v[80:83]
    v_exp_f32 v76, v76
    v_mfma_f32_16x16x32_bf16 v[84:87], v[136:139], v[184:187], v[84:87]
    ds_read_b128 v[136:139], v255 offset:10240
    v_cvt_pk_bf16_f32 v67, v74, v75
    v_mfma_f32_16x16x32_bf16 v[80:83], v[140:143], v[172:175], v[80:83]
    v_exp_f32 v77, v77
    v_mfma_f32_16x16x32_bf16 v[84:87], v[140:143], v[188:191], v[84:87]
    ds_read_b128 v[140:143], v255 offset:11264
    s_waitcnt lgkmcnt(4)
    v_mfma_f32_16x16x32_bf16 v[88:91], v[144:147], v[160:163], v[204:207]
    v_exp_f32 v78, v78
    v_cmp_gt_i32 vcc, s28, v232
    v_mfma_f32_16x16x32_bf16 v[92:95], v[144:147], v[176:179], v[208:211]
    ds_read_b128 v[144:147], v255 offset:12288
    v_cvt_pk_bf16_f32 v70, v76, v77
    v_mfma_f32_16x16x32_bf16 v[88:91], v[148:151], v[164:167], v[88:91]
    v_exp_f32 v79, v79
    v_mfma_f32_16x16x32_bf16 v[92:95], v[148:151], v[180:183], v[92:95]
    ds_read_b128 v[148:151], v255 offset:13312
    s_cbranch_vccnz Lgated_wp_40
Lgated_wp_40_r:
    v_mfma_f32_16x16x32_bf16 v[88:91], v[152:155], v[168:171], v[88:91]
    s_add_u32 s28, s28, 1
    s_cmp_eq_u32 s28, s26
    v_mfma_f32_16x16x32_bf16 v[92:95], v[152:155], v[184:187], v[92:95]
    ds_read_b128 v[152:155], v255 offset:14336
    v_cvt_pk_bf16_f32 v71, v78, v79
    v_mfma_f32_16x16x32_bf16 v[88:91], v[156:159], v[172:175], v[88:91]
    v_mfma_f32_16x16x32_bf16 v[92:95], v[156:159], v[188:191], v[92:95]
    ds_read_b128 v[156:159], v255 offset:15360
    s_cbranch_scc1 fmain_tail0_1
    v_mfma_f32_16x16x32_bf16 v[236:239], v[244:247], v[64:67], v[236:239]
    v_exp_f32 v80, v80
    v_mfma_f32_16x16x32_bf16 v[240:243], v[244:247], v[68:71], v[240:243]
    v_exp_f32 v81, v81
    s_waitcnt lgkmcnt(4)
    v_mfma_f32_16x16x32_bf16 v[0:3], v[128:131], v[64:67], v[0:3]
    v_exp_f32 v82, v82
    v_mfma_f32_16x16x32_bf16 v[4:7], v[128:131], v[68:71], v[4:7]
    ds_read_b128 v[128:131], v255 offset:32768
    v_cvt_pk_bf16_f32 v80, v80, v81
    s_add_u32 s71, s72, 32768
    s_and_b32 m0, s71, 0x1ffff
    s_sub_u32 s71, s71, 32768
    buffer_load_dwordx4 v255, s[48:51], s71 offen offset:0 sc1 lds
    v_mfma_f32_16x16x32_bf16 v[8:11], v[132:135], v[64:67], v[8:11]
    v_exp_f32 v83, v83
    v_mfma_f32_16x16x32_bf16 v[12:15], v[132:135], v[68:71], v[12:15]
    ds_read_b128 v[132:135], v255 offset:33792
    v_mfma_f32_16x16x32_bf16 v[16:19], v[136:139], v[64:67], v[16:19]
    v_exp_f32 v84, v84
    v_mfma_f32_16x16x32_bf16 v[20:23], v[136:139], v[68:71], v[20:23]
    ds_read_b128 v[136:139], v255 offset:36864
    v_cvt_pk_bf16_f32 v81, v82, v83
    buffer_load_dwordx4 v255, s[48:51], s71 offen offset:1024 sc1 lds
    v_mfma_f32_16x16x32_bf16 v[24:27], v[140:143], v[64:67], v[24:27]
    v_exp_f32 v85, v85
    v_mfma_f32_16x16x32_bf16 v[28:31], v[140:143], v[68:71], v[28:31]
    ds_read_b128 v[140:143], v255 offset:37888
    s_waitcnt lgkmcnt(4)
    v_mfma_f32_16x16x32_bf16 v[32:35], v[144:147], v[64:67], v[32:35]
    v_exp_f32 v86, v86
    v_mfma_f32_16x16x32_bf16 v[36:39], v[144:147], v[68:71], v[36:39]
    ds_read_b128 v[144:147], v255 offset:34816
    v_cvt_pk_bf16_f32 v84, v84, v85
    buffer_load_dwordx4 v255, s[48:51], s71 offen offset:2048 sc1 lds
    v_mfma_f32_16x16x32_bf16 v[40:43], v[148:151], v[64:67], v[40:43]
    v_exp_f32 v87, v87
    v_mfma_f32_16x16x32_bf16 v[44:47], v[148:151], v[68:71], v[44:47]
    ds_read_b128 v[148:151], v255 offset:35840
    v_mfma_f32_16x16x32_bf16 v[48:51], v[152:155], v[64:67], v[48:51]
    v_exp_f32 v88, v88
    v_mfma_f32_16x16x32_bf16 v[52:55], v[152:155], v[68:71], v[52:55]
    ds_read_b128 v[152:155], v255 offset:38912
    v_cvt_pk_bf16_f32 v85, v86, v87
    buffer_load_dwordx4 v255, s[48:51], s71 offen offset:3072 sc1 lds
    v_mfma_f32_16x16x32_bf16 v[56:59], v[156:159], v[64:67], v[56:59]
    v_exp_f32 v89, v89
    v_mfma_f32_16x16x32_bf16 v[60:63], v[156:159], v[68:71], v[60:63]
    ds_read_b128 v[156:159], v255 offset:39936
    s_waitcnt lgkmcnt(4)
    v_mfma_f32_16x16x32_bf16 v[64:67], v[128:131], v[160:163], v[204:207]
    ds_read_b32 v231, v228
    v_exp_f32 v90, v90
    v_mfma_f32_16x16x32_bf16 v[68:71], v[128:131], v[176:179], v[208:211]
    ds_read_b128 v[128:131], v255 offset:24576
    v_cvt_pk_bf16_f32 v82, v88, v89
    s_add_u32 s71, s72, 36864
    s_and_b32 m0, s71, 0x1ffff
    s_sub_u32 s71, s71, 32768
    buffer_load_dwordx4 v255, s[48:51], s71 offen offset:0 sc1 lds
    v_mfma_f32_16x16x32_bf16 v[64:67], v[132:135], v[164:167], v[64:67]
    v_exp_f32 v91, v91
    v_mfma_f32_16x16x32_bf16 v[68:71], v[132:135], v[180:183], v[68:71]
    ds_read_b128 v[132:135], v255 offset:25600
    v_add_u32 v230, 2, v230
    v_mfma_f32_16x16x32_bf16 v[64:67], v[136:139], v[168:171], v[64:67]
    v_exp_f32 v92, v92
    buffer_load_dwordx4 v255, s[48:51], s71 offen offset:1024 sc1 lds
    v_mfma_f32_16x16x32_bf16 v[68:71], v[136:139], v[184:187], v[68:71]
    ds_read_b128 v[136:139], v255 offset:26624
    v_cvt_pk_bf16_f32 v83, v90, v91
    v_mfma_f32_16x16x32_bf16 v[64:67], v[140:143], v[172:175], v[64:67]
    v_exp_f32 v93, v93
    v_mfma_f32_16x16x32_bf16 v[68:71], v[140:143], v[188:191], v[68:71]
    ds_read_b128 v[140:143], v255 offset:27648
    buffer_load_dwordx4 v255, s[48:51], s71 offen offset:2048 sc1 lds
    s_waitcnt lgkmcnt(4)
    v_mfma_f32_16x16x32_bf16 v[72:75], v[144:147], v[160:163], v[204:207]
    v_exp_f32 v94, v94
    v_mfma_f32_16x16x32_bf16 v[76:79], v[144:147], v[176:179], v[208:211]
    ds_read_b128 v[144:147], v255 offset:28672
    v_cvt_pk_bf16_f32 v86, v92, v93
    v_mfma_f32_16x16x32_bf16 v[72:75], v[148:151], v[164:167], v[72:75]
    v_exp_f32 v95, v95
    buffer_load_dwordx4 v255, s[48:51], s71 offen offset:3072 sc1 lds
    s_add_u32 s72, s72, 32768
    v_mfma_f32_16x16x32_bf16 v[76:79], v[148:151], v[180:183], v[76:79]
    ds_read_b128 v[148:151], v255 offset:29696
    v_cmp_ge_i32 vcc, s28, v231
    v_mfma_f32_16x16x32_bf16 v[72:75], v[152:155], v[168:171], v[72:75]
    s_add_u32 s28, s28, 1
    s_cmp_eq_u32 s28, s26
    v_mfma_f32_16x16x32_bf16 v[76:79], v[152:155], v[184:187], v[76:79]
    ds_read_b128 v[152:155], v255 offset:30720
    v_cvt_pk_bf16_f32 v87, v94, v95
    v_mfma_f32_16x16x32_bf16 v[72:75], v[156:159], v[172:175], v[72:75]
    s_cbranch_vccnz Lgated_wr_41
Lgated_wr_41_r:
    v_mfma_f32_16x16x32_bf16 v[76:79], v[156:159], v[188:191], v[76:79]
    ds_read_b128 v[156:159], v255 offset:31744
    s_cbranch_scc1 fmain_tail0_0
    v_mfma_f32_16x16x32_bf16 v[236:239], v[244:247], v[80:83], v[236:239]
    v_exp_f32 v64, v64
    v_mfma_f32_16x16x32_bf16 v[240:243], v[244:247], v[84:87], v[240:243]
    v_exp_f32 v65, v65
    s_waitcnt lgkmcnt(4)
    v_mfma_f32_16x16x32_bf16 v[0:3], v[128:131], v[80:83], v[0:3]
    v_exp_f32 v66, v66
    v_mfma_f32_16x16x32_bf16 v[4:7], v[128:131], v[84:87], v[4:7]
    ds_read_b128 v[128:131], v255 offset:49152
    v_cvt_pk_bf16_f32 v64, v64, v65
    v_mfma_f32_16x16x32_bf16 v[8:11], v[132:135], v[80:83], v[8:11]
    v_exp_f32 v67, v67
    v_mfma_f32_16x16x32_bf16 v[12:15], v[132:135], v[84:87], v[12:15]
    ds_read_b128 v[132:135], v255 offset:50176
    v_mfma_f32_16x16x32_bf16 v[16:19], v[136:139], v[80:83], v[16:19]
    v_exp_f32 v68, v68
    v_mfma_f32_16x16x32_bf16 v[20:23], v[136:139], v[84:87], v[20:23]
    ds_read_b128 v[136:139], v255 offset:53248
    v_cvt_pk_bf16_f32 v65, v66, v67
    v_mfma_f32_16x16x32_bf16 v[24:27], v[140:143], v[80:83], v[24:27]
    v_exp_f32 v69, v69
    v_mfma_f32_16x16x32_bf16 v[28:31], v[140:143], v[84:87], v[28:31]
    ds_read_b128 v[140:143], v255 offset:54272
    s_waitcnt lgkmcnt(4)
    v_mfma_f32_16x16x32_bf16 v[32:35], v[144:147], v[80:83], v[32:35]
    v_exp_f32 v70, v70
    v_mfma_f32_16x16x32_bf16 v[36:39], v[144:147], v[84:87], v[36:39]
    ds_read_b128 v[144:147], v255 offset:51200
    v_cvt_pk_bf16_f32 v68, v68, v69
    v_mfma_f32_16x16x32_bf16 v[40:43], v[148:151], v[80:83], v[40:43]
    v_exp_f32 v71, v71
    v_mfma_f32_16x16x32_bf16 v[44:47], v[148:151], v[84:87], v[44:47]
    ds_read_b128 v[148:151], v255 offset:52224
    ds_write_b32 v200, v230
    v_mfma_f32_16x16x32_bf16 v[48:51], v[152:155], v[80:83], v[48:51]
    v_exp_f32 v72, v72
    v_mfma_f32_16x16x32_bf16 v[52:55], v[152:155], v[84:87], v[52:55]
    ds_read_b128 v[152:155], v255 offset:55296
    v_cvt_pk_bf16_f32 v69, v70, v71
    v_mfma_f32_16x16x32_bf16 v[56:59], v[156:159], v[80:83], v[56:59]
    v_exp_f32 v73, v73
    v_mfma_f32_16x16x32_bf16 v[60:63], v[156:159], v[84:87], v[60:63]
    ds_read_b128 v[156:159], v255 offset:56320
    s_branch fmain_loop0
fmain_x0_0:
    v_pk_mov_b32 v[0:1], 0, 0
    v_pk_mov_b32 v[2:3], 0, 0
    v_pk_mov_b32 v[4:5], 0, 0
    v_pk_mov_b32 v[6:7], 0, 0
    v_pk_mov_b32 v[8:9], 0, 0
    v_pk_mov_b32 v[10:11], 0, 0
    v_pk_mov_b32 v[12:13], 0, 0
    v_pk_mov_b32 v[14:15], 0, 0
    v_pk_mov_b32 v[16:17], 0, 0
    v_pk_mov_b32 v[18:19], 0, 0
    v_pk_mov_b32 v[20:21], 0, 0
    v_pk_mov_b32 v[22:23], 0, 0
    v_pk_mov_b32 v[24:25], 0, 0
    v_pk_mov_b32 v[26:27], 0, 0
    v_pk_mov_b32 v[28:29], 0, 0
    v_pk_mov_b32 v[30:31], 0, 0
    v_pk_mov_b32 v[32:33], 0, 0
    v_pk_mov_b32 v[34:35], 0, 0
    v_pk_mov_b32 v[36:37], 0, 0
    v_pk_mov_b32 v[38:39], 0, 0
    v_pk_mov_b32 v[40:41], 0, 0
    v_pk_mov_b32 v[42:43], 0, 0
    v_pk_mov_b32 v[44:45], 0, 0
    v_pk_mov_b32 v[46:47], 0, 0
    v_pk_mov_b32 v[48:49], 0, 0
    v_pk_mov_b32 v[50:51], 0, 0
    v_pk_mov_b32 v[52:53], 0, 0
    v_pk_mov_b32 v[54:55], 0, 0
    v_pk_mov_b32 v[56:57], 0, 0
    v_pk_mov_b32 v[58:59], 0, 0
    v_pk_mov_b32 v[60:61], 0, 0
    v_pk_mov_b32 v[62:63], 0, 0
    v_pk_mov_b32 v[236:237], 0, 0
    v_pk_mov_b32 v[238:239], 0, 0
    v_pk_mov_b32 v[240:241], 0, 0
    v_pk_mov_b32 v[242:243], 0, 0
    s_branch fmain_tail0_1
fmain_tail0_1:
    s_nop 4
    v_mov_b32 v214, 0xff800000
    v_mov_b32 v88, 0xff800000
    v_mov_b32 v89, 0xff800000
    v_mov_b32 v90, 0xff800000
    v_mov_b32 v91, 0xff800000
    v_cndmask_b32 v80, v214, v80, s[80:81]
    v_cndmask_b32 v81, v214, v81, s[82:83]
    v_cndmask_b32 v82, v214, v82, s[84:85]
    v_cndmask_b32 v83, v214, v83, s[86:87]
    v_cndmask_b32 v92, v214, v92, s[80:81]
    v_cndmask_b32 v93, v214, v93, s[82:83]
    v_cndmask_b32 v94, v214, v94, s[84:85]
    v_cndmask_b32 v95, v214, v95, s[86:87]
    v_mfma_f32_16x16x32_bf16 v[236:239], v[244:247], v[64:67], v[236:239]
    v_exp_f32 v80, v80
    v_mfma_f32_16x16x32_bf16 v[240:243], v[244:247], v[68:71], v[240:243]
    v_exp_f32 v81, v81
    s_waitcnt lgkmcnt(4)
    v_mfma_f32_16x16x32_bf16 v[0:3], v[128:131], v[64:67], v[0:3]
    v_exp_f32 v82, v82
    v_cvt_pk_bf16_f32 v80, v80, v81
    v_mfma_f32_16x16x32_bf16 v[4:7], v[128:131], v[68:71], v[4:7]
    ds_read_b128 v[128:131], v199 offset:0
    v_exp_f32 v83, v83
    s_add_u32 s71, s72, 32768
    s_and_b32 m0, s71, 0x1ffff
    s_sub_u32 s71, s71, 32768
    buffer_load_dwordx4 v255, s[48:51], s71 offen offset:0 sc1 lds
    v_mfma_f32_16x16x32_bf16 v[8:11], v[132:135], v[64:67], v[8:11]
    v_exp_f32 v84, v84
    v_cvt_pk_bf16_f32 v81, v82, v83
    v_mfma_f32_16x16x32_bf16 v[12:15], v[132:135], v[68:71], v[12:15]
    ds_read_b128 v[132:135], v199 offset:1024
    v_exp_f32 v85, v85
    buffer_load_dwordx4 v255, s[48:51], s71 offen offset:1024 sc1 lds
    v_mfma_f32_16x16x32_bf16 v[16:19], v[136:139], v[64:67], v[16:19]
    v_exp_f32 v86, v86
    v_cvt_pk_bf16_f32 v84, v84, v85
    buffer_load_dwordx4 v255, s[48:51], s71 offen offset:2048 sc1 lds
    v_mfma_f32_16x16x32_bf16 v[20:23], v[136:139], v[68:71], v[20:23]
    ds_read_b128 v[136:139], v199 offset:2048
    v_exp_f32 v87, v87
    buffer_load_dwordx4 v255, s[48:51], s71 offen offset:3072 sc1 lds
    v_mfma_f32_16x16x32_bf16 v[24:27], v[140:143], v[64:67], v[24:27]
    v_exp_f32 v88, v88
    v_cvt_pk_bf16_f32 v85, v86, v87
    v_mfma_f32_16x16x32_bf16 v[28:31], v[140:143], v[68:71], v[28:31]
    ds_read_b128 v[140:143], v199 offset:3072
    v_exp_f32 v89, v89
    s_waitcnt lgkmcnt(4)
    v_mfma_f32_16x16x32_bf16 v[32:35], v[144:147], v[64:67], v[32:35]
    v_exp_f32 v90, v90
    v_cvt_pk_bf16_f32 v82, v88, v89
    s_add_u32 s71, s72, 36864
    s_and_b32 m0, s71, 0x1ffff
    s_sub_u32 s71, s71, 32768
    buffer_load_dwordx4 v255, s[48:51], s71 offen offset:0 sc1 lds
    v_mfma_f32_16x16x32_bf16 v[36:39], v[144:147], v[68:71], v[36:39]
    ds_read_b128 v[144:147], v199 offset:4096
    v_exp_f32 v91, v91
    v_mfma_f32_16x16x32_bf16 v[40:43], v[148:151], v[64:67], v[40:43]
    v_exp_f32 v92, v92
    v_mfma_f32_16x16x32_bf16 v[44:47], v[148:151], v[68:71], v[44:47]
    ds_read_b128 v[148:151], v199 offset:5120
    v_cvt_pk_bf16_f32 v83, v90, v91
    v_exp_f32 v93, v93
    buffer_load_dwordx4 v255, s[48:51], s71 offen offset:1024 sc1 lds
    v_mfma_f32_16x16x32_bf16 v[48:51], v[152:155], v[64:67], v[48:51]
    v_exp_f32 v94, v94
    buffer_load_dwordx4 v255, s[48:51], s71 offen offset:2048 sc1 lds
    v_mfma_f32_16x16x32_bf16 v[52:55], v[152:155], v[68:71], v[52:55]
    ds_read_b128 v[152:155], v199 offset:6144
    v_cvt_pk_bf16_f32 v86, v92, v93
    v_exp_f32 v95, v95
    buffer_load_dwordx4 v255, s[48:51], s71 offen offset:3072 sc1 lds
    v_mfma_f32_16x16x32_bf16 v[56:59], v[156:159], v[64:67], v[56:59]
    s_nop 0
    v_cvt_pk_bf16_f32 v87, v94, v95
    s_add_u32 s72, s72, 32768
    v_mfma_f32_16x16x32_bf16 v[60:63], v[156:159], v[68:71], v[60:63]
    ds_read_b128 v[156:159], v199 offset:7168
    s_nop 1
    v_mfma_f32_16x16x32_bf16 v[236:239], v[244:247], v[80:83], v[236:239]
    v_mfma_f32_16x16x32_bf16 v[240:243], v[244:247], v[84:87], v[240:243]
    s_waitcnt lgkmcnt(4)
    v_mfma_f32_16x16x32_bf16 v[0:3], v[128:131], v[80:83], v[0:3]
    v_mfma_f32_16x16x32_bf16 v[4:7], v[128:131], v[84:87], v[4:7]
    s_waitcnt vmcnt(8)
    v_add_u32 v254, 2, v254
    ds_write_b32 v201, v254
    v_mfma_f32_16x16x32_bf16 v[8:11], v[132:135], v[80:83], v[8:11]
    v_mfma_f32_16x16x32_bf16 v[12:15], v[132:135], v[84:87], v[12:15]
    v_mfma_f32_16x16x32_bf16 v[16:19], v[136:139], v[80:83], v[16:19]
    v_mfma_f32_16x16x32_bf16 v[20:23], v[136:139], v[84:87], v[20:23]
    v_mfma_f32_16x16x32_bf16 v[24:27], v[140:143], v[80:83], v[24:27]
    v_mfma_f32_16x16x32_bf16 v[28:31], v[140:143], v[84:87], v[28:31]
    s_waitcnt lgkmcnt(0)
    v_mfma_f32_16x16x32_bf16 v[32:35], v[144:147], v[80:83], v[32:35]
    v_mov_b32 v214, 0x10000
    v_mfma_f32_16x16x32_bf16 v[36:39], v[144:147], v[84:87], v[36:39]
    v_mfma_f32_16x16x32_bf16 v[40:43], v[148:151], v[80:83], v[40:43]
    ds_write_b32 v200, v214
    v_mfma_f32_16x16x32_bf16 v[44:47], v[148:151], v[84:87], v[44:47]
    v_mfma_f32_16x16x32_bf16 v[48:51], v[152:155], v[80:83], v[48:51]
    v_mfma_f32_16x16x32_bf16 v[52:55], v[152:155], v[84:87], v[52:55]
    v_mfma_f32_16x16x32_bf16 v[56:59], v[156:159], v[80:83], v[56:59]
    v_mfma_f32_16x16x32_bf16 v[60:63], v[156:159], v[84:87], v[60:63]
    s_branch fmain_done0
fmain_tail0_0:
    s_nop 4
    v_mov_b32 v214, 0xff800000
    v_mov_b32 v72, 0xff800000
    v_mov_b32 v73, 0xff800000
    v_mov_b32 v74, 0xff800000
    v_mov_b32 v75, 0xff800000
    v_cndmask_b32 v64, v214, v64, s[80:81]
    v_cndmask_b32 v65, v214, v65, s[82:83]
    v_cndmask_b32 v66, v214, v66, s[84:85]
    v_cndmask_b32 v67, v214, v67, s[86:87]
    v_cndmask_b32 v76, v214, v76, s[80:81]
    v_cndmask_b32 v77, v214, v77, s[82:83]
    v_cndmask_b32 v78, v214, v78, s[84:85]
    v_cndmask_b32 v79, v214, v79, s[86:87]
    v_mfma_f32_16x16x32_bf16 v[236:239], v[244:247], v[80:83], v[236:239]
    v_exp_f32 v64, v64
    v_mfma_f32_16x16x32_bf16 v[240:243], v[244:247], v[84:87], v[240:243]
    v_exp_f32 v65, v65
    s_waitcnt lgkmcnt(4)
    v_mfma_f32_16x16x32_bf16 v[0:3], v[128:131], v[80:83], v[0:3]
    v_exp_f32 v66, v66
    v_cvt_pk_bf16_f32 v64, v64, v65
    v_mfma_f32_16x16x32_bf16 v[4:7], v[128:131], v[84:87], v[4:7]
    ds_read_b128 v[128:131], v199 offset:0
    v_exp_f32 v67, v67
    v_mfma_f32_16x16x32_bf16 v[8:11], v[132:135], v[80:83], v[8:11]
    v_exp_f32 v68, v68
    v_cvt_pk_bf16_f32 v65, v66, v67
    v_mfma_f32_16x16x32_bf16 v[12:15], v[132:135], v[84:87], v[12:15]
    ds_read_b128 v[132:135], v199 offset:1024
    v_exp_f32 v69, v69
    v_mfma_f32_16x16x32_bf16 v[16:19], v[136:139], v[80:83], v[16:19]
    v_exp_f32 v70, v70
    v_cvt_pk_bf16_f32 v68, v68, v69
    v_mfma_f32_16x16x32_bf16 v[20:23], v[136:139], v[84:87], v[20:23]
    ds_read_b128 v[136:139], v199 offset:2048
    v_exp_f32 v71, v71
    v_mfma_f32_16x16x32_bf16 v[24:27], v[140:143], v[80:83], v[24:27]
    v_exp_f32 v72, v72
    v_cvt_pk_bf16_f32 v69, v70, v71
    v_mfma_f32_16x16x32_bf16 v[28:31], v[140:143], v[84:87], v[28:31]
    ds_read_b128 v[140:143], v199 offset:3072
    v_exp_f32 v73, v73
    s_waitcnt lgkmcnt(4)
    v_mfma_f32_16x16x32_bf16 v[32:35], v[144:147], v[80:83], v[32:35]
    v_exp_f32 v74, v74
    v_cvt_pk_bf16_f32 v66, v72, v73
    v_mfma_f32_16x16x32_bf16 v[36:39], v[144:147], v[84:87], v[36:39]
    ds_read_b128 v[144:147], v199 offset:4096
    v_exp_f32 v75, v75
    v_mfma_f32_16x16x32_bf16 v[40:43], v[148:151], v[80:83], v[40:43]
    v_exp_f32 v76, v76
    v_mfma_f32_16x16x32_bf16 v[44:47], v[148:151], v[84:87], v[44:47]
    ds_read_b128 v[148:151], v199 offset:5120
    v_cvt_pk_bf16_f32 v67, v74, v75
    v_exp_f32 v77, v77
    v_mfma_f32_16x16x32_bf16 v[48:51], v[152:155], v[80:83], v[48:51]
    v_exp_f32 v78, v78
    v_mfma_f32_16x16x32_bf16 v[52:55], v[152:155], v[84:87], v[52:55]
    ds_read_b128 v[152:155], v199 offset:6144
    v_cvt_pk_bf16_f32 v70, v76, v77
    v_exp_f32 v79, v79
    v_mfma_f32_16x16x32_bf16 v[56:59], v[156:159], v[80:83], v[56:59]
    s_nop 0
    v_cvt_pk_bf16_f32 v71, v78, v79
    v_mfma_f32_16x16x32_bf16 v[60:63], v[156:159], v[84:87], v[60:63]
    ds_read_b128 v[156:159], v199 offset:7168
fmain_tail0_last:
    s_nop 1
    v_mfma_f32_16x16x32_bf16 v[236:239], v[244:247], v[64:67], v[236:239]
    v_mfma_f32_16x16x32_bf16 v[240:243], v[244:247], v[68:71], v[240:243]
    s_waitcnt lgkmcnt(4)
    v_mfma_f32_16x16x32_bf16 v[0:3], v[128:131], v[64:67], v[0:3]
    v_mfma_f32_16x16x32_bf16 v[4:7], v[128:131], v[68:71], v[4:7]
    s_waitcnt vmcnt(8)
    v_add_u32 v254, 2, v254
    ds_write_b32 v201, v254
    v_mfma_f32_16x16x32_bf16 v[8:11], v[132:135], v[64:67], v[8:11]
    v_mfma_f32_16x16x32_bf16 v[12:15], v[132:135], v[68:71], v[12:15]
    v_mfma_f32_16x16x32_bf16 v[16:19], v[136:139], v[64:67], v[16:19]
    v_mfma_f32_16x16x32_bf16 v[20:23], v[136:139], v[68:71], v[20:23]
    v_mfma_f32_16x16x32_bf16 v[24:27], v[140:143], v[64:67], v[24:27]
    v_mfma_f32_16x16x32_bf16 v[28:31], v[140:143], v[68:71], v[28:31]
    s_waitcnt lgkmcnt(0)
    v_mfma_f32_16x16x32_bf16 v[32:35], v[144:147], v[64:67], v[32:35]
    v_mov_b32 v214, 0x10000
    v_mfma_f32_16x16x32_bf16 v[36:39], v[144:147], v[68:71], v[36:39]
    v_mfma_f32_16x16x32_bf16 v[40:43], v[148:151], v[64:67], v[40:43]
    ds_write_b32 v200, v214
    v_mfma_f32_16x16x32_bf16 v[44:47], v[148:151], v[68:71], v[44:47]
    v_mfma_f32_16x16x32_bf16 v[48:51], v[152:155], v[64:67], v[48:51]
    v_mfma_f32_16x16x32_bf16 v[52:55], v[152:155], v[68:71], v[52:55]
    v_mfma_f32_16x16x32_bf16 v[56:59], v[156:159], v[64:67], v[56:59]
    v_mfma_f32_16x16x32_bf16 v[60:63], v[156:159], v[68:71], v[60:63]
    s_branch fmain_done0
Lgated_wp_26:
    s_mov_b32 s79, 0
    s_setprio 0
Lgated_wp_26_l:
    s_sleep 2
    ds_read_b32 v232, v229
    s_add_u32 s79, s79, 1
    s_cmp_ge_u32 s79, 67108864
    s_cbranch_scc1 Lgated_wp_26_x
    s_waitcnt lgkmcnt(0)
    v_cmp_gt_i32 vcc, s28, v232
    s_cbranch_vccnz Lgated_wp_26_l
Lgated_wp_26_x:
    s_waitcnt lgkmcnt(0)
    s_setprio 1
    s_branch Lgated_wp_26_r
Lgated_wr_27:
    s_mov_b32 s79, 0
    s_setprio 0
Lgated_wr_27_l:
    s_sleep 2
    ds_read_b32 v231, v228
    s_add_u32 s79, s79, 1
    s_cmp_ge_u32 s79, 67108864
    s_cbranch_scc1 Lgated_wr_27_x
    s_waitcnt lgkmcnt(0)
    v_cmp_gt_i32 vcc, s28, v231
    s_cbranch_vccnz Lgated_wr_27_l
Lgated_wr_27_x:
    s_waitcnt lgkmcnt(0)
    s_cmp_eq_u32 s28, s26
    s_setprio 1
    s_branch Lgated_wr_27_r
Lgated_wp_28:
    s_mov_b32 s79, 0
    s_setprio 0
Lgated_wp_28_l:
    s_sleep 2
    ds_read_b32 v232, v229
    s_add_u32 s79, s79, 1
    s_cmp_ge_u32 s79, 67108864
    s_cbranch_scc1 Lgated_wp_28_x
    s_waitcnt lgkmcnt(0)
    v_cmp_gt_i32 vcc, s28, v232
    s_cbranch_vccnz Lgated_wp_28_l
Lgated_wp_28_x:
    s_waitcnt lgkmcnt(0)
    s_setprio 1
    s_branch Lgated_wp_28_r
Lgated_wr_29:
    s_mov_b32 s79, 0
    s_setprio 0
Lgated_wr_29_l:
    s_sleep 2
    ds_read_b32 v231, v228
    s_add_u32 s79, s79, 1
    s_cmp_ge_u32 s79, 67108864
    s_cbranch_scc1 Lgated_wr_29_x
    s_waitcnt lgkmcnt(0)
    v_cmp_gt_i32 vcc, s28, v231
    s_cbranch_vccnz Lgated_wr_29_l
Lgated_wr_29_x:
    s_waitcnt lgkmcnt(0)
    s_cmp_eq_u32 s28, s26
    s_setprio 1
    s_branch Lgated_wr_29_r
Lgated_wp_30:
    s_mov_b32 s79, 0
    s_setprio 0
Lgated_wp_30_l:
    s_sleep 2
    ds_read_b32 v232, v229
    s_add_u32 s79, s79, 1
    s_cmp_ge_u32 s79, 67108864
    s_cbranch_scc1 Lgated_wp_30_x
    s_waitcnt lgkmcnt(0)
    v_cmp_gt_i32 vcc, s28, v232
    s_cbranch_vccnz Lgated_wp_30_l
Lgated_wp_30_x:
    s_waitcnt lgkmcnt(0)
    s_setprio 1
    s_branch Lgated_wp_30_r
Lgated_wr_31:
    s_mov_b32 s79, 0
    s_setprio 0
Lgated_wr_31_l:
    s_sleep 2
    ds_read_b32 v231, v228
    s_add_u32 s79, s79, 1
    s_cmp_ge_u32 s79, 67108864
    s_cbranch_scc1 Lgated_wr_31_x
    s_waitcnt lgkmcnt(0)
    v_cmp_gt_i32 vcc, s28, v231
    s_cbranch_vccnz Lgated_wr_31_l
Lgated_wr_31_x:
    s_waitcnt lgkmcnt(0)
    s_cmp_eq_u32 s28, s26
    s_setprio 1
    s_branch Lgated_wr_31_r
Lgated_wp_32:
    s_mov_b32 s79, 0
    s_setprio 0
Lgated_wp_32_l:
    s_sleep 2
    ds_read_b32 v232, v229
    s_add_u32 s79, s79, 1
    s_cmp_ge_u32 s79, 67108864
    s_cbranch_scc1 Lgated_wp_32_x
    s_waitcnt lgkmcnt(0)
    v_cmp_gt_i32 vcc, s28, v232
    s_cbranch_vccnz Lgated_wp_32_l
Lgated_wp_32_x:
    s_waitcnt lgkmcnt(0)
    s_setprio 1
    s_branch Lgated_wp_32_r
Lgated_wr_33:
    s_mov_b32 s79, 0
    s_setprio 0
Lgated_wr_33_l:
    s_sleep 2
    ds_read_b32 v231, v228
    s_add_u32 s79, s79, 1
    s_cmp_ge_u32 s79, 67108864
    s_cbranch_scc1 Lgated_wr_33_x
    s_waitcnt lgkmcnt(0)
    v_cmp_gt_i32 vcc, s28, v231
    s_cbranch_vccnz Lgated_wr_33_l
Lgated_wr_33_x:
    s_waitcnt lgkmcnt(0)
    s_cmp_eq_u32 s28, s26
    s_setprio 1
    s_branch Lgated_wr_33_r
Lgated_wp_34:
    s_mov_b32 s79, 0
    s_setprio 0
Lgated_wp_34_l:
    s_sleep 2
    ds_read_b32 v232, v229
    s_add_u32 s79, s79, 1
    s_cmp_ge_u32 s79, 67108864
    s_cbranch_scc1 Lgated_wp_34_x
    s_waitcnt lgkmcnt(0)
    v_cmp_gt_i32 vcc, s28, v232
    s_cbranch_vccnz Lgated_wp_34_l
Lgated_wp_34_x:
    s_waitcnt lgkmcnt(0)
    s_setprio 1
    s_branch Lgated_wp_34_r
Lgated_wr_35:
    s_mov_b32 s79, 0
    s_setprio 0
Lgated_wr_35_l:
    s_sleep 2
    ds_read_b32 v231, v228
    s_add_u32 s79, s79, 1
    s_cmp_ge_u32 s79, 67108864
    s_cbranch_scc1 Lgated_wr_35_x
    s_waitcnt lgkmcnt(0)
    v_cmp_gt_i32 vcc, s28, v231
    s_cbranch_vccnz Lgated_wr_35_l
Lgated_wr_35_x:
    s_waitcnt lgkmcnt(0)
    s_cmp_eq_u32 s28, s26
    s_setprio 1
    s_branch Lgated_wr_35_r
Lgated_wp_36:
    s_mov_b32 s79, 0
    s_setprio 0
Lgated_wp_36_l:
    s_sleep 2
    ds_read_b32 v232, v229
    s_add_u32 s79, s79, 1
    s_cmp_ge_u32 s79, 67108864
    s_cbranch_scc1 Lgated_wp_36_x
    s_waitcnt lgkmcnt(0)
    v_cmp_gt_i32 vcc, s28, v232
    s_cbranch_vccnz Lgated_wp_36_l
Lgated_wp_36_x:
    s_waitcnt lgkmcnt(0)
    s_setprio 1
    s_branch Lgated_wp_36_r
Lgated_wr_37:
    s_mov_b32 s79, 0
    s_setprio 0
Lgated_wr_37_l:
    s_sleep 2
    ds_read_b32 v231, v228
    s_add_u32 s79, s79, 1
    s_cmp_ge_u32 s79, 67108864
    s_cbranch_scc1 Lgated_wr_37_x
    s_waitcnt lgkmcnt(0)
    v_cmp_gt_i32 vcc, s28, v231
    s_cbranch_vccnz Lgated_wr_37_l
Lgated_wr_37_x:
    s_waitcnt lgkmcnt(0)
    s_cmp_eq_u32 s28, s26
    s_setprio 1
    s_branch Lgated_wr_37_r
Lgated_wp_38:
    s_mov_b32 s79, 0
    s_setprio 0
Lgated_wp_38_l:
    s_sleep 2
    ds_read_b32 v232, v229
    s_add_u32 s79, s79, 1
    s_cmp_ge_u32 s79, 67108864
    s_cbranch_scc1 Lgated_wp_38_x
    s_waitcnt lgkmcnt(0)
    v_cmp_gt_i32 vcc, s28, v232
    s_cbranch_vccnz Lgated_wp_38_l
Lgated_wp_38_x:
    s_waitcnt lgkmcnt(0)
    s_setprio 1
    s_branch Lgated_wp_38_r
Lgated_wr_39:
    s_mov_b32 s79, 0
    s_setprio 0
Lgated_wr_39_l:
    s_sleep 2
    ds_read_b32 v231, v228
    s_add_u32 s79, s79, 1
    s_cmp_ge_u32 s79, 67108864
    s_cbranch_scc1 Lgated_wr_39_x
    s_waitcnt lgkmcnt(0)
    v_cmp_gt_i32 vcc, s28, v231
    s_cbranch_vccnz Lgated_wr_39_l
Lgated_wr_39_x:
    s_waitcnt lgkmcnt(0)
    s_cmp_eq_u32 s28, s26
    s_setprio 1
    s_branch Lgated_wr_39_r
Lgated_wp_40:
    s_mov_b32 s79, 0
    s_setprio 0
Lgated_wp_40_l:
    s_sleep 2
    ds_read_b32 v232, v229
    s_add_u32 s79, s79, 1
    s_cmp_ge_u32 s79, 67108864
    s_cbranch_scc1 Lgated_wp_40_x
    s_waitcnt lgkmcnt(0)
    v_cmp_gt_i32 vcc, s28, v232
    s_cbranch_vccnz Lgated_wp_40_l
Lgated_wp_40_x:
    s_waitcnt lgkmcnt(0)
    s_setprio 1
    s_branch Lgated_wp_40_r
Lgated_wr_41:
    s_mov_b32 s79, 0
    s_setprio 0
Lgated_wr_41_l:
    s_sleep 2
    ds_read_b32 v231, v228
    s_add_u32 s79, s79, 1
    s_cmp_ge_u32 s79, 67108864
    s_cbranch_scc1 Lgated_wr_41_x
    s_waitcnt lgkmcnt(0)
    v_cmp_gt_i32 vcc, s28, v231
    s_cbranch_vccnz Lgated_wr_41_l
Lgated_wr_41_x:
    s_waitcnt lgkmcnt(0)
    s_cmp_eq_u32 s28, s26
    s_setprio 1
    s_branch Lgated_wr_41_r
fmain_tail00:
    ds_read_b128 v[128:131], v199 offset:0
    ds_read_b128 v[132:135], v199 offset:1024
    ds_read_b128 v[136:139], v199 offset:2048
    ds_read_b128 v[140:143], v199 offset:3072
    ds_read_b128 v[144:147], v199 offset:4096
    ds_read_b128 v[148:151], v199 offset:5120
    ds_read_b128 v[152:155], v199 offset:6144
    ds_read_b128 v[156:159], v199 offset:7168
    v_pk_mov_b32 v[0:1], 0, 0
    v_pk_mov_b32 v[2:3], 0, 0
    v_pk_mov_b32 v[4:5], 0, 0
    v_pk_mov_b32 v[6:7], 0, 0
    v_pk_mov_b32 v[8:9], 0, 0
    v_pk_mov_b32 v[10:11], 0, 0
    v_pk_mov_b32 v[12:13], 0, 0
    v_pk_mov_b32 v[14:15], 0, 0
    v_pk_mov_b32 v[16:17], 0, 0
    v_pk_mov_b32 v[18:19], 0, 0
    v_pk_mov_b32 v[20:21], 0, 0
    v_pk_mov_b32 v[22:23], 0, 0
    v_pk_mov_b32 v[24:25], 0, 0
    v_pk_mov_b32 v[26:27], 0, 0
    v_pk_mov_b32 v[28:29], 0, 0
    v_pk_mov_b32 v[30:31], 0, 0
    v_pk_mov_b32 v[32:33], 0, 0
    v_pk_mov_b32 v[34:35], 0, 0
    v_pk_mov_b32 v[36:37], 0, 0
    v_pk_mov_b32 v[38:39], 0, 0
    v_pk_mov_b32 v[40:41], 0, 0
    v_pk_mov_b32 v[42:43], 0, 0
    v_pk_mov_b32 v[44:45], 0, 0
    v_pk_mov_b32 v[46:47], 0, 0
    v_pk_mov_b32 v[48:49], 0, 0
    v_pk_mov_b32 v[50:51], 0, 0
    v_pk_mov_b32 v[52:53], 0, 0
    v_pk_mov_b32 v[54:55], 0, 0
    v_pk_mov_b32 v[56:57], 0, 0
    v_pk_mov_b32 v[58:59], 0, 0
    v_pk_mov_b32 v[60:61], 0, 0
    v_pk_mov_b32 v[62:63], 0, 0
    v_pk_mov_b32 v[236:237], 0, 0
    v_pk_mov_b32 v[238:239], 0, 0
    v_pk_mov_b32 v[240:241], 0, 0
    v_pk_mov_b32 v[242:243], 0, 0
    v_exp_f32 v64, v64
    v_exp_f32 v65, v65
    v_exp_f32 v66, v66
    v_cvt_pk_bf16_f32 v64, v64, v65
    v_exp_f32 v67, v67
    v_exp_f32 v68, v68
    v_cvt_pk_bf16_f32 v65, v66, v67
    v_exp_f32 v69, v69
    v_exp_f32 v70, v70
    v_cvt_pk_bf16_f32 v68, v68, v69
    v_exp_f32 v71, v71
    v_exp_f32 v72, v72
    v_cvt_pk_bf16_f32 v69, v70, v71
    v_exp_f32 v73, v73
    v_exp_f32 v74, v74
    v_cvt_pk_bf16_f32 v66, v72, v73
    v_exp_f32 v75, v75
    v_exp_f32 v76, v76
    v_cvt_pk_bf16_f32 v67, v74, v75
    v_exp_f32 v77, v77
    v_exp_f32 v78, v78
    v_cvt_pk_bf16_f32 v70, v76, v77
    v_exp_f32 v79, v79
    s_nop 0
    v_cvt_pk_bf16_f32 v71, v78, v79
    s_branch fmain_tail0_last
fmain_svcB5:
    s_lshl_b32 s76, s23, 11
    buffer_load_dwordx2 v[196:197], v194, s[64:67], s76 offen offset:512 sc1
    s_lshl_b32 s76, s23, 11
    buffer_load_dwordx2 v[212:213], v195, s[64:67], s76 offen offset:1536 sc1
    s_branch fmain_svcB5_ret
fmain_svcB7:
    s_waitcnt vmcnt(1)
    s_cmp_eq_u32 s22, 6
    s_cbranch_scc1 fmain_svcB7k
    v_cmp_ne_u64 vcc, s[18:19], v[196:197]
    s_cbranch_vccnz fmain_pB
fmain_pB_ok:
    s_branch fmain_svcB7_ret
fmain_svcB7k:
    v_cmp_ne_u64 vcc, s[18:19], v[212:213]
    s_cbranch_vccnz fmain_pP
fmain_pP_ok:
    s_lshl_b32 s76, s23, 14
    s_add_u32 s77, s76, 0
    buffer_load_dwordx4 v[96:99], v255, s[60:63], s77 offen sc1
    s_add_u32 s77, s76, 2048
    buffer_load_dwordx4 v[100:103], v255, s[60:63], s77 offen sc1
    s_add_u32 s77, s76, 4096
    buffer_load_dwordx4 v[104:107], v255, s[60:63], s77 offen sc1
    s_add_u32 s77, s76, 6144
    buffer_load_dwordx4 v[108:111], v255, s[60:63], s77 offen sc1
    s_add_u32 s77, s76, 8192
    buffer_load_dwordx4 v[112:115], v255, s[60:63], s77 offen sc1
    s_add_u32 s77, s76, 10240
    buffer_load_dwordx4 v[116:119], v255, s[60:63], s77 offen sc1
    s_add_u32 s77, s76, 12288
    buffer_load_dwordx4 v[120:123], v255, s[60:63], s77 offen sc1
    s_add_u32 s77, s76, 14336
    buffer_load_dwordx4 v[124:127], v255, s[60:63], s77 offen sc1
    v_lshlrev_b32 v219, 8, v195
    v_lshl_add_u32 v219, v253, 8, v219
    buffer_load_dwordx4 v[224:227], v219, s[60:63], s76 offen offset:1024 sc1
    s_branch fmain_svcB7_ret
fmain_svcC6:
    s_cmp_eq_u32 s28, 15
    s_cbranch_scc1 fmain_svcK
    s_lshl_b32 s76, s23, 11
    buffer_load_dwordx2 v[196:197], v194, s[64:67], s76 offen offset:1024 sc1
    s_mov_b32 s27, 24
    s_branch fmain_svcC6_ret
fmain_svcK:
    s_waitcnt vmcnt(0)
    v_add_f32 v96, v96, v112
    v_add_f32 v97, v97, v113
    v_add_f32 v98, v98, v114
    v_add_f32 v99, v99, v115
    v_add_f32 v100, v100, v116
    v_add_f32 v101, v101, v117
    v_add_f32 v102, v102, v118
    v_add_f32 v103, v103, v119
    v_add_f32 v104, v104, v120
    v_add_f32 v105, v105, v121
    v_add_f32 v106, v106, v122
    v_add_f32 v107, v107, v123
    v_add_f32 v108, v108, v124
    v_add_f32 v109, v109, v125
    v_add_f32 v110, v110, v126
    v_add_f32 v111, v111, v127
    v_add_f32 v224, v224, v224 row_ror:4
    v_add_f32 v225, v225, v225 row_ror:4
    v_add_f32 v226, v226, v226 row_ror:4
    v_add_f32 v227, v227, v227 row_ror:4
    v_add_f32 v96, v96, v104
    v_add_f32 v97, v97, v105
    v_add_f32 v98, v98, v106
    v_add_f32 v99, v99, v107
    v_add_f32 v100, v100, v108
    v_add_f32 v101, v101, v109
    v_add_f32 v102, v102, v110
    v_add_f32 v103, v103, v111
    v_add_f32 v224, v224, v224 row_ror:2
    v_add_f32 v225, v225, v225 row_ror:2
    v_add_f32 v226, v226, v226 row_ror:2
    v_add_f32 v227, v227, v227 row_ror:2
    v_add_f32 v96, v96, v100
    v_add_f32 v97, v97, v101
    v_add_f32 v98, v98, v102
    v_add_f32 v99, v99, v103
    v_add_f32 v224, v224, v224 row_ror:1
    v_add_f32 v225, v225, v225 row_ror:1
    v_add_f32 v226, v226, v226 row_ror:1
    v_add_f32 v227, v227, v227 row_ror:1
    v_cvt_pk_bf16_f32 v96, v96, v97
    v_cvt_pk_bf16_f32 v97, v98, v99
    v_cvt_pk_bf16_f32 v98, v224, v225
    v_cvt_pk_bf16_f32 v99, v226, v227
    v_add_u32 v219, 159744, v255
    ds_write_b128 v219, v[96:99]
    s_and_b32 s76, s22, 1
    s_lshl_b32 s78, s76, 13
    s_lshl_b32 s79, s2, 14
    s_add_u32 s78, s78, s79
    v_lshl_add_u32 v224, v255, 3, s78
    s_lshl_b32 s79, s2, 11
    v_lshl_add_u32 v225, v252, 7, s79
    global_load_dword v235, v224, s[8:9]
    global_load_dword v235, v225, s[10:11]
    s_branch fmain_svcC6_ret
fmain_svcC7:
    s_waitcnt vmcnt(0)
    v_cmp_ne_u64 vcc, s[18:19], v[196:197]
    s_cbranch_vccnz fmain_pC
fmain_pC_ok:
    s_and_b32 s76, s22, 1
    s_lshl_b32 s78, s76, 13
    s_lshl_b32 s79, s2, 14
    s_add_u32 s78, s78, s79
    v_lshl_add_u32 v224, v255, 3, s78
    s_lshl_b32 s79, s2, 11
    v_lshl_add_u32 v225, v252, 7, s79
    global_load_dword v235, v224, s[8:9]
    global_load_dword v235, v225, s[10:11]
    s_branch fmain_svcC7_ret
fmain_pB:
    s_mov_b32 s79, 0
fmain_pB_l:
    s_add_u32 s79, s79, 1
    s_cmp_ge_u32 s79, 1048576
    s_cbranch_scc1 fmain_pB_ok
    s_sleep 8
    s_lshl_b32 s76, s23, 11
    buffer_load_dwordx2 v[196:197], v194, s[64:67], s76 offen offset:512 sc1
    s_waitcnt vmcnt(0)
    v_cmp_ne_u64 vcc, s[18:19], v[196:197]
    s_cbranch_vccnz fmain_pB_l
    s_branch fmain_pB_ok
fmain_pP:
    s_mov_b32 s79, 0
fmain_pP_l:
    s_add_u32 s79, s79, 1
    s_cmp_ge_u32 s79, 1048576
    s_cbranch_scc1 fmain_pP_ok
    s_sleep 8
    s_lshl_b32 s76, s23, 11
    buffer_load_dwordx2 v[212:213], v195, s[64:67], s76 offen offset:1536 sc1
    s_waitcnt vmcnt(0)
    v_cmp_ne_u64 vcc, s[18:19], v[212:213]
    s_cbranch_vccnz fmain_pP_l
    s_branch fmain_pP_ok
fmain_pC:
    s_mov_b32 s79, 0
fmain_pC_l:
    s_add_u32 s79, s79, 1
    s_cmp_ge_u32 s79, 1048576
    s_cbranch_scc1 fmain_pC_ok
    s_sleep 8
    s_lshl_b32 s76, s23, 11
    buffer_load_dwordx2 v[196:197], v194, s[64:67], s76 offen offset:1024 sc1
    s_waitcnt vmcnt(0)
    v_cmp_ne_u64 vcc, s[18:19], v[196:197]
    s_cbranch_vccnz fmain_pC_l
    s_branch fmain_pC_ok
fmain_poll1:
    s_mov_b32 s79, 0
fmain_poll1_l:
    s_add_u32 s79, s79, 1
    s_cmp_ge_u32 s79, 1048576
    s_cbranch_scc1 fmain_poll1_ok
    s_sleep 8
    s_lshl_b32 s76, s23, 11
    buffer_load_dwordx2 v[196:197], v194, s[64:67], s76 offen offset:0 sc1
    s_waitcnt vmcnt(0)
    v_cmp_ne_u64 vcc, s[18:19], v[196:197]
    s_cbranch_vccnz fmain_poll1_l
    s_branch fmain_poll1_ok
fmain_done1:
    s_nop 7
    v_add_f32 v215, v236, v240
    v_cmp_ngt_f32 vcc, 0x5f800000, v215
    s_cmp_lg_u64 vcc, 0
    s_cselect_b32 s31, 1, 0
    s_cbranch_scc0 fmain_epi2
    v_mov_b32 v216, 0x10000
    ds_write_b32 v200, v216
    s_branch fmain_slow
fmain_epi2:
    s_lshr_b32 s76, s25, 4
    s_mul_i32 s76, s76, 147456
    s_lshl_b32 s77, s23, 12
    s_add_u32 s73, s76, s77
    v_rcp_f32 v214, v236
    s_nop 0
    v_mov_b32 v215, v214
    v_pk_mul_f32 v[0:1], v[0:1], v[214:215]
    v_pk_mul_f32 v[2:3], v[2:3], v[214:215]
    v_pk_mul_f32 v[8:9], v[8:9], v[214:215]
    v_pk_mul_f32 v[10:11], v[10:11], v[214:215]
    v_cvt_pk_bf16_f32 v0, v0, v1
    v_cvt_pk_bf16_f32 v1, v2, v3
    v_cvt_pk_bf16_f32 v2, v8, v9
    v_cvt_pk_bf16_f32 v3, v10, v11
    s_add_u32 s76, s73, 0
    buffer_store_dwordx4 v[0:3], v255, s[56:59], s76 offen offset:0 sc1
    v_pk_mul_f32 v[16:17], v[16:17], v[214:215]
    v_pk_mul_f32 v[18:19], v[18:19], v[214:215]
    v_pk_mul_f32 v[24:25], v[24:25], v[214:215]
    v_pk_mul_f32 v[26:27], v[26:27], v[214:215]
    v_cvt_pk_bf16_f32 v16, v16, v17
    v_cvt_pk_bf16_f32 v17, v18, v19
    v_cvt_pk_bf16_f32 v18, v24, v25
    v_cvt_pk_bf16_f32 v19, v26, v27
    s_add_u32 s76, s73, 0
    buffer_store_dwordx4 v[16:19], v255, s[56:59], s76 offen offset:1024 sc1
    v_pk_mul_f32 v[32:33], v[32:33], v[214:215]
    v_pk_mul_f32 v[34:35], v[34:35], v[214:215]
    v_pk_mul_f32 v[40:41], v[40:41], v[214:215]
    v_pk_mul_f32 v[42:43], v[42:43], v[214:215]
    v_cvt_pk_bf16_f32 v32, v32, v33
    v_cvt_pk_bf16_f32 v33, v34, v35
    v_cvt_pk_bf16_f32 v34, v40, v41
    v_cvt_pk_bf16_f32 v35, v42, v43
    s_add_u32 s76, s73, 0
    buffer_store_dwordx4 v[32:35], v255, s[56:59], s76 offen offset:2048 sc1
    v_pk_mul_f32 v[48:49], v[48:49], v[214:215]
    v_pk_mul_f32 v[50:51], v[50:51], v[214:215]
    v_pk_mul_f32 v[56:57], v[56:57], v[214:215]
    v_pk_mul_f32 v[58:59], v[58:59], v[214:215]
    v_cvt_pk_bf16_f32 v48, v48, v49
    v_cvt_pk_bf16_f32 v49, v50, v51
    v_cvt_pk_bf16_f32 v50, v56, v57
    v_cvt_pk_bf16_f32 v51, v58, v59
    s_add_u32 s76, s73, 0
    buffer_store_dwordx4 v[48:51], v255, s[56:59], s76 offen offset:3072 sc1
    v_rcp_f32 v214, v240
    s_nop 0
    v_mov_b32 v215, v214
    v_pk_mul_f32 v[4:5], v[4:5], v[214:215]
    v_pk_mul_f32 v[6:7], v[6:7], v[214:215]
    v_pk_mul_f32 v[12:13], v[12:13], v[214:215]
    v_pk_mul_f32 v[14:15], v[14:15], v[214:215]
    v_cvt_pk_bf16_f32 v4, v4, v5
    v_cvt_pk_bf16_f32 v5, v6, v7
    v_cvt_pk_bf16_f32 v6, v12, v13
    v_cvt_pk_bf16_f32 v7, v14, v15
    s_add_u32 s76, s73, 147456
    buffer_store_dwordx4 v[4:7], v255, s[56:59], s76 offen offset:0 sc1
    v_pk_mul_f32 v[20:21], v[20:21], v[214:215]
    v_pk_mul_f32 v[22:23], v[22:23], v[214:215]
    v_pk_mul_f32 v[28:29], v[28:29], v[214:215]
    v_pk_mul_f32 v[30:31], v[30:31], v[214:215]
    v_cvt_pk_bf16_f32 v20, v20, v21
    v_cvt_pk_bf16_f32 v21, v22, v23
    v_cvt_pk_bf16_f32 v22, v28, v29
    v_cvt_pk_bf16_f32 v23, v30, v31
    s_add_u32 s76, s73, 147456
    buffer_store_dwordx4 v[20:23], v255, s[56:59], s76 offen offset:1024 sc1
    v_pk_mul_f32 v[36:37], v[36:37], v[214:215]
    v_pk_mul_f32 v[38:39], v[38:39], v[214:215]
    v_pk_mul_f32 v[44:45], v[44:45], v[214:215]
    v_pk_mul_f32 v[46:47], v[46:47], v[214:215]
    v_cvt_pk_bf16_f32 v36, v36, v37
    v_cvt_pk_bf16_f32 v37, v38, v39
    v_cvt_pk_bf16_f32 v38, v44, v45
    v_cvt_pk_bf16_f32 v39, v46, v47
    s_add_u32 s76, s73, 147456
    buffer_store_dwordx4 v[36:39], v255, s[56:59], s76 offen offset:2048 sc1
    v_pk_mul_f32 v[52:53], v[52:53], v[214:215]
    v_pk_mul_f32 v[54:55], v[54:55], v[214:215]
    v_pk_mul_f32 v[60:61], v[60:61], v[214:215]
    v_pk_mul_f32 v[62:63], v[62:63], v[214:215]
    v_cvt_pk_bf16_f32 v52, v52, v53
    v_cvt_pk_bf16_f32 v53, v54, v55
    v_cvt_pk_bf16_f32 v54, v60, v61
    v_cvt_pk_bf16_f32 v55, v62, v63
    s_add_u32 s76, s73, 147456
    buffer_store_dwordx4 v[52:55], v255, s[56:59], s76 offen offset:3072 sc1
    v_mov_b32 v214, s16
    v_mov_b32 v215, 1048576
    s_add_u32 s76, s25, s23
    s_lshl_b32 s76, s76, 2
    s_mov_b64 exec, 1
    buffer_store_dword v214, v215, s[60:63], s76 offen sc1
    s_mov_b64 exec, -1
    v_mov_b32 v216, 0x10000
    ds_write_b32 v200, v216
    s_waitcnt vmcnt(0)
    s_lshl_b32 s76, s24, 11
    s_lshl_b32 s77, s22, 8
    s_add_u32 s76, s76, s77
    s_lshl_b32 s77, s23, 3
    s_add_u32 s76, s76, s77
    s_add_u32 s76, s76, 65536
    s_mov_b64 exec, 1
    buffer_store_dwordx2 v[192:193], v255, s[64:67], s76 offen offset:0 sc1
    s_mov_b64 exec, -1
    s_cmp_eq_u32 s29, 0
    s_cbranch_scc1 fmain_p4
    s_branch fmain_end2
fmain_done0:
    s_setprio 0
    s_add_u32 s28, s26, 1
    s_and_b32 s28, s28, -2
    s_lshl_b32 s76, s24, 2
    s_sub_u32 s27, 58, s76
    s_mov_b32 s68, 0
    s_cmp_gt_i32 s28, 8
    s_cbranch_scc1 fmain_w0
    ds_read_b32 v232, v229
    s_waitcnt vmcnt(8)
    s_add_u32 s76, s28, 2
    v_mov_b32 v254, s76
    ds_write_b32 v201, v254
    s_waitcnt lgkmcnt(0)
    v_cmp_gt_i32 vcc, s28, v232
    s_cbranch_vccnz Lgated_wp_42
Lgated_wp_42_r:
    s_add_u32 s28, s28, 2
    s_add_u32 s71, s72, 32768
    s_and_b32 m0, s71, 0x1ffff
    s_sub_u32 s71, s71, 32768
    buffer_load_dwordx4 v255, s[48:51], s71 offen offset:0 sc1 lds
    s_sleep 2
    buffer_load_dwordx4 v255, s[48:51], s71 offen offset:1024 sc1 lds
    s_sleep 1
    buffer_load_dwordx4 v255, s[48:51], s71 offen offset:2048 sc1 lds
    s_sleep 2
    buffer_load_dwordx4 v255, s[48:51], s71 offen offset:3072 sc1 lds
    s_sleep 1
    s_waitcnt vmcnt(4)
    s_add_u32 s76, s28, 2
    v_mov_b32 v254, s76
    ds_write_b32 v201, v254
    s_add_u32 s71, s72, 36864
    s_and_b32 m0, s71, 0x1ffff
    s_sub_u32 s71, s71, 32768
    buffer_load_dwordx4 v255, s[48:51], s71 offen offset:0 sc1 lds
    s_sleep 2
    buffer_load_dwordx4 v255, s[48:51], s71 offen offset:1024 sc1 lds
    s_sleep 1
    buffer_load_dwordx4 v255, s[48:51], s71 offen offset:2048 sc1 lds
    s_sleep 2
    buffer_load_dwordx4 v255, s[48:51], s71 offen offset:3072 sc1 lds
    s_add_u32 s72, s72, 32768
    s_sleep 1
    s_add_u32 s78, s73, 524288
    buffer_store_dwordx4 v[96:99], v255, s[52:55], s78 offen offset:0 sc1
    s_sleep 1
    s_add_u32 s78, s73, 524288
    buffer_store_dwordx4 v[100:103], v255, s[52:55], s78 offen offset:1024 sc1
    s_sleep 1
    s_add_u32 s78, s73, 524288
    buffer_store_dwordx4 v[104:107], v255, s[52:55], s78 offen offset:2048 sc1
    ds_read_b32 v232, v229
    s_waitcnt vmcnt(11)
    s_add_u32 s76, s28, 2
    v_mov_b32 v254, s76
    ds_write_b32 v201, v254
    s_waitcnt lgkmcnt(0)
    v_cmp_gt_i32 vcc, s28, v232
    s_cbranch_vccnz Lgated_wp_43
Lgated_wp_43_r:
    s_add_u32 s28, s28, 2
    s_add_u32 s71, s72, 32768
    s_and_b32 m0, s71, 0x1ffff
    s_sub_u32 s71, s71, 32768
    buffer_load_dwordx4 v255, s[48:51], s71 offen offset:0 sc1 lds
    s_sleep 2
    buffer_load_dwordx4 v255, s[48:51], s71 offen offset:1024 sc1 lds
    s_sleep 1
    buffer_load_dwordx4 v255, s[48:51], s71 offen offset:2048 sc1 lds
    s_sleep 2
    buffer_load_dwordx4 v255, s[48:51], s71 offen offset:3072 sc1 lds
    s_sleep 1
    s_waitcnt vmcnt(7)
    s_add_u32 s76, s28, 2
    v_mov_b32 v254, s76
    ds_write_b32 v201, v254
    s_add_u32 s71, s72, 36864
    s_and_b32 m0, s71, 0x1ffff
    s_sub_u32 s71, s71, 32768
    buffer_load_dwordx4 v255, s[48:51], s71 offen offset:0 sc1 lds
    s_sleep 2
    buffer_load_dwordx4 v255, s[48:51], s71 offen offset:1024 sc1 lds
    s_sleep 1
    buffer_load_dwordx4 v255, s[48:51], s71 offen offset:2048 sc1 lds
    s_sleep 2
    buffer_load_dwordx4 v255, s[48:51], s71 offen offset:3072 sc1 lds
    s_add_u32 s72, s72, 32768
    s_sleep 1
    s_add_u32 s78, s73, 524288
    buffer_store_dwordx4 v[108:111], v255, s[52:55], s78 offen offset:3072 sc1
    s_sleep 1
    s_add_u32 s78, s73, 786432
    buffer_store_dwordx4 v[112:115], v255, s[52:55], s78 offen offset:0 sc1
    s_sleep 1
    s_add_u32 s78, s73, 786432
    buffer_store_dwordx4 v[116:119], v255, s[52:55], s78 offen offset:1024 sc1
    ds_read_b32 v232, v229
    s_waitcnt vmcnt(11)
    s_add_u32 s76, s28, 2
    v_mov_b32 v254, s76
    ds_write_b32 v201, v254
    s_waitcnt lgkmcnt(0)
    v_cmp_gt_i32 vcc, s28, v232
    s_cbranch_vccnz Lgated_wp_44
Lgated_wp_44_r:
    s_add_u32 s28, s28, 2
    s_add_u32 s71, s72, 32768
    s_and_b32 m0, s71, 0x1ffff
    s_sub_u32 s71, s71, 32768
    buffer_load_dwordx4 v255, s[48:51], s71 offen offset:0 sc1 lds
    s_sleep 2
    buffer_load_dwordx4 v255, s[48:51], s71 offen offset:1024 sc1 lds
    s_sleep 1
    buffer_load_dwordx4 v255, s[48:51], s71 offen offset:2048 sc1 lds
    s_sleep 2
    buffer_load_dwordx4 v255, s[48:51], s71 offen offset:3072 sc1 lds
    s_sleep 1
    s_waitcnt vmcnt(7)
    s_add_u32 s76, s28, 2
    v_mov_b32 v254, s76
    ds_write_b32 v201, v254
    s_add_u32 s71, s72, 36864
    s_and_b32 m0, s71, 0x1ffff
    s_sub_u32 s71, s71, 32768
    buffer_load_dwordx4 v255, s[48:51], s71 offen offset:0 sc1 lds
    s_sleep 2
    buffer_load_dwordx4 v255, s[48:51], s71 offen offset:1024 sc1 lds
    s_sleep 1
    buffer_load_dwordx4 v255, s[48:51], s71 offen offset:2048 sc1 lds
    s_sleep 2
    buffer_load_dwordx4 v255, s[48:51], s71 offen offset:3072 sc1 lds
    s_add_u32 s72, s72, 32768
    s_sleep 1
    s_add_u32 s78, s73, 786432
    buffer_store_dwordx4 v[120:123], v255, s[52:55], s78 offen offset:2048 sc1
    s_sleep 1
    s_add_u32 s78, s73, 786432
    buffer_store_dwordx4 v[124:127], v255, s[52:55], s78 offen offset:3072 sc1
    ds_read_b32 v232, v229
    s_waitcnt vmcnt(10)
    s_add_u32 s76, s28, 2
    v_mov_b32 v254, s76
    ds_write_b32 v201, v254
    s_waitcnt lgkmcnt(0)
    v_cmp_gt_i32 vcc, s28, v232
    s_cbranch_vccnz Lgated_wp_45
Lgated_wp_45_r:
    s_add_u32 s28, s28, 2
    s_add_u32 s71, s72, 32768
    s_and_b32 m0, s71, 0x1ffff
    s_sub_u32 s71, s71, 32768
    buffer_load_dwordx4 v255, s[48:51], s71 offen offset:0 sc1 lds
    s_sleep 2
    buffer_load_dwordx4 v255, s[48:51], s71 offen offset:1024 sc1 lds
    s_sleep 2
    buffer_load_dwordx4 v255, s[48:51], s71 offen offset:2048 sc1 lds
    s_sleep 2
    buffer_load_dwordx4 v255, s[48:51], s71 offen offset:3072 sc1 lds
    s_sleep 2
    s_waitcnt vmcnt(6)
    s_add_u32 s76, s28, 2
    v_mov_b32 v254, s76
    ds_write_b32 v201, v254
    s_add_u32 s71, s72, 36864
    s_and_b32 m0, s71, 0x1ffff
    s_sub_u32 s71, s71, 32768
    buffer_load_dwordx4 v255, s[48:51], s71 offen offset:0 sc1 lds
    s_sleep 2
    buffer_load_dwordx4 v255, s[48:51], s71 offen offset:1024 sc1 lds
    s_sleep 2
    buffer_load_dwordx4 v255, s[48:51], s71 offen offset:2048 sc1 lds
    s_sleep 2
    buffer_load_dwordx4 v255, s[48:51], s71 offen offset:3072 sc1 lds
    s_add_u32 s72, s72, 32768
    ds_read_b32 v232, v229
    s_waitcnt vmcnt(8)
    s_add_u32 s76, s28, 2
    v_mov_b32 v254, s76
    ds_write_b32 v201, v254
    s_waitcnt lgkmcnt(0)
    v_cmp_gt_i32 vcc, s28, v232
    s_cbranch_vccnz Lgated_wp_46
Lgated_wp_46_r:
    s_add_u32 s28, s28, 2
    s_add_u32 s71, s72, 32768
    s_and_b32 m0, s71, 0x1ffff
    s_sub_u32 s71, s71, 32768
    buffer_load_dwordx4 v255, s[48:51], s71 offen offset:0 sc1 lds
    s_sleep 2
    buffer_load_dwordx4 v255, s[48:51], s71 offen offset:1024 sc1 lds
    s_sleep 2
    buffer_load_dwordx4 v255, s[48:51], s71 offen offset:2048 sc1 lds
    s_sleep 2
    buffer_load_dwordx4 v255, s[48:51], s71 offen offset:3072 sc1 lds
    s_sleep 2
    s_waitcnt vmcnt(4)
    s_add_u32 s76, s28, 2
    v_mov_b32 v254, s76
    ds_write_b32 v201, v254
    s_add_u32 s71, s72, 36864
    s_and_b32 m0, s71, 0x1ffff
    s_sub_u32 s71, s71, 32768
    buffer_load_dwordx4 v255, s[48:51], s71 offen offset:0 sc1 lds
    s_sleep 2
    buffer_load_dwordx4 v255, s[48:51], s71 offen offset:1024 sc1 lds
    s_sleep 2
    buffer_load_dwordx4 v255, s[48:51], s71 offen offset:2048 sc1 lds
    s_sleep 2
    buffer_load_dwordx4 v255, s[48:51], s71 offen offset:3072 sc1 lds
    s_add_u32 s72, s72, 32768
    s_lshl_b32 s76, s23, 11
    s_lshl_b32 s77, s24, 6
    s_add_u32 s76, s76, s77
    s_lshl_b32 s77, s22, 3
    s_add_u32 s76, s76, s77
    s_mov_b64 exec, 1
    buffer_store_dwordx2 v[192:193], v255, s[64:67], s76 offen offset:1024 sc1
    s_mov_b64 exec, -1
fmain_w0:
    s_cmp_gt_i32 s28, 16
    s_cbranch_scc1 fmain_w0_done
    ds_read_b32 v232, v229
    s_waitcnt vmcnt(8)
    s_add_u32 s76, s28, 2
    v_mov_b32 v254, s76
    ds_write_b32 v201, v254
    s_waitcnt lgkmcnt(0)
    v_cmp_gt_i32 vcc, s28, v232
    s_cbranch_vccnz Lgated_wp_47
Lgated_wp_47_r:
    s_add_u32 s28, s28, 2
    s_add_u32 s71, s72, 32768
    s_and_b32 m0, s71, 0x1ffff
    s_sub_u32 s71, s71, 32768
    buffer_load_dwordx4 v255, s[48:51], s71 offen offset:0 sc1 lds
    s_sleep 2
    buffer_load_dwordx4 v255, s[48:51], s71 offen offset:1024 sc1 lds
    s_sleep 2
    buffer_load_dwordx4 v255, s[48:51], s71 offen offset:2048 sc1 lds
    s_sleep 2
    buffer_load_dwordx4 v255, s[48:51], s71 offen offset:3072 sc1 lds
    s_sleep 2
    s_waitcnt vmcnt(4)
    s_add_u32 s76, s28, 2
    v_mov_b32 v254, s76
    ds_write_b32 v201, v254
    s_add_u32 s71, s72, 36864
    s_and_b32 m0, s71, 0x1ffff
    s_sub_u32 s71, s71, 32768
    buffer_load_dwordx4 v255, s[48:51], s71 offen offset:0 sc1 lds
    s_sleep 2
    buffer_load_dwordx4 v255, s[48:51], s71 offen offset:1024 sc1 lds
    s_sleep 2
    buffer_load_dwordx4 v255, s[48:51], s71 offen offset:2048 sc1 lds
    s_sleep 2
    buffer_load_dwordx4 v255, s[48:51], s71 offen offset:3072 sc1 lds
    s_add_u32 s72, s72, 32768
    s_branch fmain_w0
fmain_w0_done:
    s_sub_u32 s76, s27, 16
    s_cmp_gt_i32 s28, s76
    s_cbranch_scc1 fmain_w1
    ds_read_b32 v232, v229
    s_waitcnt vmcnt(8)
    s_add_u32 s76, s28, 2
    v_mov_b32 v254, s76
    ds_write_b32 v201, v254
    s_waitcnt lgkmcnt(0)
    v_cmp_gt_i32 vcc, s28, v232
    s_cbranch_vccnz Lgated_wp_48
Lgated_wp_48_r:
    s_add_u32 s28, s28, 2
    s_setprio 2
    v_add_f32 v215, v236, v240
    v_cmp_ngt_f32 vcc, 0x5f800000, v215
    s_cmp_lg_u64 vcc, 0
    s_cselect_b32 s31, 1, 0
    s_add_u32 s71, s72, 32768
    s_and_b32 m0, s71, 0x1ffff
    s_sub_u32 s71, s71, 32768
    buffer_load_dwordx4 v255, s[48:51], s71 offen offset:0 sc1 lds
    s_lshr_b32 s76, s25, 4
    s_mul_i32 s76, s76, 147456
    s_lshl_b32 s77, s23, 12
    s_add_u32 s73, s76, s77
    v_rcp_f32 v214, v236
    s_nop 0
    v_mov_b32 v215, v214
    v_mul_f32 v0, v0, v214
    v_mul_f32 v1, v1, v214
    v_mul_f32 v2, v2, v214
    v_mul_f32 v3, v3, v214
    v_mul_f32 v8, v8, v214
    v_mul_f32 v9, v9, v214
    v_mul_f32 v10, v10, v214
    v_mul_f32 v11, v11, v214
    v_cvt_pk_bf16_f32 v0, v0, v1
    v_cvt_pk_bf16_f32 v1, v2, v3
    v_cvt_pk_bf16_f32 v2, v8, v9
    v_cvt_pk_bf16_f32 v3, v10, v11
    s_sleep 1
    buffer_load_dwordx4 v255, s[48:51], s71 offen offset:1024 sc1 lds
    v_mul_f32 v16, v16, v214
    v_mul_f32 v17, v17, v214
    v_mul_f32 v18, v18, v214
    v_mul_f32 v19, v19, v214
    v_mul_f32 v24, v24, v214
    v_mul_f32 v25, v25, v214
    v_mul_f32 v26, v26, v214
    v_mul_f32 v27, v27, v214
    v_cvt_pk_bf16_f32 v16, v16, v17
    v_cvt_pk_bf16_f32 v17, v18, v19
    v_cvt_pk_bf16_f32 v18, v24, v25
    v_cvt_pk_bf16_f32 v19, v26, v27
    s_sleep 1
    buffer_load_dwordx4 v255, s[48:51], s71 offen offset:2048 sc1 lds
    v_mul_f32 v32, v32, v214
    v_mul_f32 v33, v33, v214
    v_mul_f32 v34, v34, v214
    v_mul_f32 v35, v35, v214
    v_mul_f32 v40, v40, v214
    v_mul_f32 v41, v41, v214
    v_mul_f32 v42, v42, v214
    v_mul_f32 v43, v43, v214
    v_cvt_pk_bf16_f32 v32, v32, v33
    v_cvt_pk_bf16_f32 v33, v34, v35
    v_cvt_pk_bf16_f32 v34, v40, v41
    v_cvt_pk_bf16_f32 v35, v42, v43
    s_sleep 1
    buffer_load_dwordx4 v255, s[48:51], s71 offen offset:3072 sc1 lds
    v_mul_f32 v48, v48, v214
    v_mul_f32 v49, v49, v214
    v_mul_f32 v50, v50, v214
    v_mul_f32 v51, v51, v214
    v_mul_f32 v56, v56, v214
    v_mul_f32 v57, v57, v214
    v_mul_f32 v58, v58, v214
    v_mul_f32 v59, v59, v214
    v_cvt_pk_bf16_f32 v48, v48, v49
    v_cvt_pk_bf16_f32 v49, v50, v51
    v_cvt_pk_bf16_f32 v50, v56, v57
    v_cvt_pk_bf16_f32 v51, v58, v59
    s_sleep 1
    s_waitcnt vmcnt(4)
    s_add_u32 s76, s28, 2
    v_mov_b32 v254, s76
    ds_write_b32 v201, v254
    s_add_u32 s71, s72, 36864
    s_and_b32 m0, s71, 0x1ffff
    s_sub_u32 s71, s71, 32768
    buffer_load_dwordx4 v255, s[48:51], s71 offen offset:0 sc1 lds
    v_rcp_f32 v214, v240
    s_nop 0
    v_mov_b32 v215, v214
    v_mul_f32 v4, v4, v214
    v_mul_f32 v5, v5, v214
    v_mul_f32 v6, v6, v214
    v_mul_f32 v7, v7, v214
    v_mul_f32 v12, v12, v214
    v_mul_f32 v13, v13, v214
    v_mul_f32 v14, v14, v214
    v_mul_f32 v15, v15, v214
    v_cvt_pk_bf16_f32 v4, v4, v5
    v_cvt_pk_bf16_f32 v5, v6, v7
    v_cvt_pk_bf16_f32 v6, v12, v13
    v_cvt_pk_bf16_f32 v7, v14, v15
    s_sleep 1
    buffer_load_dwordx4 v255, s[48:51], s71 offen offset:1024 sc1 lds
    v_mul_f32 v20, v20, v214
    v_mul_f32 v21, v21, v214
    v_mul_f32 v22, v22, v214
    v_mul_f32 v23, v23, v214
    v_mul_f32 v28, v28, v214
    v_mul_f32 v29, v29, v214
    v_mul_f32 v30, v30, v214
    v_mul_f32 v31, v31, v214
    v_cvt_pk_bf16_f32 v20, v20, v21
    v_cvt_pk_bf16_f32 v21, v22, v23
    v_cvt_pk_bf16_f32 v22, v28, v29
    v_cvt_pk_bf16_f32 v23, v30, v31
    s_sleep 1
    buffer_load_dwordx4 v255, s[48:51], s71 offen offset:2048 sc1 lds
    v_mul_f32 v36, v36, v214
    v_mul_f32 v37, v37, v214
    v_mul_f32 v38, v38, v214
    v_mul_f32 v39, v39, v214
    v_mul_f32 v44, v44, v214
    v_mul_f32 v45, v45, v214
    v_mul_f32 v46, v46, v214
    v_mul_f32 v47, v47, v214
    v_cvt_pk_bf16_f32 v36, v36, v37
    v_cvt_pk_bf16_f32 v37, v38, v39
    v_cvt_pk_bf16_f32 v38, v44, v45
    v_cvt_pk_bf16_f32 v39, v46, v47
    s_sleep 1
    buffer_load_dwordx4 v255, s[48:51], s71 offen offset:3072 sc1 lds
    s_add_u32 s72, s72, 32768
    v_mul_f32 v52, v52, v214
    v_mul_f32 v53, v53, v214
    v_mul_f32 v54, v54, v214
    v_mul_f32 v55, v55, v214
    v_mul_f32 v60, v60, v214
    v_mul_f32 v61, v61, v214
    v_mul_f32 v62, v62, v214
    v_mul_f32 v63, v63, v214
    v_cvt_pk_bf16_f32 v52, v52, v53
    v_cvt_pk_bf16_f32 v53, v54, v55
    v_cvt_pk_bf16_f32 v54, v60, v61
    v_cvt_pk_bf16_f32 v55, v62, v63
    s_sleep 1
    ds_read_b32 v232, v229
    s_waitcnt vmcnt(8)
    s_add_u32 s76, s28, 2
    v_mov_b32 v254, s76
    ds_write_b32 v201, v254
    s_waitcnt lgkmcnt(0)
    v_cmp_gt_i32 vcc, s28, v232
    s_cbranch_vccnz Lgated_wp_49
Lgated_wp_49_r:
    s_add_u32 s28, s28, 2
    s_add_u32 s71, s72, 32768
    s_and_b32 m0, s71, 0x1ffff
    s_sub_u32 s71, s71, 32768
    buffer_load_dwordx4 v255, s[48:51], s71 offen offset:0 sc1 lds
    s_lshl_b32 s76, s22, 10
    s_add_u32 s76, s76, 151552
    v_add_u32 v216, s76, v255
    v_add_u32 v217, 159744, v255
    ds_read_b128 v[148:151], v216
    ds_read_b128 v[128:131], v217
    v_mov_b32 v218, 0x358637bd
    s_waitcnt lgkmcnt(0)
    v_mfma_f32_16x16x16_bf16 v[72:75], v[128:129], v[248:249], 0
    v_mfma_f32_16x16x16_bf16 v[76:79], v[130:131], v[248:249], 0
    v_mfma_f32_16x16x16_bf16 v[80:83], v[128:129], v[250:251], 0
    v_mfma_f32_16x16x16_bf16 v[84:87], v[130:131], v[250:251], 0
    v_mfma_f32_16x16x16_bf16 v[88:91], v[128:129], v[148:149], 0
    v_mfma_f32_16x16x16_bf16 v[92:95], v[130:131], v[148:149], 0
    v_mfma_f32_16x16x16_bf16 v[96:99], v[128:129], v[150:151], 0
    v_mfma_f32_16x16x16_bf16 v[100:103], v[130:131], v[150:151], 0
    s_nop 1
    v_cvt_pk_bf16_f32 v219, v72, v73
    v_lshlrev_b32 v72, 16, v219
    v_and_b32 v73, 0xffff0000, v219
    v_cvt_pk_bf16_f32 v219, v74, v75
    v_lshlrev_b32 v74, 16, v219
    v_and_b32 v75, 0xffff0000, v219
    v_cvt_pk_bf16_f32 v76, v76, v76
    v_lshlrev_b32 v76, 16, v76
    v_add_f32 v76, v218, v76
    v_cvt_pk_bf16_f32 v76, v76, v76
    v_lshlrev_b32 v76, 16, v76
    v_rcp_f32 v76, v76
    s_nop 0
    s_sleep 1
    buffer_load_dwordx4 v255, s[48:51], s71 offen offset:1024 sc1 lds
    v_mul_f32 v72, v72, v76
    v_mul_f32 v73, v73, v76
    v_mul_f32 v74, v74, v76
    v_mul_f32 v75, v75, v76
    v_cvt_pk_bf16_f32 v104, v72, v73
    v_cvt_pk_bf16_f32 v105, v74, v75
    s_sleep 1
    buffer_load_dwordx4 v255, s[48:51], s71 offen offset:2048 sc1 lds
    v_cvt_pk_bf16_f32 v219, v80, v81
    v_lshlrev_b32 v80, 16, v219
    v_and_b32 v81, 0xffff0000, v219
    v_cvt_pk_bf16_f32 v219, v82, v83
    v_lshlrev_b32 v82, 16, v219
    v_and_b32 v83, 0xffff0000, v219
    v_cvt_pk_bf16_f32 v84, v84, v84
    v_lshlrev_b32 v84, 16, v84
    v_add_f32 v84, v218, v84
    v_cvt_pk_bf16_f32 v84, v84, v84
    v_lshlrev_b32 v84, 16, v84
    v_rcp_f32 v84, v84
    s_nop 0
    s_sleep 1
    buffer_load_dwordx4 v255, s[48:51], s71 offen offset:3072 sc1 lds
    v_mul_f32 v80, v80, v84
    v_mul_f32 v81, v81, v84
    v_mul_f32 v82, v82, v84
    v_mul_f32 v83, v83, v84
    v_cvt_pk_bf16_f32 v106, v80, v81
    v_cvt_pk_bf16_f32 v107, v82, v83
    s_sleep 1
    s_waitcnt vmcnt(4)
    s_add_u32 s76, s28, 2
    v_mov_b32 v254, s76
    ds_write_b32 v201, v254
    s_add_u32 s71, s72, 36864
    s_and_b32 m0, s71, 0x1ffff
    s_sub_u32 s71, s71, 32768
    buffer_load_dwordx4 v255, s[48:51], s71 offen offset:0 sc1 lds
    v_cvt_pk_bf16_f32 v219, v88, v89
    v_lshlrev_b32 v88, 16, v219
    v_and_b32 v89, 0xffff0000, v219
    v_cvt_pk_bf16_f32 v219, v90, v91
    v_lshlrev_b32 v90, 16, v219
    v_and_b32 v91, 0xffff0000, v219
    v_cvt_pk_bf16_f32 v92, v92, v92
    v_lshlrev_b32 v92, 16, v92
    v_add_f32 v92, v218, v92
    v_cvt_pk_bf16_f32 v92, v92, v92
    v_lshlrev_b32 v92, 16, v92
    v_rcp_f32 v92, v92
    s_nop 0
    s_sleep 1
    buffer_load_dwordx4 v255, s[48:51], s71 offen offset:1024 sc1 lds
    v_mul_f32 v88, v88, v92
    v_mul_f32 v89, v89, v92
    v_mul_f32 v90, v90, v92
    v_mul_f32 v91, v91, v92
    v_cvt_pk_bf16_f32 v108, v88, v89
    v_cvt_pk_bf16_f32 v109, v90, v91
    s_sleep 1
    buffer_load_dwordx4 v255, s[48:51], s71 offen offset:2048 sc1 lds
    v_cvt_pk_bf16_f32 v219, v96, v97
    v_lshlrev_b32 v96, 16, v219
    v_and_b32 v97, 0xffff0000, v219
    v_cvt_pk_bf16_f32 v219, v98, v99
    v_lshlrev_b32 v98, 16, v219
    v_and_b32 v99, 0xffff0000, v219
    v_cvt_pk_bf16_f32 v100, v100, v100
    v_lshlrev_b32 v100, 16, v100
    v_add_f32 v100, v218, v100
    v_cvt_pk_bf16_f32 v100, v100, v100
    v_lshlrev_b32 v100, 16, v100
    v_rcp_f32 v100, v100
    s_nop 0
    s_sleep 1
    buffer_load_dwordx4 v255, s[48:51], s71 offen offset:3072 sc1 lds
    s_add_u32 s72, s72, 32768
    v_mul_f32 v96, v96, v100
    v_mul_f32 v97, v97, v100
    v_mul_f32 v98, v98, v100
    v_mul_f32 v99, v99, v100
    v_cvt_pk_bf16_f32 v110, v96, v97
    v_cvt_pk_bf16_f32 v111, v98, v99
    s_sleep 1
    s_setprio 0
    ds_read_b32 v232, v229
    s_waitcnt vmcnt(8)
    s_add_u32 s76, s28, 2
    v_mov_b32 v254, s76
    ds_write_b32 v201, v254
    s_waitcnt lgkmcnt(0)
    v_cmp_gt_i32 vcc, s28, v232
    s_cbranch_vccnz Lgated_wp_50
Lgated_wp_50_r:
    s_add_u32 s28, s28, 2
    s_add_u32 s71, s72, 32768
    s_and_b32 m0, s71, 0x1ffff
    s_sub_u32 s71, s71, 32768
    buffer_load_dwordx4 v255, s[48:51], s71 offen offset:0 sc1 lds
    s_sleep 2
    buffer_load_dwordx4 v255, s[48:51], s71 offen offset:1024 sc1 lds
    s_sleep 1
    buffer_load_dwordx4 v255, s[48:51], s71 offen offset:2048 sc1 lds
    s_sleep 2
    buffer_load_dwordx4 v255, s[48:51], s71 offen offset:3072 sc1 lds
    s_sleep 1
    s_waitcnt vmcnt(4)
    s_add_u32 s76, s28, 2
    v_mov_b32 v254, s76
    ds_write_b32 v201, v254
    s_add_u32 s71, s72, 36864
    s_and_b32 m0, s71, 0x1ffff
    s_sub_u32 s71, s71, 32768
    buffer_load_dwordx4 v255, s[48:51], s71 offen offset:0 sc1 lds
    s_sleep 2
    buffer_load_dwordx4 v255, s[48:51], s71 offen offset:1024 sc1 lds
    s_sleep 1
    buffer_load_dwordx4 v255, s[48:51], s71 offen offset:2048 sc1 lds
    s_sleep 2
    buffer_load_dwordx4 v255, s[48:51], s71 offen offset:3072 sc1 lds
    s_add_u32 s72, s72, 32768
    s_sleep 1
    s_add_u32 s76, s73, 0
    buffer_store_dwordx4 v[0:3], v255, s[56:59], s76 offen offset:0 sc1
    s_sleep 1
    s_add_u32 s76, s73, 0
    buffer_store_dwordx4 v[16:19], v255, s[56:59], s76 offen offset:1024 sc1
    s_sleep 1
    s_add_u32 s76, s73, 0
    buffer_store_dwordx4 v[32:35], v255, s[56:59], s76 offen offset:2048 sc1
    ds_read_b32 v232, v229
    s_waitcnt vmcnt(11)
    s_add_u32 s76, s28, 2
    v_mov_b32 v254, s76
    ds_write_b32 v201, v254
    s_waitcnt lgkmcnt(0)
    v_cmp_gt_i32 vcc, s28, v232
    s_cbranch_vccnz Lgated_wp_51
Lgated_wp_51_r:
    s_add_u32 s28, s28, 2
    s_add_u32 s71, s72, 32768
    s_and_b32 m0, s71, 0x1ffff
    s_sub_u32 s71, s71, 32768
    buffer_load_dwordx4 v255, s[48:51], s71 offen offset:0 sc1 lds
    s_sleep 2
    buffer_load_dwordx4 v255, s[48:51], s71 offen offset:1024 sc1 lds
    s_sleep 1
    buffer_load_dwordx4 v255, s[48:51], s71 offen offset:2048 sc1 lds
    s_sleep 2
    buffer_load_dwordx4 v255, s[48:51], s71 offen offset:3072 sc1 lds
    s_sleep 1
    s_waitcnt vmcnt(7)
    s_add_u32 s76, s28, 2
    v_mov_b32 v254, s76
    ds_write_b32 v201, v254
    s_add_u32 s71, s72, 36864
    s_and_b32 m0, s71, 0x1ffff
    s_sub_u32 s71, s71, 32768
    buffer_load_dwordx4 v255, s[48:51], s71 offen offset:0 sc1 lds
    s_sleep 2
    buffer_load_dwordx4 v255, s[48:51], s71 offen offset:1024 sc1 lds
    s_sleep 1
    buffer_load_dwordx4 v255, s[48:51], s71 offen offset:2048 sc1 lds
    s_sleep 2
    buffer_load_dwordx4 v255, s[48:51], s71 offen offset:3072 sc1 lds
    s_add_u32 s72, s72, 32768
    s_sleep 1
    s_add_u32 s76, s73, 0
    buffer_store_dwordx4 v[48:51], v255, s[56:59], s76 offen offset:3072 sc1
    s_sleep 1
    s_add_u32 s76, s73, 147456
    buffer_store_dwordx4 v[4:7], v255, s[56:59], s76 offen offset:0 sc1
    s_sleep 1
    s_add_u32 s76, s73, 147456
    buffer_store_dwordx4 v[20:23], v255, s[56:59], s76 offen offset:1024 sc1
    ds_read_b32 v232, v229
    s_waitcnt vmcnt(11)
    s_add_u32 s76, s28, 2
    v_mov_b32 v254, s76
    ds_write_b32 v201, v254
    s_waitcnt lgkmcnt(0)
    v_cmp_gt_i32 vcc, s28, v232
    s_cbranch_vccnz Lgated_wp_52
Lgated_wp_52_r:
    s_add_u32 s28, s28, 2
    s_add_u32 s71, s72, 32768
    s_and_b32 m0, s71, 0x1ffff
    s_sub_u32 s71, s71, 32768
    buffer_load_dwordx4 v255, s[48:51], s71 offen offset:0 sc1 lds
    s_sleep 2
    buffer_load_dwordx4 v255, s[48:51], s71 offen offset:1024 sc1 lds
    s_sleep 1
    buffer_load_dwordx4 v255, s[48:51], s71 offen offset:2048 sc1 lds
    s_sleep 2
    buffer_load_dwordx4 v255, s[48:51], s71 offen offset:3072 sc1 lds
    s_sleep 1
    s_waitcnt vmcnt(7)
    s_add_u32 s76, s28, 2
    v_mov_b32 v254, s76
    ds_write_b32 v201, v254
    s_add_u32 s71, s72, 36864
    s_and_b32 m0, s71, 0x1ffff
    s_sub_u32 s71, s71, 32768
    buffer_load_dwordx4 v255, s[48:51], s71 offen offset:0 sc1 lds
    s_sleep 2
    buffer_load_dwordx4 v255, s[48:51], s71 offen offset:1024 sc1 lds
    s_sleep 1
    buffer_load_dwordx4 v255, s[48:51], s71 offen offset:2048 sc1 lds
    s_sleep 2
    buffer_load_dwordx4 v255, s[48:51], s71 offen offset:3072 sc1 lds
    s_add_u32 s72, s72, 32768
    s_sleep 1
    s_add_u32 s76, s73, 147456
    buffer_store_dwordx4 v[36:39], v255, s[56:59], s76 offen offset:2048 sc1
    s_sleep 1
    s_add_u32 s76, s73, 147456
    buffer_store_dwordx4 v[52:55], v255, s[56:59], s76 offen offset:3072 sc1
    s_sleep 1
    v_mov_b32 v214, s16
    v_mov_b32 v215, 1048576
    s_add_u32 s76, s25, s23
    s_lshl_b32 s76, s76, 2
    s_mov_b64 exec, 1
    buffer_store_dword v214, v215, s[60:63], s76 offen sc1
    s_mov_b64 exec, -1
    ds_read_b32 v232, v229
    s_waitcnt vmcnt(11)
    s_add_u32 s76, s28, 2
    v_mov_b32 v254, s76
    ds_write_b32 v201, v254
    s_waitcnt lgkmcnt(0)
    v_cmp_gt_i32 vcc, s28, v232
    s_cbranch_vccnz Lgated_wp_53
Lgated_wp_53_r:
    s_add_u32 s28, s28, 2
    s_add_u32 s71, s72, 32768
    s_and_b32 m0, s71, 0x1ffff
    s_sub_u32 s71, s71, 32768
    buffer_load_dwordx4 v255, s[48:51], s71 offen offset:0 sc1 lds
    s_sleep 2
    buffer_load_dwordx4 v255, s[48:51], s71 offen offset:1024 sc1 lds
    s_sleep 1
    buffer_load_dwordx4 v255, s[48:51], s71 offen offset:2048 sc1 lds
    s_sleep 2
    buffer_load_dwordx4 v255, s[48:51], s71 offen offset:3072 sc1 lds
    s_sleep 1
    s_waitcnt vmcnt(7)
    s_add_u32 s76, s28, 2
    v_mov_b32 v254, s76
    ds_write_b32 v201, v254
    s_add_u32 s71, s72, 36864
    s_and_b32 m0, s71, 0x1ffff
    s_sub_u32 s71, s71, 32768
    buffer_load_dwordx4 v255, s[48:51], s71 offen offset:0 sc1 lds
    s_sleep 2
    buffer_load_dwordx4 v255, s[48:51], s71 offen offset:1024 sc1 lds
    s_sleep 1
    buffer_load_dwordx4 v255, s[48:51], s71 offen offset:2048 sc1 lds
    s_sleep 2
    buffer_load_dwordx4 v255, s[48:51], s71 offen offset:3072 sc1 lds
    s_add_u32 s72, s72, 32768
    s_sleep 1
    s_lshr_b32 s76, s25, 4
    s_and_b32 s77, s23, 1
    s_add_u32 s76, s76, s77
    s_mul_i32 s76, s76, 147456
    s_lshr_b32 s77, s23, 1
    s_lshl_b32 s77, s77, 10
    s_add_u32 s76, s76, s77
    s_add_u32 s76, s76, 131072
    buffer_store_dwordx4 v[104:107], v255, s[56:59], s76 offen sc1
    s_sleep 1
    s_lshr_b32 s76, s30, 4
    s_and_b32 s77, s23, 1
    s_add_u32 s76, s76, s77
    s_mul_i32 s76, s76, 147456
    s_lshr_b32 s77, s23, 1
    s_lshl_b32 s77, s77, 10
    s_add_u32 s76, s76, s77
    s_add_u32 s76, s76, 131072
    buffer_store_dwordx4 v[108:111], v255, s[56:59], s76 offen sc1
    ds_read_b32 v232, v229
    s_waitcnt vmcnt(10)
    s_add_u32 s76, s28, 2
    v_mov_b32 v254, s76
    ds_write_b32 v201, v254
    s_waitcnt lgkmcnt(0)
    v_cmp_gt_i32 vcc, s28, v232
    s_cbranch_vccnz Lgated_wp_54
Lgated_wp_54_r:
    s_add_u32 s28, s28, 2
    s_add_u32 s71, s72, 32768
    s_and_b32 m0, s71, 0x1ffff
    s_sub_u32 s71, s71, 32768
    buffer_load_dwordx4 v255, s[48:51], s71 offen offset:0 sc1 lds
    s_sleep 2
    buffer_load_dwordx4 v255, s[48:51], s71 offen offset:1024 sc1 lds
    s_sleep 2
    buffer_load_dwordx4 v255, s[48:51], s71 offen offset:2048 sc1 lds
    s_sleep 2
    buffer_load_dwordx4 v255, s[48:51], s71 offen offset:3072 sc1 lds
    s_sleep 2
    s_waitcnt vmcnt(6)
    s_add_u32 s76, s28, 2
    v_mov_b32 v254, s76
    ds_write_b32 v201, v254
    s_add_u32 s71, s72, 36864
    s_and_b32 m0, s71, 0x1ffff
    s_sub_u32 s71, s71, 32768
    buffer_load_dwordx4 v255, s[48:51], s71 offen offset:0 sc1 lds
    s_sleep 2
    buffer_load_dwordx4 v255, s[48:51], s71 offen offset:1024 sc1 lds
    s_sleep 2
    buffer_load_dwordx4 v255, s[48:51], s71 offen offset:2048 sc1 lds
    s_sleep 2
    buffer_load_dwordx4 v255, s[48:51], s71 offen offset:3072 sc1 lds
    s_add_u32 s72, s72, 32768
    ds_read_b32 v232, v229
    s_waitcnt vmcnt(8)
    s_add_u32 s76, s28, 2
    v_mov_b32 v254, s76
    ds_write_b32 v201, v254
    s_waitcnt lgkmcnt(0)
    v_cmp_gt_i32 vcc, s28, v232
    s_cbranch_vccnz Lgated_wp_55
Lgated_wp_55_r:
    s_add_u32 s28, s28, 2
    s_add_u32 s71, s72, 32768
    s_and_b32 m0, s71, 0x1ffff
    s_sub_u32 s71, s71, 32768
    buffer_load_dwordx4 v255, s[48:51], s71 offen offset:0 sc1 lds
    s_sleep 2
    buffer_load_dwordx4 v255, s[48:51], s71 offen offset:1024 sc1 lds
    s_sleep 2
    buffer_load_dwordx4 v255, s[48:51], s71 offen offset:2048 sc1 lds
    s_sleep 2
    buffer_load_dwordx4 v255, s[48:51], s71 offen offset:3072 sc1 lds
    s_sleep 2
    s_waitcnt vmcnt(4)
    s_add_u32 s76, s28, 2
    v_mov_b32 v254, s76
    ds_write_b32 v201, v254
    s_add_u32 s71, s72, 36864
    s_and_b32 m0, s71, 0x1ffff
    s_sub_u32 s71, s71, 32768
    buffer_load_dwordx4 v255, s[48:51], s71 offen offset:0 sc1 lds
    s_sleep 2
    buffer_load_dwordx4 v255, s[48:51], s71 offen offset:1024 sc1 lds
    s_sleep 2
    buffer_load_dwordx4 v255, s[48:51], s71 offen offset:2048 sc1 lds
    s_sleep 2
    buffer_load_dwordx4 v255, s[48:51], s71 offen offset:3072 sc1 lds
    s_add_u32 s72, s72, 32768
    s_cmp_eq_u32 s31, 1
    s_cbranch_scc1 fmain_w2
    s_lshl_b32 s76, s24, 11
    s_lshl_b32 s77, s22, 8
    s_add_u32 s76, s76, s77
    s_lshl_b32 s77, s23, 3
    s_add_u32 s76, s76, s77
    s_add_u32 s76, s76, 65536
    s_mov_b64 exec, 1
    buffer_store_dwordx2 v[192:193], v255, s[64:67], s76 offen offset:0 sc1
    s_mov_b64 exec, -1
fmain_w2:
    s_cmp_ge_i32 s28, s27
    s_cbranch_scc1 fmain_w2_done
    ds_read_b32 v232, v229
    s_waitcnt vmcnt(8)
    s_add_u32 s76, s28, 2
    v_mov_b32 v254, s76
    ds_write_b32 v201, v254
    s_waitcnt lgkmcnt(0)
    v_cmp_gt_i32 vcc, s28, v232
    s_cbranch_vccnz Lgated_wp_56
Lgated_wp_56_r:
    s_add_u32 s28, s28, 2
    s_add_u32 s71, s72, 32768
    s_and_b32 m0, s71, 0x1ffff
    s_sub_u32 s71, s71, 32768
    buffer_load_dwordx4 v255, s[48:51], s71 offen offset:0 sc1 lds
    s_sleep 2
    buffer_load_dwordx4 v255, s[48:51], s71 offen offset:1024 sc1 lds
    s_sleep 2
    buffer_load_dwordx4 v255, s[48:51], s71 offen offset:2048 sc1 lds
    s_sleep 2
    buffer_load_dwordx4 v255, s[48:51], s71 offen offset:3072 sc1 lds
    s_sleep 2
    s_waitcnt vmcnt(4)
    s_add_u32 s76, s28, 2
    v_mov_b32 v254, s76
    ds_write_b32 v201, v254
    s_add_u32 s71, s72, 36864
    s_and_b32 m0, s71, 0x1ffff
    s_sub_u32 s71, s71, 32768
    buffer_load_dwordx4 v255, s[48:51], s71 offen offset:0 sc1 lds
    s_sleep 2
    buffer_load_dwordx4 v255, s[48:51], s71 offen offset:1024 sc1 lds
    s_sleep 2
    buffer_load_dwordx4 v255, s[48:51], s71 offen offset:2048 sc1 lds
    s_sleep 2
    buffer_load_dwordx4 v255, s[48:51], s71 offen offset:3072 sc1 lds
    s_add_u32 s72, s72, 32768
    s_branch fmain_w2
fmain_w2_done:
    s_waitcnt vmcnt(0)
    v_mov_b32 v254, 0x10000
    ds_write_b32 v201, v254
    s_mov_b32 s73, 0
    s_branch fmain_wset
fmain_w1:
    s_cmp_ge_i32 s28, s27
    s_cbranch_scc1 fmain_lateA
    ds_read_b32 v232, v229
    s_waitcnt vmcnt(8)
    s_add_u32 s76, s28, 2
    v_mov_b32 v254, s76
    ds_write_b32 v201, v254
    s_waitcnt lgkmcnt(0)
    v_cmp_gt_i32 vcc, s28, v232
    s_cbranch_vccnz Lgated_wp_57
Lgated_wp_57_r:
    s_add_u32 s28, s28, 2
    s_add_u32 s71, s72, 32768
    s_and_b32 m0, s71, 0x1ffff
    s_sub_u32 s71, s71, 32768
    buffer_load_dwordx4 v255, s[48:51], s71 offen offset:0 sc1 lds
    s_sleep 2
    buffer_load_dwordx4 v255, s[48:51], s71 offen offset:1024 sc1 lds
    s_sleep 2
    buffer_load_dwordx4 v255, s[48:51], s71 offen offset:2048 sc1 lds
    s_sleep 2
    buffer_load_dwordx4 v255, s[48:51], s71 offen offset:3072 sc1 lds
    s_sleep 2
    s_waitcnt vmcnt(4)
    s_add_u32 s76, s28, 2
    v_mov_b32 v254, s76
    ds_write_b32 v201, v254
    s_add_u32 s71, s72, 36864
    s_and_b32 m0, s71, 0x1ffff
    s_sub_u32 s71, s71, 32768
    buffer_load_dwordx4 v255, s[48:51], s71 offen offset:0 sc1 lds
    s_sleep 2
    buffer_load_dwordx4 v255, s[48:51], s71 offen offset:1024 sc1 lds
    s_sleep 2
    buffer_load_dwordx4 v255, s[48:51], s71 offen offset:2048 sc1 lds
    s_sleep 2
    buffer_load_dwordx4 v255, s[48:51], s71 offen offset:3072 sc1 lds
    s_add_u32 s72, s72, 32768
    s_branch fmain_w1
fmain_lateA:
    s_setprio 2
    s_waitcnt vmcnt(8)
    s_add_u32 s76, s28, 2
    v_mov_b32 v254, s76
    ds_write_b32 v201, v254
    v_add_f32 v215, v236, v240
    v_cmp_ngt_f32 vcc, 0x5f800000, v215
    s_cmp_lg_u64 vcc, 0
    s_cselect_b32 s31, 1, 0
    s_lshr_b32 s76, s25, 4
    s_mul_i32 s76, s76, 147456
    s_lshl_b32 s77, s23, 12
    s_add_u32 s73, s76, s77
    v_rcp_f32 v214, v236
    s_nop 0
    v_mov_b32 v215, v214
    v_mul_f32 v0, v0, v214
    v_mul_f32 v1, v1, v214
    v_mul_f32 v2, v2, v214
    v_mul_f32 v3, v3, v214
    v_mul_f32 v8, v8, v214
    v_mul_f32 v9, v9, v214
    v_mul_f32 v10, v10, v214
    v_mul_f32 v11, v11, v214
    v_cvt_pk_bf16_f32 v0, v0, v1
    v_cvt_pk_bf16_f32 v1, v2, v3
    v_cvt_pk_bf16_f32 v2, v8, v9
    v_cvt_pk_bf16_f32 v3, v10, v11
    v_mul_f32 v16, v16, v214
    v_mul_f32 v17, v17, v214
    v_mul_f32 v18, v18, v214
    v_mul_f32 v19, v19, v214
    v_mul_f32 v24, v24, v214
    v_mul_f32 v25, v25, v214
    v_mul_f32 v26, v26, v214
    v_mul_f32 v27, v27, v214
    v_cvt_pk_bf16_f32 v16, v16, v17
    v_cvt_pk_bf16_f32 v17, v18, v19
    v_cvt_pk_bf16_f32 v18, v24, v25
    v_cvt_pk_bf16_f32 v19, v26, v27
    v_mul_f32 v32, v32, v214
    v_mul_f32 v33, v33, v214
    v_mul_f32 v34, v34, v214
    v_mul_f32 v35, v35, v214
    v_mul_f32 v40, v40, v214
    v_mul_f32 v41, v41, v214
    v_mul_f32 v42, v42, v214
    v_mul_f32 v43, v43, v214
    v_cvt_pk_bf16_f32 v32, v32, v33
    v_cvt_pk_bf16_f32 v33, v34, v35
    v_cvt_pk_bf16_f32 v34, v40, v41
    v_cvt_pk_bf16_f32 v35, v42, v43
    v_mul_f32 v48, v48, v214
    v_mul_f32 v49, v49, v214
    v_mul_f32 v50, v50, v214
    v_mul_f32 v51, v51, v214
    v_mul_f32 v56, v56, v214
    v_mul_f32 v57, v57, v214
    v_mul_f32 v58, v58, v214
    v_mul_f32 v59, v59, v214
    v_cvt_pk_bf16_f32 v48, v48, v49
    v_cvt_pk_bf16_f32 v49, v50, v51
    v_cvt_pk_bf16_f32 v50, v56, v57
    v_cvt_pk_bf16_f32 v51, v58, v59
    s_waitcnt vmcnt(0)
    v_mov_b32 v254, 0x10000
    ds_write_b32 v201, v254
    s_add_u32 s76, s73, 0
    buffer_store_dwordx4 v[0:3], v255, s[56:59], s76 offen offset:0 sc1
    v_rcp_f32 v214, v240
    s_nop 0
    v_mov_b32 v215, v214
    v_mul_f32 v4, v4, v214
    v_mul_f32 v5, v5, v214
    v_mul_f32 v6, v6, v214
    v_mul_f32 v7, v7, v214
    v_mul_f32 v12, v12, v214
    v_mul_f32 v13, v13, v214
    v_mul_f32 v14, v14, v214
    v_mul_f32 v15, v15, v214
    v_cvt_pk_bf16_f32 v4, v4, v5
    v_cvt_pk_bf16_f32 v5, v6, v7
    v_cvt_pk_bf16_f32 v6, v12, v13
    v_cvt_pk_bf16_f32 v7, v14, v15
    s_add_u32 s76, s73, 0
    buffer_store_dwordx4 v[16:19], v255, s[56:59], s76 offen offset:1024 sc1
    v_mul_f32 v20, v20, v214
    v_mul_f32 v21, v21, v214
    v_mul_f32 v22, v22, v214
    v_mul_f32 v23, v23, v214
    v_mul_f32 v28, v28, v214
    v_mul_f32 v29, v29, v214
    v_mul_f32 v30, v30, v214
    v_mul_f32 v31, v31, v214
    v_cvt_pk_bf16_f32 v20, v20, v21
    v_cvt_pk_bf16_f32 v21, v22, v23
    v_cvt_pk_bf16_f32 v22, v28, v29
    v_cvt_pk_bf16_f32 v23, v30, v31
    s_add_u32 s76, s73, 0
    buffer_store_dwordx4 v[32:35], v255, s[56:59], s76 offen offset:2048 sc1
    v_mul_f32 v36, v36, v214
    v_mul_f32 v37, v37, v214
    v_mul_f32 v38, v38, v214
    v_mul_f32 v39, v39, v214
    v_mul_f32 v44, v44, v214
    v_mul_f32 v45, v45, v214
    v_mul_f32 v46, v46, v214
    v_mul_f32 v47, v47, v214
    v_cvt_pk_bf16_f32 v36, v36, v37
    v_cvt_pk_bf16_f32 v37, v38, v39
    v_cvt_pk_bf16_f32 v38, v44, v45
    v_cvt_pk_bf16_f32 v39, v46, v47
    s_add_u32 s76, s73, 0
    buffer_store_dwordx4 v[48:51], v255, s[56:59], s76 offen offset:3072 sc1
    v_mul_f32 v52, v52, v214
    v_mul_f32 v53, v53, v214
    v_mul_f32 v54, v54, v214
    v_mul_f32 v55, v55, v214
    v_mul_f32 v60, v60, v214
    v_mul_f32 v61, v61, v214
    v_mul_f32 v62, v62, v214
    v_mul_f32 v63, v63, v214
    v_cvt_pk_bf16_f32 v52, v52, v53
    v_cvt_pk_bf16_f32 v53, v54, v55
    v_cvt_pk_bf16_f32 v54, v60, v61
    v_cvt_pk_bf16_f32 v55, v62, v63
    s_add_u32 s76, s73, 147456
    buffer_store_dwordx4 v[4:7], v255, s[56:59], s76 offen offset:0 sc1
    s_lshl_b32 s76, s22, 10
    s_add_u32 s76, s76, 151552
    v_add_u32 v216, s76, v255
    v_add_u32 v217, 159744, v255
    ds_read_b128 v[148:151], v216
    ds_read_b128 v[128:131], v217
    v_mov_b32 v218, 0x358637bd
    s_waitcnt lgkmcnt(0)
    v_mfma_f32_16x16x16_bf16 v[72:75], v[128:129], v[248:249], 0
    v_mfma_f32_16x16x16_bf16 v[76:79], v[130:131], v[248:249], 0
    v_mfma_f32_16x16x16_bf16 v[80:83], v[128:129], v[250:251], 0
    v_mfma_f32_16x16x16_bf16 v[84:87], v[130:131], v[250:251], 0
    v_mfma_f32_16x16x16_bf16 v[88:91], v[128:129], v[148:149], 0
    v_mfma_f32_16x16x16_bf16 v[92:95], v[130:131], v[148:149], 0
    v_mfma_f32_16x16x16_bf16 v[96:99], v[128:129], v[150:151], 0
    v_mfma_f32_16x16x16_bf16 v[100:103], v[130:131], v[150:151], 0
    s_nop 1
    v_cvt_pk_bf16_f32 v219, v72, v73
    v_lshlrev_b32 v72, 16, v219
    v_and_b32 v73, 0xffff0000, v219
    v_cvt_pk_bf16_f32 v219, v74, v75
    v_lshlrev_b32 v74, 16, v219
    v_and_b32 v75, 0xffff0000, v219
    v_cvt_pk_bf16_f32 v76, v76, v76
    v_lshlrev_b32 v76, 16, v76
    v_add_f32 v76, v218, v76
    v_cvt_pk_bf16_f32 v76, v76, v76
    v_lshlrev_b32 v76, 16, v76
    v_rcp_f32 v76, v76
    s_nop 0
    s_add_u32 s76, s73, 147456
    buffer_store_dwordx4 v[20:23], v255, s[56:59], s76 offen offset:1024 sc1
    v_mul_f32 v72, v72, v76
    v_mul_f32 v73, v73, v76
    v_mul_f32 v74, v74, v76
    v_mul_f32 v75, v75, v76
    v_cvt_pk_bf16_f32 v104, v72, v73
    v_cvt_pk_bf16_f32 v105, v74, v75
    s_add_u32 s76, s73, 147456
    buffer_store_dwordx4 v[36:39], v255, s[56:59], s76 offen offset:2048 sc1
    v_cvt_pk_bf16_f32 v219, v80, v81
    v_lshlrev_b32 v80, 16, v219
    v_and_b32 v81, 0xffff0000, v219
    v_cvt_pk_bf16_f32 v219, v82, v83
    v_lshlrev_b32 v82, 16, v219
    v_and_b32 v83, 0xffff0000, v219
    v_cvt_pk_bf16_f32 v84, v84, v84
    v_lshlrev_b32 v84, 16, v84
    v_add_f32 v84, v218, v84
    v_cvt_pk_bf16_f32 v84, v84, v84
    v_lshlrev_b32 v84, 16, v84
    v_rcp_f32 v84, v84
    s_nop 0
    s_add_u32 s76, s73, 147456
    buffer_store_dwordx4 v[52:55], v255, s[56:59], s76 offen offset:3072 sc1
    v_mul_f32 v80, v80, v84
    v_mul_f32 v81, v81, v84
    v_mul_f32 v82, v82, v84
    v_mul_f32 v83, v83, v84
    v_cvt_pk_bf16_f32 v106, v80, v81
    v_cvt_pk_bf16_f32 v107, v82, v83
    v_mov_b32 v214, s16
    v_mov_b32 v215, 1048576
    s_add_u32 s76, s25, s23
    s_lshl_b32 s76, s76, 2
    s_mov_b64 exec, 1
    buffer_store_dword v214, v215, s[60:63], s76 offen sc1
    s_mov_b64 exec, -1
    v_cvt_pk_bf16_f32 v219, v88, v89
    v_lshlrev_b32 v88, 16, v219
    v_and_b32 v89, 0xffff0000, v219
    v_cvt_pk_bf16_f32 v219, v90, v91
    v_lshlrev_b32 v90, 16, v219
    v_and_b32 v91, 0xffff0000, v219
    v_cvt_pk_bf16_f32 v92, v92, v92
    v_lshlrev_b32 v92, 16, v92
    v_add_f32 v92, v218, v92
    v_cvt_pk_bf16_f32 v92, v92, v92
    v_lshlrev_b32 v92, 16, v92
    v_rcp_f32 v92, v92
    s_nop 0
    v_mul_f32 v88, v88, v92
    v_mul_f32 v89, v89, v92
    v_mul_f32 v90, v90, v92
    v_mul_f32 v91, v91, v92
    v_cvt_pk_bf16_f32 v108, v88, v89
    v_cvt_pk_bf16_f32 v109, v90, v91
    v_cvt_pk_bf16_f32 v219, v96, v97
    v_lshlrev_b32 v96, 16, v219
    v_and_b32 v97, 0xffff0000, v219
    v_cvt_pk_bf16_f32 v219, v98, v99
    v_lshlrev_b32 v98, 16, v219
    v_and_b32 v99, 0xffff0000, v219
    v_cvt_pk_bf16_f32 v100, v100, v100
    v_lshlrev_b32 v100, 16, v100
    v_add_f32 v100, v218, v100
    v_cvt_pk_bf16_f32 v100, v100, v100
    v_lshlrev_b32 v100, 16, v100
    v_rcp_f32 v100, v100
    s_nop 0
    v_mul_f32 v96, v96, v100
    v_mul_f32 v97, v97, v100
    v_mul_f32 v98, v98, v100
    v_mul_f32 v99, v99, v100
    v_cvt_pk_bf16_f32 v110, v96, v97
    v_cvt_pk_bf16_f32 v111, v98, v99
    s_lshr_b32 s76, s25, 4
    s_and_b32 s77, s23, 1
    s_add_u32 s76, s76, s77
    s_mul_i32 s76, s76, 147456
    s_lshr_b32 s77, s23, 1
    s_lshl_b32 s77, s77, 10
    s_add_u32 s76, s76, s77
    s_add_u32 s76, s76, 131072
    buffer_store_dwordx4 v[104:107], v255, s[56:59], s76 offen sc1
    s_lshr_b32 s76, s30, 4
    s_and_b32 s77, s23, 1
    s_add_u32 s76, s76, s77
    s_mul_i32 s76, s76, 147456
    s_lshr_b32 s77, s23, 1
    s_lshl_b32 s77, s77, 10
    s_add_u32 s76, s76, s77
    s_add_u32 s76, s76, 131072
    buffer_store_dwordx4 v[108:111], v255, s[56:59], s76 offen sc1
    s_xor_b32 s73, s31, 1
fmain_wset:
    v_lshrrev_b32 v220, 7, v255
    v_lshlrev_b32 v220, 10, v220
    v_bfe_u32 v221, v255, 5, 2
    v_xor_b32 v221, v221, v253
    v_lshl_add_u32 v220, v221, 5, v220
    v_and_b32 v221, 16, v255
    v_add_u32 v224, v221, v220
    v_add_u32 v225, 7168, v224
    v_add_u32 v226, 14336, v224
    v_add_u32 v227, 21504, v224
    s_add_u32 s69, s72, 32768
    s_and_b32 s69, s69, 0x1ffff
    s_setprio 0
    ds_read_b32 v232, v229
    s_waitcnt lgkmcnt(0)
    v_cmp_gt_i32 vcc, s28, v232
    s_cbranch_vccnz Lgated_wp_58
Lgated_wp_58_r:
    s_add_u32 s15, s72, 32768
    s_and_b32 s15, s15, 0x1ffff
    s_add_u32 s72, s72, 32768
    s_add_u32 s28, s28, 2
    s_lshl_b32 s71, s68, 15
    s_add_u32 s75, s71, 32768
    s_add_u32 s68, s68, 2
    s_add_u32 m0, s15, 0
    s_nop 0
    buffer_load_dwordx4 v224, s[40:43], s71 offen offset:0 lds
    s_sleep 2
    buffer_load_dwordx4 v225, s[40:43], s71 offen offset:1024 lds
    s_sleep 2
    buffer_load_dwordx4 v226, s[40:43], s71 offen offset:2048 lds
    s_sleep 2
    buffer_load_dwordx4 v227, s[40:43], s71 offen offset:3072 lds
    s_sleep 2
    s_add_u32 m0, s15, 4096
    s_nop 0
    buffer_load_dwordx4 v224, s[40:43], s75 offen offset:0 lds
    s_sleep 2
    buffer_load_dwordx4 v225, s[40:43], s75 offen offset:1024 lds
    s_sleep 2
    buffer_load_dwordx4 v226, s[40:43], s75 offen offset:2048 lds
    s_sleep 2
    buffer_load_dwordx4 v227, s[40:43], s75 offen offset:3072 lds
    s_cmp_eq_u32 s73, 0
    s_cbranch_scc1 fmain_tl
    s_waitcnt vmcnt(8)
    s_lshl_b32 s76, s24, 11
    s_lshl_b32 s77, s22, 8
    s_add_u32 s76, s76, s77
    s_lshl_b32 s77, s23, 3
    s_add_u32 s76, s76, s77
    s_add_u32 s76, s76, 65536
    s_mov_b64 exec, 1
    buffer_store_dwordx2 v[192:193], v255, s[64:67], s76 offen offset:0 sc1
    s_mov_b64 exec, -1
fmain_tl:
    s_cmp_ge_u32 s68, 8
    s_cbranch_scc1 fmain_tl_done
    ds_read_b32 v232, v229
    s_waitcnt lgkmcnt(0)
    v_cmp_gt_i32 vcc, s28, v232
    s_cbranch_vccnz Lgated_wp_59
Lgated_wp_59_r:
    s_add_u32 s15, s72, 32768
    s_and_b32 s15, s15, 0x1ffff
    s_add_u32 s72, s72, 32768
    s_add_u32 s28, s28, 2
    s_lshl_b32 s71, s68, 15
    s_add_u32 s75, s71, 32768
    s_add_u32 s68, s68, 2
    v_cmp_gt_i32 vcc, 0x8000, v232
    s_cbranch_vccz fmain_tl_fast
    s_add_u32 m0, s15, 0
    s_nop 0
    buffer_load_dwordx4 v224, s[40:43], s71 offen offset:0 lds
    s_sleep 2
    buffer_load_dwordx4 v225, s[40:43], s71 offen offset:1024 lds
    s_sleep 2
    buffer_load_dwordx4 v226, s[40:43], s71 offen offset:2048 lds
    s_sleep 2
    buffer_load_dwordx4 v227, s[40:43], s71 offen offset:3072 lds
    s_sleep 2
    s_add_u32 m0, s15, 4096
    s_nop 0
    buffer_load_dwordx4 v224, s[40:43], s75 offen offset:0 lds
    s_sleep 2
    buffer_load_dwordx4 v225, s[40:43], s75 offen offset:1024 lds
    s_sleep 2
    buffer_load_dwordx4 v226, s[40:43], s75 offen offset:2048 lds
    s_sleep 2
    buffer_load_dwordx4 v227, s[40:43], s75 offen offset:3072 lds
    s_branch fmain_tl
fmain_tl_fast:
    s_add_u32 m0, s15, 0
    s_nop 0
    buffer_load_dwordx4 v224, s[40:43], s71 offen offset:0 lds
    buffer_load_dwordx4 v225, s[40:43], s71 offen offset:1024 lds
    buffer_load_dwordx4 v226, s[40:43], s71 offen offset:2048 lds
    buffer_load_dwordx4 v227, s[40:43], s71 offen offset:3072 lds
    s_add_u32 m0, s15, 4096
    s_nop 0
    buffer_load_dwordx4 v224, s[40:43], s75 offen offset:0 lds
    buffer_load_dwordx4 v225, s[40:43], s75 offen offset:1024 lds
    buffer_load_dwordx4 v226, s[40:43], s75 offen offset:2048 lds
    buffer_load_dwordx4 v227, s[40:43], s75 offen offset:3072 lds
    s_branch fmain_tl
Lgated_wp_42:
    s_mov_b32 s79, 0
Lgated_wp_42_l:
    s_sleep 2
    ds_read_b32 v232, v229
    s_add_u32 s79, s79, 1
    s_cmp_ge_u32 s79, 67108864
    s_cbranch_scc1 Lgated_wp_42_x
    s_waitcnt lgkmcnt(0)
    v_cmp_gt_i32 vcc, s28, v232
    s_cbranch_vccnz Lgated_wp_42_l
Lgated_wp_42_x:
    s_waitcnt lgkmcnt(0)
    s_branch Lgated_wp_42_r
Lgated_wp_43:
    s_mov_b32 s79, 0
Lgated_wp_43_l:
    s_sleep 2
    ds_read_b32 v232, v229
    s_add_u32 s79, s79, 1
    s_cmp_ge_u32 s79, 67108864
    s_cbranch_scc1 Lgated_wp_43_x
    s_waitcnt lgkmcnt(0)
    v_cmp_gt_i32 vcc, s28, v232
    s_cbranch_vccnz Lgated_wp_43_l
Lgated_wp_43_x:
    s_waitcnt lgkmcnt(0)
    s_branch Lgated_wp_43_r
Lgated_wp_44:
    s_mov_b32 s79, 0
Lgated_wp_44_l:
    s_sleep 2
    ds_read_b32 v232, v229
    s_add_u32 s79, s79, 1
    s_cmp_ge_u32 s79, 67108864
    s_cbranch_scc1 Lgated_wp_44_x
    s_waitcnt lgkmcnt(0)
    v_cmp_gt_i32 vcc, s28, v232
    s_cbranch_vccnz Lgated_wp_44_l
Lgated_wp_44_x:
    s_waitcnt lgkmcnt(0)
    s_branch Lgated_wp_44_r
Lgated_wp_45:
    s_mov_b32 s79, 0
Lgated_wp_45_l:
    s_sleep 2
    ds_read_b32 v232, v229
    s_add_u32 s79, s79, 1
    s_cmp_ge_u32 s79, 67108864
    s_cbranch_scc1 Lgated_wp_45_x
    s_waitcnt lgkmcnt(0)
    v_cmp_gt_i32 vcc, s28, v232
    s_cbranch_vccnz Lgated_wp_45_l
Lgated_wp_45_x:
    s_waitcnt lgkmcnt(0)
    s_branch Lgated_wp_45_r
Lgated_wp_46:
    s_mov_b32 s79, 0
Lgated_wp_46_l:
    s_sleep 2
    ds_read_b32 v232, v229
    s_add_u32 s79, s79, 1
    s_cmp_ge_u32 s79, 67108864
    s_cbranch_scc1 Lgated_wp_46_x
    s_waitcnt lgkmcnt(0)
    v_cmp_gt_i32 vcc, s28, v232
    s_cbranch_vccnz Lgated_wp_46_l
Lgated_wp_46_x:
    s_waitcnt lgkmcnt(0)
    s_branch Lgated_wp_46_r
Lgated_wp_47:
    s_mov_b32 s79, 0
Lgated_wp_47_l:
    s_sleep 2
    ds_read_b32 v232, v229
    s_add_u32 s79, s79, 1
    s_cmp_ge_u32 s79, 67108864
    s_cbranch_scc1 Lgated_wp_47_x
    s_waitcnt lgkmcnt(0)
    v_cmp_gt_i32 vcc, s28, v232
    s_cbranch_vccnz Lgated_wp_47_l
Lgated_wp_47_x:
    s_waitcnt lgkmcnt(0)
    s_branch Lgated_wp_47_r
Lgated_wp_48:
    s_mov_b32 s79, 0
Lgated_wp_48_l:
    s_sleep 2
    ds_read_b32 v232, v229
    s_add_u32 s79, s79, 1
    s_cmp_ge_u32 s79, 67108864
    s_cbranch_scc1 Lgated_wp_48_x
    s_waitcnt lgkmcnt(0)
    v_cmp_gt_i32 vcc, s28, v232
    s_cbranch_vccnz Lgated_wp_48_l
Lgated_wp_48_x:
    s_waitcnt lgkmcnt(0)
    s_branch Lgated_wp_48_r
Lgated_wp_49:
    s_mov_b32 s79, 0
Lgated_wp_49_l:
    s_sleep 2
    ds_read_b32 v232, v229
    s_add_u32 s79, s79, 1
    s_cmp_ge_u32 s79, 67108864
    s_cbranch_scc1 Lgated_wp_49_x
    s_waitcnt lgkmcnt(0)
    v_cmp_gt_i32 vcc, s28, v232
    s_cbranch_vccnz Lgated_wp_49_l
Lgated_wp_49_x:
    s_waitcnt lgkmcnt(0)
    s_branch Lgated_wp_49_r
Lgated_wp_50:
    s_mov_b32 s79, 0
Lgated_wp_50_l:
    s_sleep 2
    ds_read_b32 v232, v229
    s_add_u32 s79, s79, 1
    s_cmp_ge_u32 s79, 67108864
    s_cbranch_scc1 Lgated_wp_50_x
    s_waitcnt lgkmcnt(0)
    v_cmp_gt_i32 vcc, s28, v232
    s_cbranch_vccnz Lgated_wp_50_l
Lgated_wp_50_x:
    s_waitcnt lgkmcnt(0)
    s_branch Lgated_wp_50_r
Lgated_wp_51:
    s_mov_b32 s79, 0
Lgated_wp_51_l:
    s_sleep 2
    ds_read_b32 v232, v229
    s_add_u32 s79, s79, 1
    s_cmp_ge_u32 s79, 67108864
    s_cbranch_scc1 Lgated_wp_51_x
    s_waitcnt lgkmcnt(0)
    v_cmp_gt_i32 vcc, s28, v232
    s_cbranch_vccnz Lgated_wp_51_l
Lgated_wp_51_x:
    s_waitcnt lgkmcnt(0)
    s_branch Lgated_wp_51_r
Lgated_wp_52:
    s_mov_b32 s79, 0
Lgated_wp_52_l:
    s_sleep 2
    ds_read_b32 v232, v229
    s_add_u32 s79, s79, 1
    s_cmp_ge_u32 s79, 67108864
    s_cbranch_scc1 Lgated_wp_52_x
    s_waitcnt lgkmcnt(0)
    v_cmp_gt_i32 vcc, s28, v232
    s_cbranch_vccnz Lgated_wp_52_l
Lgated_wp_52_x:
    s_waitcnt lgkmcnt(0)
    s_branch Lgated_wp_52_r
Lgated_wp_53:
    s_mov_b32 s79, 0
Lgated_wp_53_l:
    s_sleep 2
    ds_read_b32 v232, v229
    s_add_u32 s79, s79, 1
    s_cmp_ge_u32 s79, 67108864
    s_cbranch_scc1 Lgated_wp_53_x
    s_waitcnt lgkmcnt(0)
    v_cmp_gt_i32 vcc, s28, v232
    s_cbranch_vccnz Lgated_wp_53_l
Lgated_wp_53_x:
    s_waitcnt lgkmcnt(0)
    s_branch Lgated_wp_53_r
Lgated_wp_54:
    s_mov_b32 s79, 0
Lgated_wp_54_l:
    s_sleep 2
    ds_read_b32 v232, v229
    s_add_u32 s79, s79, 1
    s_cmp_ge_u32 s79, 67108864
    s_cbranch_scc1 Lgated_wp_54_x
    s_waitcnt lgkmcnt(0)
    v_cmp_gt_i32 vcc, s28, v232
    s_cbranch_vccnz Lgated_wp_54_l
Lgated_wp_54_x:
    s_waitcnt lgkmcnt(0)
    s_branch Lgated_wp_54_r
Lgated_wp_55:
    s_mov_b32 s79, 0
Lgated_wp_55_l:
    s_sleep 2
    ds_read_b32 v232, v229
    s_add_u32 s79, s79, 1
    s_cmp_ge_u32 s79, 67108864
    s_cbranch_scc1 Lgated_wp_55_x
    s_waitcnt lgkmcnt(0)
    v_cmp_gt_i32 vcc, s28, v232
    s_cbranch_vccnz Lgated_wp_55_l
Lgated_wp_55_x:
    s_waitcnt lgkmcnt(0)
    s_branch Lgated_wp_55_r
Lgated_wp_56:
    s_mov_b32 s79, 0
Lgated_wp_56_l:
    s_sleep 2
    ds_read_b32 v232, v229
    s_add_u32 s79, s79, 1
    s_cmp_ge_u32 s79, 67108864
    s_cbranch_scc1 Lgated_wp_56_x
    s_waitcnt lgkmcnt(0)
    v_cmp_gt_i32 vcc, s28, v232
    s_cbranch_vccnz Lgated_wp_56_l
Lgated_wp_56_x:
    s_waitcnt lgkmcnt(0)
    s_branch Lgated_wp_56_r
Lgated_wp_57:
    s_mov_b32 s79, 0
Lgated_wp_57_l:
    s_sleep 2
    ds_read_b32 v232, v229
    s_add_u32 s79, s79, 1
    s_cmp_ge_u32 s79, 67108864
    s_cbranch_scc1 Lgated_wp_57_x
    s_waitcnt lgkmcnt(0)
    v_cmp_gt_i32 vcc, s28, v232
    s_cbranch_vccnz Lgated_wp_57_l
Lgated_wp_57_x:
    s_waitcnt lgkmcnt(0)
    s_branch Lgated_wp_57_r
Lgated_wp_58:
    s_mov_b32 s79, 0
Lgated_wp_58_l:
    s_sleep 2
    ds_read_b32 v232, v229
    s_add_u32 s79, s79, 1
    s_cmp_ge_u32 s79, 67108864
    s_cbranch_scc1 Lgated_wp_58_x
    s_waitcnt lgkmcnt(0)
    v_cmp_gt_i32 vcc, s28, v232
    s_cbranch_vccnz Lgated_wp_58_l
Lgated_wp_58_x:
    s_waitcnt lgkmcnt(0)
    s_branch Lgated_wp_58_r
Lgated_wp_59:
    s_mov_b32 s79, 0
Lgated_wp_59_l:
    s_sleep 2
    ds_read_b32 v232, v229
    s_add_u32 s79, s79, 1
    s_cmp_ge_u32 s79, 67108864
    s_cbranch_scc1 Lgated_wp_59_x
    s_waitcnt lgkmcnt(0)
    v_cmp_gt_i32 vcc, s28, v232
    s_cbranch_vccnz Lgated_wp_59_l
Lgated_wp_59_x:
    s_waitcnt lgkmcnt(0)
    s_branch Lgated_wp_59_r
fmain_slow:
    s_waitcnt vmcnt(0) lgkmcnt(0)
    v_pk_mov_b32 v[0:1], 0, 0
    v_pk_mov_b32 v[2:3], 0, 0
    v_pk_mov_b32 v[4:5], 0, 0
    v_pk_mov_b32 v[6:7], 0, 0
    v_pk_mov_b32 v[8:9], 0, 0
    v_pk_mov_b32 v[10:11], 0, 0
    v_pk_mov_b32 v[12:13], 0, 0
    v_pk_mov_b32 v[14:15], 0, 0
    v_pk_mov_b32 v[16:17], 0, 0
    v_pk_mov_b32 v[18:19], 0, 0
    v_pk_mov_b32 v[20:21], 0, 0
    v_pk_mov_b32 v[22:23], 0, 0
    v_pk_mov_b32 v[24:25], 0, 0
    v_pk_mov_b32 v[26:27], 0, 0
    v_pk_mov_b32 v[28:29], 0, 0
    v_pk_mov_b32 v[30:31], 0, 0
    v_pk_mov_b32 v[32:33], 0, 0
    v_pk_mov_b32 v[34:35], 0, 0
    v_pk_mov_b32 v[36:37], 0, 0
    v_pk_mov_b32 v[38:39], 0, 0
    v_pk_mov_b32 v[40:41], 0, 0
    v_pk_mov_b32 v[42:43], 0, 0
    v_pk_mov_b32 v[44:45], 0, 0
    v_pk_mov_b32 v[46:47], 0, 0
    v_pk_mov_b32 v[48:49], 0, 0
    v_pk_mov_b32 v[50:51], 0, 0
    v_pk_mov_b32 v[52:53], 0, 0
    v_pk_mov_b32 v[54:55], 0, 0
    v_pk_mov_b32 v[56:57], 0, 0
    v_pk_mov_b32 v[58:59], 0, 0
    v_pk_mov_b32 v[60:61], 0, 0
    v_pk_mov_b32 v[62:63], 0, 0
    v_pk_mov_b32 v[236:237], 0, 0
    v_pk_mov_b32 v[238:239], 0, 0
    v_pk_mov_b32 v[240:241], 0, 0
    v_pk_mov_b32 v[242:243], 0, 0
    v_mov_b32 v204, 0xff800000
    v_mov_b32 v208, 0xff800000
    s_mov_b32 s28, 0
fmain_slow_loop:
    s_lshl_b32 s76, s28, 14
    s_add_u32 s77, s76, 4096
    buffer_load_dwordx4 v[128:131], v255, s[48:51], s76 offen offset:0 sc1
    buffer_load_dwordx4 v[132:135], v255, s[48:51], s76 offen offset:1024 sc1
    buffer_load_dwordx4 v[136:139], v255, s[48:51], s77 offen offset:0 sc1
    buffer_load_dwordx4 v[140:143], v255, s[48:51], s77 offen offset:1024 sc1
    buffer_load_dwordx4 v[144:147], v255, s[48:51], s76 offen offset:2048 sc1
    buffer_load_dwordx4 v[148:151], v255, s[48:51], s76 offen offset:3072 sc1
    buffer_load_dwordx4 v[152:155], v255, s[48:51], s77 offen offset:2048 sc1
    buffer_load_dwordx4 v[156:159], v255, s[48:51], s77 offen offset:3072 sc1
    s_waitcnt vmcnt(0)
    v_mfma_f32_16x16x32_bf16 v[64:67], v[128:131], v[160:163], 0
    v_mfma_f32_16x16x32_bf16 v[68:71], v[128:131], v[176:179], 0
    v_mfma_f32_16x16x32_bf16 v[64:67], v[132:135], v[164:167], v[64:67]
    v_mfma_f32_16x16x32_bf16 v[68:71], v[132:135], v[180:183], v[68:71]
    v_mfma_f32_16x16x32_bf16 v[64:67], v[136:139], v[168:171], v[64:67]
    v_mfma_f32_16x16x32_bf16 v[68:71], v[136:139], v[184:187], v[68:71]
    v_mfma_f32_16x16x32_bf16 v[64:67], v[140:143], v[172:175], v[64:67]
    v_mfma_f32_16x16x32_bf16 v[68:71], v[140:143], v[188:191], v[68:71]
    v_mfma_f32_16x16x32_bf16 v[72:75], v[144:147], v[160:163], 0
    v_mfma_f32_16x16x32_bf16 v[76:79], v[144:147], v[176:179], 0
    v_mfma_f32_16x16x32_bf16 v[72:75], v[148:151], v[164:167], v[72:75]
    v_mfma_f32_16x16x32_bf16 v[76:79], v[148:151], v[180:183], v[76:79]
    v_mfma_f32_16x16x32_bf16 v[72:75], v[152:155], v[168:171], v[72:75]
    v_mfma_f32_16x16x32_bf16 v[76:79], v[152:155], v[184:187], v[76:79]
    v_mfma_f32_16x16x32_bf16 v[72:75], v[156:159], v[172:175], v[72:75]
    v_mfma_f32_16x16x32_bf16 v[76:79], v[156:159], v[188:191], v[76:79]
    s_add_u32 s76, s76, 8192
    s_add_u32 s77, s76, 4096
    buffer_load_dwordx4 v[128:131], v255, s[48:51], s76 offen offset:0 sc1
    buffer_load_dwordx4 v[132:135], v255, s[48:51], s76 offen offset:1024 sc1
    buffer_load_dwordx4 v[136:139], v255, s[48:51], s76 offen offset:2048 sc1
    buffer_load_dwordx4 v[140:143], v255, s[48:51], s76 offen offset:3072 sc1
    buffer_load_dwordx4 v[144:147], v255, s[48:51], s77 offen offset:0 sc1
    buffer_load_dwordx4 v[148:151], v255, s[48:51], s77 offen offset:1024 sc1
    buffer_load_dwordx4 v[152:155], v255, s[48:51], s77 offen offset:2048 sc1
    buffer_load_dwordx4 v[156:159], v255, s[48:51], s77 offen offset:3072 sc1
    s_cmp_lg_u32 s28, s26
    s_cbranch_scc1 fmain_slow_nomask
    v_mov_b32 v214, 0xff800000
    v_mov_b32 v72, 0xff800000
    v_mov_b32 v73, 0xff800000
    v_mov_b32 v74, 0xff800000
    v_mov_b32 v75, 0xff800000
    v_cndmask_b32 v64, v214, v64, s[80:81]
    v_cndmask_b32 v65, v214, v65, s[82:83]
    v_cndmask_b32 v66, v214, v66, s[84:85]
    v_cndmask_b32 v67, v214, v67, s[86:87]
    v_cndmask_b32 v76, v214, v76, s[80:81]
    v_cndmask_b32 v77, v214, v77, s[82:83]
    v_cndmask_b32 v78, v214, v78, s[84:85]
    v_cndmask_b32 v79, v214, v79, s[86:87]
fmain_slow_nomask:
    v_max3_f32 v215, v64, v65, v66
    v_max3_f32 v215, v215, v67, v72
    v_max3_f32 v215, v215, v73, v74
    v_max_f32 v215, v215, v75
    v_mov_b32 v217, v215
    s_nop 1
    v_permlane16_swap_b32 v215, v217
    s_nop 1
    v_max_f32 v215, v215, v217
    v_mov_b32 v217, v215
    s_nop 1
    v_permlane32_swap_b32 v215, v217
    s_nop 1
    v_max_f32 v215, v215, v217
    v_max_f32 v215, v215, v204
    v_sub_f32 v216, v204, v215
    v_mov_b32 v204, v215
    v_exp_f32 v216, v216
    v_sub_f32 v64, v64, v215
    v_sub_f32 v65, v65, v215
    v_sub_f32 v66, v66, v215
    v_sub_f32 v67, v67, v215
    v_sub_f32 v72, v72, v215
    v_sub_f32 v73, v73, v215
    v_sub_f32 v74, v74, v215
    v_sub_f32 v75, v75, v215
    v_mul_f32 v236, v236, v216
    v_mul_f32 v237, v237, v216
    v_mul_f32 v238, v238, v216
    v_mul_f32 v239, v239, v216
    v_mul_f32 v0, v0, v216
    v_mul_f32 v1, v1, v216
    v_mul_f32 v2, v2, v216
    v_mul_f32 v3, v3, v216
    v_mul_f32 v8, v8, v216
    v_mul_f32 v9, v9, v216
    v_mul_f32 v10, v10, v216
    v_mul_f32 v11, v11, v216
    v_mul_f32 v16, v16, v216
    v_mul_f32 v17, v17, v216
    v_mul_f32 v18, v18, v216
    v_mul_f32 v19, v19, v216
    v_mul_f32 v24, v24, v216
    v_mul_f32 v25, v25, v216
    v_mul_f32 v26, v26, v216
    v_mul_f32 v27, v27, v216
    v_mul_f32 v32, v32, v216
    v_mul_f32 v33, v33, v216
    v_mul_f32 v34, v34, v216
    v_mul_f32 v35, v35, v216
    v_mul_f32 v40, v40, v216
    v_mul_f32 v41, v41, v216
    v_mul_f32 v42, v42, v216
    v_mul_f32 v43, v43, v216
    v_mul_f32 v48, v48, v216
    v_mul_f32 v49, v49, v216
    v_mul_f32 v50, v50, v216
    v_mul_f32 v51, v51, v216
    v_mul_f32 v56, v56, v216
    v_mul_f32 v57, v57, v216
    v_mul_f32 v58, v58, v216
    v_mul_f32 v59, v59, v216
    v_max3_f32 v215, v68, v69, v70
    v_max3_f32 v215, v215, v71, v76
    v_max3_f32 v215, v215, v77, v78
    v_max_f32 v215, v215, v79
    v_mov_b32 v217, v215
    s_nop 1
    v_permlane16_swap_b32 v215, v217
    s_nop 1
    v_max_f32 v215, v215, v217
    v_mov_b32 v217, v215
    s_nop 1
    v_permlane32_swap_b32 v215, v217
    s_nop 1
    v_max_f32 v215, v215, v217
    v_max_f32 v215, v215, v208
    v_sub_f32 v216, v208, v215
    v_mov_b32 v208, v215
    v_exp_f32 v216, v216
    v_sub_f32 v68, v68, v215
    v_sub_f32 v69, v69, v215
    v_sub_f32 v70, v70, v215
    v_sub_f32 v71, v71, v215
    v_sub_f32 v76, v76, v215
    v_sub_f32 v77, v77, v215
    v_sub_f32 v78, v78, v215
    v_sub_f32 v79, v79, v215
    v_mul_f32 v240, v240, v216
    v_mul_f32 v241, v241, v216
    v_mul_f32 v242, v242, v216
    v_mul_f32 v243, v243, v216
    v_mul_f32 v4, v4, v216
    v_mul_f32 v5, v5, v216
    v_mul_f32 v6, v6, v216
    v_mul_f32 v7, v7, v216
    v_mul_f32 v12, v12, v216
    v_mul_f32 v13, v13, v216
    v_mul_f32 v14, v14, v216
    v_mul_f32 v15, v15, v216
    v_mul_f32 v20, v20, v216
    v_mul_f32 v21, v21, v216
    v_mul_f32 v22, v22, v216
    v_mul_f32 v23, v23, v216
    v_mul_f32 v28, v28, v216
    v_mul_f32 v29, v29, v216
    v_mul_f32 v30, v30, v216
    v_mul_f32 v31, v31, v216
    v_mul_f32 v36, v36, v216
    v_mul_f32 v37, v37, v216
    v_mul_f32 v38, v38, v216
    v_mul_f32 v39, v39, v216
    v_mul_f32 v44, v44, v216
    v_mul_f32 v45, v45, v216
    v_mul_f32 v46, v46, v216
    v_mul_f32 v47, v47, v216
    v_mul_f32 v52, v52, v216
    v_mul_f32 v53, v53, v216
    v_mul_f32 v54, v54, v216
    v_mul_f32 v55, v55, v216
    v_mul_f32 v60, v60, v216
    v_mul_f32 v61, v61, v216
    v_mul_f32 v62, v62, v216
    v_mul_f32 v63, v63, v216
    v_exp_f32 v64, v64
    v_exp_f32 v65, v65
    v_exp_f32 v66, v66
    v_cvt_pk_bf16_f32 v64, v64, v65
    v_exp_f32 v67, v67
    v_exp_f32 v68, v68
    v_cvt_pk_bf16_f32 v65, v66, v67
    v_exp_f32 v69, v69
    v_exp_f32 v70, v70
    v_cvt_pk_bf16_f32 v68, v68, v69
    v_exp_f32 v71, v71
    v_exp_f32 v72, v72
    v_cvt_pk_bf16_f32 v69, v70, v71
    v_exp_f32 v73, v73
    v_exp_f32 v74, v74
    v_cvt_pk_bf16_f32 v66, v72, v73
    v_exp_f32 v75, v75
    v_exp_f32 v76, v76
    v_cvt_pk_bf16_f32 v67, v74, v75
    v_exp_f32 v77, v77
    v_exp_f32 v78, v78
    v_cvt_pk_bf16_f32 v70, v76, v77
    v_exp_f32 v79, v79
    s_nop 0
    v_cvt_pk_bf16_f32 v71, v78, v79
    s_waitcnt vmcnt(0)
    s_nop 1
    v_mfma_f32_16x16x32_bf16 v[236:239], v[244:247], v[64:67], v[236:239]
    v_mfma_f32_16x16x32_bf16 v[240:243], v[244:247], v[68:71], v[240:243]
    v_mfma_f32_16x16x32_bf16 v[0:3], v[128:131], v[64:67], v[0:3]
    v_mfma_f32_16x16x32_bf16 v[4:7], v[128:131], v[68:71], v[4:7]
    v_mfma_f32_16x16x32_bf16 v[8:11], v[132:135], v[64:67], v[8:11]
    v_mfma_f32_16x16x32_bf16 v[12:15], v[132:135], v[68:71], v[12:15]
    v_mfma_f32_16x16x32_bf16 v[16:19], v[136:139], v[64:67], v[16:19]
    v_mfma_f32_16x16x32_bf16 v[20:23], v[136:139], v[68:71], v[20:23]
    v_mfma_f32_16x16x32_bf16 v[24:27], v[140:143], v[64:67], v[24:27]
    v_mfma_f32_16x16x32_bf16 v[28:31], v[140:143], v[68:71], v[28:31]
    v_mfma_f32_16x16x32_bf16 v[32:35], v[144:147], v[64:67], v[32:35]
    v_mfma_f32_16x16x32_bf16 v[36:39], v[144:147], v[68:71], v[36:39]
    v_mfma_f32_16x16x32_bf16 v[40:43], v[148:151], v[64:67], v[40:43]
    v_mfma_f32_16x16x32_bf16 v[44:47], v[148:151], v[68:71], v[44:47]
    v_mfma_f32_16x16x32_bf16 v[48:51], v[152:155], v[64:67], v[48:51]
    v_mfma_f32_16x16x32_bf16 v[52:55], v[152:155], v[68:71], v[52:55]
    v_mfma_f32_16x16x32_bf16 v[56:59], v[156:159], v[64:67], v[56:59]
    v_mfma_f32_16x16x32_bf16 v[60:63], v[156:159], v[68:71], v[60:63]
    s_add_u32 s28, s28, 1
    s_cmp_le_u32 s28, s26
    s_cbranch_scc1 fmain_slow_loop
    s_nop 7
    s_branch fmain_epi2
fmain_tl_done:
    s_cmp_eq_u32 s31, 1
    s_cbranch_scc1 fmain_slow
fmain_p4:
    v_lshrrev_b32 v0, 4, v255
    s_lshl_b32 s76, s14, 1
    s_sub_u32 s77, 6, s76
    s_cmp_lt_u32 s14, 2
    s_cselect_b32 s76, s76, s77
    s_cselect_b32 s77, 0, 1024
    s_lshl_b32 s76, s76, 8
    s_lshl_b32 s78, s24, 11
    s_add_u32 s76, s76, s78
    s_lshl_b32 s78, s22, 6
    s_add_u32 s76, s76, s78
    s_add_u32 s26, s76, 65536
    v_bfe_u32 v3, v0, 3, 1
    v_lshl_add_u32 v236, v3, 8, v195
    v_bfe_u32 v3, v0, 4, 1
    v_mul_lo_u32 v3, v3, s77
    v_add_u32 v236, v236, v3
    buffer_load_dwordx2 v[238:239], v236, s[64:67], s26 offen sc1
    v_mov_b32 v240, v224
    v_mov_b32 v241, v225
    v_mov_b32 v242, v226
    v_mov_b32 v243, v227
    s_lshl_b32 s76, s17, 7
    s_lshl_b32 s77, s22, 17
    s_add_u32 s77, s77, s76
    s_sub_u32 s78, 524288, s77
    s_add_u32 s36, s10, s77
    s_addc_u32 s37, s11, 0
    s_mov_b32 s38, s78
    s_mov_b32 s39, 0x20000
    v_lshrrev_b32 v2, 2, v252
    v_lshl_add_u32 v2, v253, 2, v2
    v_bfe_u32 v3, v2, 1, 2
    v_lshlrev_b32 v2, 7, v2
    v_lshl_add_u32 v2, v3, 5, v2
    v_and_b32 v3, 3, v252
    v_lshl_add_u32 v2, v3, 3, v2
    v_xor_b32 v224, 0, v2
    v_xor_b32 v225, 32, v2
    v_xor_b32 v226, 64, v2
    v_xor_b32 v227, 96, v2
    s_mul_i32 s76, s3, 589824
    s_add_u32 s76, s76, 33554432
    s_add_u32 s32, s20, s76
    s_addc_u32 s33, s21, 0
    s_mov_b32 s34, 589824
    s_mov_b32 s35, 0x20000
    s_mov_b32 s44, s12
    s_mov_b32 s45, s13
    s_mov_b32 s46, 2097152
    s_mov_b32 s47, 0x20000
    s_lshl_b32 s28, s22, 15
    s_lshl_b32 s27, s22, 12
    s_add_u32 s27, s27, 131072
    s_waitcnt vmcnt(9)
    s_add_u32 s72, s69, 0
    s_and_b32 s72, s72, 0x1ffff
    v_add_u32 v244, s72, v224
    v_add_u32 v245, s72, v225
    v_add_u32 v246, s72, v226
    v_add_u32 v247, s72, v227
    ds_read_b64_tr_b16 v[0:1], v244 offset:0
    ds_read_b64_tr_b16 v[2:3], v244 offset:2048
    ds_read_b64_tr_b16 v[4:5], v245 offset:0
    ds_read_b64_tr_b16 v[6:7], v245 offset:2048
    ds_read_b64_tr_b16 v[8:9], v246 offset:0
    ds_read_b64_tr_b16 v[10:11], v246 offset:2048
    ds_read_b64_tr_b16 v[12:13], v247 offset:0
    ds_read_b64_tr_b16 v[14:15], v247 offset:2048
    s_waitcnt lgkmcnt(0)
    s_add_u32 s71, s69, 0
    s_and_b32 s71, s71, 0x1ffff
    s_add_u32 m0, s71, 0
    s_mov_b32 s76, 262144
    buffer_load_dwordx4 v240, s[40:43], s76 offen offset:0 lds
    buffer_load_dwordx4 v241, s[40:43], s76 offen offset:1024 lds
    buffer_load_dwordx4 v242, s[40:43], s76 offen offset:2048 lds
    buffer_load_dwordx4 v243, s[40:43], s76 offen offset:3072 lds
    ds_read_b64_tr_b16 v[16:17], v244 offset:4096
    ds_read_b64_tr_b16 v[18:19], v244 offset:6144
    ds_read_b64_tr_b16 v[20:21], v245 offset:4096
    ds_read_b64_tr_b16 v[22:23], v245 offset:6144
    ds_read_b64_tr_b16 v[24:25], v246 offset:4096
    ds_read_b64_tr_b16 v[26:27], v246 offset:6144
    ds_read_b64_tr_b16 v[28:29], v247 offset:4096
    ds_read_b64_tr_b16 v[30:31], v247 offset:6144
    s_waitcnt lgkmcnt(0)
    s_add_u32 s71, s69, 0
    s_and_b32 s71, s71, 0x1ffff
    s_add_u32 m0, s71, 4096
    s_mov_b32 s76, 294912
    buffer_load_dwordx4 v240, s[40:43], s76 offen offset:0 lds
    buffer_load_dwordx4 v241, s[40:43], s76 offen offset:1024 lds
    buffer_load_dwordx4 v242, s[40:43], s76 offen offset:2048 lds
    buffer_load_dwordx4 v243, s[40:43], s76 offen offset:3072 lds
    s_add_u32 s72, s69, 32768
    s_and_b32 s72, s72, 0x1ffff
    v_add_u32 v244, s72, v224
    v_add_u32 v245, s72, v225
    v_add_u32 v246, s72, v226
    v_add_u32 v247, s72, v227
    ds_read_b64_tr_b16 v[32:33], v244 offset:0
    ds_read_b64_tr_b16 v[34:35], v244 offset:2048
    ds_read_b64_tr_b16 v[36:37], v245 offset:0
    ds_read_b64_tr_b16 v[38:39], v245 offset:2048
    ds_read_b64_tr_b16 v[40:41], v246 offset:0
    ds_read_b64_tr_b16 v[42:43], v246 offset:2048
    ds_read_b64_tr_b16 v[44:45], v247 offset:0
    ds_read_b64_tr_b16 v[46:47], v247 offset:2048
    s_waitcnt lgkmcnt(0)
    s_add_u32 s71, s69, 32768
    s_and_b32 s71, s71, 0x1ffff
    s_add_u32 m0, s71, 0
    s_mov_b32 s76, 327680
    buffer_load_dwordx4 v240, s[40:43], s76 offen offset:0 lds
    buffer_load_dwordx4 v241, s[40:43], s76 offen offset:1024 lds
    buffer_load_dwordx4 v242, s[40:43], s76 offen offset:2048 lds
    buffer_load_dwordx4 v243, s[40:43], s76 offen offset:3072 lds
    ds_read_b64_tr_b16 v[48:49], v244 offset:4096
    ds_read_b64_tr_b16 v[50:51], v244 offset:6144
    ds_read_b64_tr_b16 v[52:53], v245 offset:4096
    ds_read_b64_tr_b16 v[54:55], v245 offset:6144
    ds_read_b64_tr_b16 v[56:57], v246 offset:4096
    ds_read_b64_tr_b16 v[58:59], v246 offset:6144
    ds_read_b64_tr_b16 v[60:61], v247 offset:4096
    ds_read_b64_tr_b16 v[62:63], v247 offset:6144
    s_waitcnt lgkmcnt(0)
    s_add_u32 s71, s69, 32768
    s_and_b32 s71, s71, 0x1ffff
    s_add_u32 m0, s71, 4096
    s_mov_b32 s76, 360448
    buffer_load_dwordx4 v240, s[40:43], s76 offen offset:0 lds
    buffer_load_dwordx4 v241, s[40:43], s76 offen offset:1024 lds
    buffer_load_dwordx4 v242, s[40:43], s76 offen offset:2048 lds
    buffer_load_dwordx4 v243, s[40:43], s76 offen offset:3072 lds
    s_add_u32 s72, s69, 65536
    s_and_b32 s72, s72, 0x1ffff
    v_add_u32 v244, s72, v224
    v_add_u32 v245, s72, v225
    v_add_u32 v246, s72, v226
    v_add_u32 v247, s72, v227
    ds_read_b64_tr_b16 v[128:129], v244 offset:0
    ds_read_b64_tr_b16 v[130:131], v244 offset:2048
    ds_read_b64_tr_b16 v[132:133], v245 offset:0
    ds_read_b64_tr_b16 v[134:135], v245 offset:2048
    ds_read_b64_tr_b16 v[136:137], v246 offset:0
    ds_read_b64_tr_b16 v[138:139], v246 offset:2048
    ds_read_b64_tr_b16 v[140:141], v247 offset:0
    ds_read_b64_tr_b16 v[142:143], v247 offset:2048
    s_waitcnt vmcnt(16)
    v_cmp_ne_u64 vcc, s[18:19], v[238:239]
    s_cbranch_vccnz fmain_poll4
fmain_poll4_ok:
    s_add_u32 s77, s28, 0
    buffer_load_dwordx4 v[160:163], v255, s[32:35], s77 offen offset:0 sc1
    s_add_u32 s77, s28, 147456
    buffer_load_dwordx4 v[164:167], v255, s[32:35], s77 offen offset:0 sc1
    s_add_u32 s77, s28, 294912
    buffer_load_dwordx4 v[168:171], v255, s[32:35], s77 offen offset:0 sc1
    s_add_u32 s77, s28, 442368
    buffer_load_dwordx4 v[172:175], v255, s[32:35], s77 offen offset:0 sc1
    s_add_u32 s77, s28, 0
    buffer_load_dwordx4 v[176:179], v255, s[32:35], s77 offen offset:1024 sc1
    s_add_u32 s77, s28, 147456
    buffer_load_dwordx4 v[180:183], v255, s[32:35], s77 offen offset:1024 sc1
    s_add_u32 s77, s28, 294912
    buffer_load_dwordx4 v[184:187], v255, s[32:35], s77 offen offset:1024 sc1
    s_add_u32 s77, s28, 442368
    buffer_load_dwordx4 v[188:191], v255, s[32:35], s77 offen offset:1024 sc1
    s_add_u32 s77, s28, 0
    buffer_load_dwordx4 v[192:195], v255, s[32:35], s77 offen offset:2048 sc1
    s_add_u32 s77, s28, 147456
    buffer_load_dwordx4 v[196:199], v255, s[32:35], s77 offen offset:2048 sc1
    s_add_u32 s77, s28, 294912
    buffer_load_dwordx4 v[200:203], v255, s[32:35], s77 offen offset:2048 sc1
    s_add_u32 s77, s28, 442368
    buffer_load_dwordx4 v[204:207], v255, s[32:35], s77 offen offset:2048 sc1
    s_waitcnt vmcnt(8) lgkmcnt(0)
    v_mfma_f32_16x16x32_bf16 v[64:67], v[0:3], v[160:163], 0
    s_add_u32 s77, s28, 0
    buffer_load_dwordx4 v[208:211], v255, s[32:35], s77 offen offset:3072 sc1
    v_mfma_f32_16x16x32_bf16 v[68:71], v[4:7], v[160:163], 0
    v_mfma_f32_16x16x32_bf16 v[72:75], v[8:11], v[160:163], 0
    v_mfma_f32_16x16x32_bf16 v[76:79], v[12:15], v[160:163], 0
    v_mfma_f32_16x16x32_bf16 v[80:83], v[0:3], v[164:167], 0
    s_add_u32 s77, s28, 147456
    buffer_load_dwordx4 v[212:215], v255, s[32:35], s77 offen offset:3072 sc1
    v_mfma_f32_16x16x32_bf16 v[84:87], v[4:7], v[164:167], 0
    v_mfma_f32_16x16x32_bf16 v[88:91], v[8:11], v[164:167], 0
    v_mfma_f32_16x16x32_bf16 v[92:95], v[12:15], v[164:167], 0
    v_mfma_f32_16x16x32_bf16 v[96:99], v[0:3], v[168:171], 0
    s_add_u32 s77, s28, 294912
    buffer_load_dwordx4 v[216:219], v255, s[32:35], s77 offen offset:3072 sc1
    v_mfma_f32_16x16x32_bf16 v[100:103], v[4:7], v[168:171], 0
    v_mfma_f32_16x16x32_bf16 v[104:107], v[8:11], v[168:171], 0
    v_mfma_f32_16x16x32_bf16 v[108:111], v[12:15], v[168:171], 0
    v_mfma_f32_16x16x32_bf16 v[112:115], v[0:3], v[172:175], 0
    s_add_u32 s77, s28, 442368
    buffer_load_dwordx4 v[220:223], v255, s[32:35], s77 offen offset:3072 sc1
    v_mfma_f32_16x16x32_bf16 v[116:119], v[4:7], v[172:175], 0
    v_mfma_f32_16x16x32_bf16 v[120:123], v[8:11], v[172:175], 0
    v_mfma_f32_16x16x32_bf16 v[124:127], v[12:15], v[172:175], 0
    s_waitcnt vmcnt(8) lgkmcnt(0)
    v_mfma_f32_16x16x32_bf16 v[64:67], v[16:19], v[176:179], v[64:67]
    s_add_u32 s77, s28, 4096
    buffer_load_dwordx4 v[160:163], v255, s[32:35], s77 offen offset:0 sc1
    v_mfma_f32_16x16x32_bf16 v[68:71], v[20:23], v[176:179], v[68:71]
    v_mfma_f32_16x16x32_bf16 v[72:75], v[24:27], v[176:179], v[72:75]
    v_mfma_f32_16x16x32_bf16 v[76:79], v[28:31], v[176:179], v[76:79]
    v_mfma_f32_16x16x32_bf16 v[80:83], v[16:19], v[180:183], v[80:83]
    s_add_u32 s77, s28, 151552
    buffer_load_dwordx4 v[164:167], v255, s[32:35], s77 offen offset:0 sc1
    v_mfma_f32_16x16x32_bf16 v[84:87], v[20:23], v[180:183], v[84:87]
    v_mfma_f32_16x16x32_bf16 v[88:91], v[24:27], v[180:183], v[88:91]
    v_mfma_f32_16x16x32_bf16 v[92:95], v[28:31], v[180:183], v[92:95]
    v_mfma_f32_16x16x32_bf16 v[96:99], v[16:19], v[184:187], v[96:99]
    s_add_u32 s77, s28, 299008
    buffer_load_dwordx4 v[168:171], v255, s[32:35], s77 offen offset:0 sc1
    v_mfma_f32_16x16x32_bf16 v[100:103], v[20:23], v[184:187], v[100:103]
    v_mfma_f32_16x16x32_bf16 v[104:107], v[24:27], v[184:187], v[104:107]
    v_mfma_f32_16x16x32_bf16 v[108:111], v[28:31], v[184:187], v[108:111]
    v_mfma_f32_16x16x32_bf16 v[112:115], v[16:19], v[188:191], v[112:115]
    s_add_u32 s77, s28, 446464
    buffer_load_dwordx4 v[172:175], v255, s[32:35], s77 offen offset:0 sc1
    v_mfma_f32_16x16x32_bf16 v[116:119], v[20:23], v[188:191], v[116:119]
    v_mfma_f32_16x16x32_bf16 v[120:123], v[24:27], v[188:191], v[120:123]
    v_mfma_f32_16x16x32_bf16 v[124:127], v[28:31], v[188:191], v[124:127]
    s_waitcnt vmcnt(8) lgkmcnt(0)
    v_mfma_f32_16x16x32_bf16 v[64:67], v[32:35], v[192:195], v[64:67]
    s_add_u32 s77, s28, 4096
    buffer_load_dwordx4 v[176:179], v255, s[32:35], s77 offen offset:1024 sc1
    v_mfma_f32_16x16x32_bf16 v[68:71], v[36:39], v[192:195], v[68:71]
    v_mfma_f32_16x16x32_bf16 v[72:75], v[40:43], v[192:195], v[72:75]
    v_mfma_f32_16x16x32_bf16 v[76:79], v[44:47], v[192:195], v[76:79]
    v_mfma_f32_16x16x32_bf16 v[80:83], v[32:35], v[196:199], v[80:83]
    s_add_u32 s77, s28, 151552
    buffer_load_dwordx4 v[180:183], v255, s[32:35], s77 offen offset:1024 sc1
    v_mfma_f32_16x16x32_bf16 v[84:87], v[36:39], v[196:199], v[84:87]
    v_mfma_f32_16x16x32_bf16 v[88:91], v[40:43], v[196:199], v[88:91]
    v_mfma_f32_16x16x32_bf16 v[92:95], v[44:47], v[196:199], v[92:95]
    v_mfma_f32_16x16x32_bf16 v[96:99], v[32:35], v[200:203], v[96:99]
    s_add_u32 s77, s28, 299008
    buffer_load_dwordx4 v[184:187], v255, s[32:35], s77 offen offset:1024 sc1
    v_mfma_f32_16x16x32_bf16 v[100:103], v[36:39], v[200:203], v[100:103]
    v_mfma_f32_16x16x32_bf16 v[104:107], v[40:43], v[200:203], v[104:107]
    v_mfma_f32_16x16x32_bf16 v[108:111], v[44:47], v[200:203], v[108:111]
    v_mfma_f32_16x16x32_bf16 v[112:115], v[32:35], v[204:207], v[112:115]
    s_add_u32 s77, s28, 446464
    buffer_load_dwordx4 v[188:191], v255, s[32:35], s77 offen offset:1024 sc1
    v_mfma_f32_16x16x32_bf16 v[116:119], v[36:39], v[204:207], v[116:119]
    v_mfma_f32_16x16x32_bf16 v[120:123], v[40:43], v[204:207], v[120:123]
    v_mfma_f32_16x16x32_bf16 v[124:127], v[44:47], v[204:207], v[124:127]
    s_waitcnt vmcnt(8) lgkmcnt(0)
    v_mfma_f32_16x16x32_bf16 v[64:67], v[48:51], v[208:211], v[64:67]
    s_add_u32 s77, s28, 4096
    buffer_load_dwordx4 v[192:195], v255, s[32:35], s77 offen offset:2048 sc1
    v_mfma_f32_16x16x32_bf16 v[68:71], v[52:55], v[208:211], v[68:71]
    v_mfma_f32_16x16x32_bf16 v[72:75], v[56:59], v[208:211], v[72:75]
    v_mfma_f32_16x16x32_bf16 v[76:79], v[60:63], v[208:211], v[76:79]
    v_mfma_f32_16x16x32_bf16 v[80:83], v[48:51], v[212:215], v[80:83]
    s_add_u32 s77, s28, 151552
    buffer_load_dwordx4 v[196:199], v255, s[32:35], s77 offen offset:2048 sc1
    v_mfma_f32_16x16x32_bf16 v[84:87], v[52:55], v[212:215], v[84:87]
    v_mfma_f32_16x16x32_bf16 v[88:91], v[56:59], v[212:215], v[88:91]
    v_mfma_f32_16x16x32_bf16 v[92:95], v[60:63], v[212:215], v[92:95]
    v_mfma_f32_16x16x32_bf16 v[96:99], v[48:51], v[216:219], v[96:99]
    s_add_u32 s77, s28, 299008
    buffer_load_dwordx4 v[200:203], v255, s[32:35], s77 offen offset:2048 sc1
    v_mfma_f32_16x16x32_bf16 v[100:103], v[52:55], v[216:219], v[100:103]
    v_mfma_f32_16x16x32_bf16 v[104:107], v[56:59], v[216:219], v[104:107]
    v_mfma_f32_16x16x32_bf16 v[108:111], v[60:63], v[216:219], v[108:111]
    v_mfma_f32_16x16x32_bf16 v[112:115], v[48:51], v[220:223], v[112:115]
    s_add_u32 s77, s28, 446464
    buffer_load_dwordx4 v[204:207], v255, s[32:35], s77 offen offset:2048 sc1
    v_mfma_f32_16x16x32_bf16 v[116:119], v[52:55], v[220:223], v[116:119]
    v_mfma_f32_16x16x32_bf16 v[120:123], v[56:59], v[220:223], v[120:123]
    v_mfma_f32_16x16x32_bf16 v[124:127], v[60:63], v[220:223], v[124:127]
    s_waitcnt vmcnt(8) lgkmcnt(0)
    v_mfma_f32_16x16x32_bf16 v[64:67], v[128:131], v[160:163], v[64:67]
    ds_read_b64_tr_b16 v[144:145], v244 offset:4096
    s_add_u32 s77, s28, 4096
    buffer_load_dwordx4 v[208:211], v255, s[32:35], s77 offen offset:3072 sc1
    v_mfma_f32_16x16x32_bf16 v[68:71], v[132:135], v[160:163], v[68:71]
    ds_read_b64_tr_b16 v[146:147], v244 offset:6144
    v_mfma_f32_16x16x32_bf16 v[72:75], v[136:139], v[160:163], v[72:75]
    ds_read_b64_tr_b16 v[148:149], v245 offset:4096
    s_add_u32 s77, s28, 151552
    buffer_load_dwordx4 v[212:215], v255, s[32:35], s77 offen offset:3072 sc1
    v_mfma_f32_16x16x32_bf16 v[76:79], v[140:143], v[160:163], v[76:79]
    ds_read_b64_tr_b16 v[150:151], v245 offset:6144
    v_mfma_f32_16x16x32_bf16 v[80:83], v[128:131], v[164:167], v[80:83]
    ds_read_b64_tr_b16 v[152:153], v246 offset:4096
    s_add_u32 s77, s28, 299008
    buffer_load_dwordx4 v[216:219], v255, s[32:35], s77 offen offset:3072 sc1
    v_mfma_f32_16x16x32_bf16 v[84:87], v[132:135], v[164:167], v[84:87]
    ds_read_b64_tr_b16 v[154:155], v246 offset:6144
    v_mfma_f32_16x16x32_bf16 v[88:91], v[136:139], v[164:167], v[88:91]
    ds_read_b64_tr_b16 v[156:157], v247 offset:4096
    s_add_u32 s77, s28, 446464
    buffer_load_dwordx4 v[220:223], v255, s[32:35], s77 offen offset:3072 sc1
    v_mfma_f32_16x16x32_bf16 v[92:95], v[140:143], v[164:167], v[92:95]
    ds_read_b64_tr_b16 v[158:159], v247 offset:6144
    v_mfma_f32_16x16x32_bf16 v[96:99], v[128:131], v[168:171], v[96:99]
    s_add_u32 s71, s69, 65536
    s_and_b32 s71, s71, 0x1ffff
    s_add_u32 m0, s71, 0
    s_mov_b32 s76, 393216
    buffer_load_dwordx4 v240, s[40:43], s76 offen offset:0 lds
    v_mfma_f32_16x16x32_bf16 v[100:103], v[132:135], v[168:171], v[100:103]
    v_mfma_f32_16x16x32_bf16 v[104:107], v[136:139], v[168:171], v[104:107]
    buffer_load_dwordx4 v241, s[40:43], s76 offen offset:1024 lds
    v_mfma_f32_16x16x32_bf16 v[108:111], v[140:143], v[168:171], v[108:111]
    v_mfma_f32_16x16x32_bf16 v[112:115], v[128:131], v[172:175], v[112:115]
    buffer_load_dwordx4 v242, s[40:43], s76 offen offset:2048 lds
    v_mfma_f32_16x16x32_bf16 v[116:119], v[132:135], v[172:175], v[116:119]
    v_mfma_f32_16x16x32_bf16 v[120:123], v[136:139], v[172:175], v[120:123]
    buffer_load_dwordx4 v243, s[40:43], s76 offen offset:3072 lds
    v_mfma_f32_16x16x32_bf16 v[124:127], v[140:143], v[172:175], v[124:127]
    s_waitcnt vmcnt(12) lgkmcnt(0)
    v_mfma_f32_16x16x32_bf16 v[64:67], v[144:147], v[176:179], v[64:67]
    s_add_u32 s77, s28, 8192
    buffer_load_dwordx4 v[160:163], v255, s[32:35], s77 offen offset:0 sc1
    v_mfma_f32_16x16x32_bf16 v[68:71], v[148:151], v[176:179], v[68:71]
    s_add_u32 s72, s69, 98304
    s_and_b32 s72, s72, 0x1ffff
    v_add_u32 v244, s72, v224
    v_add_u32 v245, s72, v225
    v_add_u32 v246, s72, v226
    v_add_u32 v247, s72, v227
    v_mfma_f32_16x16x32_bf16 v[72:75], v[152:155], v[176:179], v[72:75]
    s_add_u32 s77, s28, 155648
    buffer_load_dwordx4 v[164:167], v255, s[32:35], s77 offen offset:0 sc1
    v_mfma_f32_16x16x32_bf16 v[76:79], v[156:159], v[176:179], v[76:79]
    ds_read_b64_tr_b16 v[128:129], v244 offset:0
    v_mfma_f32_16x16x32_bf16 v[80:83], v[144:147], v[180:183], v[80:83]
    ds_read_b64_tr_b16 v[130:131], v244 offset:2048
    ds_read_b64_tr_b16 v[132:133], v245 offset:0
    s_add_u32 s77, s28, 303104
    buffer_load_dwordx4 v[168:171], v255, s[32:35], s77 offen offset:0 sc1
    v_mfma_f32_16x16x32_bf16 v[84:87], v[148:151], v[180:183], v[84:87]
    ds_read_b64_tr_b16 v[134:135], v245 offset:2048
    v_mfma_f32_16x16x32_bf16 v[88:91], v[152:155], v[180:183], v[88:91]
    ds_read_b64_tr_b16 v[136:137], v246 offset:0
    ds_read_b64_tr_b16 v[138:139], v246 offset:2048
    s_add_u32 s77, s28, 450560
    buffer_load_dwordx4 v[172:175], v255, s[32:35], s77 offen offset:0 sc1
    v_mfma_f32_16x16x32_bf16 v[92:95], v[156:159], v[180:183], v[92:95]
    ds_read_b64_tr_b16 v[140:141], v247 offset:0
    ds_read_b64_tr_b16 v[142:143], v247 offset:2048
    v_mfma_f32_16x16x32_bf16 v[96:99], v[144:147], v[184:187], v[96:99]
    s_add_u32 s71, s69, 65536
    s_and_b32 s71, s71, 0x1ffff
    s_add_u32 m0, s71, 4096
    s_mov_b32 s76, 425984
    buffer_load_dwordx4 v240, s[40:43], s76 offen offset:0 lds
    v_mfma_f32_16x16x32_bf16 v[100:103], v[148:151], v[184:187], v[100:103]
    v_mfma_f32_16x16x32_bf16 v[104:107], v[152:155], v[184:187], v[104:107]
    buffer_load_dwordx4 v241, s[40:43], s76 offen offset:1024 lds
    v_mfma_f32_16x16x32_bf16 v[108:111], v[156:159], v[184:187], v[108:111]
    v_mfma_f32_16x16x32_bf16 v[112:115], v[144:147], v[188:191], v[112:115]
    buffer_load_dwordx4 v242, s[40:43], s76 offen offset:2048 lds
    v_mfma_f32_16x16x32_bf16 v[116:119], v[148:151], v[188:191], v[116:119]
    v_mfma_f32_16x16x32_bf16 v[120:123], v[152:155], v[188:191], v[120:123]
    buffer_load_dwordx4 v243, s[40:43], s76 offen offset:3072 lds
    v_mfma_f32_16x16x32_bf16 v[124:127], v[156:159], v[188:191], v[124:127]
    s_waitcnt vmcnt(16) lgkmcnt(0)
    v_mfma_f32_16x16x32_bf16 v[64:67], v[128:131], v[192:195], v[64:67]
    ds_read_b64_tr_b16 v[144:145], v244 offset:4096
    s_add_u32 s77, s28, 8192
    buffer_load_dwordx4 v[176:179], v255, s[32:35], s77 offen offset:1024 sc1
    v_mfma_f32_16x16x32_bf16 v[68:71], v[132:135], v[192:195], v[68:71]
    ds_read_b64_tr_b16 v[146:147], v244 offset:6144
    v_mfma_f32_16x16x32_bf16 v[72:75], v[136:139], v[192:195], v[72:75]
    ds_read_b64_tr_b16 v[148:149], v245 offset:4096
    s_add_u32 s77, s28, 155648
    buffer_load_dwordx4 v[180:183], v255, s[32:35], s77 offen offset:1024 sc1
    v_mfma_f32_16x16x32_bf16 v[76:79], v[140:143], v[192:195], v[76:79]
    ds_read_b64_tr_b16 v[150:151], v245 offset:6144
    v_mfma_f32_16x16x32_bf16 v[80:83], v[128:131], v[196:199], v[80:83]
    ds_read_b64_tr_b16 v[152:153], v246 offset:4096
    s_add_u32 s77, s28, 303104
    buffer_load_dwordx4 v[184:187], v255, s[32:35], s77 offen offset:1024 sc1
    v_mfma_f32_16x16x32_bf16 v[84:87], v[132:135], v[196:199], v[84:87]
    ds_read_b64_tr_b16 v[154:155], v246 offset:6144
    v_mfma_f32_16x16x32_bf16 v[88:91], v[136:139], v[196:199], v[88:91]
    ds_read_b64_tr_b16 v[156:157], v247 offset:4096
    s_add_u32 s77, s28, 450560
    buffer_load_dwordx4 v[188:191], v255, s[32:35], s77 offen offset:1024 sc1
    v_mfma_f32_16x16x32_bf16 v[92:95], v[140:143], v[196:199], v[92:95]
    ds_read_b64_tr_b16 v[158:159], v247 offset:6144
    v_mfma_f32_16x16x32_bf16 v[96:99], v[128:131], v[200:203], v[96:99]
    s_add_u32 s71, s69, 98304
    s_and_b32 s71, s71, 0x1ffff
    s_add_u32 m0, s71, 0
    s_mov_b32 s76, 458752
    buffer_load_dwordx4 v240, s[40:43], s76 offen offset:0 lds
    v_mfma_f32_16x16x32_bf16 v[100:103], v[132:135], v[200:203], v[100:103]
    v_mfma_f32_16x16x32_bf16 v[104:107], v[136:139], v[200:203], v[104:107]
    buffer_load_dwordx4 v241, s[40:43], s76 offen offset:1024 lds
    v_mfma_f32_16x16x32_bf16 v[108:111], v[140:143], v[200:203], v[108:111]
    v_mfma_f32_16x16x32_bf16 v[112:115], v[128:131], v[204:207], v[112:115]
    buffer_load_dwordx4 v242, s[40:43], s76 offen offset:2048 lds
    v_mfma_f32_16x16x32_bf16 v[116:119], v[132:135], v[204:207], v[116:119]
    v_mfma_f32_16x16x32_bf16 v[120:123], v[136:139], v[204:207], v[120:123]
    buffer_load_dwordx4 v243, s[40:43], s76 offen offset:3072 lds
    v_mfma_f32_16x16x32_bf16 v[124:127], v[140:143], v[204:207], v[124:127]
    s_waitcnt vmcnt(20) lgkmcnt(0)
    v_mfma_f32_16x16x32_bf16 v[64:67], v[144:147], v[208:211], v[64:67]
    s_add_u32 s77, s28, 8192
    buffer_load_dwordx4 v[192:195], v255, s[32:35], s77 offen offset:2048 sc1
    v_mfma_f32_16x16x32_bf16 v[68:71], v[148:151], v[208:211], v[68:71]
    s_add_u32 s72, s69, 0
    s_and_b32 s72, s72, 0x1ffff
    v_add_u32 v244, s72, v224
    v_add_u32 v245, s72, v225
    v_add_u32 v246, s72, v226
    v_add_u32 v247, s72, v227
    v_mfma_f32_16x16x32_bf16 v[72:75], v[152:155], v[208:211], v[72:75]
    s_add_u32 s77, s28, 155648
    buffer_load_dwordx4 v[196:199], v255, s[32:35], s77 offen offset:2048 sc1
    v_mfma_f32_16x16x32_bf16 v[76:79], v[156:159], v[208:211], v[76:79]
    ds_read_b64_tr_b16 v[128:129], v244 offset:0
    v_mfma_f32_16x16x32_bf16 v[80:83], v[144:147], v[212:215], v[80:83]
    ds_read_b64_tr_b16 v[130:131], v244 offset:2048
    ds_read_b64_tr_b16 v[132:133], v245 offset:0
    s_add_u32 s77, s28, 303104
    buffer_load_dwordx4 v[200:203], v255, s[32:35], s77 offen offset:2048 sc1
    v_mfma_f32_16x16x32_bf16 v[84:87], v[148:151], v[212:215], v[84:87]
    ds_read_b64_tr_b16 v[134:135], v245 offset:2048
    v_mfma_f32_16x16x32_bf16 v[88:91], v[152:155], v[212:215], v[88:91]
    ds_read_b64_tr_b16 v[136:137], v246 offset:0
    ds_read_b64_tr_b16 v[138:139], v246 offset:2048
    s_add_u32 s77, s28, 450560
    buffer_load_dwordx4 v[204:207], v255, s[32:35], s77 offen offset:2048 sc1
    v_mfma_f32_16x16x32_bf16 v[92:95], v[156:159], v[212:215], v[92:95]
    ds_read_b64_tr_b16 v[140:141], v247 offset:0
    ds_read_b64_tr_b16 v[142:143], v247 offset:2048
    v_mfma_f32_16x16x32_bf16 v[96:99], v[144:147], v[216:219], v[96:99]
    s_add_u32 s71, s69, 98304
    s_and_b32 s71, s71, 0x1ffff
    s_add_u32 m0, s71, 4096
    s_mov_b32 s76, 491520
    buffer_load_dwordx4 v240, s[40:43], s76 offen offset:0 lds
    v_mfma_f32_16x16x32_bf16 v[100:103], v[148:151], v[216:219], v[100:103]
    v_mfma_f32_16x16x32_bf16 v[104:107], v[152:155], v[216:219], v[104:107]
    buffer_load_dwordx4 v241, s[40:43], s76 offen offset:1024 lds
    v_mfma_f32_16x16x32_bf16 v[108:111], v[156:159], v[216:219], v[108:111]
    v_mfma_f32_16x16x32_bf16 v[112:115], v[144:147], v[220:223], v[112:115]
    buffer_load_dwordx4 v242, s[40:43], s76 offen offset:2048 lds
    v_mfma_f32_16x16x32_bf16 v[116:119], v[148:151], v[220:223], v[116:119]
    v_mfma_f32_16x16x32_bf16 v[120:123], v[152:155], v[220:223], v[120:123]
    buffer_load_dwordx4 v243, s[40:43], s76 offen offset:3072 lds
    v_mfma_f32_16x16x32_bf16 v[124:127], v[156:159], v[220:223], v[124:127]
    s_waitcnt vmcnt(20) lgkmcnt(0)
    v_mfma_f32_16x16x32_bf16 v[64:67], v[128:131], v[160:163], v[64:67]
    ds_read_b64_tr_b16 v[144:145], v244 offset:4096
    s_add_u32 s77, s28, 8192
    buffer_load_dwordx4 v[208:211], v255, s[32:35], s77 offen offset:3072 sc1
    v_mfma_f32_16x16x32_bf16 v[68:71], v[132:135], v[160:163], v[68:71]
    ds_read_b64_tr_b16 v[146:147], v244 offset:6144
    v_mfma_f32_16x16x32_bf16 v[72:75], v[136:139], v[160:163], v[72:75]
    ds_read_b64_tr_b16 v[148:149], v245 offset:4096
    s_add_u32 s77, s28, 155648
    buffer_load_dwordx4 v[212:215], v255, s[32:35], s77 offen offset:3072 sc1
    v_mfma_f32_16x16x32_bf16 v[76:79], v[140:143], v[160:163], v[76:79]
    ds_read_b64_tr_b16 v[150:151], v245 offset:6144
    v_mfma_f32_16x16x32_bf16 v[80:83], v[128:131], v[164:167], v[80:83]
    ds_read_b64_tr_b16 v[152:153], v246 offset:4096
    s_add_u32 s77, s28, 303104
    buffer_load_dwordx4 v[216:219], v255, s[32:35], s77 offen offset:3072 sc1
    v_mfma_f32_16x16x32_bf16 v[84:87], v[132:135], v[164:167], v[84:87]
    ds_read_b64_tr_b16 v[154:155], v246 offset:6144
    v_mfma_f32_16x16x32_bf16 v[88:91], v[136:139], v[164:167], v[88:91]
    ds_read_b64_tr_b16 v[156:157], v247 offset:4096
    s_add_u32 s77, s28, 450560
    buffer_load_dwordx4 v[220:223], v255, s[32:35], s77 offen offset:3072 sc1
    v_mfma_f32_16x16x32_bf16 v[92:95], v[140:143], v[164:167], v[92:95]
    ds_read_b64_tr_b16 v[158:159], v247 offset:6144
    v_mfma_f32_16x16x32_bf16 v[96:99], v[128:131], v[168:171], v[96:99]
    s_add_u32 s71, s69, 0
    s_and_b32 s71, s71, 0x1ffff
    s_add_u32 m0, s71, 0
    s_mov_b32 s76, 524288
    buffer_load_dwordx4 v240, s[40:43], s76 offen offset:0 lds
    v_mfma_f32_16x16x32_bf16 v[100:103], v[132:135], v[168:171], v[100:103]
    v_mfma_f32_16x16x32_bf16 v[104:107], v[136:139], v[168:171], v[104:107]
    buffer_load_dwordx4 v241, s[40:43], s76 offen offset:1024 lds
    v_mfma_f32_16x16x32_bf16 v[108:111], v[140:143], v[168:171], v[108:111]
    v_mfma_f32_16x16x32_bf16 v[112:115], v[128:131], v[172:175], v[112:115]
    buffer_load_dwordx4 v242, s[40:43], s76 offen offset:2048 lds
    v_mfma_f32_16x16x32_bf16 v[116:119], v[132:135], v[172:175], v[116:119]
    v_mfma_f32_16x16x32_bf16 v[120:123], v[136:139], v[172:175], v[120:123]
    buffer_load_dwordx4 v243, s[40:43], s76 offen offset:3072 lds
    v_mfma_f32_16x16x32_bf16 v[124:127], v[140:143], v[172:175], v[124:127]
    s_waitcnt vmcnt(20) lgkmcnt(0)
    v_mfma_f32_16x16x32_bf16 v[64:67], v[144:147], v[176:179], v[64:67]
    s_add_u32 s77, s28, 12288
    buffer_load_dwordx4 v[160:163], v255, s[32:35], s77 offen offset:0 sc1
    v_mfma_f32_16x16x32_bf16 v[68:71], v[148:151], v[176:179], v[68:71]
    s_add_u32 s72, s69, 32768
    s_and_b32 s72, s72, 0x1ffff
    v_add_u32 v244, s72, v224
    v_add_u32 v245, s72, v225
    v_add_u32 v246, s72, v226
    v_add_u32 v247, s72, v227
    v_mfma_f32_16x16x32_bf16 v[72:75], v[152:155], v[176:179], v[72:75]
    s_add_u32 s77, s28, 159744
    buffer_load_dwordx4 v[164:167], v255, s[32:35], s77 offen offset:0 sc1
    v_mfma_f32_16x16x32_bf16 v[76:79], v[156:159], v[176:179], v[76:79]
    ds_read_b64_tr_b16 v[128:129], v244 offset:0
    v_mfma_f32_16x16x32_bf16 v[80:83], v[144:147], v[180:183], v[80:83]
    ds_read_b64_tr_b16 v[130:131], v244 offset:2048
    ds_read_b64_tr_b16 v[132:133], v245 offset:0
    s_add_u32 s77, s28, 307200
    buffer_load_dwordx4 v[168:171], v255, s[32:35], s77 offen offset:0 sc1
    v_mfma_f32_16x16x32_bf16 v[84:87], v[148:151], v[180:183], v[84:87]
    ds_read_b64_tr_b16 v[134:135], v245 offset:2048
    v_mfma_f32_16x16x32_bf16 v[88:91], v[152:155], v[180:183], v[88:91]
    ds_read_b64_tr_b16 v[136:137], v246 offset:0
    ds_read_b64_tr_b16 v[138:139], v246 offset:2048
    s_add_u32 s77, s28, 454656
    buffer_load_dwordx4 v[172:175], v255, s[32:35], s77 offen offset:0 sc1
    v_mfma_f32_16x16x32_bf16 v[92:95], v[156:159], v[180:183], v[92:95]
    ds_read_b64_tr_b16 v[140:141], v247 offset:0
    ds_read_b64_tr_b16 v[142:143], v247 offset:2048
    v_mfma_f32_16x16x32_bf16 v[96:99], v[144:147], v[184:187], v[96:99]
    s_add_u32 s71, s69, 0
    s_and_b32 s71, s71, 0x1ffff
    s_add_u32 m0, s71, 4096
    s_mov_b32 s76, 557056
    buffer_load_dwordx4 v240, s[40:43], s76 offen offset:0 lds
    v_mfma_f32_16x16x32_bf16 v[100:103], v[148:151], v[184:187], v[100:103]
    v_mfma_f32_16x16x32_bf16 v[104:107], v[152:155], v[184:187], v[104:107]
    buffer_load_dwordx4 v241, s[40:43], s76 offen offset:1024 lds
    v_mfma_f32_16x16x32_bf16 v[108:111], v[156:159], v[184:187], v[108:111]
    v_mfma_f32_16x16x32_bf16 v[112:115], v[144:147], v[188:191], v[112:115]
    buffer_load_dwordx4 v242, s[40:43], s76 offen offset:2048 lds
    v_mfma_f32_16x16x32_bf16 v[116:119], v[148:151], v[188:191], v[116:119]
    v_mfma_f32_16x16x32_bf16 v[120:123], v[152:155], v[188:191], v[120:123]
    buffer_load_dwordx4 v243, s[40:43], s76 offen offset:3072 lds
    v_mfma_f32_16x16x32_bf16 v[124:127], v[156:159], v[188:191], v[124:127]
    s_waitcnt vmcnt(20) lgkmcnt(0)
    v_mfma_f32_16x16x32_bf16 v[64:67], v[128:131], v[192:195], v[64:67]
    ds_read_b64_tr_b16 v[144:145], v244 offset:4096
    s_add_u32 s77, s28, 12288
    buffer_load_dwordx4 v[176:179], v255, s[32:35], s77 offen offset:1024 sc1
    v_mfma_f32_16x16x32_bf16 v[68:71], v[132:135], v[192:195], v[68:71]
    ds_read_b64_tr_b16 v[146:147], v244 offset:6144
    v_mfma_f32_16x16x32_bf16 v[72:75], v[136:139], v[192:195], v[72:75]
    ds_read_b64_tr_b16 v[148:149], v245 offset:4096
    s_add_u32 s77, s28, 159744
    buffer_load_dwordx4 v[180:183], v255, s[32:35], s77 offen offset:1024 sc1
    v_mfma_f32_16x16x32_bf16 v[76:79], v[140:143], v[192:195], v[76:79]
    ds_read_b64_tr_b16 v[150:151], v245 offset:6144
    v_mfma_f32_16x16x32_bf16 v[80:83], v[128:131], v[196:199], v[80:83]
    ds_read_b64_tr_b16 v[152:153], v246 offset:4096
    s_add_u32 s77, s28, 307200
    buffer_load_dwordx4 v[184:187], v255, s[32:35], s77 offen offset:1024 sc1
    v_mfma_f32_16x16x32_bf16 v[84:87], v[132:135], v[196:199], v[84:87]
    ds_read_b64_tr_b16 v[154:155], v246 offset:6144
    v_mfma_f32_16x16x32_bf16 v[88:91], v[136:139], v[196:199], v[88:91]
    ds_read_b64_tr_b16 v[156:157], v247 offset:4096
    s_add_u32 s77, s28, 454656
    buffer_load_dwordx4 v[188:191], v255, s[32:35], s77 offen offset:1024 sc1
    v_mfma_f32_16x16x32_bf16 v[92:95], v[140:143], v[196:199], v[92:95]
    ds_read_b64_tr_b16 v[158:159], v247 offset:6144
    v_mfma_f32_16x16x32_bf16 v[96:99], v[128:131], v[200:203], v[96:99]
    s_add_u32 s71, s69, 32768
    s_and_b32 s71, s71, 0x1ffff
    s_add_u32 m0, s71, 0
    s_mov_b32 s76, 589824
    buffer_load_dwordx4 v240, s[40:43], s76 offen offset:0 lds
    v_mfma_f32_16x16x32_bf16 v[100:103], v[132:135], v[200:203], v[100:103]
    v_mfma_f32_16x16x32_bf16 v[104:107], v[136:139], v[200:203], v[104:107]
    buffer_load_dwordx4 v241, s[40:43], s76 offen offset:1024 lds
    v_mfma_f32_16x16x32_bf16 v[108:111], v[140:143], v[200:203], v[108:111]
    v_mfma_f32_16x16x32_bf16 v[112:115], v[128:131], v[204:207], v[112:115]
    buffer_load_dwordx4 v242, s[40:43], s76 offen offset:2048 lds
    v_mfma_f32_16x16x32_bf16 v[116:119], v[132:135], v[204:207], v[116:119]
    v_mfma_f32_16x16x32_bf16 v[120:123], v[136:139], v[204:207], v[120:123]
    buffer_load_dwordx4 v243, s[40:43], s76 offen offset:3072 lds
    v_mfma_f32_16x16x32_bf16 v[124:127], v[140:143], v[204:207], v[124:127]
    s_waitcnt vmcnt(20) lgkmcnt(0)
    v_mfma_f32_16x16x32_bf16 v[64:67], v[144:147], v[208:211], v[64:67]
    s_add_u32 s77, s28, 12288
    buffer_load_dwordx4 v[192:195], v255, s[32:35], s77 offen offset:2048 sc1
    v_mfma_f32_16x16x32_bf16 v[68:71], v[148:151], v[208:211], v[68:71]
    s_add_u32 s72, s69, 65536
    s_and_b32 s72, s72, 0x1ffff
    v_add_u32 v244, s72, v224
    v_add_u32 v245, s72, v225
    v_add_u32 v246, s72, v226
    v_add_u32 v247, s72, v227
    v_mfma_f32_16x16x32_bf16 v[72:75], v[152:155], v[208:211], v[72:75]
    s_add_u32 s77, s28, 159744
    buffer_load_dwordx4 v[196:199], v255, s[32:35], s77 offen offset:2048 sc1
    v_mfma_f32_16x16x32_bf16 v[76:79], v[156:159], v[208:211], v[76:79]
    ds_read_b64_tr_b16 v[128:129], v244 offset:0
    v_mfma_f32_16x16x32_bf16 v[80:83], v[144:147], v[212:215], v[80:83]
    ds_read_b64_tr_b16 v[130:131], v244 offset:2048
    ds_read_b64_tr_b16 v[132:133], v245 offset:0
    s_add_u32 s77, s28, 307200
    buffer_load_dwordx4 v[200:203], v255, s[32:35], s77 offen offset:2048 sc1
    v_mfma_f32_16x16x32_bf16 v[84:87], v[148:151], v[212:215], v[84:87]
    ds_read_b64_tr_b16 v[134:135], v245 offset:2048
    v_mfma_f32_16x16x32_bf16 v[88:91], v[152:155], v[212:215], v[88:91]
    ds_read_b64_tr_b16 v[136:137], v246 offset:0
    ds_read_b64_tr_b16 v[138:139], v246 offset:2048
    s_add_u32 s77, s28, 454656
    buffer_load_dwordx4 v[204:207], v255, s[32:35], s77 offen offset:2048 sc1
    v_mfma_f32_16x16x32_bf16 v[92:95], v[156:159], v[212:215], v[92:95]
    ds_read_b64_tr_b16 v[140:141], v247 offset:0
    ds_read_b64_tr_b16 v[142:143], v247 offset:2048
    v_mfma_f32_16x16x32_bf16 v[96:99], v[144:147], v[216:219], v[96:99]
    s_add_u32 s71, s69, 32768
    s_and_b32 s71, s71, 0x1ffff
    s_add_u32 m0, s71, 4096
    s_mov_b32 s76, 622592
    buffer_load_dwordx4 v240, s[40:43], s76 offen offset:0 lds
    v_mfma_f32_16x16x32_bf16 v[100:103], v[148:151], v[216:219], v[100:103]
    v_mfma_f32_16x16x32_bf16 v[104:107], v[152:155], v[216:219], v[104:107]
    buffer_load_dwordx4 v241, s[40:43], s76 offen offset:1024 lds
    v_mfma_f32_16x16x32_bf16 v[108:111], v[156:159], v[216:219], v[108:111]
    v_mfma_f32_16x16x32_bf16 v[112:115], v[144:147], v[220:223], v[112:115]
    buffer_load_dwordx4 v242, s[40:43], s76 offen offset:2048 lds
    v_mfma_f32_16x16x32_bf16 v[116:119], v[148:151], v[220:223], v[116:119]
    v_mfma_f32_16x16x32_bf16 v[120:123], v[152:155], v[220:223], v[120:123]
    buffer_load_dwordx4 v243, s[40:43], s76 offen offset:3072 lds
    v_mfma_f32_16x16x32_bf16 v[124:127], v[156:159], v[220:223], v[124:127]
    s_waitcnt vmcnt(20) lgkmcnt(0)
    v_mfma_f32_16x16x32_bf16 v[64:67], v[128:131], v[160:163], v[64:67]
    ds_read_b64_tr_b16 v[144:145], v244 offset:4096
    s_add_u32 s77, s28, 12288
    buffer_load_dwordx4 v[208:211], v255, s[32:35], s77 offen offset:3072 sc1
    v_mfma_f32_16x16x32_bf16 v[68:71], v[132:135], v[160:163], v[68:71]
    ds_read_b64_tr_b16 v[146:147], v244 offset:6144
    v_mfma_f32_16x16x32_bf16 v[72:75], v[136:139], v[160:163], v[72:75]
    ds_read_b64_tr_b16 v[148:149], v245 offset:4096
    s_add_u32 s77, s28, 159744
    buffer_load_dwordx4 v[212:215], v255, s[32:35], s77 offen offset:3072 sc1
    v_mfma_f32_16x16x32_bf16 v[76:79], v[140:143], v[160:163], v[76:79]
    ds_read_b64_tr_b16 v[150:151], v245 offset:6144
    v_mfma_f32_16x16x32_bf16 v[80:83], v[128:131], v[164:167], v[80:83]
    ds_read_b64_tr_b16 v[152:153], v246 offset:4096
    s_add_u32 s77, s28, 307200
    buffer_load_dwordx4 v[216:219], v255, s[32:35], s77 offen offset:3072 sc1
    v_mfma_f32_16x16x32_bf16 v[84:87], v[132:135], v[164:167], v[84:87]
    ds_read_b64_tr_b16 v[154:155], v246 offset:6144
    v_mfma_f32_16x16x32_bf16 v[88:91], v[136:139], v[164:167], v[88:91]
    ds_read_b64_tr_b16 v[156:157], v247 offset:4096
    s_add_u32 s77, s28, 454656
    buffer_load_dwordx4 v[220:223], v255, s[32:35], s77 offen offset:3072 sc1
    v_mfma_f32_16x16x32_bf16 v[92:95], v[140:143], v[164:167], v[92:95]
    ds_read_b64_tr_b16 v[158:159], v247 offset:6144
    v_mfma_f32_16x16x32_bf16 v[96:99], v[128:131], v[168:171], v[96:99]
    s_add_u32 s71, s69, 65536
    s_and_b32 s71, s71, 0x1ffff
    s_add_u32 m0, s71, 0
    s_mov_b32 s76, 655360
    buffer_load_dwordx4 v240, s[40:43], s76 offen offset:0 lds
    v_mfma_f32_16x16x32_bf16 v[100:103], v[132:135], v[168:171], v[100:103]
    v_mfma_f32_16x16x32_bf16 v[104:107], v[136:139], v[168:171], v[104:107]
    buffer_load_dwordx4 v241, s[40:43], s76 offen offset:1024 lds
    v_mfma_f32_16x16x32_bf16 v[108:111], v[140:143], v[168:171], v[108:111]
    v_mfma_f32_16x16x32_bf16 v[112:115], v[128:131], v[172:175], v[112:115]
    buffer_load_dwordx4 v242, s[40:43], s76 offen offset:2048 lds
    v_mfma_f32_16x16x32_bf16 v[116:119], v[132:135], v[172:175], v[116:119]
    v_mfma_f32_16x16x32_bf16 v[120:123], v[136:139], v[172:175], v[120:123]
    buffer_load_dwordx4 v243, s[40:43], s76 offen offset:3072 lds
    v_mfma_f32_16x16x32_bf16 v[124:127], v[140:143], v[172:175], v[124:127]
    s_waitcnt vmcnt(20) lgkmcnt(0)
    v_mfma_f32_16x16x32_bf16 v[64:67], v[144:147], v[176:179], v[64:67]
    s_add_u32 s77, s28, 16384
    buffer_load_dwordx4 v[160:163], v255, s[32:35], s77 offen offset:0 sc1
    v_mfma_f32_16x16x32_bf16 v[68:71], v[148:151], v[176:179], v[68:71]
    s_add_u32 s72, s69, 98304
    s_and_b32 s72, s72, 0x1ffff
    v_add_u32 v244, s72, v224
    v_add_u32 v245, s72, v225
    v_add_u32 v246, s72, v226
    v_add_u32 v247, s72, v227
    v_mfma_f32_16x16x32_bf16 v[72:75], v[152:155], v[176:179], v[72:75]
    s_add_u32 s77, s28, 163840
    buffer_load_dwordx4 v[164:167], v255, s[32:35], s77 offen offset:0 sc1
    v_mfma_f32_16x16x32_bf16 v[76:79], v[156:159], v[176:179], v[76:79]
    ds_read_b64_tr_b16 v[128:129], v244 offset:0
    v_mfma_f32_16x16x32_bf16 v[80:83], v[144:147], v[180:183], v[80:83]
    ds_read_b64_tr_b16 v[130:131], v244 offset:2048
    ds_read_b64_tr_b16 v[132:133], v245 offset:0
    s_add_u32 s77, s28, 311296
    buffer_load_dwordx4 v[168:171], v255, s[32:35], s77 offen offset:0 sc1
    v_mfma_f32_16x16x32_bf16 v[84:87], v[148:151], v[180:183], v[84:87]
    ds_read_b64_tr_b16 v[134:135], v245 offset:2048
    v_mfma_f32_16x16x32_bf16 v[88:91], v[152:155], v[180:183], v[88:91]
    ds_read_b64_tr_b16 v[136:137], v246 offset:0
    ds_read_b64_tr_b16 v[138:139], v246 offset:2048
    s_add_u32 s77, s28, 458752
    buffer_load_dwordx4 v[172:175], v255, s[32:35], s77 offen offset:0 sc1
    v_mfma_f32_16x16x32_bf16 v[92:95], v[156:159], v[180:183], v[92:95]
    ds_read_b64_tr_b16 v[140:141], v247 offset:0
    ds_read_b64_tr_b16 v[142:143], v247 offset:2048
    v_mfma_f32_16x16x32_bf16 v[96:99], v[144:147], v[184:187], v[96:99]
    s_add_u32 s71, s69, 65536
    s_and_b32 s71, s71, 0x1ffff
    s_add_u32 m0, s71, 4096
    s_mov_b32 s76, 688128
    buffer_load_dwordx4 v240, s[40:43], s76 offen offset:0 lds
    v_mfma_f32_16x16x32_bf16 v[100:103], v[148:151], v[184:187], v[100:103]
    v_mfma_f32_16x16x32_bf16 v[104:107], v[152:155], v[184:187], v[104:107]
    buffer_load_dwordx4 v241, s[40:43], s76 offen offset:1024 lds
    v_mfma_f32_16x16x32_bf16 v[108:111], v[156:159], v[184:187], v[108:111]
    v_mfma_f32_16x16x32_bf16 v[112:115], v[144:147], v[188:191], v[112:115]
    buffer_load_dwordx4 v242, s[40:43], s76 offen offset:2048 lds
    v_mfma_f32_16x16x32_bf16 v[116:119], v[148:151], v[188:191], v[116:119]
    v_mfma_f32_16x16x32_bf16 v[120:123], v[152:155], v[188:191], v[120:123]
    buffer_load_dwordx4 v243, s[40:43], s76 offen offset:3072 lds
    v_mfma_f32_16x16x32_bf16 v[124:127], v[156:159], v[188:191], v[124:127]
    s_waitcnt vmcnt(20) lgkmcnt(0)
    v_mfma_f32_16x16x32_bf16 v[64:67], v[128:131], v[192:195], v[64:67]
    ds_read_b64_tr_b16 v[144:145], v244 offset:4096
    s_add_u32 s77, s28, 16384
    buffer_load_dwordx4 v[176:179], v255, s[32:35], s77 offen offset:1024 sc1
    v_mfma_f32_16x16x32_bf16 v[68:71], v[132:135], v[192:195], v[68:71]
    ds_read_b64_tr_b16 v[146:147], v244 offset:6144
    v_mfma_f32_16x16x32_bf16 v[72:75], v[136:139], v[192:195], v[72:75]
    ds_read_b64_tr_b16 v[148:149], v245 offset:4096
    s_add_u32 s77, s28, 163840
    buffer_load_dwordx4 v[180:183], v255, s[32:35], s77 offen offset:1024 sc1
    v_mfma_f32_16x16x32_bf16 v[76:79], v[140:143], v[192:195], v[76:79]
    ds_read_b64_tr_b16 v[150:151], v245 offset:6144
    v_mfma_f32_16x16x32_bf16 v[80:83], v[128:131], v[196:199], v[80:83]
    ds_read_b64_tr_b16 v[152:153], v246 offset:4096
    s_add_u32 s77, s28, 311296
    buffer_load_dwordx4 v[184:187], v255, s[32:35], s77 offen offset:1024 sc1
    v_mfma_f32_16x16x32_bf16 v[84:87], v[132:135], v[196:199], v[84:87]
    ds_read_b64_tr_b16 v[154:155], v246 offset:6144
    v_mfma_f32_16x16x32_bf16 v[88:91], v[136:139], v[196:199], v[88:91]
    ds_read_b64_tr_b16 v[156:157], v247 offset:4096
    s_add_u32 s77, s28, 458752
    buffer_load_dwordx4 v[188:191], v255, s[32:35], s77 offen offset:1024 sc1
    v_mfma_f32_16x16x32_bf16 v[92:95], v[140:143], v[196:199], v[92:95]
    ds_read_b64_tr_b16 v[158:159], v247 offset:6144
    v_mfma_f32_16x16x32_bf16 v[96:99], v[128:131], v[200:203], v[96:99]
    s_add_u32 s71, s69, 98304
    s_and_b32 s71, s71, 0x1ffff
    s_add_u32 m0, s71, 0
    s_mov_b32 s76, 720896
    buffer_load_dwordx4 v240, s[40:43], s76 offen offset:0 lds
    v_mfma_f32_16x16x32_bf16 v[100:103], v[132:135], v[200:203], v[100:103]
    v_mfma_f32_16x16x32_bf16 v[104:107], v[136:139], v[200:203], v[104:107]
    buffer_load_dwordx4 v241, s[40:43], s76 offen offset:1024 lds
    v_mfma_f32_16x16x32_bf16 v[108:111], v[140:143], v[200:203], v[108:111]
    v_mfma_f32_16x16x32_bf16 v[112:115], v[128:131], v[204:207], v[112:115]
    buffer_load_dwordx4 v242, s[40:43], s76 offen offset:2048 lds
    v_mfma_f32_16x16x32_bf16 v[116:119], v[132:135], v[204:207], v[116:119]
    v_mfma_f32_16x16x32_bf16 v[120:123], v[136:139], v[204:207], v[120:123]
    buffer_load_dwordx4 v243, s[40:43], s76 offen offset:3072 lds
    v_mfma_f32_16x16x32_bf16 v[124:127], v[140:143], v[204:207], v[124:127]
    s_waitcnt vmcnt(20) lgkmcnt(0)
    v_mfma_f32_16x16x32_bf16 v[64:67], v[144:147], v[208:211], v[64:67]
    s_add_u32 s77, s28, 16384
    buffer_load_dwordx4 v[192:195], v255, s[32:35], s77 offen offset:2048 sc1
    v_mfma_f32_16x16x32_bf16 v[68:71], v[148:151], v[208:211], v[68:71]
    s_add_u32 s72, s69, 0
    s_and_b32 s72, s72, 0x1ffff
    v_add_u32 v244, s72, v224
    v_add_u32 v245, s72, v225
    v_add_u32 v246, s72, v226
    v_add_u32 v247, s72, v227
    v_mfma_f32_16x16x32_bf16 v[72:75], v[152:155], v[208:211], v[72:75]
    s_add_u32 s77, s28, 163840
    buffer_load_dwordx4 v[196:199], v255, s[32:35], s77 offen offset:2048 sc1
    v_mfma_f32_16x16x32_bf16 v[76:79], v[156:159], v[208:211], v[76:79]
    ds_read_b64_tr_b16 v[128:129], v244 offset:0
    v_mfma_f32_16x16x32_bf16 v[80:83], v[144:147], v[212:215], v[80:83]
    ds_read_b64_tr_b16 v[130:131], v244 offset:2048
    ds_read_b64_tr_b16 v[132:133], v245 offset:0
    s_add_u32 s77, s28, 311296
    buffer_load_dwordx4 v[200:203], v255, s[32:35], s77 offen offset:2048 sc1
    v_mfma_f32_16x16x32_bf16 v[84:87], v[148:151], v[212:215], v[84:87]
    ds_read_b64_tr_b16 v[134:135], v245 offset:2048
    v_mfma_f32_16x16x32_bf16 v[88:91], v[152:155], v[212:215], v[88:91]
    ds_read_b64_tr_b16 v[136:137], v246 offset:0
    ds_read_b64_tr_b16 v[138:139], v246 offset:2048
    s_add_u32 s77, s28, 458752
    buffer_load_dwordx4 v[204:207], v255, s[32:35], s77 offen offset:2048 sc1
    v_mfma_f32_16x16x32_bf16 v[92:95], v[156:159], v[212:215], v[92:95]
    ds_read_b64_tr_b16 v[140:141], v247 offset:0
    ds_read_b64_tr_b16 v[142:143], v247 offset:2048
    v_mfma_f32_16x16x32_bf16 v[96:99], v[144:147], v[216:219], v[96:99]
    s_add_u32 s71, s69, 98304
    s_and_b32 s71, s71, 0x1ffff
    s_add_u32 m0, s71, 4096
    s_mov_b32 s76, 753664
    buffer_load_dwordx4 v240, s[40:43], s76 offen offset:0 lds
    v_mfma_f32_16x16x32_bf16 v[100:103], v[148:151], v[216:219], v[100:103]
    v_mfma_f32_16x16x32_bf16 v[104:107], v[152:155], v[216:219], v[104:107]
    buffer_load_dwordx4 v241, s[40:43], s76 offen offset:1024 lds
    v_mfma_f32_16x16x32_bf16 v[108:111], v[156:159], v[216:219], v[108:111]
    v_mfma_f32_16x16x32_bf16 v[112:115], v[144:147], v[220:223], v[112:115]
    buffer_load_dwordx4 v242, s[40:43], s76 offen offset:2048 lds
    v_mfma_f32_16x16x32_bf16 v[116:119], v[148:151], v[220:223], v[116:119]
    v_mfma_f32_16x16x32_bf16 v[120:123], v[152:155], v[220:223], v[120:123]
    buffer_load_dwordx4 v243, s[40:43], s76 offen offset:3072 lds
    v_mfma_f32_16x16x32_bf16 v[124:127], v[156:159], v[220:223], v[124:127]
    s_waitcnt vmcnt(20) lgkmcnt(0)
    v_mfma_f32_16x16x32_bf16 v[64:67], v[128:131], v[160:163], v[64:67]
    ds_read_b64_tr_b16 v[144:145], v244 offset:4096
    s_add_u32 s77, s28, 16384
    buffer_load_dwordx4 v[208:211], v255, s[32:35], s77 offen offset:3072 sc1
    v_mfma_f32_16x16x32_bf16 v[68:71], v[132:135], v[160:163], v[68:71]
    ds_read_b64_tr_b16 v[146:147], v244 offset:6144
    v_mfma_f32_16x16x32_bf16 v[72:75], v[136:139], v[160:163], v[72:75]
    ds_read_b64_tr_b16 v[148:149], v245 offset:4096
    s_add_u32 s77, s28, 163840
    buffer_load_dwordx4 v[212:215], v255, s[32:35], s77 offen offset:3072 sc1
    v_mfma_f32_16x16x32_bf16 v[76:79], v[140:143], v[160:163], v[76:79]
    ds_read_b64_tr_b16 v[150:151], v245 offset:6144
    v_mfma_f32_16x16x32_bf16 v[80:83], v[128:131], v[164:167], v[80:83]
    ds_read_b64_tr_b16 v[152:153], v246 offset:4096
    s_add_u32 s77, s28, 311296
    buffer_load_dwordx4 v[216:219], v255, s[32:35], s77 offen offset:3072 sc1
    v_mfma_f32_16x16x32_bf16 v[84:87], v[132:135], v[164:167], v[84:87]
    ds_read_b64_tr_b16 v[154:155], v246 offset:6144
    v_mfma_f32_16x16x32_bf16 v[88:91], v[136:139], v[164:167], v[88:91]
    ds_read_b64_tr_b16 v[156:157], v247 offset:4096
    s_add_u32 s77, s28, 458752
    buffer_load_dwordx4 v[220:223], v255, s[32:35], s77 offen offset:3072 sc1
    v_mfma_f32_16x16x32_bf16 v[92:95], v[140:143], v[164:167], v[92:95]
    ds_read_b64_tr_b16 v[158:159], v247 offset:6144
    v_mfma_f32_16x16x32_bf16 v[96:99], v[128:131], v[168:171], v[96:99]
    s_add_u32 s71, s69, 0
    s_and_b32 s71, s71, 0x1ffff
    s_add_u32 m0, s71, 0
    s_mov_b32 s76, 786432
    buffer_load_dwordx4 v240, s[40:43], s76 offen offset:0 lds
    v_mfma_f32_16x16x32_bf16 v[100:103], v[132:135], v[168:171], v[100:103]
    v_mfma_f32_16x16x32_bf16 v[104:107], v[136:139], v[168:171], v[104:107]
    buffer_load_dwordx4 v241, s[40:43], s76 offen offset:1024 lds
    v_mfma_f32_16x16x32_bf16 v[108:111], v[140:143], v[168:171], v[108:111]
    v_mfma_f32_16x16x32_bf16 v[112:115], v[128:131], v[172:175], v[112:115]
    buffer_load_dwordx4 v242, s[40:43], s76 offen offset:2048 lds
    v_mfma_f32_16x16x32_bf16 v[116:119], v[132:135], v[172:175], v[116:119]
    v_mfma_f32_16x16x32_bf16 v[120:123], v[136:139], v[172:175], v[120:123]
    buffer_load_dwordx4 v243, s[40:43], s76 offen offset:3072 lds
    v_mfma_f32_16x16x32_bf16 v[124:127], v[140:143], v[172:175], v[124:127]
    s_waitcnt vmcnt(20) lgkmcnt(0)
    v_mfma_f32_16x16x32_bf16 v[64:67], v[144:147], v[176:179], v[64:67]
    s_add_u32 s77, s28, 20480
    buffer_load_dwordx4 v[160:163], v255, s[32:35], s77 offen offset:0 sc1
    v_mfma_f32_16x16x32_bf16 v[68:71], v[148:151], v[176:179], v[68:71]
    s_add_u32 s72, s69, 32768
    s_and_b32 s72, s72, 0x1ffff
    v_add_u32 v244, s72, v224
    v_add_u32 v245, s72, v225
    v_add_u32 v246, s72, v226
    v_add_u32 v247, s72, v227
    v_mfma_f32_16x16x32_bf16 v[72:75], v[152:155], v[176:179], v[72:75]
    s_add_u32 s77, s28, 167936
    buffer_load_dwordx4 v[164:167], v255, s[32:35], s77 offen offset:0 sc1
    v_mfma_f32_16x16x32_bf16 v[76:79], v[156:159], v[176:179], v[76:79]
    ds_read_b64_tr_b16 v[128:129], v244 offset:0
    v_mfma_f32_16x16x32_bf16 v[80:83], v[144:147], v[180:183], v[80:83]
    ds_read_b64_tr_b16 v[130:131], v244 offset:2048
    ds_read_b64_tr_b16 v[132:133], v245 offset:0
    s_add_u32 s77, s28, 315392
    buffer_load_dwordx4 v[168:171], v255, s[32:35], s77 offen offset:0 sc1
    v_mfma_f32_16x16x32_bf16 v[84:87], v[148:151], v[180:183], v[84:87]
    ds_read_b64_tr_b16 v[134:135], v245 offset:2048
    v_mfma_f32_16x16x32_bf16 v[88:91], v[152:155], v[180:183], v[88:91]
    ds_read_b64_tr_b16 v[136:137], v246 offset:0
    ds_read_b64_tr_b16 v[138:139], v246 offset:2048
    s_add_u32 s77, s28, 462848
    buffer_load_dwordx4 v[172:175], v255, s[32:35], s77 offen offset:0 sc1
    v_mfma_f32_16x16x32_bf16 v[92:95], v[156:159], v[180:183], v[92:95]
    ds_read_b64_tr_b16 v[140:141], v247 offset:0
    ds_read_b64_tr_b16 v[142:143], v247 offset:2048
    v_mfma_f32_16x16x32_bf16 v[96:99], v[144:147], v[184:187], v[96:99]
    s_add_u32 s71, s69, 0
    s_and_b32 s71, s71, 0x1ffff
    s_add_u32 m0, s71, 4096
    s_mov_b32 s76, 819200
    buffer_load_dwordx4 v240, s[40:43], s76 offen offset:0 lds
    v_mfma_f32_16x16x32_bf16 v[100:103], v[148:151], v[184:187], v[100:103]
    v_mfma_f32_16x16x32_bf16 v[104:107], v[152:155], v[184:187], v[104:107]
    buffer_load_dwordx4 v241, s[40:43], s76 offen offset:1024 lds
    v_mfma_f32_16x16x32_bf16 v[108:111], v[156:159], v[184:187], v[108:111]
    v_mfma_f32_16x16x32_bf16 v[112:115], v[144:147], v[188:191], v[112:115]
    buffer_load_dwordx4 v242, s[40:43], s76 offen offset:2048 lds
    v_mfma_f32_16x16x32_bf16 v[116:119], v[148:151], v[188:191], v[116:119]
    v_mfma_f32_16x16x32_bf16 v[120:123], v[152:155], v[188:191], v[120:123]
    buffer_load_dwordx4 v243, s[40:43], s76 offen offset:3072 lds
    v_mfma_f32_16x16x32_bf16 v[124:127], v[156:159], v[188:191], v[124:127]
    s_waitcnt vmcnt(20) lgkmcnt(0)
    v_mfma_f32_16x16x32_bf16 v[64:67], v[128:131], v[192:195], v[64:67]
    ds_read_b64_tr_b16 v[144:145], v244 offset:4096
    s_add_u32 s77, s28, 20480
    buffer_load_dwordx4 v[176:179], v255, s[32:35], s77 offen offset:1024 sc1
    v_mfma_f32_16x16x32_bf16 v[68:71], v[132:135], v[192:195], v[68:71]
    ds_read_b64_tr_b16 v[146:147], v244 offset:6144
    v_mfma_f32_16x16x32_bf16 v[72:75], v[136:139], v[192:195], v[72:75]
    ds_read_b64_tr_b16 v[148:149], v245 offset:4096
    s_add_u32 s77, s28, 167936
    buffer_load_dwordx4 v[180:183], v255, s[32:35], s77 offen offset:1024 sc1
    v_mfma_f32_16x16x32_bf16 v[76:79], v[140:143], v[192:195], v[76:79]
    ds_read_b64_tr_b16 v[150:151], v245 offset:6144
    v_mfma_f32_16x16x32_bf16 v[80:83], v[128:131], v[196:199], v[80:83]
    ds_read_b64_tr_b16 v[152:153], v246 offset:4096
    s_add_u32 s77, s28, 315392
    buffer_load_dwordx4 v[184:187], v255, s[32:35], s77 offen offset:1024 sc1
    v_mfma_f32_16x16x32_bf16 v[84:87], v[132:135], v[196:199], v[84:87]
    ds_read_b64_tr_b16 v[154:155], v246 offset:6144
    v_mfma_f32_16x16x32_bf16 v[88:91], v[136:139], v[196:199], v[88:91]
    ds_read_b64_tr_b16 v[156:157], v247 offset:4096
    s_add_u32 s77, s28, 462848
    buffer_load_dwordx4 v[188:191], v255, s[32:35], s77 offen offset:1024 sc1
    v_mfma_f32_16x16x32_bf16 v[92:95], v[140:143], v[196:199], v[92:95]
    ds_read_b64_tr_b16 v[158:159], v247 offset:6144
    v_mfma_f32_16x16x32_bf16 v[96:99], v[128:131], v[200:203], v[96:99]
    s_add_u32 s71, s69, 32768
    s_and_b32 s71, s71, 0x1ffff
    s_add_u32 m0, s71, 0
    s_mov_b32 s76, 851968
    buffer_load_dwordx4 v240, s[40:43], s76 offen offset:0 lds
    v_mfma_f32_16x16x32_bf16 v[100:103], v[132:135], v[200:203], v[100:103]
    v_mfma_f32_16x16x32_bf16 v[104:107], v[136:139], v[200:203], v[104:107]
    buffer_load_dwordx4 v241, s[40:43], s76 offen offset:1024 lds
    v_mfma_f32_16x16x32_bf16 v[108:111], v[140:143], v[200:203], v[108:111]
    v_mfma_f32_16x16x32_bf16 v[112:115], v[128:131], v[204:207], v[112:115]
    buffer_load_dwordx4 v242, s[40:43], s76 offen offset:2048 lds
    v_mfma_f32_16x16x32_bf16 v[116:119], v[132:135], v[204:207], v[116:119]
    v_mfma_f32_16x16x32_bf16 v[120:123], v[136:139], v[204:207], v[120:123]
    buffer_load_dwordx4 v243, s[40:43], s76 offen offset:3072 lds
    v_mfma_f32_16x16x32_bf16 v[124:127], v[140:143], v[204:207], v[124:127]
    s_waitcnt vmcnt(20) lgkmcnt(0)
    v_mfma_f32_16x16x32_bf16 v[64:67], v[144:147], v[208:211], v[64:67]
    s_add_u32 s77, s28, 20480
    buffer_load_dwordx4 v[192:195], v255, s[32:35], s77 offen offset:2048 sc1
    v_mfma_f32_16x16x32_bf16 v[68:71], v[148:151], v[208:211], v[68:71]
    s_add_u32 s72, s69, 65536
    s_and_b32 s72, s72, 0x1ffff
    v_add_u32 v244, s72, v224
    v_add_u32 v245, s72, v225
    v_add_u32 v246, s72, v226
    v_add_u32 v247, s72, v227
    v_mfma_f32_16x16x32_bf16 v[72:75], v[152:155], v[208:211], v[72:75]
    s_add_u32 s77, s28, 167936
    buffer_load_dwordx4 v[196:199], v255, s[32:35], s77 offen offset:2048 sc1
    v_mfma_f32_16x16x32_bf16 v[76:79], v[156:159], v[208:211], v[76:79]
    ds_read_b64_tr_b16 v[128:129], v244 offset:0
    v_mfma_f32_16x16x32_bf16 v[80:83], v[144:147], v[212:215], v[80:83]
    ds_read_b64_tr_b16 v[130:131], v244 offset:2048
    ds_read_b64_tr_b16 v[132:133], v245 offset:0
    s_add_u32 s77, s28, 315392
    buffer_load_dwordx4 v[200:203], v255, s[32:35], s77 offen offset:2048 sc1
    v_mfma_f32_16x16x32_bf16 v[84:87], v[148:151], v[212:215], v[84:87]
    ds_read_b64_tr_b16 v[134:135], v245 offset:2048
    v_mfma_f32_16x16x32_bf16 v[88:91], v[152:155], v[212:215], v[88:91]
    ds_read_b64_tr_b16 v[136:137], v246 offset:0
    ds_read_b64_tr_b16 v[138:139], v246 offset:2048
    s_add_u32 s77, s28, 462848
    buffer_load_dwordx4 v[204:207], v255, s[32:35], s77 offen offset:2048 sc1
    v_mfma_f32_16x16x32_bf16 v[92:95], v[156:159], v[212:215], v[92:95]
    ds_read_b64_tr_b16 v[140:141], v247 offset:0
    ds_read_b64_tr_b16 v[142:143], v247 offset:2048
    v_mfma_f32_16x16x32_bf16 v[96:99], v[144:147], v[216:219], v[96:99]
    s_add_u32 s71, s69, 32768
    s_and_b32 s71, s71, 0x1ffff
    s_add_u32 m0, s71, 4096
    s_mov_b32 s76, 884736
    buffer_load_dwordx4 v240, s[40:43], s76 offen offset:0 lds
    v_mfma_f32_16x16x32_bf16 v[100:103], v[148:151], v[216:219], v[100:103]
    v_mfma_f32_16x16x32_bf16 v[104:107], v[152:155], v[216:219], v[104:107]
    buffer_load_dwordx4 v241, s[40:43], s76 offen offset:1024 lds
    v_mfma_f32_16x16x32_bf16 v[108:111], v[156:159], v[216:219], v[108:111]
    v_mfma_f32_16x16x32_bf16 v[112:115], v[144:147], v[220:223], v[112:115]
    buffer_load_dwordx4 v242, s[40:43], s76 offen offset:2048 lds
    v_mfma_f32_16x16x32_bf16 v[116:119], v[148:151], v[220:223], v[116:119]
    v_mfma_f32_16x16x32_bf16 v[120:123], v[152:155], v[220:223], v[120:123]
    buffer_load_dwordx4 v243, s[40:43], s76 offen offset:3072 lds
    v_mfma_f32_16x16x32_bf16 v[124:127], v[156:159], v[220:223], v[124:127]
    s_waitcnt vmcnt(20) lgkmcnt(0)
    v_mfma_f32_16x16x32_bf16 v[64:67], v[128:131], v[160:163], v[64:67]
    ds_read_b64_tr_b16 v[144:145], v244 offset:4096
    s_add_u32 s77, s28, 20480
    buffer_load_dwordx4 v[208:211], v255, s[32:35], s77 offen offset:3072 sc1
    v_mfma_f32_16x16x32_bf16 v[68:71], v[132:135], v[160:163], v[68:71]
    ds_read_b64_tr_b16 v[146:147], v244 offset:6144
    v_mfma_f32_16x16x32_bf16 v[72:75], v[136:139], v[160:163], v[72:75]
    ds_read_b64_tr_b16 v[148:149], v245 offset:4096
    s_add_u32 s77, s28, 167936
    buffer_load_dwordx4 v[212:215], v255, s[32:35], s77 offen offset:3072 sc1
    v_mfma_f32_16x16x32_bf16 v[76:79], v[140:143], v[160:163], v[76:79]
    ds_read_b64_tr_b16 v[150:151], v245 offset:6144
    v_mfma_f32_16x16x32_bf16 v[80:83], v[128:131], v[164:167], v[80:83]
    ds_read_b64_tr_b16 v[152:153], v246 offset:4096
    s_add_u32 s77, s28, 315392
    buffer_load_dwordx4 v[216:219], v255, s[32:35], s77 offen offset:3072 sc1
    v_mfma_f32_16x16x32_bf16 v[84:87], v[132:135], v[164:167], v[84:87]
    ds_read_b64_tr_b16 v[154:155], v246 offset:6144
    v_mfma_f32_16x16x32_bf16 v[88:91], v[136:139], v[164:167], v[88:91]
    ds_read_b64_tr_b16 v[156:157], v247 offset:4096
    s_add_u32 s77, s28, 462848
    buffer_load_dwordx4 v[220:223], v255, s[32:35], s77 offen offset:3072 sc1
    v_mfma_f32_16x16x32_bf16 v[92:95], v[140:143], v[164:167], v[92:95]
    ds_read_b64_tr_b16 v[158:159], v247 offset:6144
    v_mfma_f32_16x16x32_bf16 v[96:99], v[128:131], v[168:171], v[96:99]
    s_add_u32 s71, s69, 65536
    s_and_b32 s71, s71, 0x1ffff
    s_add_u32 m0, s71, 0
    s_mov_b32 s76, 917504
    buffer_load_dwordx4 v240, s[40:43], s76 offen offset:0 lds
    v_mfma_f32_16x16x32_bf16 v[100:103], v[132:135], v[168:171], v[100:103]
    v_mfma_f32_16x16x32_bf16 v[104:107], v[136:139], v[168:171], v[104:107]
    buffer_load_dwordx4 v241, s[40:43], s76 offen offset:1024 lds
    v_mfma_f32_16x16x32_bf16 v[108:111], v[140:143], v[168:171], v[108:111]
    v_mfma_f32_16x16x32_bf16 v[112:115], v[128:131], v[172:175], v[112:115]
    buffer_load_dwordx4 v242, s[40:43], s76 offen offset:2048 lds
    v_mfma_f32_16x16x32_bf16 v[116:119], v[132:135], v[172:175], v[116:119]
    v_mfma_f32_16x16x32_bf16 v[120:123], v[136:139], v[172:175], v[120:123]
    buffer_load_dwordx4 v243, s[40:43], s76 offen offset:3072 lds
    v_mfma_f32_16x16x32_bf16 v[124:127], v[140:143], v[172:175], v[124:127]
    s_waitcnt vmcnt(20) lgkmcnt(0)
    v_mfma_f32_16x16x32_bf16 v[64:67], v[144:147], v[176:179], v[64:67]
    s_add_u32 s77, s28, 24576
    buffer_load_dwordx4 v[160:163], v255, s[32:35], s77 offen offset:0 sc1
    v_mfma_f32_16x16x32_bf16 v[68:71], v[148:151], v[176:179], v[68:71]
    s_add_u32 s72, s69, 98304
    s_and_b32 s72, s72, 0x1ffff
    v_add_u32 v244, s72, v224
    v_add_u32 v245, s72, v225
    v_add_u32 v246, s72, v226
    v_add_u32 v247, s72, v227
    v_mfma_f32_16x16x32_bf16 v[72:75], v[152:155], v[176:179], v[72:75]
    s_add_u32 s77, s28, 172032
    buffer_load_dwordx4 v[164:167], v255, s[32:35], s77 offen offset:0 sc1
    v_mfma_f32_16x16x32_bf16 v[76:79], v[156:159], v[176:179], v[76:79]
    ds_read_b64_tr_b16 v[128:129], v244 offset:0
    v_mfma_f32_16x16x32_bf16 v[80:83], v[144:147], v[180:183], v[80:83]
    ds_read_b64_tr_b16 v[130:131], v244 offset:2048
    ds_read_b64_tr_b16 v[132:133], v245 offset:0
    s_add_u32 s77, s28, 319488
    buffer_load_dwordx4 v[168:171], v255, s[32:35], s77 offen offset:0 sc1
    v_mfma_f32_16x16x32_bf16 v[84:87], v[148:151], v[180:183], v[84:87]
    ds_read_b64_tr_b16 v[134:135], v245 offset:2048
    v_mfma_f32_16x16x32_bf16 v[88:91], v[152:155], v[180:183], v[88:91]
    ds_read_b64_tr_b16 v[136:137], v246 offset:0
    ds_read_b64_tr_b16 v[138:139], v246 offset:2048
    s_add_u32 s77, s28, 466944
    buffer_load_dwordx4 v[172:175], v255, s[32:35], s77 offen offset:0 sc1
    v_mfma_f32_16x16x32_bf16 v[92:95], v[156:159], v[180:183], v[92:95]
    ds_read_b64_tr_b16 v[140:141], v247 offset:0
    ds_read_b64_tr_b16 v[142:143], v247 offset:2048
    v_mfma_f32_16x16x32_bf16 v[96:99], v[144:147], v[184:187], v[96:99]
    s_add_u32 s71, s69, 65536
    s_and_b32 s71, s71, 0x1ffff
    s_add_u32 m0, s71, 4096
    s_mov_b32 s76, 950272
    buffer_load_dwordx4 v240, s[40:43], s76 offen offset:0 lds
    v_mfma_f32_16x16x32_bf16 v[100:103], v[148:151], v[184:187], v[100:103]
    v_mfma_f32_16x16x32_bf16 v[104:107], v[152:155], v[184:187], v[104:107]
    buffer_load_dwordx4 v241, s[40:43], s76 offen offset:1024 lds
    v_mfma_f32_16x16x32_bf16 v[108:111], v[156:159], v[184:187], v[108:111]
    v_mfma_f32_16x16x32_bf16 v[112:115], v[144:147], v[188:191], v[112:115]
    buffer_load_dwordx4 v242, s[40:43], s76 offen offset:2048 lds
    v_mfma_f32_16x16x32_bf16 v[116:119], v[148:151], v[188:191], v[116:119]
    v_mfma_f32_16x16x32_bf16 v[120:123], v[152:155], v[188:191], v[120:123]
    buffer_load_dwordx4 v243, s[40:43], s76 offen offset:3072 lds
    v_mfma_f32_16x16x32_bf16 v[124:127], v[156:159], v[188:191], v[124:127]
    s_waitcnt vmcnt(20) lgkmcnt(0)
    v_mfma_f32_16x16x32_bf16 v[64:67], v[128:131], v[192:195], v[64:67]
    ds_read_b64_tr_b16 v[144:145], v244 offset:4096
    s_add_u32 s77, s28, 24576
    buffer_load_dwordx4 v[176:179], v255, s[32:35], s77 offen offset:1024 sc1
    v_mfma_f32_16x16x32_bf16 v[68:71], v[132:135], v[192:195], v[68:71]
    ds_read_b64_tr_b16 v[146:147], v244 offset:6144
    v_mfma_f32_16x16x32_bf16 v[72:75], v[136:139], v[192:195], v[72:75]
    ds_read_b64_tr_b16 v[148:149], v245 offset:4096
    s_add_u32 s77, s28, 172032
    buffer_load_dwordx4 v[180:183], v255, s[32:35], s77 offen offset:1024 sc1
    v_mfma_f32_16x16x32_bf16 v[76:79], v[140:143], v[192:195], v[76:79]
    ds_read_b64_tr_b16 v[150:151], v245 offset:6144
    v_mfma_f32_16x16x32_bf16 v[80:83], v[128:131], v[196:199], v[80:83]
    ds_read_b64_tr_b16 v[152:153], v246 offset:4096
    s_add_u32 s77, s28, 319488
    buffer_load_dwordx4 v[184:187], v255, s[32:35], s77 offen offset:1024 sc1
    v_mfma_f32_16x16x32_bf16 v[84:87], v[132:135], v[196:199], v[84:87]
    ds_read_b64_tr_b16 v[154:155], v246 offset:6144
    v_mfma_f32_16x16x32_bf16 v[88:91], v[136:139], v[196:199], v[88:91]
    ds_read_b64_tr_b16 v[156:157], v247 offset:4096
    s_add_u32 s77, s28, 466944
    buffer_load_dwordx4 v[188:191], v255, s[32:35], s77 offen offset:1024 sc1
    v_mfma_f32_16x16x32_bf16 v[92:95], v[140:143], v[196:199], v[92:95]
    ds_read_b64_tr_b16 v[158:159], v247 offset:6144
    v_mfma_f32_16x16x32_bf16 v[96:99], v[128:131], v[200:203], v[96:99]
    s_add_u32 s71, s69, 98304
    s_and_b32 s71, s71, 0x1ffff
    s_add_u32 m0, s71, 0
    s_mov_b32 s76, 983040
    buffer_load_dwordx4 v240, s[40:43], s76 offen offset:0 lds
    v_mfma_f32_16x16x32_bf16 v[100:103], v[132:135], v[200:203], v[100:103]
    v_mfma_f32_16x16x32_bf16 v[104:107], v[136:139], v[200:203], v[104:107]
    buffer_load_dwordx4 v241, s[40:43], s76 offen offset:1024 lds
    v_mfma_f32_16x16x32_bf16 v[108:111], v[140:143], v[200:203], v[108:111]
    v_mfma_f32_16x16x32_bf16 v[112:115], v[128:131], v[204:207], v[112:115]
    buffer_load_dwordx4 v242, s[40:43], s76 offen offset:2048 lds
    v_mfma_f32_16x16x32_bf16 v[116:119], v[132:135], v[204:207], v[116:119]
    v_mfma_f32_16x16x32_bf16 v[120:123], v[136:139], v[204:207], v[120:123]
    buffer_load_dwordx4 v243, s[40:43], s76 offen offset:3072 lds
    v_mfma_f32_16x16x32_bf16 v[124:127], v[140:143], v[204:207], v[124:127]
    s_waitcnt vmcnt(20) lgkmcnt(0)
    v_mfma_f32_16x16x32_bf16 v[64:67], v[144:147], v[208:211], v[64:67]
    s_add_u32 s77, s28, 24576
    buffer_load_dwordx4 v[192:195], v255, s[32:35], s77 offen offset:2048 sc1
    v_mfma_f32_16x16x32_bf16 v[68:71], v[148:151], v[208:211], v[68:71]
    s_add_u32 s72, s69, 0
    s_and_b32 s72, s72, 0x1ffff
    v_add_u32 v244, s72, v224
    v_add_u32 v245, s72, v225
    v_add_u32 v246, s72, v226
    v_add_u32 v247, s72, v227
    v_mfma_f32_16x16x32_bf16 v[72:75], v[152:155], v[208:211], v[72:75]
    s_add_u32 s77, s28, 172032
    buffer_load_dwordx4 v[196:199], v255, s[32:35], s77 offen offset:2048 sc1
    v_mfma_f32_16x16x32_bf16 v[76:79], v[156:159], v[208:211], v[76:79]
    ds_read_b64_tr_b16 v[128:129], v244 offset:0
    v_mfma_f32_16x16x32_bf16 v[80:83], v[144:147], v[212:215], v[80:83]
    ds_read_b64_tr_b16 v[130:131], v244 offset:2048
    ds_read_b64_tr_b16 v[132:133], v245 offset:0
    s_add_u32 s77, s28, 319488
    buffer_load_dwordx4 v[200:203], v255, s[32:35], s77 offen offset:2048 sc1
    v_mfma_f32_16x16x32_bf16 v[84:87], v[148:151], v[212:215], v[84:87]
    ds_read_b64_tr_b16 v[134:135], v245 offset:2048
    v_mfma_f32_16x16x32_bf16 v[88:91], v[152:155], v[212:215], v[88:91]
    ds_read_b64_tr_b16 v[136:137], v246 offset:0
    ds_read_b64_tr_b16 v[138:139], v246 offset:2048
    s_add_u32 s77, s28, 466944
    buffer_load_dwordx4 v[204:207], v255, s[32:35], s77 offen offset:2048 sc1
    v_mfma_f32_16x16x32_bf16 v[92:95], v[156:159], v[212:215], v[92:95]
    ds_read_b64_tr_b16 v[140:141], v247 offset:0
    ds_read_b64_tr_b16 v[142:143], v247 offset:2048
    v_mfma_f32_16x16x32_bf16 v[96:99], v[144:147], v[216:219], v[96:99]
    s_add_u32 s71, s69, 98304
    s_and_b32 s71, s71, 0x1ffff
    s_add_u32 m0, s71, 4096
    s_mov_b32 s76, 1015808
    buffer_load_dwordx4 v240, s[40:43], s76 offen offset:0 lds
    v_mfma_f32_16x16x32_bf16 v[100:103], v[148:151], v[216:219], v[100:103]
    v_mfma_f32_16x16x32_bf16 v[104:107], v[152:155], v[216:219], v[104:107]
    buffer_load_dwordx4 v241, s[40:43], s76 offen offset:1024 lds
    v_mfma_f32_16x16x32_bf16 v[108:111], v[156:159], v[216:219], v[108:111]
    v_mfma_f32_16x16x32_bf16 v[112:115], v[144:147], v[220:223], v[112:115]
    buffer_load_dwordx4 v242, s[40:43], s76 offen offset:2048 lds
    v_mfma_f32_16x16x32_bf16 v[116:119], v[148:151], v[220:223], v[116:119]
    v_mfma_f32_16x16x32_bf16 v[120:123], v[152:155], v[220:223], v[120:123]
    buffer_load_dwordx4 v243, s[40:43], s76 offen offset:3072 lds
    v_mfma_f32_16x16x32_bf16 v[124:127], v[156:159], v[220:223], v[124:127]
    s_waitcnt vmcnt(20) lgkmcnt(0)
    v_mfma_f32_16x16x32_bf16 v[64:67], v[128:131], v[160:163], v[64:67]
    ds_read_b64_tr_b16 v[144:145], v244 offset:4096
    s_add_u32 s77, s28, 24576
    buffer_load_dwordx4 v[208:211], v255, s[32:35], s77 offen offset:3072 sc1
    v_mfma_f32_16x16x32_bf16 v[68:71], v[132:135], v[160:163], v[68:71]
    ds_read_b64_tr_b16 v[146:147], v244 offset:6144
    v_mfma_f32_16x16x32_bf16 v[72:75], v[136:139], v[160:163], v[72:75]
    ds_read_b64_tr_b16 v[148:149], v245 offset:4096
    s_add_u32 s77, s28, 172032
    buffer_load_dwordx4 v[212:215], v255, s[32:35], s77 offen offset:3072 sc1
    v_mfma_f32_16x16x32_bf16 v[76:79], v[140:143], v[160:163], v[76:79]
    ds_read_b64_tr_b16 v[150:151], v245 offset:6144
    v_mfma_f32_16x16x32_bf16 v[80:83], v[128:131], v[164:167], v[80:83]
    ds_read_b64_tr_b16 v[152:153], v246 offset:4096
    s_add_u32 s77, s28, 319488
    buffer_load_dwordx4 v[216:219], v255, s[32:35], s77 offen offset:3072 sc1
    v_mfma_f32_16x16x32_bf16 v[84:87], v[132:135], v[164:167], v[84:87]
    ds_read_b64_tr_b16 v[154:155], v246 offset:6144
    v_mfma_f32_16x16x32_bf16 v[88:91], v[136:139], v[164:167], v[88:91]
    ds_read_b64_tr_b16 v[156:157], v247 offset:4096
    s_add_u32 s77, s28, 466944
    buffer_load_dwordx4 v[220:223], v255, s[32:35], s77 offen offset:3072 sc1
    v_mfma_f32_16x16x32_bf16 v[92:95], v[140:143], v[164:167], v[92:95]
    ds_read_b64_tr_b16 v[158:159], v247 offset:6144
    v_mfma_f32_16x16x32_bf16 v[96:99], v[128:131], v[168:171], v[96:99]
    s_add_u32 s71, s69, 0
    s_and_b32 s71, s71, 0x1ffff
    s_add_u32 m0, s71, 0
    s_mov_b32 s76, 0
    buffer_load_dwordx4 v240, s[36:39], s76 offen offset:0 lds
    v_mfma_f32_16x16x32_bf16 v[100:103], v[132:135], v[168:171], v[100:103]
    v_mfma_f32_16x16x32_bf16 v[104:107], v[136:139], v[168:171], v[104:107]
    buffer_load_dwordx4 v241, s[36:39], s76 offen offset:1024 lds
    v_mfma_f32_16x16x32_bf16 v[108:111], v[140:143], v[168:171], v[108:111]
    v_mfma_f32_16x16x32_bf16 v[112:115], v[128:131], v[172:175], v[112:115]
    buffer_load_dwordx4 v242, s[36:39], s76 offen offset:2048 lds
    v_mfma_f32_16x16x32_bf16 v[116:119], v[132:135], v[172:175], v[116:119]
    v_mfma_f32_16x16x32_bf16 v[120:123], v[136:139], v[172:175], v[120:123]
    buffer_load_dwordx4 v243, s[36:39], s76 offen offset:3072 lds
    v_mfma_f32_16x16x32_bf16 v[124:127], v[140:143], v[172:175], v[124:127]
    s_barrier
    v_lshlrev_b32 v236, 2, v252
    s_lshl_b32 s78, s3, 8
    s_add_u32 s78, s78, 1048576
    buffer_load_dword v248, v236, s[60:63], s78 offen offset:0 sc1
    buffer_load_dword v249, v236, s[60:63], s78 offen offset:64 sc1
    buffer_load_dword v250, v236, s[60:63], s78 offen offset:128 sc1
    buffer_load_dword v251, v236, s[60:63], s78 offen offset:192 sc1
    s_waitcnt vmcnt(24) lgkmcnt(0)
    v_mfma_f32_16x16x32_bf16 v[64:67], v[144:147], v[176:179], v[64:67]
    s_add_u32 s77, s28, 28672
    buffer_load_dwordx4 v[160:163], v255, s[32:35], s77 offen offset:0 sc1
    v_mfma_f32_16x16x32_bf16 v[68:71], v[148:151], v[176:179], v[68:71]
    s_add_u32 s72, s69, 32768
    s_and_b32 s72, s72, 0x1ffff
    v_add_u32 v244, s72, v224
    v_add_u32 v245, s72, v225
    v_add_u32 v246, s72, v226
    v_add_u32 v247, s72, v227
    v_mfma_f32_16x16x32_bf16 v[72:75], v[152:155], v[176:179], v[72:75]
    s_add_u32 s77, s28, 176128
    buffer_load_dwordx4 v[164:167], v255, s[32:35], s77 offen offset:0 sc1
    v_mfma_f32_16x16x32_bf16 v[76:79], v[156:159], v[176:179], v[76:79]
    ds_read_b64_tr_b16 v[128:129], v244 offset:0
    v_mfma_f32_16x16x32_bf16 v[80:83], v[144:147], v[180:183], v[80:83]
    ds_read_b64_tr_b16 v[130:131], v244 offset:2048
    ds_read_b64_tr_b16 v[132:133], v245 offset:0
    s_add_u32 s77, s28, 323584
    buffer_load_dwordx4 v[168:171], v255, s[32:35], s77 offen offset:0 sc1
    v_mfma_f32_16x16x32_bf16 v[84:87], v[148:151], v[180:183], v[84:87]
    ds_read_b64_tr_b16 v[134:135], v245 offset:2048
    v_mfma_f32_16x16x32_bf16 v[88:91], v[152:155], v[180:183], v[88:91]
    ds_read_b64_tr_b16 v[136:137], v246 offset:0
    ds_read_b64_tr_b16 v[138:139], v246 offset:2048
    s_add_u32 s77, s28, 471040
    buffer_load_dwordx4 v[172:175], v255, s[32:35], s77 offen offset:0 sc1
    v_mfma_f32_16x16x32_bf16 v[92:95], v[156:159], v[180:183], v[92:95]
    ds_read_b64_tr_b16 v[140:141], v247 offset:0
    ds_read_b64_tr_b16 v[142:143], v247 offset:2048
    v_mfma_f32_16x16x32_bf16 v[96:99], v[144:147], v[184:187], v[96:99]
    s_add_u32 s71, s69, 0
    s_and_b32 s71, s71, 0x1ffff
    s_add_u32 m0, s71, 4096
    s_mov_b32 s76, 32768
    buffer_load_dwordx4 v240, s[36:39], s76 offen offset:0 lds
    v_mfma_f32_16x16x32_bf16 v[100:103], v[148:151], v[184:187], v[100:103]
    v_mfma_f32_16x16x32_bf16 v[104:107], v[152:155], v[184:187], v[104:107]
    buffer_load_dwordx4 v241, s[36:39], s76 offen offset:1024 lds
    v_mfma_f32_16x16x32_bf16 v[108:111], v[156:159], v[184:187], v[108:111]
    v_mfma_f32_16x16x32_bf16 v[112:115], v[144:147], v[188:191], v[112:115]
    buffer_load_dwordx4 v242, s[36:39], s76 offen offset:2048 lds
    v_mfma_f32_16x16x32_bf16 v[116:119], v[148:151], v[188:191], v[116:119]
    v_mfma_f32_16x16x32_bf16 v[120:123], v[152:155], v[188:191], v[120:123]
    buffer_load_dwordx4 v243, s[36:39], s76 offen offset:3072 lds
    v_mfma_f32_16x16x32_bf16 v[124:127], v[156:159], v[188:191], v[124:127]
    s_waitcnt vmcnt(24) lgkmcnt(0)
    v_mfma_f32_16x16x32_bf16 v[64:67], v[128:131], v[192:195], v[64:67]
    ds_read_b64_tr_b16 v[144:145], v244 offset:4096
    s_add_u32 s77, s28, 28672
    buffer_load_dwordx4 v[176:179], v255, s[32:35], s77 offen offset:1024 sc1
    v_mfma_f32_16x16x32_bf16 v[68:71], v[132:135], v[192:195], v[68:71]
    ds_read_b64_tr_b16 v[146:147], v244 offset:6144
    v_mfma_f32_16x16x32_bf16 v[72:75], v[136:139], v[192:195], v[72:75]
    ds_read_b64_tr_b16 v[148:149], v245 offset:4096
    s_add_u32 s77, s28, 176128
    buffer_load_dwordx4 v[180:183], v255, s[32:35], s77 offen offset:1024 sc1
    v_mfma_f32_16x16x32_bf16 v[76:79], v[140:143], v[192:195], v[76:79]
    ds_read_b64_tr_b16 v[150:151], v245 offset:6144
    v_mfma_f32_16x16x32_bf16 v[80:83], v[128:131], v[196:199], v[80:83]
    ds_read_b64_tr_b16 v[152:153], v246 offset:4096
    s_add_u32 s77, s28, 323584
    buffer_load_dwordx4 v[184:187], v255, s[32:35], s77 offen offset:1024 sc1
    v_mfma_f32_16x16x32_bf16 v[84:87], v[132:135], v[196:199], v[84:87]
    ds_read_b64_tr_b16 v[154:155], v246 offset:6144
    v_mfma_f32_16x16x32_bf16 v[88:91], v[136:139], v[196:199], v[88:91]
    ds_read_b64_tr_b16 v[156:157], v247 offset:4096
    s_add_u32 s77, s28, 471040
    buffer_load_dwordx4 v[188:191], v255, s[32:35], s77 offen offset:1024 sc1
    v_mfma_f32_16x16x32_bf16 v[92:95], v[140:143], v[196:199], v[92:95]
    ds_read_b64_tr_b16 v[158:159], v247 offset:6144
    v_mfma_f32_16x16x32_bf16 v[96:99], v[128:131], v[200:203], v[96:99]
    s_add_u32 s71, s69, 32768
    s_and_b32 s71, s71, 0x1ffff
    s_add_u32 m0, s71, 0
    s_mov_b32 s76, 65536
    buffer_load_dwordx4 v240, s[36:39], s76 offen offset:0 lds
    v_mfma_f32_16x16x32_bf16 v[100:103], v[132:135], v[200:203], v[100:103]
    v_mfma_f32_16x16x32_bf16 v[104:107], v[136:139], v[200:203], v[104:107]
    buffer_load_dwordx4 v241, s[36:39], s76 offen offset:1024 lds
    v_mfma_f32_16x16x32_bf16 v[108:111], v[140:143], v[200:203], v[108:111]
    v_mfma_f32_16x16x32_bf16 v[112:115], v[128:131], v[204:207], v[112:115]
    buffer_load_dwordx4 v242, s[36:39], s76 offen offset:2048 lds
    v_mfma_f32_16x16x32_bf16 v[116:119], v[132:135], v[204:207], v[116:119]
    v_mfma_f32_16x16x32_bf16 v[120:123], v[136:139], v[204:207], v[120:123]
    buffer_load_dwordx4 v243, s[36:39], s76 offen offset:3072 lds
    v_mfma_f32_16x16x32_bf16 v[124:127], v[140:143], v[204:207], v[124:127]
    s_waitcnt vmcnt(24) lgkmcnt(0)
    v_mfma_f32_16x16x32_bf16 v[64:67], v[144:147], v[208:211], v[64:67]
    s_add_u32 s77, s28, 28672
    buffer_load_dwordx4 v[192:195], v255, s[32:35], s77 offen offset:2048 sc1
    v_mfma_f32_16x16x32_bf16 v[68:71], v[148:151], v[208:211], v[68:71]
    s_add_u32 s72, s69, 65536
    s_and_b32 s72, s72, 0x1ffff
    v_add_u32 v244, s72, v224
    v_add_u32 v245, s72, v225
    v_add_u32 v246, s72, v226
    v_add_u32 v247, s72, v227
    v_mfma_f32_16x16x32_bf16 v[72:75], v[152:155], v[208:211], v[72:75]
    s_add_u32 s77, s28, 176128
    buffer_load_dwordx4 v[196:199], v255, s[32:35], s77 offen offset:2048 sc1
    v_mfma_f32_16x16x32_bf16 v[76:79], v[156:159], v[208:211], v[76:79]
    ds_read_b64_tr_b16 v[128:129], v244 offset:0
    v_mfma_f32_16x16x32_bf16 v[80:83], v[144:147], v[212:215], v[80:83]
    ds_read_b64_tr_b16 v[130:131], v244 offset:2048
    ds_read_b64_tr_b16 v[132:133], v245 offset:0
    s_add_u32 s77, s28, 323584
    buffer_load_dwordx4 v[200:203], v255, s[32:35], s77 offen offset:2048 sc1
    v_mfma_f32_16x16x32_bf16 v[84:87], v[148:151], v[212:215], v[84:87]
    ds_read_b64_tr_b16 v[134:135], v245 offset:2048
    v_mfma_f32_16x16x32_bf16 v[88:91], v[152:155], v[212:215], v[88:91]
    ds_read_b64_tr_b16 v[136:137], v246 offset:0
    ds_read_b64_tr_b16 v[138:139], v246 offset:2048
    s_add_u32 s77, s28, 471040
    buffer_load_dwordx4 v[204:207], v255, s[32:35], s77 offen offset:2048 sc1
    v_mfma_f32_16x16x32_bf16 v[92:95], v[156:159], v[212:215], v[92:95]
    ds_read_b64_tr_b16 v[140:141], v247 offset:0
    ds_read_b64_tr_b16 v[142:143], v247 offset:2048
    v_mfma_f32_16x16x32_bf16 v[96:99], v[144:147], v[216:219], v[96:99]
    s_add_u32 s71, s69, 32768
    s_and_b32 s71, s71, 0x1ffff
    s_add_u32 m0, s71, 4096
    s_mov_b32 s76, 98304
    buffer_load_dwordx4 v240, s[36:39], s76 offen offset:0 lds
    v_mfma_f32_16x16x32_bf16 v[100:103], v[148:151], v[216:219], v[100:103]
    v_mfma_f32_16x16x32_bf16 v[104:107], v[152:155], v[216:219], v[104:107]
    buffer_load_dwordx4 v241, s[36:39], s76 offen offset:1024 lds
    v_mfma_f32_16x16x32_bf16 v[108:111], v[156:159], v[216:219], v[108:111]
    v_mfma_f32_16x16x32_bf16 v[112:115], v[144:147], v[220:223], v[112:115]
    buffer_load_dwordx4 v242, s[36:39], s76 offen offset:2048 lds
    v_mfma_f32_16x16x32_bf16 v[116:119], v[148:151], v[220:223], v[116:119]
    v_mfma_f32_16x16x32_bf16 v[120:123], v[152:155], v[220:223], v[120:123]
    buffer_load_dwordx4 v243, s[36:39], s76 offen offset:3072 lds
    v_mfma_f32_16x16x32_bf16 v[124:127], v[156:159], v[220:223], v[124:127]
    s_waitcnt vmcnt(20) lgkmcnt(0)
    v_mfma_f32_16x16x32_bf16 v[64:67], v[128:131], v[160:163], v[64:67]
    ds_read_b64_tr_b16 v[144:145], v244 offset:4096
    s_add_u32 s77, s28, 28672
    buffer_load_dwordx4 v[208:211], v255, s[32:35], s77 offen offset:3072 sc1
    v_mfma_f32_16x16x32_bf16 v[68:71], v[132:135], v[160:163], v[68:71]
    ds_read_b64_tr_b16 v[146:147], v244 offset:6144
    v_mfma_f32_16x16x32_bf16 v[72:75], v[136:139], v[160:163], v[72:75]
    ds_read_b64_tr_b16 v[148:149], v245 offset:4096
    v_mfma_f32_16x16x32_bf16 v[76:79], v[140:143], v[160:163], v[76:79]
    ds_read_b64_tr_b16 v[150:151], v245 offset:6144
    v_mfma_f32_16x16x32_bf16 v[80:83], v[128:131], v[164:167], v[80:83]
    ds_read_b64_tr_b16 v[152:153], v246 offset:4096
    s_add_u32 s77, s28, 176128
    buffer_load_dwordx4 v[212:215], v255, s[32:35], s77 offen offset:3072 sc1
    v_mfma_f32_16x16x32_bf16 v[84:87], v[132:135], v[164:167], v[84:87]
    ds_read_b64_tr_b16 v[154:155], v246 offset:6144
    v_mfma_f32_16x16x32_bf16 v[88:91], v[136:139], v[164:167], v[88:91]
    ds_read_b64_tr_b16 v[156:157], v247 offset:4096
    v_mfma_f32_16x16x32_bf16 v[92:95], v[140:143], v[164:167], v[92:95]
    ds_read_b64_tr_b16 v[158:159], v247 offset:6144
    v_mfma_f32_16x16x32_bf16 v[96:99], v[128:131], v[168:171], v[96:99]
    s_add_u32 s77, s28, 323584
    buffer_load_dwordx4 v[216:219], v255, s[32:35], s77 offen offset:3072 sc1
    v_mfma_f32_16x16x32_bf16 v[100:103], v[132:135], v[168:171], v[100:103]
    v_mfma_f32_16x16x32_bf16 v[104:107], v[136:139], v[168:171], v[104:107]
    v_mfma_f32_16x16x32_bf16 v[108:111], v[140:143], v[168:171], v[108:111]
    v_mfma_f32_16x16x32_bf16 v[112:115], v[128:131], v[172:175], v[112:115]
    s_add_u32 s77, s28, 471040
    buffer_load_dwordx4 v[220:223], v255, s[32:35], s77 offen offset:3072 sc1
    v_mfma_f32_16x16x32_bf16 v[116:119], v[132:135], v[172:175], v[116:119]
    v_mfma_f32_16x16x32_bf16 v[120:123], v[136:139], v[172:175], v[120:123]
    v_mfma_f32_16x16x32_bf16 v[124:127], v[140:143], v[172:175], v[124:127]
    s_waitcnt vmcnt(16) lgkmcnt(0)
    v_mfma_f32_16x16x32_bf16 v[64:67], v[144:147], v[176:179], v[64:67]
    s_add_u32 s77, s27, 0
    buffer_load_dwordx4 v[160:163], v255, s[32:35], s77 offen offset:0 sc1
    v_mfma_f32_16x16x32_bf16 v[68:71], v[148:151], v[176:179], v[68:71]
    s_add_u32 s72, s69, 98304
    s_and_b32 s72, s72, 0x1ffff
    v_add_u32 v244, s72, v224
    v_add_u32 v245, s72, v225
    v_add_u32 v246, s72, v226
    v_add_u32 v247, s72, v227
    v_mfma_f32_16x16x32_bf16 v[72:75], v[152:155], v[176:179], v[72:75]
    v_mfma_f32_16x16x32_bf16 v[76:79], v[156:159], v[176:179], v[76:79]
    ds_read_b64_tr_b16 v[128:129], v244 offset:0
    v_mfma_f32_16x16x32_bf16 v[80:83], v[144:147], v[180:183], v[80:83]
    ds_read_b64_tr_b16 v[130:131], v244 offset:2048
    ds_read_b64_tr_b16 v[132:133], v245 offset:0
    s_add_u32 s77, s27, 147456
    buffer_load_dwordx4 v[164:167], v255, s[32:35], s77 offen offset:0 sc1
    v_mfma_f32_16x16x32_bf16 v[84:87], v[148:151], v[180:183], v[84:87]
    ds_read_b64_tr_b16 v[134:135], v245 offset:2048
    v_mfma_f32_16x16x32_bf16 v[88:91], v[152:155], v[180:183], v[88:91]
    ds_read_b64_tr_b16 v[136:137], v246 offset:0
    ds_read_b64_tr_b16 v[138:139], v246 offset:2048
    v_mfma_f32_16x16x32_bf16 v[92:95], v[156:159], v[180:183], v[92:95]
    ds_read_b64_tr_b16 v[140:141], v247 offset:0
    ds_read_b64_tr_b16 v[142:143], v247 offset:2048
    v_mfma_f32_16x16x32_bf16 v[96:99], v[144:147], v[184:187], v[96:99]
    s_add_u32 s77, s27, 294912
    buffer_load_dwordx4 v[168:171], v255, s[32:35], s77 offen offset:0 sc1
    v_mfma_f32_16x16x32_bf16 v[100:103], v[148:151], v[184:187], v[100:103]
    v_mfma_f32_16x16x32_bf16 v[104:107], v[152:155], v[184:187], v[104:107]
    v_mfma_f32_16x16x32_bf16 v[108:111], v[156:159], v[184:187], v[108:111]
    v_mfma_f32_16x16x32_bf16 v[112:115], v[144:147], v[188:191], v[112:115]
    s_add_u32 s77, s27, 442368
    buffer_load_dwordx4 v[172:175], v255, s[32:35], s77 offen offset:0 sc1
    v_mfma_f32_16x16x32_bf16 v[116:119], v[148:151], v[188:191], v[116:119]
    v_mfma_f32_16x16x32_bf16 v[120:123], v[152:155], v[188:191], v[120:123]
    v_mfma_f32_16x16x32_bf16 v[124:127], v[156:159], v[188:191], v[124:127]
    s_waitcnt vmcnt(12) lgkmcnt(0)
    v_mfma_f32_16x16x32_bf16 v[64:67], v[128:131], v[192:195], v[64:67]
    ds_read_b64_tr_b16 v[144:145], v244 offset:4096
    s_add_u32 s77, s27, 0
    buffer_load_dwordx4 v[176:179], v255, s[32:35], s77 offen offset:1024 sc1
    v_mfma_f32_16x16x32_bf16 v[68:71], v[132:135], v[192:195], v[68:71]
    ds_read_b64_tr_b16 v[146:147], v244 offset:6144
    v_mfma_f32_16x16x32_bf16 v[72:75], v[136:139], v[192:195], v[72:75]
    ds_read_b64_tr_b16 v[148:149], v245 offset:4096
    v_mfma_f32_16x16x32_bf16 v[76:79], v[140:143], v[192:195], v[76:79]
    ds_read_b64_tr_b16 v[150:151], v245 offset:6144
    v_mfma_f32_16x16x32_bf16 v[80:83], v[128:131], v[196:199], v[80:83]
    ds_read_b64_tr_b16 v[152:153], v246 offset:4096
    s_add_u32 s77, s27, 147456
    buffer_load_dwordx4 v[180:183], v255, s[32:35], s77 offen offset:1024 sc1
    v_mfma_f32_16x16x32_bf16 v[84:87], v[132:135], v[196:199], v[84:87]
    ds_read_b64_tr_b16 v[154:155], v246 offset:6144
    v_mfma_f32_16x16x32_bf16 v[88:91], v[136:139], v[196:199], v[88:91]
    ds_read_b64_tr_b16 v[156:157], v247 offset:4096
    v_mfma_f32_16x16x32_bf16 v[92:95], v[140:143], v[196:199], v[92:95]
    ds_read_b64_tr_b16 v[158:159], v247 offset:6144
    v_mfma_f32_16x16x32_bf16 v[96:99], v[128:131], v[200:203], v[96:99]
    s_add_u32 s77, s27, 294912
    buffer_load_dwordx4 v[184:187], v255, s[32:35], s77 offen offset:1024 sc1
    v_mfma_f32_16x16x32_bf16 v[100:103], v[132:135], v[200:203], v[100:103]
    v_mfma_f32_16x16x32_bf16 v[104:107], v[136:139], v[200:203], v[104:107]
    v_mfma_f32_16x16x32_bf16 v[108:111], v[140:143], v[200:203], v[108:111]
    v_mfma_f32_16x16x32_bf16 v[112:115], v[128:131], v[204:207], v[112:115]
    s_add_u32 s77, s27, 442368
    buffer_load_dwordx4 v[188:191], v255, s[32:35], s77 offen offset:1024 sc1
    v_mfma_f32_16x16x32_bf16 v[116:119], v[132:135], v[204:207], v[116:119]
    v_mfma_f32_16x16x32_bf16 v[120:123], v[136:139], v[204:207], v[120:123]
    v_mfma_f32_16x16x32_bf16 v[124:127], v[140:143], v[204:207], v[124:127]
    s_waitcnt vmcnt(8) lgkmcnt(0)
    v_mfma_f32_16x16x32_bf16 v[64:67], v[144:147], v[208:211], v[64:67]
    s_add_u32 s77, s27, 0
    buffer_load_dwordx4 v[192:195], v255, s[32:35], s77 offen offset:2048 sc1
    v_mfma_f32_16x16x32_bf16 v[68:71], v[148:151], v[208:211], v[68:71]
    s_add_u32 s72, s69, 0
    s_and_b32 s72, s72, 0x1ffff
    v_add_u32 v244, s72, v224
    v_add_u32 v245, s72, v225
    v_add_u32 v246, s72, v226
    v_add_u32 v247, s72, v227
    v_mfma_f32_16x16x32_bf16 v[72:75], v[152:155], v[208:211], v[72:75]
    v_mfma_f32_16x16x32_bf16 v[76:79], v[156:159], v[208:211], v[76:79]
    ds_read_b64_tr_b16 v[128:129], v244 offset:0
    v_mfma_f32_16x16x32_bf16 v[80:83], v[144:147], v[212:215], v[80:83]
    ds_read_b64_tr_b16 v[130:131], v244 offset:2048
    ds_read_b64_tr_b16 v[132:133], v245 offset:0
    s_add_u32 s77, s27, 147456
    buffer_load_dwordx4 v[196:199], v255, s[32:35], s77 offen offset:2048 sc1
    v_mfma_f32_16x16x32_bf16 v[84:87], v[148:151], v[212:215], v[84:87]
    ds_read_b64_tr_b16 v[134:135], v245 offset:2048
    v_mfma_f32_16x16x32_bf16 v[88:91], v[152:155], v[212:215], v[88:91]
    ds_read_b64_tr_b16 v[136:137], v246 offset:0
    ds_read_b64_tr_b16 v[138:139], v246 offset:2048
    v_mfma_f32_16x16x32_bf16 v[92:95], v[156:159], v[212:215], v[92:95]
    ds_read_b64_tr_b16 v[140:141], v247 offset:0
    ds_read_b64_tr_b16 v[142:143], v247 offset:2048
    v_mfma_f32_16x16x32_bf16 v[96:99], v[144:147], v[216:219], v[96:99]
    s_add_u32 s77, s27, 294912
    buffer_load_dwordx4 v[200:203], v255, s[32:35], s77 offen offset:2048 sc1
    v_mfma_f32_16x16x32_bf16 v[100:103], v[148:151], v[216:219], v[100:103]
    v_mfma_f32_16x16x32_bf16 v[104:107], v[152:155], v[216:219], v[104:107]
    v_mfma_f32_16x16x32_bf16 v[108:111], v[156:159], v[216:219], v[108:111]
    v_mfma_f32_16x16x32_bf16 v[112:115], v[144:147], v[220:223], v[112:115]
    s_add_u32 s77, s27, 442368
    buffer_load_dwordx4 v[204:207], v255, s[32:35], s77 offen offset:2048 sc1
    v_mfma_f32_16x16x32_bf16 v[116:119], v[148:151], v[220:223], v[116:119]
    v_mfma_f32_16x16x32_bf16 v[120:123], v[152:155], v[220:223], v[120:123]
    v_mfma_f32_16x16x32_bf16 v[124:127], v[156:159], v[220:223], v[124:127]
    s_waitcnt vmcnt(8) lgkmcnt(0)
    v_swap_b32 v162, v164
    v_swap_b32 v163, v165
    v_swap_b32 v170, v172
    v_swap_b32 v171, v173
    s_nop 1
    v_mfma_f32_16x16x32_bf16 v[0:3], v[128:131], v[160:163], 0
    ds_read_b64_tr_b16 v[144:145], v244 offset:4096
    s_add_u32 s77, s27, 0
    buffer_load_dwordx4 v[208:211], v255, s[32:35], s77 offen offset:3072 sc1
    v_mfma_f32_16x16x32_bf16 v[4:7], v[132:135], v[160:163], 0
    ds_read_b64_tr_b16 v[146:147], v244 offset:6144
    v_mfma_f32_16x16x32_bf16 v[8:11], v[136:139], v[160:163], 0
    ds_read_b64_tr_b16 v[148:149], v245 offset:4096
    v_mfma_f32_16x16x32_bf16 v[12:15], v[140:143], v[160:163], 0
    ds_read_b64_tr_b16 v[150:151], v245 offset:6144
    v_mfma_f32_16x16x32_bf16 v[16:19], v[128:131], v[164:167], 0
    ds_read_b64_tr_b16 v[152:153], v246 offset:4096
    s_add_u32 s77, s27, 147456
    buffer_load_dwordx4 v[212:215], v255, s[32:35], s77 offen offset:3072 sc1
    v_mfma_f32_16x16x32_bf16 v[20:23], v[132:135], v[164:167], 0
    ds_read_b64_tr_b16 v[154:155], v246 offset:6144
    v_mfma_f32_16x16x32_bf16 v[24:27], v[136:139], v[164:167], 0
    ds_read_b64_tr_b16 v[156:157], v247 offset:4096
    v_mfma_f32_16x16x32_bf16 v[28:31], v[140:143], v[164:167], 0
    ds_read_b64_tr_b16 v[158:159], v247 offset:6144
    v_mfma_f32_16x16x32_bf16 v[32:35], v[128:131], v[168:171], 0
    s_add_u32 s77, s27, 294912
    buffer_load_dwordx4 v[216:219], v255, s[32:35], s77 offen offset:3072 sc1
    v_mfma_f32_16x16x32_bf16 v[36:39], v[132:135], v[168:171], 0
    v_mfma_f32_16x16x32_bf16 v[40:43], v[136:139], v[168:171], 0
    v_mfma_f32_16x16x32_bf16 v[44:47], v[140:143], v[168:171], 0
    v_mfma_f32_16x16x32_bf16 v[48:51], v[128:131], v[172:175], 0
    s_add_u32 s77, s27, 442368
    buffer_load_dwordx4 v[220:223], v255, s[32:35], s77 offen offset:3072 sc1
    v_mfma_f32_16x16x32_bf16 v[52:55], v[132:135], v[172:175], 0
    v_mfma_f32_16x16x32_bf16 v[56:59], v[136:139], v[172:175], 0
    v_mfma_f32_16x16x32_bf16 v[60:63], v[140:143], v[172:175], 0
    s_waitcnt vmcnt(8) lgkmcnt(0)
    v_swap_b32 v178, v180
    v_swap_b32 v179, v181
    v_swap_b32 v186, v188
    v_swap_b32 v187, v189
    s_nop 1
    v_mfma_f32_16x16x32_bf16 v[0:3], v[144:147], v[176:179], v[0:3]
    v_mfma_f32_16x16x32_bf16 v[4:7], v[148:151], v[176:179], v[4:7]
    s_add_u32 s72, s69, 32768
    s_and_b32 s72, s72, 0x1ffff
    v_add_u32 v244, s72, v224
    v_add_u32 v245, s72, v225
    v_add_u32 v246, s72, v226
    v_add_u32 v247, s72, v227
    v_mfma_f32_16x16x32_bf16 v[8:11], v[152:155], v[176:179], v[8:11]
    v_mfma_f32_16x16x32_bf16 v[12:15], v[156:159], v[176:179], v[12:15]
    ds_read_b64_tr_b16 v[128:129], v244 offset:0
    v_mfma_f32_16x16x32_bf16 v[16:19], v[144:147], v[180:183], v[16:19]
    ds_read_b64_tr_b16 v[130:131], v244 offset:2048
    ds_read_b64_tr_b16 v[132:133], v245 offset:0
    v_mfma_f32_16x16x32_bf16 v[20:23], v[148:151], v[180:183], v[20:23]
    ds_read_b64_tr_b16 v[134:135], v245 offset:2048
    v_mfma_f32_16x16x32_bf16 v[24:27], v[152:155], v[180:183], v[24:27]
    ds_read_b64_tr_b16 v[136:137], v246 offset:0
    ds_read_b64_tr_b16 v[138:139], v246 offset:2048
    v_mfma_f32_16x16x32_bf16 v[28:31], v[156:159], v[180:183], v[28:31]
    ds_read_b64_tr_b16 v[140:141], v247 offset:0
    ds_read_b64_tr_b16 v[142:143], v247 offset:2048
    v_mfma_f32_16x16x32_bf16 v[32:35], v[144:147], v[184:187], v[32:35]
    v_mfma_f32_16x16x32_bf16 v[36:39], v[148:151], v[184:187], v[36:39]
    v_mfma_f32_16x16x32_bf16 v[40:43], v[152:155], v[184:187], v[40:43]
    v_mfma_f32_16x16x32_bf16 v[44:47], v[156:159], v[184:187], v[44:47]
    v_mfma_f32_16x16x32_bf16 v[48:51], v[144:147], v[188:191], v[48:51]
    v_mfma_f32_16x16x32_bf16 v[52:55], v[148:151], v[188:191], v[52:55]
    v_mfma_f32_16x16x32_bf16 v[56:59], v[152:155], v[188:191], v[56:59]
    v_mfma_f32_16x16x32_bf16 v[60:63], v[156:159], v[188:191], v[60:63]
    s_waitcnt vmcnt(4) lgkmcnt(0)
    v_swap_b32 v194, v196
    v_swap_b32 v195, v197
    v_swap_b32 v202, v204
    v_swap_b32 v203, v205
    s_nop 1
    v_mfma_f32_16x16x32_bf16 v[0:3], v[128:131], v[192:195], v[0:3]
    ds_read_b64_tr_b16 v[144:145], v244 offset:4096
    v_mfma_f32_16x16x32_bf16 v[4:7], v[132:135], v[192:195], v[4:7]
    ds_read_b64_tr_b16 v[146:147], v244 offset:6144
    v_mfma_f32_16x16x32_bf16 v[8:11], v[136:139], v[192:195], v[8:11]
    ds_read_b64_tr_b16 v[148:149], v245 offset:4096
    v_mfma_f32_16x16x32_bf16 v[12:15], v[140:143], v[192:195], v[12:15]
    ds_read_b64_tr_b16 v[150:151], v245 offset:6144
    v_mfma_f32_16x16x32_bf16 v[16:19], v[128:131], v[196:199], v[16:19]
    ds_read_b64_tr_b16 v[152:153], v246 offset:4096
    v_mfma_f32_16x16x32_bf16 v[20:23], v[132:135], v[196:199], v[20:23]
    ds_read_b64_tr_b16 v[154:155], v246 offset:6144
    v_mfma_f32_16x16x32_bf16 v[24:27], v[136:139], v[196:199], v[24:27]
    ds_read_b64_tr_b16 v[156:157], v247 offset:4096
    v_mfma_f32_16x16x32_bf16 v[28:31], v[140:143], v[196:199], v[28:31]
    ds_read_b64_tr_b16 v[158:159], v247 offset:6144
    v_mfma_f32_16x16x32_bf16 v[32:35], v[128:131], v[200:203], v[32:35]
    v_mfma_f32_16x16x32_bf16 v[36:39], v[132:135], v[200:203], v[36:39]
    v_mfma_f32_16x16x32_bf16 v[40:43], v[136:139], v[200:203], v[40:43]
    v_mfma_f32_16x16x32_bf16 v[44:47], v[140:143], v[200:203], v[44:47]
    v_mfma_f32_16x16x32_bf16 v[48:51], v[128:131], v[204:207], v[48:51]
    v_mfma_f32_16x16x32_bf16 v[52:55], v[132:135], v[204:207], v[52:55]
    v_mfma_f32_16x16x32_bf16 v[56:59], v[136:139], v[204:207], v[56:59]
    v_mfma_f32_16x16x32_bf16 v[60:63], v[140:143], v[204:207], v[60:63]
    s_waitcnt vmcnt(0) lgkmcnt(0)
    v_swap_b32 v210, v212
    v_swap_b32 v211, v213
    v_swap_b32 v218, v220
    v_swap_b32 v219, v221
    s_nop 1
    v_mfma_f32_16x16x32_bf16 v[0:3], v[144:147], v[208:211], v[0:3]
    v_mfma_f32_16x16x32_bf16 v[4:7], v[148:151], v[208:211], v[4:7]
    v_mfma_f32_16x16x32_bf16 v[8:11], v[152:155], v[208:211], v[8:11]
    v_mfma_f32_16x16x32_bf16 v[12:15], v[156:159], v[208:211], v[12:15]
    v_mfma_f32_16x16x32_bf16 v[16:19], v[144:147], v[212:215], v[16:19]
    v_mfma_f32_16x16x32_bf16 v[20:23], v[148:151], v[212:215], v[20:23]
    v_mfma_f32_16x16x32_bf16 v[24:27], v[152:155], v[212:215], v[24:27]
    v_mfma_f32_16x16x32_bf16 v[28:31], v[156:159], v[212:215], v[28:31]
    v_mfma_f32_16x16x32_bf16 v[32:35], v[144:147], v[216:219], v[32:35]
    v_mfma_f32_16x16x32_bf16 v[36:39], v[148:151], v[216:219], v[36:39]
    v_mfma_f32_16x16x32_bf16 v[40:43], v[152:155], v[216:219], v[40:43]
    v_mfma_f32_16x16x32_bf16 v[44:47], v[156:159], v[216:219], v[44:47]
    v_mfma_f32_16x16x32_bf16 v[48:51], v[144:147], v[220:223], v[48:51]
    v_mfma_f32_16x16x32_bf16 v[52:55], v[148:151], v[220:223], v[52:55]
    v_mfma_f32_16x16x32_bf16 v[56:59], v[152:155], v[220:223], v[56:59]
    v_mfma_f32_16x16x32_bf16 v[60:63], v[156:159], v[220:223], v[60:63]
    s_waitcnt vmcnt(0)
    s_nop 7
    s_add_u32 s76, s22, 1
    s_and_b32 s76, s76, 3
    s_lshl_b32 s76, s76, 13
    v_add_u32 v130, s76, v255
    s_lshr_b32 s76, s22, 1
    s_lshl_b32 s76, s76, 15
    s_and_b32 s77, s22, 1
    s_lshl_b32 s77, s77, 12
    s_add_u32 s76, s76, s77
    v_lshlrev_b32 v134, 9, v253
    v_lshl_add_u32 v134, v252, 4, v134
    v_add_u32 v134, s76, v134
    v_lshlrev_b32 v135, 10, v252
    v_lshl_add_u32 v135, v253, 4, v135
    s_lshl_b32 s78, s3, 16
    s_lshl_b32 s77, s22, 14
    s_add_u32 s78, s78, s77
    s_lshl_b32 s77, s17, 7
    s_add_u32 s78, s78, s77
    v_sub_f32 v128, 1.0, v248
    v_cvt_pk_bf16_f32 v128, v128, v128
    v_lshlrev_b32 v128, 16, v128
    v_mov_b32 v129, v128
    v_mov_b32 v132, v248
    v_mov_b32 v133, v248
    v_pk_mul_f32 v[64:65], v[128:129], v[64:65]
    v_pk_fma_f32 v[64:65], v[132:133], v[0:1], v[64:65]
    v_pk_mul_f32 v[66:67], v[128:129], v[66:67]
    v_pk_fma_f32 v[66:67], v[132:133], v[2:3], v[66:67]
    ds_write_b128 v130, v[64:67] offset:0
    v_pk_mul_f32 v[68:69], v[128:129], v[68:69]
    v_pk_fma_f32 v[68:69], v[132:133], v[4:5], v[68:69]
    v_pk_mul_f32 v[70:71], v[128:129], v[70:71]
    v_pk_fma_f32 v[70:71], v[132:133], v[6:7], v[70:71]
    ds_write_b128 v130, v[68:71] offset:1024
    v_pk_mul_f32 v[72:73], v[128:129], v[72:73]
    v_pk_fma_f32 v[72:73], v[132:133], v[8:9], v[72:73]
    v_pk_mul_f32 v[74:75], v[128:129], v[74:75]
    v_pk_fma_f32 v[74:75], v[132:133], v[10:11], v[74:75]
    ds_write_b128 v130, v[72:75] offset:2048
    v_pk_mul_f32 v[76:77], v[128:129], v[76:77]
    v_pk_fma_f32 v[76:77], v[132:133], v[12:13], v[76:77]
    v_pk_mul_f32 v[78:79], v[128:129], v[78:79]
    v_pk_fma_f32 v[78:79], v[132:133], v[14:15], v[78:79]
    ds_write_b128 v130, v[76:79] offset:3072
    v_sub_f32 v128, 1.0, v249
    v_cvt_pk_bf16_f32 v128, v128, v128
    v_lshlrev_b32 v128, 16, v128
    v_mov_b32 v129, v128
    v_mov_b32 v132, v249
    v_mov_b32 v133, v249
    v_pk_mul_f32 v[80:81], v[128:129], v[80:81]
    v_pk_fma_f32 v[80:81], v[132:133], v[16:17], v[80:81]
    v_pk_mul_f32 v[82:83], v[128:129], v[82:83]
    v_pk_fma_f32 v[82:83], v[132:133], v[18:19], v[82:83]
    ds_write_b128 v130, v[80:83] offset:4096
    v_pk_mul_f32 v[84:85], v[128:129], v[84:85]
    v_pk_fma_f32 v[84:85], v[132:133], v[20:21], v[84:85]
    v_pk_mul_f32 v[86:87], v[128:129], v[86:87]
    v_pk_fma_f32 v[86:87], v[132:133], v[22:23], v[86:87]
    ds_write_b128 v130, v[84:87] offset:5120
    v_pk_mul_f32 v[88:89], v[128:129], v[88:89]
    v_pk_fma_f32 v[88:89], v[132:133], v[24:25], v[88:89]
    v_pk_mul_f32 v[90:91], v[128:129], v[90:91]
    v_pk_fma_f32 v[90:91], v[132:133], v[26:27], v[90:91]
    ds_write_b128 v130, v[88:91] offset:6144
    v_pk_mul_f32 v[92:93], v[128:129], v[92:93]
    v_pk_fma_f32 v[92:93], v[132:133], v[28:29], v[92:93]
    v_pk_mul_f32 v[94:95], v[128:129], v[94:95]
    v_pk_fma_f32 v[94:95], v[132:133], v[30:31], v[94:95]
    ds_write_b128 v130, v[92:95] offset:7168
    v_sub_f32 v128, 1.0, v250
    v_cvt_pk_bf16_f32 v128, v128, v128
    v_lshlrev_b32 v128, 16, v128
    v_mov_b32 v129, v128
    v_mov_b32 v132, v250
    v_mov_b32 v133, v250
    v_pk_mul_f32 v[96:97], v[128:129], v[96:97]
    v_pk_fma_f32 v[96:97], v[132:133], v[32:33], v[96:97]
    v_pk_mul_f32 v[98:99], v[128:129], v[98:99]
    v_pk_fma_f32 v[98:99], v[132:133], v[34:35], v[98:99]
    ds_write_b128 v130, v[96:99] offset:32768
    v_pk_mul_f32 v[100:101], v[128:129], v[100:101]
    v_pk_fma_f32 v[100:101], v[132:133], v[36:37], v[100:101]
    v_pk_mul_f32 v[102:103], v[128:129], v[102:103]
    v_pk_fma_f32 v[102:103], v[132:133], v[38:39], v[102:103]
    ds_write_b128 v130, v[100:103] offset:33792
    v_pk_mul_f32 v[104:105], v[128:129], v[104:105]
    v_pk_fma_f32 v[104:105], v[132:133], v[40:41], v[104:105]
    v_pk_mul_f32 v[106:107], v[128:129], v[106:107]
    v_pk_fma_f32 v[106:107], v[132:133], v[42:43], v[106:107]
    ds_write_b128 v130, v[104:107] offset:34816
    v_pk_mul_f32 v[108:109], v[128:129], v[108:109]
    v_pk_fma_f32 v[108:109], v[132:133], v[44:45], v[108:109]
    v_pk_mul_f32 v[110:111], v[128:129], v[110:111]
    v_pk_fma_f32 v[110:111], v[132:133], v[46:47], v[110:111]
    ds_write_b128 v130, v[108:111] offset:35840
    v_sub_f32 v128, 1.0, v251
    v_cvt_pk_bf16_f32 v128, v128, v128
    v_lshlrev_b32 v128, 16, v128
    v_mov_b32 v129, v128
    v_mov_b32 v132, v251
    v_mov_b32 v133, v251
    v_pk_mul_f32 v[112:113], v[128:129], v[112:113]
    v_pk_fma_f32 v[112:113], v[132:133], v[48:49], v[112:113]
    v_pk_mul_f32 v[114:115], v[128:129], v[114:115]
    v_pk_fma_f32 v[114:115], v[132:133], v[50:51], v[114:115]
    ds_write_b128 v130, v[112:115] offset:36864
    v_pk_mul_f32 v[116:117], v[128:129], v[116:117]
    v_pk_fma_f32 v[116:117], v[132:133], v[52:53], v[116:117]
    v_pk_mul_f32 v[118:119], v[128:129], v[118:119]
    v_pk_fma_f32 v[118:119], v[132:133], v[54:55], v[118:119]
    ds_write_b128 v130, v[116:119] offset:37888
    v_pk_mul_f32 v[120:121], v[128:129], v[120:121]
    v_pk_fma_f32 v[120:121], v[132:133], v[56:57], v[120:121]
    v_pk_mul_f32 v[122:123], v[128:129], v[122:123]
    v_pk_fma_f32 v[122:123], v[132:133], v[58:59], v[122:123]
    ds_write_b128 v130, v[120:123] offset:38912
    v_pk_mul_f32 v[124:125], v[128:129], v[124:125]
    v_pk_fma_f32 v[124:125], v[132:133], v[60:61], v[124:125]
    v_pk_mul_f32 v[126:127], v[128:129], v[126:127]
    v_pk_fma_f32 v[126:127], v[132:133], v[62:63], v[126:127]
    ds_write_b128 v130, v[124:127] offset:39936
    s_waitcnt lgkmcnt(0)
    s_barrier
    ds_read_b128 v[0:3], v134 offset:8192
    ds_read_b128 v[4:7], v134 offset:8448
    ds_read_b128 v[8:11], v134 offset:10240
    ds_read_b128 v[12:15], v134 offset:10496
    ds_read_b128 v[16:19], v134 offset:16384
    ds_read_b128 v[20:23], v134 offset:16640
    ds_read_b128 v[24:27], v134 offset:18432
    ds_read_b128 v[28:31], v134 offset:18688
    ds_read_b128 v[32:35], v134 offset:24576
    ds_read_b128 v[36:39], v134 offset:24832
    ds_read_b128 v[40:43], v134 offset:26624
    ds_read_b128 v[44:47], v134 offset:26880
    s_waitcnt lgkmcnt(8)
    ds_read_b128 v[48:51], v134 offset:0
    ds_read_b128 v[52:55], v134 offset:256
    ds_read_b128 v[56:59], v134 offset:2048
    ds_read_b128 v[60:63], v134 offset:2304
    s_waitcnt lgkmcnt(0)
    v_pk_add_f32 v[0:1], v[0:1], v[16:17]
    v_pk_add_f32 v[32:33], v[32:33], v[48:49]
    v_pk_add_f32 v[0:1], v[0:1], v[32:33]
    v_pk_add_f32 v[2:3], v[2:3], v[18:19]
    v_pk_add_f32 v[34:35], v[34:35], v[50:51]
    v_pk_add_f32 v[2:3], v[2:3], v[34:35]
    v_pk_add_f32 v[4:5], v[4:5], v[20:21]
    v_pk_add_f32 v[36:37], v[36:37], v[52:53]
    v_pk_add_f32 v[4:5], v[4:5], v[36:37]
    v_pk_add_f32 v[6:7], v[6:7], v[22:23]
    v_pk_add_f32 v[38:39], v[38:39], v[54:55]
    v_pk_add_f32 v[6:7], v[6:7], v[38:39]
    v_cvt_pk_bf16_f32 v0, v0, v1
    v_cvt_pk_bf16_f32 v1, v2, v3
    v_cvt_pk_bf16_f32 v2, v4, v5
    v_cvt_pk_bf16_f32 v3, v6, v7
    buffer_store_dwordx4 v[0:3], v135, s[44:47], s78 offen offset:0
    v_pk_add_f32 v[8:9], v[8:9], v[24:25]
    v_pk_add_f32 v[40:41], v[40:41], v[56:57]
    v_pk_add_f32 v[8:9], v[8:9], v[40:41]
    v_pk_add_f32 v[10:11], v[10:11], v[26:27]
    v_pk_add_f32 v[42:43], v[42:43], v[58:59]
    v_pk_add_f32 v[10:11], v[10:11], v[42:43]
    v_pk_add_f32 v[12:13], v[12:13], v[28:29]
    v_pk_add_f32 v[44:45], v[44:45], v[60:61]
    v_pk_add_f32 v[12:13], v[12:13], v[44:45]
    v_pk_add_f32 v[14:15], v[14:15], v[30:31]
    v_pk_add_f32 v[46:47], v[46:47], v[62:63]
    v_pk_add_f32 v[14:15], v[14:15], v[46:47]
    v_cvt_pk_bf16_f32 v8, v8, v9
    v_cvt_pk_bf16_f32 v9, v10, v11
    v_cvt_pk_bf16_f32 v10, v12, v13
    v_cvt_pk_bf16_f32 v11, v14, v15
    buffer_store_dwordx4 v[8:11], v135, s[44:47], s78 offen offset:64
    s_or_b32 s76, s2, s22
    s_cmp_lg_u32 s76, 0
    s_cbranch_scc1 fmain_end2
    v_mov_b32 v128, s18
    v_mov_b32 v129, 2097152
    s_mov_b64 exec, 1
    buffer_store_dword v128, v129, s[60:63], 0 offen sc1
    s_mov_b64 exec, -1
    s_branch fmain_end2
fmain_poll4:
    s_mov_b32 s79, 0
fmain_poll4_l:
    s_add_u32 s79, s79, 1
    s_cmp_ge_u32 s79, 1048576
    s_cbranch_scc1 fmain_poll4_ok
    s_sleep 3
    buffer_load_dwordx2 v[238:239], v236, s[64:67], s26 offen sc1
    s_waitcnt vmcnt(0)
    v_cmp_ne_u64 vcc, s[18:19], v[238:239]
    s_cbranch_vccnz fmain_poll4_l
    s_branch fmain_poll4_ok
fmain_end2:
fmain_end:
    s_endpgm

.section .rodata,"a"
.p2align 6
.amdhsa_kernel gated_mix__linear_attn_block__compressed_kv_cla__prompt_kernel
  .amdhsa_next_free_vgpr 256
  .amdhsa_next_free_sgpr 100
  .amdhsa_accum_offset 256
  .amdhsa_group_segment_fixed_size 0
  .amdhsa_kernarg_size 104
  .amdhsa_user_sgpr_count 2
  .amdhsa_user_sgpr_kernarg_segment_ptr 1
  .amdhsa_system_sgpr_workgroup_id_x 1
  .amdhsa_float_denorm_mode_32 3
  .amdhsa_float_denorm_mode_16_64 3
.end_amdhsa_kernel
```
